```python
import torch

def _softmax(x, axis=-1):
    return torch.softmax(x, dim=axis)

def _gelu(x):
    return torch.nn.functional.gelu(x, approximate='tanh')

def _silu(x):
    return torch.nn.functional.silu(x)

def _sigmoid(x):
    return torch.sigmoid(x)

def _layernorm(x, axis=-1, eps=1e-05):
    m = x.mean(dim=axis, keepdim=True)
    v = x.var(dim=axis, keepdim=True, unbiased=False)
    return (x - m) / torch.sqrt(v + eps)

def _scatter_add(tgt, idx, src, axis=0):
    return tgt.clone().index_add_(axis, idx, src)

def _segment_sum(src, seg, n):
    out = torch.zeros((n,) + src.shape[1:], dtype=src.dtype)
    return out.index_add_(0, seg, src)

def _pad(x, pw):
    flat = tuple((v for pair in reversed(pw) for v in pair))
    return torch.nn.functional.pad(x, flat)
kernel_name = 'gated_mix__memory_aug_recurrent_mem_tr__glu_gated_glu__prompt'

def setup_inputs():

    _w = lambda a: (lambda t: t.to(torch.bfloat16) if t.is_floating_point() else t)(torch.as_tensor(a))

    def _A_setup():
        B, S, Dm = (1, 2048, 640)
        H, Dh = (32, 192)
        M, seg = (8, 32)
        seg = min(seg, S)
        S = S // seg * seg
        return {'x': _w((lambda *s: torch.randn(*s, dtype=torch.bfloat16) * 0.05)(B, S, Dm)), 'mem0': _w((lambda *s: torch.randn(*s, dtype=torch.bfloat16) * 0.8)(B, M, Dm)), 'Wq': _w((lambda *s: torch.randn(*s, dtype=torch.bfloat16) * 1.6)(Dm, H, Dh) * Dm ** (-0.5)), 'Wk': _w((lambda *s: torch.randn(*s, dtype=torch.bfloat16) * 1.6)(Dm, H, Dh) * Dm ** (-0.5)), 'Wv': _w((lambda *s: torch.randn(*s, dtype=torch.bfloat16) * 0.8)(Dm, H, Dh) * Dm ** (-0.5)), 'Wo': _w((lambda *s: torch.randn(*s, dtype=torch.bfloat16) * 0.8)(H, Dh, Dm) * (H * Dh) ** (-0.5)), 'seg_len': seg}
    _A_in = _A_setup()

    def _B_setup():
        B, S, D, F = (1, 2048, 640, 1536)
        return {'x': _w((lambda *s: torch.randn(*s, dtype=torch.bfloat16) * 0.05)(B, S, D)), 'w_gate': _w((lambda *s: torch.randn(*s, dtype=torch.bfloat16) * 0.4)(D, F)), 'w_up': _w((lambda *s: torch.randn(*s, dtype=torch.bfloat16) * 0.05)(D, F)), 'w_down': _w((lambda *s: torch.randn(*s, dtype=torch.bfloat16) * 0.05)(F, D))}
    _B_in = _B_setup()
    return {'A_x': _A_in['x'], 'A_mem0': _A_in['mem0'], 'A_Wq': _A_in['Wq'], 'A_Wk': _A_in['Wk'], 'A_Wv': _A_in['Wv'], 'A_Wo': _A_in['Wo'], 'A_seg_len': _A_in['seg_len'], 'B_x': _B_in['x'], 'B_w_gate': _B_in['w_gate'], 'B_w_up': _B_in['w_up'], 'B_w_down': _B_in['w_down'], 'gate_w': _w((lambda *s: torch.randn(*s, dtype=torch.bfloat16) * 0.05)(640) * 16.0)}

def reference(A_x, A_mem0, A_Wq, A_Wk, A_Wv, A_Wo, A_seg_len, B_x, B_w_gate, B_w_up, B_w_down, gate_w):

    def _A_ref(x, mem0, Wq, Wk, Wv, Wo, seg_len):
        B, S, Dm = x.shape
        H, Dh = (Wq.shape[1], Wq.shape[2])
        M = mem0.shape[1]
        scale = Dh ** (-0.5)
        n_seg = S // seg_len
        L = M + seg_len
        idx = torch.arange(L)
        mask = (idx[:, None] < M) | (idx[:, None] >= idx[None, :])
        mem = mem0
        outs = []
        for s in range(n_seg):
            xs = x[:, s * seg_len:(s + 1) * seg_len, :].clone()
            h = torch.concatenate([mem, xs], axis=1)
            q = torch.einsum('btd,dhe->bhte', h, Wq)
            k = torch.einsum('btd,dhe->bhte', h, Wk)
            v = torch.einsum('btd,dhe->bhte', h, Wv)
            scores = torch.einsum('bhqe,bhke->bhqk', q, k) * scale
            scores = torch.where(mask[None, None], scores, -1000000000.0)
            p = _softmax(scores, axis=-1)
            o = torch.einsum('bhqk,bhke->bhqe', p, v)
            o = torch.einsum('bhte,hed->btd', o, Wo)
            mem = o[:, :M, :].clone()
            outs.append(o[:, M:, :])
        return torch.concatenate(outs, axis=1)

    def _B_ref(x, w_gate, w_up, w_down):
        g = torch.einsum('bsd,df->bsf', x, w_gate)
        u = torch.einsum('bsd,df->bsf', x, w_up)
        h = _sigmoid(g) * u
        return torch.einsum('bsf,fd->bsd', h, w_down)
    x = A_x
    g = _sigmoid((x * gate_w).sum(-1, keepdims=True))
    a = _A_ref(x, A_mem0, A_Wq, A_Wk, A_Wv, A_Wo, A_seg_len)
    b = _B_ref(x, B_w_gate, B_w_up, B_w_down)
    return g * a + (1 - g) * b
```

```asm
; @launch grid=(256,1,1) block=(256,1,1) lds=163840
.amdgcn_target "amdgcn-amd-amdhsa--gfx950"
.text
.globl gated_mix__memory_aug_recurrent_mem_tr__glu_gated_glu__prompt_kernel
.p2align 8
.type gated_mix__memory_aug_recurrent_mem_tr__glu_gated_glu__prompt_kernel,@function
gated_mix__memory_aug_recurrent_mem_tr__glu_gated_glu__prompt_kernel:
    s_cmp_ge_u32 s2, 256
    s_cbranch_scc1 EXIT
    s_load_dwordx16 s[32:47], s[0:1], 0
    s_load_dwordx8 s[48:55], s[0:1], 64
    s_load_dwordx4 s[56:59], s[0:1], 96
    s_load_dwordx2 s[60:61], s[0:1], 112
    s_getreg_b32 s28, hwreg(HW_REG_XCC_ID, 0, 4)
    v_lshrrev_b32 v1, 6, v0
    v_lshlrev_b32 v8, 4, v0
    v_and_b32 v0, 63, v0
    v_readfirstlane_b32 s30, v1
    s_mov_b32 s68, 65536
    s_waitcnt lgkmcnt(0)
    s_mov_b32 s4, s60
    s_mov_b32 s5, s61
    s_mov_b32 s6, 0x10000000
    s_mov_b32 s7, 0x20000
    s_mov_b32 s8, s32
    s_mov_b32 s9, s33
    s_mov_b32 s10, 2621440
    s_mov_b32 s11, 0x20000
    s_mov_b32 s64, s58
    s_mov_b32 s65, s59
    s_mov_b32 s66, 256
    s_mov_b32 s67, 0x20000
    s_cmp_lg_u32 s30, 0
    s_cbranch_scc1 PRO_NORANK
    s_lshl_b32 s69, s28, 2
    v_mov_b32 v2, 1
    v_mov_b32 v3, s69
    s_mov_b64 exec, 1
    buffer_atomic_add v2, v3, s[64:67], 0 offen sc0 sc1
    s_mov_b64 exec, -1
    s_lshl_b32 s69, s2, 8
    s_add_u32 s69, s69, 2097152
    v_mov_b32 v4, 0
    v_lshlrev_b32 v5, 2, v0
    buffer_store_dword v4, v5, s[4:7], s69 offen sc1
PRO_NORANK:
    v_mov_b32 v4, -1
    v_mov_b32 v5, -1
    v_mov_b32 v6, -1
    v_mov_b32 v7, -1
    s_lshl_b32 s69, s2, 13
    s_add_u32 s70, s69, 4096
    buffer_store_dwordx4 v[4:7], v8, s[4:7], s69 offen sc1
    buffer_store_dwordx4 v[4:7], v8, s[4:7], s70 offen sc1
    s_waitcnt vmcnt(0)
    s_cmp_lg_u32 s30, 0
    s_cbranch_scc1 PRO_NOBC
    v_mov_b32 v3, 0
    s_mov_b64 exec, 1
    ds_write_b32 v3, v2
    s_mov_b64 exec, -1
    s_waitcnt lgkmcnt(0)
PRO_NOBC:
    s_barrier
    s_cmp_lg_u32 s30, 0
    s_cbranch_scc1 PRO_NOARR
    v_mov_b32 v4, 1
    v_mov_b32 v3, 128
    s_mov_b64 exec, 1
    buffer_atomic_add v4, v3, s[64:67], 0 offen sc1
    s_mov_b64 exec, -1
PRO_NOARR:
    v_mov_b32 v3, 0
    ds_read_b32 v2, v3
    s_waitcnt lgkmcnt(0)
    v_readfirstlane_b32 s29, v2
    s_barrier
    s_cmp_ge_u32 s28, 8
    s_cbranch_scc1 SAFEWAIT
    s_cmp_ge_u32 s29, 32
    s_cbranch_scc1 SAFEWAIT
    s_cmp_lt_u32 s29, 12
    s_cbranch_scc1 ROLE_CF
    s_cmp_lt_u32 s29, 16
    s_cbranch_scc1 ROLE_KF
    s_cmp_lt_u32 s29, 20
    s_cbranch_scc1 ROLE_VF
    s_cmp_lt_u32 s29, 24
    s_cbranch_scc1 ROLE_QF
    s_cmp_lt_u32 s29, 27
    s_cbranch_scc1 ROLE_FF
    s_branch ROLE_WF
ROLE_CF:
    s_mov_b32 s12, s36
    s_mov_b32 s13, s37
    s_mov_b32 s14, 7864320
    s_mov_b32 s15, 0x20000
    s_mov_b32 s16, s38
    s_mov_b32 s17, s39
    s_mov_b32 s18, 7864320
    s_mov_b32 s19, 0x20000
    s_mov_b32 s20, s40
    s_mov_b32 s21, s41
    s_mov_b32 s22, 7864320
    s_mov_b32 s23, 0x20000
    s_mov_b32 s24, s42
    s_mov_b32 s25, s43
    s_mov_b32 s26, 7864320
    s_mov_b32 s27, 0x20000
    s_mul_i32 s73, s29, 0x5556
    s_lshr_b32 s73, s73, 16
    s_mul_i32 s75, s73, 3
    s_sub_u32 s75, s29, s75
    s_lshl_b32 s74, s28, 2
    s_add_u32 s74, s74, s73
    s_min_u32 s86, s29, 9
    v_lshrrev_b32 v2, 3, v0
    v_and_b32 v3, 7, v0
    v_lshrrev_b32 v4, 4, v0
    v_lshrrev_b32 v4, 1, v4
    v_and_b32 v4, 1, v4
    v_lshlrev_b32 v4, 1, v4
    s_and_b32 s69, s30, 1
    s_lshl_b32 s69, s69, 2
    v_or_b32 v4, s69, v4
    v_xor_b32 v3, v3, v4
    v_lshlrev_b32 v3, 4, v3
    s_mov_b32 s69, 1280
    v_mad_u32_u24 v12, v2, s69, v3
    v_lshrrev_b32 v2, 3, v0
    v_and_b32 v3, 7, v0
    v_lshrrev_b32 v4, 4, v0
    v_lshrrev_b32 v4, 1, v4
    v_and_b32 v4, 1, v4
    v_lshlrev_b32 v4, 1, v4
    s_and_b32 s69, s30, 1
    s_lshl_b32 s69, s69, 2
    v_or_b32 v4, s69, v4
    v_xor_b32 v3, v3, v4
    v_lshlrev_b32 v3, 4, v3
    s_mov_b32 s69, 12288
    v_mad_u32_u24 v13, v2, s69, v3
    v_lshrrev_b32 v2, 4, v0
    v_bfe_u32 v3, v0, 2, 2
    v_and_b32 v4, 3, v0
    v_lshrrev_b32 v5, 1, v3
    v_and_b32 v6, 1, v2
    v_lshl_or_b32 v8, v5, 1, v6
    v_lshlrev_b32 v7, 2, v8
    v_lshlrev_b32 v5, 1, v8
    v_lshrrev_b32 v6, 1, v2
    v_lshl_add_u32 v6, v6, 4, v7
    v_and_b32 v7, 1, v3
    v_add_u32 v6, v6, v7
    s_lshl_b32 s69, s30, 1
    v_lshrrev_b32 v7, 1, v4
    v_or_b32 v7, s69, v7
    v_xor_b32 v7, v7, v5
    v_lshlrev_b32 v7, 4, v7
    v_and_b32 v4, 1, v4
    v_lshl_or_b32 v7, v4, 3, v7
    v_lshl_add_u32 v14, v6, 7, v7
    s_mul_i32 s71, s74, 384
    s_lshl_b32 s72, s75, 7
    s_add_u32 s71, s71, s72
    s_mul_i32 s69, s30, 98304
    s_add_u32 s69, s69, s71
    s_lshl_b32 s70, s30, 10
    s_add_u32 m0, s70, 0
    s_nop 0
    buffer_load_dwordx4 v13, s[16:19], s69 offen lds
    s_add_u32 m0, m0, 4096
    s_add_u32 s69, s69, 393216
    buffer_load_dwordx4 v13, s[16:19], s69 offen lds
    s_add_u32 m0, m0, 4096
    s_add_u32 s69, s69, 393216
    buffer_load_dwordx4 v13, s[16:19], s69 offen lds
    s_add_u32 m0, m0, 4096
    s_add_u32 s69, s69, 393216
    buffer_load_dwordx4 v13, s[16:19], s69 offen lds
    s_add_u32 m0, m0, 4096
    s_add_u32 s69, s69, 393216
    buffer_load_dwordx4 v13, s[16:19], s69 offen lds
    s_add_u32 m0, m0, 4096
    s_add_u32 s69, s69, 393216
    buffer_load_dwordx4 v13, s[16:19], s69 offen lds
    s_add_u32 m0, m0, 4096
    s_add_u32 s69, s69, 393216
    buffer_load_dwordx4 v13, s[16:19], s69 offen lds
    s_add_u32 m0, m0, 4096
    s_add_u32 s69, s69, 393216
    buffer_load_dwordx4 v13, s[16:19], s69 offen lds
    s_add_u32 m0, m0, 4096
    s_add_u32 s69, s69, 393216
    buffer_load_dwordx4 v13, s[16:19], s69 offen lds
    s_add_u32 m0, m0, 4096
    s_add_u32 s69, s69, 393216
    buffer_load_dwordx4 v13, s[16:19], s69 offen lds
    s_add_u32 m0, m0, 4096
    s_add_u32 s69, s69, 393216
    buffer_load_dwordx4 v13, s[16:19], s69 offen lds
    s_add_u32 m0, m0, 4096
    s_add_u32 s69, s69, 393216
    buffer_load_dwordx4 v13, s[16:19], s69 offen lds
    s_add_u32 m0, m0, 4096
    s_add_u32 s69, s69, 393216
    buffer_load_dwordx4 v13, s[16:19], s69 offen lds
    s_add_u32 m0, m0, 4096
    s_add_u32 s69, s69, 393216
    buffer_load_dwordx4 v13, s[16:19], s69 offen lds
    s_add_u32 m0, m0, 4096
    s_add_u32 s69, s69, 393216
    buffer_load_dwordx4 v13, s[16:19], s69 offen lds
    s_add_u32 m0, m0, 4096
    s_add_u32 s69, s69, 393216
    buffer_load_dwordx4 v13, s[16:19], s69 offen lds
    s_add_u32 m0, m0, 4096
    s_add_u32 s69, s69, 393216
    buffer_load_dwordx4 v13, s[16:19], s69 offen lds
    s_add_u32 m0, m0, 4096
    s_add_u32 s69, s69, 393216
    buffer_load_dwordx4 v13, s[16:19], s69 offen lds
    s_add_u32 m0, m0, 4096
    s_add_u32 s69, s69, 393216
    buffer_load_dwordx4 v13, s[16:19], s69 offen lds
    s_add_u32 m0, m0, 4096
    s_add_u32 s69, s69, 393216
    buffer_load_dwordx4 v13, s[16:19], s69 offen lds
    s_mul_i32 s71, s74, 384
    s_lshl_b32 s72, s75, 7
    s_add_u32 s71, s71, s72
    s_mul_i32 s69, s30, 98304
    s_add_u32 s69, s69, s71
    s_lshl_b32 s70, s30, 10
    s_add_u32 m0, s70, 81920
    s_nop 0
    buffer_load_dwordx4 v13, s[20:23], s69 offen lds
    s_add_u32 m0, m0, 4096
    s_add_u32 s69, s69, 393216
    buffer_load_dwordx4 v13, s[20:23], s69 offen lds
    s_add_u32 m0, m0, 4096
    s_add_u32 s69, s69, 393216
    buffer_load_dwordx4 v13, s[20:23], s69 offen lds
    s_add_u32 m0, m0, 4096
    s_add_u32 s69, s69, 393216
    buffer_load_dwordx4 v13, s[20:23], s69 offen lds
    s_add_u32 m0, m0, 4096
    s_add_u32 s69, s69, 393216
    buffer_load_dwordx4 v13, s[20:23], s69 offen lds
    s_add_u32 m0, m0, 4096
    s_add_u32 s69, s69, 393216
    buffer_load_dwordx4 v13, s[20:23], s69 offen lds
    s_add_u32 m0, m0, 4096
    s_add_u32 s69, s69, 393216
    buffer_load_dwordx4 v13, s[20:23], s69 offen lds
    s_add_u32 m0, m0, 4096
    s_add_u32 s69, s69, 393216
    buffer_load_dwordx4 v13, s[20:23], s69 offen lds
    s_add_u32 m0, m0, 4096
    s_add_u32 s69, s69, 393216
    buffer_load_dwordx4 v13, s[20:23], s69 offen lds
    s_add_u32 m0, m0, 4096
    s_add_u32 s69, s69, 393216
    buffer_load_dwordx4 v13, s[20:23], s69 offen lds
    s_add_u32 m0, m0, 4096
    s_add_u32 s69, s69, 393216
    buffer_load_dwordx4 v13, s[20:23], s69 offen lds
    s_add_u32 m0, m0, 4096
    s_add_u32 s69, s69, 393216
    buffer_load_dwordx4 v13, s[20:23], s69 offen lds
    s_add_u32 m0, m0, 4096
    s_add_u32 s69, s69, 393216
    buffer_load_dwordx4 v13, s[20:23], s69 offen lds
    s_add_u32 m0, m0, 4096
    s_add_u32 s69, s69, 393216
    buffer_load_dwordx4 v13, s[20:23], s69 offen lds
    s_add_u32 m0, m0, 4096
    s_add_u32 s69, s69, 393216
    buffer_load_dwordx4 v13, s[20:23], s69 offen lds
    s_add_u32 m0, m0, 4096
    s_add_u32 s69, s69, 393216
    buffer_load_dwordx4 v13, s[20:23], s69 offen lds
    s_add_u32 m0, m0, 4096
    s_add_u32 s69, s69, 393216
    buffer_load_dwordx4 v13, s[20:23], s69 offen lds
    s_add_u32 m0, m0, 4096
    s_add_u32 s69, s69, 393216
    buffer_load_dwordx4 v13, s[20:23], s69 offen lds
    s_add_u32 m0, m0, 4096
    s_add_u32 s69, s69, 393216
    buffer_load_dwordx4 v13, s[20:23], s69 offen lds
    s_add_u32 m0, m0, 4096
    s_add_u32 s69, s69, 393216
    buffer_load_dwordx4 v13, s[20:23], s69 offen lds
    s_waitcnt vmcnt(20)
    s_barrier
    v_add_u32 v9, 0, v14
    ds_read_b64_tr_b16 a[80:81], v9 offset:0
    ds_read_b64_tr_b16 a[82:83], v9 offset:256
    ds_read_b64_tr_b16 a[84:85], v9 offset:4096
    ds_read_b64_tr_b16 a[86:87], v9 offset:4352
    ds_read_b64_tr_b16 a[88:89], v9 offset:8192
    ds_read_b64_tr_b16 a[90:91], v9 offset:8448
    ds_read_b64_tr_b16 a[92:93], v9 offset:12288
    ds_read_b64_tr_b16 a[94:95], v9 offset:12544
    ds_read_b64_tr_b16 a[96:97], v9 offset:16384
    ds_read_b64_tr_b16 a[98:99], v9 offset:16640
    ds_read_b64_tr_b16 a[100:101], v9 offset:20480
    ds_read_b64_tr_b16 a[102:103], v9 offset:20736
    s_waitcnt lgkmcnt(0)
    ds_read_b64_tr_b16 a[104:105], v9 offset:24576
    ds_read_b64_tr_b16 a[106:107], v9 offset:24832
    ds_read_b64_tr_b16 a[108:109], v9 offset:28672
    ds_read_b64_tr_b16 a[110:111], v9 offset:28928
    ds_read_b64_tr_b16 a[112:113], v9 offset:32768
    ds_read_b64_tr_b16 a[114:115], v9 offset:33024
    ds_read_b64_tr_b16 a[116:117], v9 offset:36864
    ds_read_b64_tr_b16 a[118:119], v9 offset:37120
    s_waitcnt lgkmcnt(0)
    v_add_u32 v9, 40960, v14
    ds_read_b64_tr_b16 a[120:121], v9 offset:0
    ds_read_b64_tr_b16 a[122:123], v9 offset:256
    ds_read_b64_tr_b16 a[124:125], v9 offset:4096
    ds_read_b64_tr_b16 a[126:127], v9 offset:4352
    ds_read_b64_tr_b16 a[128:129], v9 offset:8192
    ds_read_b64_tr_b16 a[130:131], v9 offset:8448
    ds_read_b64_tr_b16 a[132:133], v9 offset:12288
    ds_read_b64_tr_b16 a[134:135], v9 offset:12544
    ds_read_b64_tr_b16 a[136:137], v9 offset:16384
    ds_read_b64_tr_b16 a[138:139], v9 offset:16640
    ds_read_b64_tr_b16 a[140:141], v9 offset:20480
    ds_read_b64_tr_b16 a[142:143], v9 offset:20736
    s_waitcnt lgkmcnt(0)
    ds_read_b64_tr_b16 a[144:145], v9 offset:24576
    ds_read_b64_tr_b16 a[146:147], v9 offset:24832
    ds_read_b64_tr_b16 a[148:149], v9 offset:28672
    ds_read_b64_tr_b16 a[150:151], v9 offset:28928
    ds_read_b64_tr_b16 a[152:153], v9 offset:32768
    ds_read_b64_tr_b16 a[154:155], v9 offset:33024
    ds_read_b64_tr_b16 a[156:157], v9 offset:36864
    ds_read_b64_tr_b16 a[158:159], v9 offset:37120
    s_waitcnt lgkmcnt(0)
    s_barrier
    s_mul_i32 s71, s74, 384
    s_lshl_b32 s72, s75, 7
    s_add_u32 s71, s71, s72
    s_mul_i32 s69, s30, 98304
    s_add_u32 s69, s69, s71
    s_lshl_b32 s70, s30, 10
    s_add_u32 m0, s70, 0
    s_nop 0
    buffer_load_dwordx4 v13, s[12:15], s69 offen lds
    s_add_u32 m0, m0, 4096
    s_add_u32 s69, s69, 393216
    buffer_load_dwordx4 v13, s[12:15], s69 offen lds
    s_add_u32 m0, m0, 4096
    s_add_u32 s69, s69, 393216
    buffer_load_dwordx4 v13, s[12:15], s69 offen lds
    s_add_u32 m0, m0, 4096
    s_add_u32 s69, s69, 393216
    buffer_load_dwordx4 v13, s[12:15], s69 offen lds
    s_add_u32 m0, m0, 4096
    s_add_u32 s69, s69, 393216
    buffer_load_dwordx4 v13, s[12:15], s69 offen lds
    s_add_u32 m0, m0, 4096
    s_add_u32 s69, s69, 393216
    buffer_load_dwordx4 v13, s[12:15], s69 offen lds
    s_add_u32 m0, m0, 4096
    s_add_u32 s69, s69, 393216
    buffer_load_dwordx4 v13, s[12:15], s69 offen lds
    s_add_u32 m0, m0, 4096
    s_add_u32 s69, s69, 393216
    buffer_load_dwordx4 v13, s[12:15], s69 offen lds
    s_add_u32 m0, m0, 4096
    s_add_u32 s69, s69, 393216
    buffer_load_dwordx4 v13, s[12:15], s69 offen lds
    s_add_u32 m0, m0, 4096
    s_add_u32 s69, s69, 393216
    buffer_load_dwordx4 v13, s[12:15], s69 offen lds
    s_add_u32 m0, m0, 4096
    s_add_u32 s69, s69, 393216
    buffer_load_dwordx4 v13, s[12:15], s69 offen lds
    s_add_u32 m0, m0, 4096
    s_add_u32 s69, s69, 393216
    buffer_load_dwordx4 v13, s[12:15], s69 offen lds
    s_add_u32 m0, m0, 4096
    s_add_u32 s69, s69, 393216
    buffer_load_dwordx4 v13, s[12:15], s69 offen lds
    s_add_u32 m0, m0, 4096
    s_add_u32 s69, s69, 393216
    buffer_load_dwordx4 v13, s[12:15], s69 offen lds
    s_add_u32 m0, m0, 4096
    s_add_u32 s69, s69, 393216
    buffer_load_dwordx4 v13, s[12:15], s69 offen lds
    s_add_u32 m0, m0, 4096
    s_add_u32 s69, s69, 393216
    buffer_load_dwordx4 v13, s[12:15], s69 offen lds
    s_add_u32 m0, m0, 4096
    s_add_u32 s69, s69, 393216
    buffer_load_dwordx4 v13, s[12:15], s69 offen lds
    s_add_u32 m0, m0, 4096
    s_add_u32 s69, s69, 393216
    buffer_load_dwordx4 v13, s[12:15], s69 offen lds
    s_add_u32 m0, m0, 4096
    s_add_u32 s69, s69, 393216
    buffer_load_dwordx4 v13, s[12:15], s69 offen lds
    s_add_u32 m0, m0, 4096
    s_add_u32 s69, s69, 393216
    buffer_load_dwordx4 v13, s[12:15], s69 offen lds
    s_waitcnt vmcnt(20)
    s_barrier
    v_add_u32 v9, 81920, v14
    ds_read_b64_tr_b16 v[176:177], v9 offset:0
    ds_read_b64_tr_b16 v[178:179], v9 offset:256
    ds_read_b64_tr_b16 v[180:181], v9 offset:4096
    ds_read_b64_tr_b16 v[182:183], v9 offset:4352
    ds_read_b64_tr_b16 v[184:185], v9 offset:8192
    ds_read_b64_tr_b16 v[186:187], v9 offset:8448
    ds_read_b64_tr_b16 v[188:189], v9 offset:12288
    ds_read_b64_tr_b16 v[190:191], v9 offset:12544
    ds_read_b64_tr_b16 v[192:193], v9 offset:16384
    ds_read_b64_tr_b16 v[194:195], v9 offset:16640
    ds_read_b64_tr_b16 v[196:197], v9 offset:20480
    ds_read_b64_tr_b16 v[198:199], v9 offset:20736
    s_waitcnt lgkmcnt(0)
    ds_read_b64_tr_b16 v[200:201], v9 offset:24576
    ds_read_b64_tr_b16 v[202:203], v9 offset:24832
    ds_read_b64_tr_b16 v[204:205], v9 offset:28672
    ds_read_b64_tr_b16 v[206:207], v9 offset:28928
    ds_read_b64_tr_b16 v[208:209], v9 offset:32768
    ds_read_b64_tr_b16 v[210:211], v9 offset:33024
    ds_read_b64_tr_b16 v[212:213], v9 offset:36864
    ds_read_b64_tr_b16 v[214:215], v9 offset:37120
    s_waitcnt lgkmcnt(0)
    v_add_u32 v9, 122880, v14
    ds_read_b64_tr_b16 v[216:217], v9 offset:0
    ds_read_b64_tr_b16 v[218:219], v9 offset:256
    ds_read_b64_tr_b16 v[220:221], v9 offset:4096
    ds_read_b64_tr_b16 v[222:223], v9 offset:4352
    ds_read_b64_tr_b16 v[224:225], v9 offset:8192
    ds_read_b64_tr_b16 v[226:227], v9 offset:8448
    ds_read_b64_tr_b16 v[228:229], v9 offset:12288
    ds_read_b64_tr_b16 v[230:231], v9 offset:12544
    ds_read_b64_tr_b16 v[232:233], v9 offset:16384
    ds_read_b64_tr_b16 v[234:235], v9 offset:16640
    ds_read_b64_tr_b16 v[236:237], v9 offset:20480
    ds_read_b64_tr_b16 v[238:239], v9 offset:20736
    s_waitcnt lgkmcnt(0)
    ds_read_b64_tr_b16 v[240:241], v9 offset:24576
    ds_read_b64_tr_b16 v[242:243], v9 offset:24832
    ds_read_b64_tr_b16 v[244:245], v9 offset:28672
    ds_read_b64_tr_b16 v[246:247], v9 offset:28928
    ds_read_b64_tr_b16 v[248:249], v9 offset:32768
    ds_read_b64_tr_b16 v[250:251], v9 offset:33024
    ds_read_b64_tr_b16 v[252:253], v9 offset:36864
    ds_read_b64_tr_b16 v[254:255], v9 offset:37120
    s_waitcnt lgkmcnt(0)
    s_barrier
    s_mul_i32 s71, s28, 983040
    s_lshl_b32 s72, s86, 7
    s_add_u32 s71, s71, s72
    s_mul_i32 s69, s30, 10240
    s_add_u32 s69, s69, s71
    s_lshl_b32 s70, s30, 10
    s_add_u32 m0, s70, 81920
    s_nop 0
    buffer_load_dwordx4 v12, s[24:27], s69 offen lds
    s_add_u32 m0, m0, 4096
    s_add_u32 s69, s69, 40960
    buffer_load_dwordx4 v12, s[24:27], s69 offen lds
    s_add_u32 m0, m0, 4096
    s_add_u32 s69, s69, 40960
    buffer_load_dwordx4 v12, s[24:27], s69 offen lds
    s_add_u32 m0, m0, 4096
    s_add_u32 s69, s69, 40960
    buffer_load_dwordx4 v12, s[24:27], s69 offen lds
    s_add_u32 m0, m0, 4096
    s_add_u32 s69, s69, 40960
    buffer_load_dwordx4 v12, s[24:27], s69 offen lds
    s_add_u32 m0, m0, 4096
    s_add_u32 s69, s69, 40960
    buffer_load_dwordx4 v12, s[24:27], s69 offen lds
    s_add_u32 m0, m0, 4096
    s_add_u32 s69, s69, 40960
    buffer_load_dwordx4 v12, s[24:27], s69 offen lds
    s_add_u32 m0, m0, 4096
    s_add_u32 s69, s69, 40960
    buffer_load_dwordx4 v12, s[24:27], s69 offen lds
    s_add_u32 m0, m0, 4096
    s_add_u32 s69, s69, 40960
    buffer_load_dwordx4 v12, s[24:27], s69 offen lds
    s_add_u32 m0, m0, 4096
    s_add_u32 s69, s69, 40960
    buffer_load_dwordx4 v12, s[24:27], s69 offen lds
    s_add_u32 m0, m0, 4096
    s_add_u32 s69, s69, 40960
    buffer_load_dwordx4 v12, s[24:27], s69 offen lds
    s_add_u32 m0, m0, 4096
    s_add_u32 s69, s69, 40960
    buffer_load_dwordx4 v12, s[24:27], s69 offen lds
    s_waitcnt vmcnt(12)
    s_barrier
    v_add_u32 v9, 0, v14
    ds_read_b64_tr_b16 a[0:1], v9 offset:0
    ds_read_b64_tr_b16 a[2:3], v9 offset:256
    ds_read_b64_tr_b16 a[4:5], v9 offset:4096
    ds_read_b64_tr_b16 a[6:7], v9 offset:4352
    ds_read_b64_tr_b16 a[8:9], v9 offset:8192
    ds_read_b64_tr_b16 a[10:11], v9 offset:8448
    ds_read_b64_tr_b16 a[12:13], v9 offset:12288
    ds_read_b64_tr_b16 a[14:15], v9 offset:12544
    ds_read_b64_tr_b16 a[16:17], v9 offset:16384
    ds_read_b64_tr_b16 a[18:19], v9 offset:16640
    ds_read_b64_tr_b16 a[20:21], v9 offset:20480
    ds_read_b64_tr_b16 a[22:23], v9 offset:20736
    s_waitcnt lgkmcnt(0)
    ds_read_b64_tr_b16 a[24:25], v9 offset:24576
    ds_read_b64_tr_b16 a[26:27], v9 offset:24832
    ds_read_b64_tr_b16 a[28:29], v9 offset:28672
    ds_read_b64_tr_b16 a[30:31], v9 offset:28928
    ds_read_b64_tr_b16 a[32:33], v9 offset:32768
    ds_read_b64_tr_b16 a[34:35], v9 offset:33024
    ds_read_b64_tr_b16 a[36:37], v9 offset:36864
    ds_read_b64_tr_b16 a[38:39], v9 offset:37120
    s_waitcnt lgkmcnt(0)
    v_add_u32 v9, 40960, v14
    ds_read_b64_tr_b16 a[40:41], v9 offset:0
    ds_read_b64_tr_b16 a[42:43], v9 offset:256
    ds_read_b64_tr_b16 a[44:45], v9 offset:4096
    ds_read_b64_tr_b16 a[46:47], v9 offset:4352
    ds_read_b64_tr_b16 a[48:49], v9 offset:8192
    ds_read_b64_tr_b16 a[50:51], v9 offset:8448
    ds_read_b64_tr_b16 a[52:53], v9 offset:12288
    ds_read_b64_tr_b16 a[54:55], v9 offset:12544
    ds_read_b64_tr_b16 a[56:57], v9 offset:16384
    ds_read_b64_tr_b16 a[58:59], v9 offset:16640
    ds_read_b64_tr_b16 a[60:61], v9 offset:20480
    ds_read_b64_tr_b16 a[62:63], v9 offset:20736
    s_waitcnt lgkmcnt(0)
    ds_read_b64_tr_b16 a[64:65], v9 offset:24576
    ds_read_b64_tr_b16 a[66:67], v9 offset:24832
    ds_read_b64_tr_b16 a[68:69], v9 offset:28672
    ds_read_b64_tr_b16 a[70:71], v9 offset:28928
    ds_read_b64_tr_b16 a[72:73], v9 offset:32768
    ds_read_b64_tr_b16 a[74:75], v9 offset:33024
    ds_read_b64_tr_b16 a[76:77], v9 offset:36864
    ds_read_b64_tr_b16 a[78:79], v9 offset:37120
    s_waitcnt lgkmcnt(0)
    s_barrier
    s_mul_i32 s71, s28, 983040
    s_lshl_b32 s72, s86, 7
    s_add_u32 s71, s71, s72
    s_add_u32 s71, s71, 491520
    s_mul_i32 s69, s30, 10240
    s_add_u32 s69, s69, s71
    s_lshl_b32 s70, s30, 10
    s_add_u32 m0, s70, 0
    s_nop 0
    buffer_load_dwordx4 v12, s[24:27], s69 offen lds
    s_add_u32 m0, m0, 4096
    s_add_u32 s69, s69, 40960
    buffer_load_dwordx4 v12, s[24:27], s69 offen lds
    s_add_u32 m0, m0, 4096
    s_add_u32 s69, s69, 40960
    buffer_load_dwordx4 v12, s[24:27], s69 offen lds
    s_add_u32 m0, m0, 4096
    s_add_u32 s69, s69, 40960
    buffer_load_dwordx4 v12, s[24:27], s69 offen lds
    s_add_u32 m0, m0, 4096
    s_add_u32 s69, s69, 40960
    buffer_load_dwordx4 v12, s[24:27], s69 offen lds
    s_add_u32 m0, m0, 4096
    s_add_u32 s69, s69, 40960
    buffer_load_dwordx4 v12, s[24:27], s69 offen lds
    s_add_u32 m0, m0, 4096
    s_add_u32 s69, s69, 40960
    buffer_load_dwordx4 v12, s[24:27], s69 offen lds
    s_add_u32 m0, m0, 4096
    s_add_u32 s69, s69, 40960
    buffer_load_dwordx4 v12, s[24:27], s69 offen lds
    s_add_u32 m0, m0, 4096
    s_add_u32 s69, s69, 40960
    buffer_load_dwordx4 v12, s[24:27], s69 offen lds
    s_add_u32 m0, m0, 4096
    s_add_u32 s69, s69, 40960
    buffer_load_dwordx4 v12, s[24:27], s69 offen lds
    s_add_u32 m0, m0, 4096
    s_add_u32 s69, s69, 40960
    buffer_load_dwordx4 v12, s[24:27], s69 offen lds
    s_add_u32 m0, m0, 4096
    s_add_u32 s69, s69, 40960
    buffer_load_dwordx4 v12, s[24:27], s69 offen lds
    s_waitcnt vmcnt(12)
    s_barrier
    v_add_u32 v9, 81920, v14
    ds_read_b64_tr_b16 a[160:161], v9 offset:0
    ds_read_b64_tr_b16 a[162:163], v9 offset:256
    ds_read_b64_tr_b16 a[164:165], v9 offset:4096
    ds_read_b64_tr_b16 a[166:167], v9 offset:4352
    ds_read_b64_tr_b16 a[168:169], v9 offset:8192
    ds_read_b64_tr_b16 a[170:171], v9 offset:8448
    ds_read_b64_tr_b16 a[172:173], v9 offset:12288
    ds_read_b64_tr_b16 a[174:175], v9 offset:12544
    ds_read_b64_tr_b16 a[176:177], v9 offset:16384
    ds_read_b64_tr_b16 a[178:179], v9 offset:16640
    ds_read_b64_tr_b16 a[180:181], v9 offset:20480
    ds_read_b64_tr_b16 a[182:183], v9 offset:20736
    s_waitcnt lgkmcnt(0)
    ds_read_b64_tr_b16 a[184:185], v9 offset:24576
    ds_read_b64_tr_b16 a[186:187], v9 offset:24832
    ds_read_b64_tr_b16 a[188:189], v9 offset:28672
    ds_read_b64_tr_b16 a[190:191], v9 offset:28928
    ds_read_b64_tr_b16 a[192:193], v9 offset:32768
    ds_read_b64_tr_b16 a[194:195], v9 offset:33024
    ds_read_b64_tr_b16 a[196:197], v9 offset:36864
    ds_read_b64_tr_b16 a[198:199], v9 offset:37120
    s_waitcnt lgkmcnt(0)
    v_add_u32 v9, 122880, v14
    ds_read_b64_tr_b16 a[200:201], v9 offset:0
    ds_read_b64_tr_b16 a[202:203], v9 offset:256
    ds_read_b64_tr_b16 a[204:205], v9 offset:4096
    ds_read_b64_tr_b16 a[206:207], v9 offset:4352
    s_waitcnt lgkmcnt(0)
    s_barrier
    s_waitcnt vmcnt(0)
    s_barrier
    v_add_u32 v9, 0, v14
    ds_read_b64_tr_b16 a[208:209], v9 offset:0
    ds_read_b64_tr_b16 a[210:211], v9 offset:256
    ds_read_b64_tr_b16 a[212:213], v9 offset:4096
    ds_read_b64_tr_b16 a[214:215], v9 offset:4352
    ds_read_b64_tr_b16 a[216:217], v9 offset:8192
    ds_read_b64_tr_b16 a[218:219], v9 offset:8448
    ds_read_b64_tr_b16 a[220:221], v9 offset:12288
    ds_read_b64_tr_b16 a[222:223], v9 offset:12544
    ds_read_b64_tr_b16 a[224:225], v9 offset:16384
    ds_read_b64_tr_b16 a[226:227], v9 offset:16640
    ds_read_b64_tr_b16 a[228:229], v9 offset:20480
    ds_read_b64_tr_b16 a[230:231], v9 offset:20736
    s_waitcnt lgkmcnt(0)
    ds_read_b64_tr_b16 a[232:233], v9 offset:24576
    ds_read_b64_tr_b16 a[234:235], v9 offset:24832
    ds_read_b64_tr_b16 a[236:237], v9 offset:28672
    ds_read_b64_tr_b16 a[238:239], v9 offset:28928
    ds_read_b64_tr_b16 a[240:241], v9 offset:32768
    ds_read_b64_tr_b16 a[242:243], v9 offset:33024
    ds_read_b64_tr_b16 a[244:245], v9 offset:36864
    ds_read_b64_tr_b16 a[246:247], v9 offset:37120
    s_waitcnt lgkmcnt(0)
    v_add_u32 v9, 40960, v14
    ds_read_b64_tr_b16 a[248:249], v9 offset:0
    ds_read_b64_tr_b16 a[250:251], v9 offset:256
    ds_read_b64_tr_b16 a[252:253], v9 offset:4096
    ds_read_b64_tr_b16 a[254:255], v9 offset:4352
    s_waitcnt lgkmcnt(0)
    s_barrier
    v_mov_b32 v2, 128
wa_1:
    buffer_load_dword v3, v2, s[64:67], 0 offen sc1
    s_waitcnt vmcnt(0)
    v_cmp_ne_u32 vcc, 0x100, v3
    s_cbranch_vccz wad_2
    s_sub_u32 s68, s68, 1
    s_cbranch_scc0 ok_3
    s_mov_b32 s69, 1
    s_branch FAIL
ok_3:
    s_sleep 4
    s_branch wa_1
wad_2:
    v_and_b32 v2, 7, v0
    v_lshlrev_b32 v2, 2, v2
    buffer_load_dword v3, v2, s[64:67], 0 offen sc1
    s_waitcnt vmcnt(0)
    v_cmp_ne_u32 vcc, 32, v3
    s_cbranch_vccnz SAFEENTRY
    s_mov_b32 s12, s34
    s_mov_b32 s13, s35
    s_mov_b32 s14, 10240
    s_mov_b32 s15, 0x20000
    s_lshl_b32 s69, s30, 6
    v_add_u32 v16, s69, v0
    v_lshlrev_b32 v17, 1, v16
    s_mov_b32 s69, 0
    buffer_load_ushort v80, v17, s[12:15], s69 offen offset:0
    buffer_load_ushort v88, v17, s[12:15], s69 offen offset:512
    buffer_load_ushort v96, v17, s[12:15], s69 offen offset:1024
    s_mov_b32 s69, 1280
    buffer_load_ushort v81, v17, s[12:15], s69 offen offset:0
    buffer_load_ushort v89, v17, s[12:15], s69 offen offset:512
    buffer_load_ushort v97, v17, s[12:15], s69 offen offset:1024
    s_mov_b32 s69, 2560
    buffer_load_ushort v82, v17, s[12:15], s69 offen offset:0
    buffer_load_ushort v90, v17, s[12:15], s69 offen offset:512
    buffer_load_ushort v98, v17, s[12:15], s69 offen offset:1024
    s_mov_b32 s69, 3840
    buffer_load_ushort v83, v17, s[12:15], s69 offen offset:0
    buffer_load_ushort v91, v17, s[12:15], s69 offen offset:512
    buffer_load_ushort v99, v17, s[12:15], s69 offen offset:1024
    s_mov_b32 s69, 5120
    buffer_load_ushort v84, v17, s[12:15], s69 offen offset:0
    buffer_load_ushort v92, v17, s[12:15], s69 offen offset:512
    buffer_load_ushort v100, v17, s[12:15], s69 offen offset:1024
    s_mov_b32 s69, 6400
    buffer_load_ushort v85, v17, s[12:15], s69 offen offset:0
    buffer_load_ushort v93, v17, s[12:15], s69 offen offset:512
    buffer_load_ushort v101, v17, s[12:15], s69 offen offset:1024
    s_mov_b32 s69, 7680
    buffer_load_ushort v86, v17, s[12:15], s69 offen offset:0
    buffer_load_ushort v94, v17, s[12:15], s69 offen offset:512
    buffer_load_ushort v102, v17, s[12:15], s69 offen offset:1024
    s_mov_b32 s69, 8960
    buffer_load_ushort v87, v17, s[12:15], s69 offen offset:0
    buffer_load_ushort v95, v17, s[12:15], s69 offen offset:512
    buffer_load_ushort v103, v17, s[12:15], s69 offen offset:1024
    v_and_b32 v18, 0xeb, v16
    v_bfe_u32 v19, v16, 2, 1
    v_lshl_or_b32 v18, v19, 4, v18
    v_bfe_u32 v19, v16, 4, 1
    v_lshl_or_b32 v18, v19, 2, v18
    v_lshlrev_b32 v17, 4, v18
    v_and_b32 v30, 15, v0
    v_lshrrev_b32 v31, 4, v0
    v_and_b32 v32, 7, v0
    v_bfe_u32 v33, v0, 3, 1
    v_and_b32 v20, 1, v31
    v_lshrrev_b32 v21, 1, v31
    v_bfe_u32 v22, v0, 2, 2
    v_and_b32 v23, 1, v0
    v_bfe_u32 v24, v0, 1, 1
    v_lshlrev_b32 v38, 4, v32
    v_lshl_add_u32 v38, v31, 7, v38
    v_lshlrev_b32 v25, 4, v22
    v_lshl_add_u32 v25, v23, 3, v25
    v_lshl_add_u32 v75, v31, 6, v25
    v_lshl_add_u32 v1, v20, 6, v25
    v_lshl_add_u32 v1, v24, 7, v1
    v_lshl_add_u32 v1, v21, 9, v1
    v_lshlrev_b32 v26, 3, v20
    v_lshl_add_u32 v26, v21, 2, v26
    s_lshl_b32 s69, s30, 8
    v_lshl_add_u32 v2, v30, 4, v26
    v_add_u32 v2, s69, v2
    v_mov_b32 v43, 0x4444
    v_mov_b32 v34, 0xeeee
    v_cmp_eq_u32 vcc, 1, v33
    s_nop 1
    v_cndmask_b32 v43, v43, v34, vcc
    v_lshlrev_b32 v5, 4, v0
    v_lshl_add_u32 v15, v33, 9, v38
    s_mul_i32 s71, s74, 4608
    s_add_u32 s71, s71, 245760
    v_lshrrev_b32 v34, 1, v31
    v_lshl_add_u32 v34, v34, 1, v33
    s_mov_b32 s72, 1536
    v_mul_u32_u24 v35, s72, v34
    v_and_b32 v68, 1, v31
    v_lshlrev_b32 v68, 7, v68
    v_lshl_add_u32 v68, v32, 4, v68
    v_add_u32 v68, v68, v35
    v_add_u32 v68, s71, v68
    v_cmp_eq_u32 vcc, 3, v34
    v_mov_b32 v35, 0x80000000
    s_nop 0
    v_cndmask_b32 v68, v68, v35, vcc
    v_lshlrev_b32 v34, 4, v30
    v_lshl_add_u32 v34, v31, 8, v34
    v_add_u32 v34, 512, v34
    v_add_u32 v4, s71, v34
    s_mul_i32 s72, s75, 1536
    s_add_u32 s71, s71, s72
    s_cmp_eq_u32 s30, 0
    s_cbranch_scc1 cw0_4
    s_sub_u32 s72, s30, 1
    s_and_b32 s72, s72, 1
    s_lshl_b32 s72, s72, 7
    s_add_u32 s71, s71, s72
    s_add_u32 s71, s71, 512
    v_lshlrev_b32 v34, 4, v32
    v_lshl_add_u32 v34, v31, 8, v34
    v_add_u32 v3, s71, v34
    s_mov_b32 s62, 0x00ff00ff
    s_mov_b32 s63, 0x00ff00ff
    s_branch cw1_5
cw0_4:
    v_add_u32 v3, s71, v38
    s_mov_b32 s62, 0x00ff00ff
    s_mov_b32 s63, 0
cw1_5:
    s_cmp_lg_u32 s30, 3
    s_cbranch_scc1 nw3_6
    v_mov_b32 v3, 0x80000000
nw3_6:
    v_mov_b32 v60, -1
    v_mov_b32 v61, -1
    v_mov_b32 v62, -1
    v_mov_b32 v63, -1
    s_lshl_b32 s69, s75, 2
    s_add_u32 s69, s69, s30
    s_lshl_b32 s69, s69, 8
    v_lshlrev_b32 v34, 7, v20
    v_lshl_add_u32 v34, v30, 3, v34
    v_lshl_add_u32 v34, v21, 2, v34
    v_add_u32 v6, s69, v34
    s_mul_i32 s71, s28, 12288
    s_add_u32 s71, s71, 393216
    s_mul_i32 s69, s30, 3072
    v_add_u32 v7, s69, v5
    v_add_u32 v69, s71, v7
    s_lshl_b32 s69, s29, 10
    s_lshl_b32 s70, s30, 7
    s_add_u32 s69, s69, s70
    s_add_u32 s69, s69, s71
    v_lshlrev_b32 v34, 4, v32
    v_lshl_add_u32 v34, v21, 9, v34
    v_lshl_add_u32 v34, v20, 3, v34
    v_add_u32 v67, s69, v34
    s_lshl_b32 s69, s86, 2
    s_add_u32 s69, s69, s30
    s_lshl_b32 s69, s69, 12
    v_and_b32 v36, 31, v0
    v_lshlrev_b32 v36, 4, v36
    v_lshrrev_b32 v37, 5, v0
    v_lshl_add_u32 v34, v37, 11, v36
    v_add_u32 v8, s69, v34
    v_mov_b32 v35, 0x80000000
    v_lshl_add_u32 v34, v37, 2, 1
    v_cmp_eq_u32 vcc, s28, v34
    v_add_u32 v34, 512, v8
    s_nop 0
    v_cndmask_b32 v40, v34, v35, vcc
    v_lshl_add_u32 v34, v37, 2, 2
    v_cmp_eq_u32 vcc, s28, v34
    v_add_u32 v34, 1024, v8
    s_nop 0
    v_cndmask_b32 v41, v34, v35, vcc
    v_lshl_add_u32 v34, v37, 2, 3
    v_cmp_eq_u32 vcc, s28, v34
    v_add_u32 v34, 1536, v8
    s_nop 0
    v_cndmask_b32 v42, v34, v35, vcc
    v_lshl_add_u32 v34, v37, 2, 0
    v_cmp_eq_u32 vcc, s28, v34
    v_add_u32 v34, 0, v8
    s_nop 0
    v_cndmask_b32 v8, v34, v35, vcc
    s_lshl_b32 s70, s28, 9
    s_add_u32 s69, s69, s70
    v_lshl_add_u32 v34, v37, 3, v36
    v_add_u32 v11, s69, v34
    s_lshr_b32 s71, s30, 1
    s_lshl_b32 s71, s71, 1
    s_lshl_b32 s72, s86, 2
    s_add_u32 s71, s71, s72
    s_lshl_b32 s71, s71, 12
    s_lshl_b32 s72, s28, 9
    s_add_u32 s71, s71, s72
    s_add_u32 s71, s71, 0
    v_lshl_add_u32 v34, v37, 12, v36
    v_add_u32 v76, s71, v34
    s_mul_i32 s71, s28, 10240
    s_add_u32 s71, s71, 163840
    s_lshl_b32 s69, s86, 10
    s_add_u32 s69, s69, s71
    s_lshr_b32 s70, s30, 1
    s_lshl_b32 s70, s70, 9
    s_add_u32 s69, s69, s70
    s_and_b32 s70, s30, 1
    s_lshl_b32 s70, s70, 6
    s_add_u32 s69, s69, s70
    v_and_b32 v34, 3, v0
    v_lshl_add_u32 v34, v34, 4, v26
    v_lshl_add_u32 v34, v33, 7, v34
    v_bfe_u32 v35, v0, 2, 1
    v_lshl_add_u32 v34, v35, 8, v34
    v_add_u32 v12, s69, v34
    s_mul_i32 s69, s30, 2560
    v_add_u32 v9, s69, v5
    v_and_b32 v34, 31, v0
    v_lshlrev_b32 v34, 4, v34
    s_add_u32 s69, s69, 2048
    v_add_u32 v10, s69, v34
    v_add_u32 v70, s71, v9
    v_add_u32 v71, s71, v10
    s_mul_i32 s71, s74, 4608
    s_mul_i32 s72, s75, 1536
    s_add_u32 s71, s71, s72
    s_add_u32 s71, s71, 245760
    s_cmp_eq_u32 s30, 1
    s_cbranch_scc1 rw1_7
    s_add_u32 s71, s71, 512
    v_add_u32 v74, s71, v5
    s_mul_i32 s71, s28, 12288
    s_lshl_b32 s72, s29, 10
    s_add_u32 s71, s71, s72
    s_add_u32 s71, s71, 393216
    v_add_u32 v64, s71, v5
    s_branch rwd_8
rw1_7:
    v_add_u32 v74, s71, v5
    v_mov_b32 v34, 0x80000000
    v_cmp_le_u32 vcc, 16, v0
    s_nop 1
    v_cndmask_b32 v74, v74, v34, vcc
    s_mul_i32 s71, s28, 10240
    s_lshl_b32 s72, s86, 10
    s_add_u32 s71, s71, s72
    s_add_u32 s71, s71, 163840
    v_add_u32 v64, s71, v5
    s_cmp_lt_u32 s29, 10
    s_cbranch_scc1 rwd_8
    v_mov_b32 v64, 0x80000000
rwd_8:
    s_cmp_lt_u32 s29, 10
    s_cbranch_scc1 nooob_9
    v_mov_b32 v11, 0x80000000
    v_mov_b32 v12, 0x80000000
nooob_9:
    s_lshl_b32 s69, s74, 7
    s_add_u32 s69, s69, 2097152
    v_lshlrev_b32 v34, 2, v32
    v_add_u32 v13, s69, v34
    s_lshl_b32 s70, s75, 2
    s_add_u32 s70, s70, s30
    s_lshl_b32 s70, s70, 2
    s_add_u32 s69, s69, s70
    s_add_u32 s69, s69, 32
    v_mov_b32 v65, s69
    s_mul_i32 s78, s74, 786432
    s_add_u32 s78, s78, 4194304
    s_sub_u32 s69, s30, 1
    s_and_b32 s69, s69, 1
    s_mul_i32 s69, s69, 6144
    s_lshl_b32 s70, s75, 11
    s_add_u32 s69, s69, s70
    s_add_u32 s78, s78, s69
    s_mul_i32 s79, s74, 786432
    s_add_u32 s79, s79, 29360128
    s_lshl_b32 s69, s75, 2
    s_add_u32 s69, s69, s30
    s_lshl_b32 s69, s69, 10
    s_add_u32 s79, s79, s69
    s_mul_i32 s80, s74, 196608
    s_add_u32 s80, s80, 79691776
    s_lshl_b32 s69, s75, 10
    s_add_u32 s80, s80, s69
    s_mul_i32 s81, s74, 196608
    s_add_u32 s81, s81, 85983232
    s_mov_b32 s82, 0x00ff00ff
    s_mov_b32 s83, 0x00ff00ff
    s_mov_b32 s84, 0x3dd53b95
    s_mov_b32 s31, 0
    s_mov_b32 s76, 0
    s_mov_b32 s77, 1048576
    s_waitcnt vmcnt(0)
    v_lshl_or_b32 v104, v81, 16, v80
    v_lshl_or_b32 v105, v83, 16, v82
    v_lshl_or_b32 v106, v85, 16, v84
    v_lshl_or_b32 v107, v87, 16, v86
    ds_write_b128 v17, v[104:107] offset:0
    v_lshl_or_b32 v108, v89, 16, v88
    v_lshl_or_b32 v109, v91, 16, v90
    v_lshl_or_b32 v110, v93, 16, v92
    v_lshl_or_b32 v111, v95, 16, v94
    ds_write_b128 v17, v[108:111] offset:4096
    s_cmp_ge_u32 s30, 2
    s_cbranch_scc1 nw2_10
    v_lshl_or_b32 v112, v97, 16, v96
    v_lshl_or_b32 v113, v99, 16, v98
    v_lshl_or_b32 v114, v101, 16, v100
    v_lshl_or_b32 v115, v103, 16, v102
    ds_write_b128 v17, v[112:115] offset:8192
nw2_10:
    s_mov_b32 s85, 1
pf_11:
    buffer_load_dword v72, v13, s[4:7], 0 offen sc1
    s_waitcnt vmcnt(0)
    v_cmp_gt_u32 vcc, s85, v72
    s_cbranch_vccz pfd_12
    s_sub_u32 s68, s68, 1
    s_cbranch_scc0 ok_13
    s_mov_b32 s69, 20
    s_branch FAIL
ok_13:
    s_sleep 1
    s_branch pf_11
pfd_12:
    s_sub_u32 s69, s30, 1
    s_cmp_ge_u32 s69, 2
    s_cbranch_scc1 nk_14
    buffer_load_dwordx4 v[44:47], v5, s[4:7], s78 offen sc1
    buffer_load_dwordx4 v[48:51], v5, s[4:7], s78 offen offset:1024 sc1
nk_14:
    buffer_load_dwordx4 v[52:55], v5, s[4:7], s79 offen sc1
    buffer_load_dword v72, v13, s[4:7], 0 offen sc1
    s_add_u32 s78, s78, 12288
    s_add_u32 s79, s79, 12288
    v_mov_b32 v16, 0
    v_mov_b32 v17, 0
    v_mov_b32 v18, 0
    v_mov_b32 v19, 0
    v_mov_b32 v20, 0
    v_mov_b32 v21, 0
    v_mov_b32 v22, 0
    v_mov_b32 v23, 0
    v_mov_b32 v24, 0
    v_mov_b32 v25, 0
    v_mov_b32 v26, 0
    v_mov_b32 v27, 0
    v_mov_b32 v32, 0
    v_mov_b32 v33, 0
    v_mov_b32 v34, 0
    v_mov_b32 v35, 0
    v_mov_b32 v36, 0
    v_mov_b32 v37, 0
    v_mov_b32 v38, 0
    v_mov_b32 v39, 0
    s_waitcnt vmcnt(0) lgkmcnt(0)
cloop_15:
    s_barrier
    ds_read_b64_tr_b16 v[80:81], v1 offset:0
    ds_read_b64_tr_b16 v[82:83], v1 offset:256
    ds_read_b64_tr_b16 v[84:85], v1 offset:1024
    ds_read_b64_tr_b16 v[86:87], v1 offset:1280
    ds_read_b64_tr_b16 v[88:89], v1 offset:2048
    ds_read_b64_tr_b16 v[90:91], v1 offset:2304
    ds_read_b64_tr_b16 v[92:93], v1 offset:3072
    ds_read_b64_tr_b16 v[94:95], v1 offset:3328
    ds_read_b64_tr_b16 v[96:97], v1 offset:4096
    ds_read_b64_tr_b16 v[98:99], v1 offset:4352
    ds_read_b64_tr_b16 v[100:101], v1 offset:5120
    ds_read_b64_tr_b16 v[102:103], v1 offset:5376
    s_waitcnt lgkmcnt(10)
    v_smfmac_f32_16x16x64_bf16 v[16:19], v[80:83], a[0:7], v43
    v_smfmac_f32_16x16x64_bf16 v[20:23], v[80:83], a[80:87], v43
    ds_read_b64_tr_b16 v[104:105], v1 offset:6144
    ds_read_b64_tr_b16 v[106:107], v1 offset:6400
    s_waitcnt lgkmcnt(10)
    v_smfmac_f32_16x16x64_bf16 v[16:19], v[84:87], a[8:15], v43
    v_smfmac_f32_16x16x64_bf16 v[20:23], v[84:87], a[88:95], v43
    ds_read_b64_tr_b16 v[108:109], v1 offset:7168
    ds_read_b64_tr_b16 v[110:111], v1 offset:7424
    s_waitcnt lgkmcnt(10)
    v_smfmac_f32_16x16x64_bf16 v[16:19], v[88:91], a[16:23], v43
    v_smfmac_f32_16x16x64_bf16 v[20:23], v[88:91], a[96:103], v43
    ds_read_b64_tr_b16 v[112:113], v1 offset:8192
    ds_read_b64_tr_b16 v[114:115], v1 offset:8448
    s_waitcnt lgkmcnt(10)
    v_smfmac_f32_16x16x64_bf16 v[16:19], v[92:95], a[24:31], v43
    v_smfmac_f32_16x16x64_bf16 v[20:23], v[92:95], a[104:111], v43
    ds_read_b64_tr_b16 v[116:117], v1 offset:9216
    ds_read_b64_tr_b16 v[118:119], v1 offset:9472
    s_waitcnt lgkmcnt(10)
    v_smfmac_f32_16x16x64_bf16 v[16:19], v[96:99], a[32:39], v43
    v_smfmac_f32_16x16x64_bf16 v[20:23], v[96:99], a[112:119], v43
    s_cmp_ge_u32 s30, 2
    s_cbranch_scc1 rj_16
    buffer_store_dwordx4 v[60:63], v64, s[4:7], s77 offen
    buffer_store_dwordx4 v[60:63], v74, s[4:7], s77 offen
rj_16:
    s_waitcnt lgkmcnt(8)
    v_smfmac_f32_16x16x64_bf16 v[16:19], v[100:103], a[40:47], v43
    v_smfmac_f32_16x16x64_bf16 v[20:23], v[100:103], a[120:127], v43
    s_waitcnt lgkmcnt(6)
    v_smfmac_f32_16x16x64_bf16 v[16:19], v[104:107], a[48:55], v43
    v_smfmac_f32_16x16x64_bf16 v[20:23], v[104:107], a[128:135], v43
    s_waitcnt lgkmcnt(4)
    v_smfmac_f32_16x16x64_bf16 v[16:19], v[108:111], a[56:63], v43
    v_smfmac_f32_16x16x64_bf16 v[20:23], v[108:111], a[136:143], v43
    s_waitcnt lgkmcnt(2)
    v_smfmac_f32_16x16x64_bf16 v[16:19], v[112:115], a[64:71], v43
    v_smfmac_f32_16x16x64_bf16 v[20:23], v[112:115], a[144:151], v43
    s_waitcnt lgkmcnt(0)
    v_smfmac_f32_16x16x64_bf16 v[16:19], v[116:119], a[72:79], v43
    v_smfmac_f32_16x16x64_bf16 v[20:23], v[116:119], a[152:159], v43
    s_nop 10
    v_permlane32_swap_b32 v16, v18
    v_permlane32_swap_b32 v17, v19
    v_add_f32 v16, v16, v18
    v_add_f32 v17, v17, v19
    v_permlane32_swap_b32 v20, v22
    v_permlane32_swap_b32 v21, v23
    v_add_f32 v20, v20, v22
    v_add_f32 v21, v21, v23
    v_cvt_pk_bf16_f32 v28, v16, v17
    v_cvt_pk_bf16_f32 v30, v20, v21
    ds_write_b32 v2, v28 offset:10240
    ds_write_b32 v2, v30 offset:11264
    s_waitcnt lgkmcnt(0)
    s_barrier
    s_cmp_eq_u32 s30, 3
    s_cbranch_scc1 nosc_17
    ds_read_b64_tr_b16 v[160:161], v75 offset:10240
    ds_read_b64_tr_b16 v[162:163], v75 offset:10496
    ds_read_b64_tr_b16 v[164:165], v75 offset:10752
    ds_read_b64_tr_b16 v[166:167], v75 offset:11008
    s_cmp_lg_u32 s30, 0
    s_cbranch_scc1 tok_18
    ds_read_b64_tr_b16 v[44:45], v75 offset:11264
    ds_read_b64_tr_b16 v[46:47], v75 offset:11520
    ds_read_b64_tr_b16 v[48:49], v75 offset:11776
    ds_read_b64_tr_b16 v[50:51], v75 offset:12032
tok_18:
    buffer_store_dword v30, v2, s[4:7], s80 offen
    v_smfmac_f32_16x16x64_bf16 v[24:27], v[80:83], v[176:183], v43
    v_smfmac_f32_16x16x64_bf16 v[24:27], v[84:87], v[184:191], v43
    v_smfmac_f32_16x16x64_bf16 v[24:27], v[88:91], v[192:199], v43
    s_waitcnt lgkmcnt(0)
    v_mfma_f32_16x16x32_bf16 v[56:59], v[44:47], v[160:163], 0
    v_mfma_f32_16x16x32_bf16 v[56:59], v[48:51], v[164:167], v[56:59]
    v_smfmac_f32_16x16x64_bf16 v[24:27], v[92:95], v[200:207], v43
    v_smfmac_f32_16x16x64_bf16 v[24:27], v[96:99], v[208:215], v43
    s_nop 5
    v_min_u32 v56, -2, v56
    s_mov_b64 exec, s[62:63]
    buffer_store_dwordx4 v[56:59], v3, s[4:7], s76 offen
    s_mov_b64 exec, -1
    s_branch v2_19
nosc_17:
    buffer_store_dword v30, v2, s[4:7], s80 offen
    v_smfmac_f32_16x16x64_bf16 v[24:27], v[80:83], v[176:183], v43
    v_smfmac_f32_16x16x64_bf16 v[24:27], v[84:87], v[184:191], v43
    v_smfmac_f32_16x16x64_bf16 v[24:27], v[88:91], v[192:199], v43
    v_smfmac_f32_16x16x64_bf16 v[24:27], v[92:95], v[200:207], v43
    v_smfmac_f32_16x16x64_bf16 v[24:27], v[96:99], v[208:215], v43
v2_19:
    v_smfmac_f32_16x16x64_bf16 v[24:27], v[100:103], v[216:223], v43
    v_smfmac_f32_16x16x64_bf16 v[24:27], v[104:107], v[224:231], v43
    v_smfmac_f32_16x16x64_bf16 v[24:27], v[108:111], v[232:239], v43
    v_smfmac_f32_16x16x64_bf16 v[24:27], v[112:115], v[240:247], v43
    v_smfmac_f32_16x16x64_bf16 v[24:27], v[116:119], v[248:255], v43
    s_nop 11
    v_permlane32_swap_b32 v24, v26
    v_permlane32_swap_b32 v25, v27
    v_add_f32 v24, v24, v26
    v_add_f32 v25, v25, v27
    v_cvt_pk_bf16_f32 v32, v24, v25
    s_waitcnt vmcnt(0)
    buffer_load_dwordx4 v[120:123], v4, s[4:7], s76 offen offset:0 sc1
    buffer_load_dwordx4 v[124:127], v4, s[4:7], s76 offen offset:1536 sc1
    buffer_load_dwordx4 v[128:131], v4, s[4:7], s76 offen offset:3072 sc1
    buffer_load_dwordx4 v[132:135], v68, s[4:7], s76 offen sc1
pl_20:
    s_waitcnt vmcnt(0)
    v_max3_u32 v73, v120, v124, v128
    v_max_u32 v73, v73, v132
    v_cmp_eq_u32 vcc, -1, v73
    s_cbranch_vccz pd_21
    v_cmp_eq_u32 vcc, -1, v120
    s_cbranch_vccz ps_22
    buffer_load_dwordx4 v[120:123], v4, s[4:7], s76 offen offset:0 sc1
ps_22:
    v_cmp_eq_u32 vcc, -1, v124
    s_cbranch_vccz ps_23
    buffer_load_dwordx4 v[124:127], v4, s[4:7], s76 offen offset:1536 sc1
ps_23:
    v_cmp_eq_u32 vcc, -1, v128
    s_cbranch_vccz ps_24
    buffer_load_dwordx4 v[128:131], v4, s[4:7], s76 offen offset:3072 sc1
ps_24:
    v_cmp_eq_u32 vcc, -1, v132
    s_cbranch_vccz ps_25
    buffer_load_dwordx4 v[132:135], v68, s[4:7], s76 offen sc1
ps_25:
    s_sub_u32 s68, s68, 1
    s_cbranch_scc0 ok_26
    s_mov_b32 s69, 21
    s_branch FAIL
ok_26:
    s_branch pl_20
pd_21:
    v_pk_add_f32 v[16:17], v[120:121], v[124:125]
    v_pk_add_f32 v[18:19], v[122:123], v[126:127]
    v_permlane32_swap_b32 v132, v134
    v_permlane32_swap_b32 v133, v135
    v_pk_add_f32 v[16:17], v[16:17], v[128:129]
    v_pk_add_f32 v[18:19], v[18:19], v[130:131]
    v_add_f32 v20, v132, v134
    v_add_f32 v21, v133, v135
    v_max3_f32 v24, v16, v17, v18
    v_add_f32_dpp v20, v20, v20 row_ror:8 row_mask:0xf bank_mask:0xf
    v_add_f32_dpp v21, v21, v21 row_ror:8 row_mask:0xf bank_mask:0xf
    v_max_f32 v24, v24, v19
    v_max3_f32 v24, v24, v20, v21
    s_nop 1
    v_max_f32_dpp v24, v24, v24 row_ror:8 row_mask:0xf bank_mask:0xf
    v_mov_b32 v25, v24
    s_nop 1
    v_permlane32_swap_b32 v24, v25
    v_max_f32 v24, v24, v25
    v_mov_b32 v25, v24
    s_nop 1
    v_permlane16_swap_b32 v24, v25
    v_max_f32 v24, v24, v25
    v_mul_f32 v24, s84, v24
    v_fma_f32 v16, v16, s84, -v24
    v_fma_f32 v17, v17, s84, -v24
    v_fma_f32 v18, v18, s84, -v24
    v_fma_f32 v19, v19, s84, -v24
    v_fma_f32 v20, v20, s84, -v24
    v_fma_f32 v21, v21, s84, -v24
    v_exp_f32 v16, v16
    v_exp_f32 v17, v17
    v_exp_f32 v18, v18
    v_exp_f32 v19, v19
    v_exp_f32 v20, v20
    v_exp_f32 v21, v21
    v_cvt_pk_bf16_f32 v28, v16, v17
    v_cvt_pk_bf16_f32 v29, v18, v19
    v_cvt_pk_bf16_f32 v36, v20, v21
    v_mov_b32_dpp v30, v28 row_ror:8 row_mask:0xf bank_mask:0xf
    v_mov_b32_dpp v31, v29 row_ror:8 row_mask:0xf bank_mask:0xf
    v_mfma_f32_16x16x32_bf16 v[56:59], v[32:35], v[36:39], 0
    s_nop 0
    v_mfma_f32_16x16x32_bf16 v[56:59], v[52:55], v[28:31], v[56:59]
    s_add_u32 s80, s80, 3072
    s_add_u32 s85, s31, 1
    v_add_f32 v24, v16, v17
    v_add_f32 v25, v18, v19
    v_add_f32 v26, v20, v21
    v_add_f32 v24, v24, v25
    v_fma_f32 v24, v26, 0.5, v24
    s_nop 1
    v_add_f32_dpp v24, v24, v24 row_ror:8 row_mask:0xf bank_mask:0xf
    v_mov_b32 v25, v24
    s_nop 1
    v_permlane32_swap_b32 v24, v25
    v_add_f32 v24, v24, v25
    v_mov_b32 v25, v24
    s_nop 1
    v_permlane16_swap_b32 v24, v25
    v_add_f32 v24, v24, v25
    v_rcp_f32 v24, v24
    s_nop 0
    v_mul_f32 v56, v56, v24
    v_mul_f32 v57, v57, v24
    v_mul_f32 v58, v58, v24
    v_mul_f32 v59, v59, v24
    v_cvt_pk_bf16_f32 v28, v56, v57
    v_cvt_pk_bf16_f32 v29, v58, v59
    v_min_u32 v28, -2, v28
    s_mov_b64 exec, s[82:83]
    buffer_store_dwordx2 v[28:29], v67, s[4:7], s76 offen
    s_mov_b64 exec, -1
    buffer_store_dword v32, v6, s[4:7], s81 offen
    s_add_u32 s81, s81, 3072
    v_mov_b32 v56, 0
    v_mov_b32 v57, 0
    v_mov_b32 v58, 0
    v_mov_b32 v59, 0
    s_cmp_ge_u32 s29, 10
    s_cbranch_scc1 nowo_27
    s_barrier
    buffer_load_dwordx4 v[128:131], v69, s[4:7], s76 offen offset:0 sc1
    buffer_load_dwordx4 v[132:135], v69, s[4:7], s76 offen offset:1024 sc1
    buffer_load_dwordx4 v[136:139], v69, s[4:7], s76 offen offset:2048 sc1
pl_29:
    s_waitcnt vmcnt(0)
    v_max3_u32 v73, v128, v130, v132
    v_max3_u32 v73, v73, v134, v136
    v_max_u32 v73, v73, v138
    v_cmp_eq_u32 vcc, -1, v73
    s_cbranch_vccz pd_30
    v_max_u32 v73, v128, v130
    v_cmp_eq_u32 vcc, -1, v73
    s_cbranch_vccz ps_31
    buffer_load_dwordx4 v[128:131], v69, s[4:7], s76 offen offset:0 sc1
ps_31:
    v_max_u32 v73, v132, v134
    v_cmp_eq_u32 vcc, -1, v73
    s_cbranch_vccz ps_32
    buffer_load_dwordx4 v[132:135], v69, s[4:7], s76 offen offset:1024 sc1
ps_32:
    v_max_u32 v73, v136, v138
    v_cmp_eq_u32 vcc, -1, v73
    s_cbranch_vccz ps_33
    buffer_load_dwordx4 v[136:139], v69, s[4:7], s76 offen offset:2048 sc1
ps_33:
    s_sub_u32 s68, s68, 1
    s_cbranch_scc0 ok_34
    s_mov_b32 s69, 22
    s_branch FAIL
ok_34:
    s_branch pl_29
pd_30:
    ds_write_b128 v7, v[128:131] offset:12288
    ds_write_b128 v7, v[132:135] offset:13312
    ds_write_b128 v7, v[136:139] offset:14336
    v_mov_b32 v66, s85
    s_mov_b64 exec, 1
    buffer_store_dword v66, v65, s[4:7], 0 offen
    s_mov_b64 exec, -1
    s_waitcnt lgkmcnt(0)
    s_barrier
    ds_read_b128 v[80:83], v15 offset:12288
    ds_read_b128 v[84:87], v15 offset:13312
    ds_read_b128 v[88:91], v15 offset:14336
    ds_read_b128 v[92:95], v15 offset:15360
    ds_read_b128 v[96:99], v15 offset:16384
    ds_read_b128 v[100:103], v15 offset:17408
    ds_read_b128 v[104:107], v15 offset:18432
    ds_read_b128 v[108:111], v15 offset:19456
    ds_read_b128 v[112:115], v15 offset:20480
    ds_read_b128 v[116:119], v15 offset:21504
    ds_read_b128 v[120:123], v15 offset:22528
    ds_read_b128 v[124:127], v15 offset:23552
    s_waitcnt lgkmcnt(11)
    v_smfmac_f32_16x16x64_bf16 v[56:59], v[80:83], a[160:167], v43
    s_add_u32 s85, s31, 2
    v_cmp_gt_u32 vcc, s85, v72
    s_cbranch_vccz rdy_35
pf_36:
    buffer_load_dword v72, v13, s[4:7], 0 offen sc1
    s_waitcnt vmcnt(0)
    v_cmp_gt_u32 vcc, s85, v72
    s_cbranch_vccz pfd_37
    s_sub_u32 s68, s68, 1
    s_cbranch_scc0 ok_38
    s_mov_b32 s69, 23
    s_branch FAIL
ok_38:
    s_sleep 1
    s_branch pf_36
pfd_37:
rdy_35:
    s_sub_u32 s69, s30, 1
    s_cmp_lt_u32 s69, 2
    s_cbranch_scc1 nr_39
    buffer_store_dwordx4 v[60:63], v76, s[4:7], s77 offen sc1
nr_39:
    s_sub_u32 s69, s30, 1
    s_cmp_ge_u32 s69, 2
    s_cbranch_scc1 nk_40
    buffer_load_dwordx4 v[44:47], v5, s[4:7], s78 offen sc1
    buffer_load_dwordx4 v[48:51], v5, s[4:7], s78 offen offset:1024 sc1
nk_40:
    s_waitcnt lgkmcnt(10)
    v_smfmac_f32_16x16x64_bf16 v[56:59], v[84:87], a[168:175], v43
    s_waitcnt lgkmcnt(9)
    v_smfmac_f32_16x16x64_bf16 v[56:59], v[88:91], a[176:183], v43
    s_waitcnt lgkmcnt(8)
    v_smfmac_f32_16x16x64_bf16 v[56:59], v[92:95], a[184:191], v43
    buffer_load_dwordx4 v[52:55], v5, s[4:7], s79 offen sc1
    buffer_load_dword v72, v13, s[4:7], 0 offen sc1
    s_add_u32 s78, s78, 12288
    s_add_u32 s79, s79, 12288
    s_waitcnt lgkmcnt(7)
    v_smfmac_f32_16x16x64_bf16 v[56:59], v[96:99], a[192:199], v43
    s_waitcnt lgkmcnt(6)
    v_smfmac_f32_16x16x64_bf16 v[56:59], v[100:103], a[200:207], v43
    s_waitcnt lgkmcnt(5)
    v_smfmac_f32_16x16x64_bf16 v[56:59], v[104:107], a[208:215], v43
    s_waitcnt lgkmcnt(4)
    v_smfmac_f32_16x16x64_bf16 v[56:59], v[108:111], a[216:223], v43
    s_waitcnt lgkmcnt(3)
    v_smfmac_f32_16x16x64_bf16 v[56:59], v[112:115], a[224:231], v43
    s_waitcnt lgkmcnt(2)
    v_smfmac_f32_16x16x64_bf16 v[56:59], v[116:119], a[232:239], v43
    s_waitcnt lgkmcnt(1)
    v_smfmac_f32_16x16x64_bf16 v[56:59], v[120:123], a[240:247], v43
    s_waitcnt lgkmcnt(0)
    v_smfmac_f32_16x16x64_bf16 v[56:59], v[124:127], a[248:255], v43
    s_nop 11
    v_permlane32_swap_b32 v56, v58
    v_permlane32_swap_b32 v57, v59
    v_add_f32 v24, v56, v58
    v_add_f32 v25, v57, v59
    v_min_u32 v24, -2, v24
    buffer_store_dwordx2 v[24:25], v11, s[4:7], s76 offen sc1
    s_waitcnt vmcnt(0)
    buffer_load_dwordx4 v[80:83], v8, s[4:7], s76 offen sc1
    buffer_load_dwordx4 v[84:87], v40, s[4:7], s76 offen sc1
    buffer_load_dwordx4 v[88:91], v41, s[4:7], s76 offen sc1
    buffer_load_dwordx4 v[92:95], v42, s[4:7], s76 offen sc1
pl_42:
    s_waitcnt vmcnt(0)
    v_max3_u32 v73, v80, v82, v84
    v_max3_u32 v73, v73, v86, v88
    v_max3_u32 v73, v73, v90, v92
    v_max_u32 v73, v73, v94
    v_cmp_eq_u32 vcc, -1, v73
    s_cbranch_vccz pd_43
    v_max_u32 v73, v80, v82
    v_cmp_eq_u32 vcc, -1, v73
    s_cbranch_vccz ps_44
    buffer_load_dwordx4 v[80:83], v8, s[4:7], s76 offen sc1
ps_44:
    v_max_u32 v73, v84, v86
    v_cmp_eq_u32 vcc, -1, v73
    s_cbranch_vccz ps_45
    buffer_load_dwordx4 v[84:87], v40, s[4:7], s76 offen sc1
ps_45:
    v_max_u32 v73, v88, v90
    v_cmp_eq_u32 vcc, -1, v73
    s_cbranch_vccz ps_46
    buffer_load_dwordx4 v[88:91], v41, s[4:7], s76 offen sc1
ps_46:
    v_max_u32 v73, v92, v94
    v_cmp_eq_u32 vcc, -1, v73
    s_cbranch_vccz ps_47
    buffer_load_dwordx4 v[92:95], v42, s[4:7], s76 offen sc1
ps_47:
    s_sub_u32 s68, s68, 1
    s_cbranch_scc0 ok_48
    s_mov_b32 s69, 24
    s_branch FAIL
ok_48:
    s_branch pl_42
pd_43:
    v_pk_add_f32 v[16:17], v[80:81], v[84:85]
    v_pk_add_f32 v[18:19], v[82:83], v[86:87]
    v_pk_add_f32 v[20:21], v[88:89], v[92:93]
    v_pk_add_f32 v[22:23], v[90:91], v[94:95]
sumd_41:
    v_pk_add_f32 v[16:17], v[16:17], v[20:21]
    v_pk_add_f32 v[18:19], v[18:19], v[22:23]
    s_nop 1
    v_permlane32_swap_b32 v16, v18
    v_permlane32_swap_b32 v17, v19
    v_pk_add_f32 v[16:17], v[16:17], v[24:25]
    v_pk_add_f32 v[16:17], v[16:17], v[18:19]
    v_cvt_pk_bf16_f32 v28, v16, v17
    v_min_u32 v28, -2, v28
    buffer_store_dword v28, v12, s[4:7], s76 offen
    v_mov_b32 v16, 0
    v_mov_b32 v17, 0
    v_mov_b32 v18, 0
    v_mov_b32 v19, 0
    v_mov_b32 v20, 0
    v_mov_b32 v21, 0
    v_mov_b32 v22, 0
    v_mov_b32 v23, 0
    v_mov_b32 v24, 0
    v_mov_b32 v25, 0
    v_mov_b32 v26, 0
    v_mov_b32 v27, 0
    s_barrier
    s_branch h2_28
nowo_27:
    s_waitcnt vmcnt(0)
    v_mov_b32 v66, s85
    s_mov_b64 exec, 1
    buffer_store_dword v66, v65, s[4:7], 0 offen
    s_mov_b64 exec, -1
    s_add_u32 s85, s31, 2
    v_cmp_gt_u32 vcc, s85, v72
    s_cbranch_vccz rdy_49
pf_50:
    buffer_load_dword v72, v13, s[4:7], 0 offen sc1
    s_waitcnt vmcnt(0)
    v_cmp_gt_u32 vcc, s85, v72
    s_cbranch_vccz pfd_51
    s_sub_u32 s68, s68, 1
    s_cbranch_scc0 ok_52
    s_mov_b32 s69, 26
    s_branch FAIL
ok_52:
    s_sleep 1
    s_branch pf_50
pfd_51:
rdy_49:
    s_sub_u32 s69, s30, 1
    s_cmp_ge_u32 s69, 2
    s_cbranch_scc1 nk_53
    buffer_load_dwordx4 v[44:47], v5, s[4:7], s78 offen sc1
    buffer_load_dwordx4 v[48:51], v5, s[4:7], s78 offen offset:1024 sc1
nk_53:
    buffer_load_dwordx4 v[52:55], v5, s[4:7], s79 offen sc1
    buffer_load_dword v72, v13, s[4:7], 0 offen sc1
    s_add_u32 s78, s78, 12288
    s_add_u32 s79, s79, 12288
    v_mov_b32 v16, 0
    v_mov_b32 v17, 0
    v_mov_b32 v18, 0
    v_mov_b32 v19, 0
    v_mov_b32 v20, 0
    v_mov_b32 v21, 0
    v_mov_b32 v22, 0
    v_mov_b32 v23, 0
    v_mov_b32 v24, 0
    v_mov_b32 v25, 0
    v_mov_b32 v26, 0
    v_mov_b32 v27, 0
h2_28:
    buffer_load_dwordx4 v[160:163], v70, s[4:7], s76 offen offset:0 sc1
    buffer_load_dwordx4 v[164:167], v70, s[4:7], s76 offen offset:1024 sc1
    buffer_load_dwordx4 v[168:171], v71, s[4:7], s76 offen sc1
pl_54:
    s_waitcnt vmcnt(0)
    v_max3_u32 v73, v160, v161, v162
    v_max3_u32 v73, v73, v163, v164
    v_max3_u32 v73, v73, v165, v166
    v_max3_u32 v73, v73, v167, v168
    v_max3_u32 v73, v73, v169, v170
    v_max_u32 v73, v73, v171
    v_cmp_eq_u32 vcc, -1, v73
    s_cbranch_vccz pd_55
    v_max3_u32 v73, v160, v161, v162
    v_max_u32 v73, v73, v163
    v_cmp_eq_u32 vcc, -1, v73
    s_cbranch_vccz ps_56
    buffer_load_dwordx4 v[160:163], v70, s[4:7], s76 offen offset:0 sc1
ps_56:
    v_max3_u32 v73, v164, v165, v166
    v_max_u32 v73, v73, v167
    v_cmp_eq_u32 vcc, -1, v73
    s_cbranch_vccz ps_57
    buffer_load_dwordx4 v[164:167], v70, s[4:7], s76 offen offset:1024 sc1
ps_57:
    v_max3_u32 v73, v168, v169, v170
    v_max_u32 v73, v73, v171
    v_cmp_eq_u32 vcc, -1, v73
    s_cbranch_vccz ps_58
    buffer_load_dwordx4 v[168:171], v71, s[4:7], s76 offen sc1
ps_58:
    s_sub_u32 s68, s68, 1
    s_cbranch_scc0 ok_59
    s_mov_b32 s69, 25
    s_branch FAIL
ok_59:
    s_branch pl_54
pd_55:
    ds_write_b128 v9, v[160:163] offset:0
    ds_write_b128 v9, v[164:167] offset:1024
    ds_write_b128 v10, v[168:171] offset:0
    s_add_u32 s31, s31, 1
    s_and_b32 s76, s31, 3
    s_lshl_b32 s76, s76, 19
    s_xor_b32 s77, s76, 1048576
    s_waitcnt lgkmcnt(0)
    s_cmp_lt_u32 s31, 63
    s_cbranch_scc1 cloop_15
    s_barrier
    ds_read_b64_tr_b16 v[80:81], v1 offset:0
    ds_read_b64_tr_b16 v[82:83], v1 offset:256
    ds_read_b64_tr_b16 v[84:85], v1 offset:1024
    ds_read_b64_tr_b16 v[86:87], v1 offset:1280
    ds_read_b64_tr_b16 v[88:89], v1 offset:2048
    ds_read_b64_tr_b16 v[90:91], v1 offset:2304
    ds_read_b64_tr_b16 v[92:93], v1 offset:3072
    ds_read_b64_tr_b16 v[94:95], v1 offset:3328
    ds_read_b64_tr_b16 v[96:97], v1 offset:4096
    ds_read_b64_tr_b16 v[98:99], v1 offset:4352
    ds_read_b64_tr_b16 v[100:101], v1 offset:5120
    ds_read_b64_tr_b16 v[102:103], v1 offset:5376
    s_waitcnt lgkmcnt(10)
    v_smfmac_f32_16x16x64_bf16 v[20:23], v[80:83], a[80:87], v43
    v_smfmac_f32_16x16x64_bf16 v[24:27], v[80:83], v[176:183], v43
    ds_read_b64_tr_b16 v[104:105], v1 offset:6144
    ds_read_b64_tr_b16 v[106:107], v1 offset:6400
    s_waitcnt lgkmcnt(10)
    v_smfmac_f32_16x16x64_bf16 v[20:23], v[84:87], a[88:95], v43
    v_smfmac_f32_16x16x64_bf16 v[24:27], v[84:87], v[184:191], v43
    ds_read_b64_tr_b16 v[108:109], v1 offset:7168
    ds_read_b64_tr_b16 v[110:111], v1 offset:7424
    s_waitcnt lgkmcnt(10)
    v_smfmac_f32_16x16x64_bf16 v[20:23], v[88:91], a[96:103], v43
    v_smfmac_f32_16x16x64_bf16 v[24:27], v[88:91], v[192:199], v43
    ds_read_b64_tr_b16 v[112:113], v1 offset:8192
    ds_read_b64_tr_b16 v[114:115], v1 offset:8448
    s_waitcnt lgkmcnt(10)
    v_smfmac_f32_16x16x64_bf16 v[20:23], v[92:95], a[104:111], v43
    v_smfmac_f32_16x16x64_bf16 v[24:27], v[92:95], v[200:207], v43
    ds_read_b64_tr_b16 v[116:117], v1 offset:9216
    ds_read_b64_tr_b16 v[118:119], v1 offset:9472
    s_waitcnt lgkmcnt(10)
    v_smfmac_f32_16x16x64_bf16 v[20:23], v[96:99], a[112:119], v43
    v_smfmac_f32_16x16x64_bf16 v[24:27], v[96:99], v[208:215], v43
    s_waitcnt lgkmcnt(8)
    v_smfmac_f32_16x16x64_bf16 v[20:23], v[100:103], a[120:127], v43
    v_smfmac_f32_16x16x64_bf16 v[24:27], v[100:103], v[216:223], v43
    s_waitcnt lgkmcnt(6)
    v_smfmac_f32_16x16x64_bf16 v[20:23], v[104:107], a[128:135], v43
    v_smfmac_f32_16x16x64_bf16 v[24:27], v[104:107], v[224:231], v43
    s_waitcnt lgkmcnt(4)
    v_smfmac_f32_16x16x64_bf16 v[20:23], v[108:111], a[136:143], v43
    v_smfmac_f32_16x16x64_bf16 v[24:27], v[108:111], v[232:239], v43
    s_waitcnt lgkmcnt(2)
    v_smfmac_f32_16x16x64_bf16 v[20:23], v[112:115], a[144:151], v43
    v_smfmac_f32_16x16x64_bf16 v[24:27], v[112:115], v[240:247], v43
    s_waitcnt lgkmcnt(0)
    v_smfmac_f32_16x16x64_bf16 v[20:23], v[116:119], a[152:159], v43
    v_smfmac_f32_16x16x64_bf16 v[24:27], v[116:119], v[248:255], v43
    s_nop 10
    v_permlane32_swap_b32 v20, v22
    v_permlane32_swap_b32 v21, v23
    v_add_f32 v20, v20, v22
    v_add_f32 v21, v21, v23
    v_permlane32_swap_b32 v24, v26
    v_permlane32_swap_b32 v25, v27
    v_add_f32 v24, v24, v26
    v_add_f32 v25, v25, v27
    v_cvt_pk_bf16_f32 v30, v20, v21
    v_cvt_pk_bf16_f32 v32, v24, v25
    buffer_store_dword v30, v2, s[4:7], s80 offen
    buffer_store_dword v32, v6, s[4:7], s81 offen
    s_add_u32 s85, s31, 1
    s_waitcnt vmcnt(0)
    v_mov_b32 v66, s85
    s_mov_b64 exec, 1
    buffer_store_dword v66, v65, s[4:7], 0 offen
    s_mov_b64 exec, -1
    s_branch EXIT
ROLE_KF:
    s_mov_b32 s12, s38
    s_mov_b32 s13, s39
    s_mov_b32 s14, 7864320
    s_mov_b32 s15, 0x20000
    s_sub_u32 s73, s29, 12
    s_lshl_b32 s74, s28, 2
    s_add_u32 s74, s74, s73
    s_mul_i32 s69, s30, 10240
    v_lshlrev_b32 v2, 4, v0
    v_add_u32 v2, s69, v2
    buffer_load_dwordx4 v[96:99], v2, s[8:11], 0 offen offset:0
    buffer_load_dwordx4 v[100:103], v2, s[8:11], 0 offen offset:1024
    buffer_load_dwordx4 v[104:107], v2, s[8:11], 0 offen offset:2048
    buffer_load_dwordx4 v[108:111], v2, s[8:11], 0 offen offset:3072
    v_add_u32 v2, 4096, v2
    buffer_load_dwordx4 v[112:115], v2, s[8:11], 0 offen offset:0
    buffer_load_dwordx4 v[116:119], v2, s[8:11], 0 offen offset:1024
    buffer_load_dwordx4 v[120:123], v2, s[8:11], 0 offen offset:2048
    buffer_load_dwordx4 v[124:127], v2, s[8:11], 0 offen offset:3072
    v_add_u32 v2, 4096, v2
    buffer_load_dwordx4 v[128:131], v2, s[8:11], 0 offen offset:0
    buffer_load_dwordx4 v[132:135], v2, s[8:11], 0 offen offset:1024
    v_lshrrev_b32 v2, 3, v0
    v_and_b32 v3, 7, v0
    v_lshrrev_b32 v4, 4, v0
    v_and_b32 v4, 1, v4
    v_lshlrev_b32 v4, 1, v4
    s_and_b32 s69, s30, 1
    s_lshl_b32 s69, s69, 2
    v_or_b32 v4, s69, v4
    v_xor_b32 v3, v3, v4
    v_lshlrev_b32 v3, 4, v3
    s_mov_b32 s69, 12288
    v_mad_u32_u24 v12, v2, s69, v3
    v_lshrrev_b32 v2, 4, v0
    v_bfe_u32 v3, v0, 2, 2
    v_and_b32 v4, 3, v0
    v_lshrrev_b32 v5, 1, v3
    v_and_b32 v6, 1, v2
    v_lshl_or_b32 v5, v6, 1, v5
    v_lshlrev_b32 v5, 1, v5
    v_lshl_add_u32 v6, v2, 3, v3
    s_lshl_b32 s69, s30, 1
    v_lshrrev_b32 v7, 1, v4
    v_or_b32 v7, s69, v7
    v_xor_b32 v7, v7, v5
    v_lshlrev_b32 v7, 4, v7
    v_and_b32 v4, 1, v4
    v_lshl_or_b32 v7, v4, 3, v7
    v_lshl_add_u32 v14, v6, 7, v7
    s_mul_i32 s71, s74, 384
    s_add_u32 s71, s71, 0
    s_mul_i32 s69, s30, 98304
    s_add_u32 s69, s69, s71
    s_lshl_b32 s70, s30, 10
    s_add_u32 m0, s70, 0
    s_nop 0
    buffer_load_dwordx4 v12, s[12:15], s69 offen lds
    s_add_u32 m0, m0, 4096
    s_add_u32 s69, s69, 393216
    buffer_load_dwordx4 v12, s[12:15], s69 offen lds
    s_add_u32 m0, m0, 4096
    s_add_u32 s69, s69, 393216
    buffer_load_dwordx4 v12, s[12:15], s69 offen lds
    s_add_u32 m0, m0, 4096
    s_add_u32 s69, s69, 393216
    buffer_load_dwordx4 v12, s[12:15], s69 offen lds
    s_add_u32 m0, m0, 4096
    s_add_u32 s69, s69, 393216
    buffer_load_dwordx4 v12, s[12:15], s69 offen lds
    s_add_u32 m0, m0, 4096
    s_add_u32 s69, s69, 393216
    buffer_load_dwordx4 v12, s[12:15], s69 offen lds
    s_add_u32 m0, m0, 4096
    s_add_u32 s69, s69, 393216
    buffer_load_dwordx4 v12, s[12:15], s69 offen lds
    s_add_u32 m0, m0, 4096
    s_add_u32 s69, s69, 393216
    buffer_load_dwordx4 v12, s[12:15], s69 offen lds
    s_add_u32 m0, m0, 4096
    s_add_u32 s69, s69, 393216
    buffer_load_dwordx4 v12, s[12:15], s69 offen lds
    s_add_u32 m0, m0, 4096
    s_add_u32 s69, s69, 393216
    buffer_load_dwordx4 v12, s[12:15], s69 offen lds
    s_add_u32 m0, m0, 4096
    s_add_u32 s69, s69, 393216
    buffer_load_dwordx4 v12, s[12:15], s69 offen lds
    s_add_u32 m0, m0, 4096
    s_add_u32 s69, s69, 393216
    buffer_load_dwordx4 v12, s[12:15], s69 offen lds
    s_add_u32 m0, m0, 4096
    s_add_u32 s69, s69, 393216
    buffer_load_dwordx4 v12, s[12:15], s69 offen lds
    s_add_u32 m0, m0, 4096
    s_add_u32 s69, s69, 393216
    buffer_load_dwordx4 v12, s[12:15], s69 offen lds
    s_add_u32 m0, m0, 4096
    s_add_u32 s69, s69, 393216
    buffer_load_dwordx4 v12, s[12:15], s69 offen lds
    s_add_u32 m0, m0, 4096
    s_add_u32 s69, s69, 393216
    buffer_load_dwordx4 v12, s[12:15], s69 offen lds
    s_add_u32 m0, m0, 4096
    s_add_u32 s69, s69, 393216
    buffer_load_dwordx4 v12, s[12:15], s69 offen lds
    s_add_u32 m0, m0, 4096
    s_add_u32 s69, s69, 393216
    buffer_load_dwordx4 v12, s[12:15], s69 offen lds
    s_add_u32 m0, m0, 4096
    s_add_u32 s69, s69, 393216
    buffer_load_dwordx4 v12, s[12:15], s69 offen lds
    s_add_u32 m0, m0, 4096
    s_add_u32 s69, s69, 393216
    buffer_load_dwordx4 v12, s[12:15], s69 offen lds
    s_mul_i32 s71, s74, 384
    s_add_u32 s71, s71, 128
    s_mul_i32 s69, s30, 98304
    s_add_u32 s69, s69, s71
    s_lshl_b32 s70, s30, 10
    s_add_u32 m0, s70, 81920
    s_nop 0
    buffer_load_dwordx4 v12, s[12:15], s69 offen lds
    s_add_u32 m0, m0, 4096
    s_add_u32 s69, s69, 393216
    buffer_load_dwordx4 v12, s[12:15], s69 offen lds
    s_add_u32 m0, m0, 4096
    s_add_u32 s69, s69, 393216
    buffer_load_dwordx4 v12, s[12:15], s69 offen lds
    s_add_u32 m0, m0, 4096
    s_add_u32 s69, s69, 393216
    buffer_load_dwordx4 v12, s[12:15], s69 offen lds
    s_add_u32 m0, m0, 4096
    s_add_u32 s69, s69, 393216
    buffer_load_dwordx4 v12, s[12:15], s69 offen lds
    s_add_u32 m0, m0, 4096
    s_add_u32 s69, s69, 393216
    buffer_load_dwordx4 v12, s[12:15], s69 offen lds
    s_add_u32 m0, m0, 4096
    s_add_u32 s69, s69, 393216
    buffer_load_dwordx4 v12, s[12:15], s69 offen lds
    s_add_u32 m0, m0, 4096
    s_add_u32 s69, s69, 393216
    buffer_load_dwordx4 v12, s[12:15], s69 offen lds
    s_add_u32 m0, m0, 4096
    s_add_u32 s69, s69, 393216
    buffer_load_dwordx4 v12, s[12:15], s69 offen lds
    s_add_u32 m0, m0, 4096
    s_add_u32 s69, s69, 393216
    buffer_load_dwordx4 v12, s[12:15], s69 offen lds
    s_add_u32 m0, m0, 4096
    s_add_u32 s69, s69, 393216
    buffer_load_dwordx4 v12, s[12:15], s69 offen lds
    s_add_u32 m0, m0, 4096
    s_add_u32 s69, s69, 393216
    buffer_load_dwordx4 v12, s[12:15], s69 offen lds
    s_add_u32 m0, m0, 4096
    s_add_u32 s69, s69, 393216
    buffer_load_dwordx4 v12, s[12:15], s69 offen lds
    s_add_u32 m0, m0, 4096
    s_add_u32 s69, s69, 393216
    buffer_load_dwordx4 v12, s[12:15], s69 offen lds
    s_add_u32 m0, m0, 4096
    s_add_u32 s69, s69, 393216
    buffer_load_dwordx4 v12, s[12:15], s69 offen lds
    s_add_u32 m0, m0, 4096
    s_add_u32 s69, s69, 393216
    buffer_load_dwordx4 v12, s[12:15], s69 offen lds
    s_add_u32 m0, m0, 4096
    s_add_u32 s69, s69, 393216
    buffer_load_dwordx4 v12, s[12:15], s69 offen lds
    s_add_u32 m0, m0, 4096
    s_add_u32 s69, s69, 393216
    buffer_load_dwordx4 v12, s[12:15], s69 offen lds
    s_add_u32 m0, m0, 4096
    s_add_u32 s69, s69, 393216
    buffer_load_dwordx4 v12, s[12:15], s69 offen lds
    s_add_u32 m0, m0, 4096
    s_add_u32 s69, s69, 393216
    buffer_load_dwordx4 v12, s[12:15], s69 offen lds
    s_waitcnt vmcnt(20)
    s_barrier
    v_add_u32 v9, 0, v14
    ds_read_b64_tr_b16 a[0:1], v9 offset:0
    ds_read_b64_tr_b16 a[2:3], v9 offset:512
    ds_read_b64_tr_b16 a[4:5], v9 offset:4096
    ds_read_b64_tr_b16 a[6:7], v9 offset:4608
    ds_read_b64_tr_b16 a[8:9], v9 offset:8192
    ds_read_b64_tr_b16 a[10:11], v9 offset:8704
    ds_read_b64_tr_b16 a[12:13], v9 offset:12288
    ds_read_b64_tr_b16 a[14:15], v9 offset:12800
    ds_read_b64_tr_b16 a[16:17], v9 offset:16384
    ds_read_b64_tr_b16 a[18:19], v9 offset:16896
    ds_read_b64_tr_b16 a[20:21], v9 offset:20480
    ds_read_b64_tr_b16 a[22:23], v9 offset:20992
    s_waitcnt lgkmcnt(0)
    ds_read_b64_tr_b16 a[24:25], v9 offset:24576
    ds_read_b64_tr_b16 a[26:27], v9 offset:25088
    ds_read_b64_tr_b16 a[28:29], v9 offset:28672
    ds_read_b64_tr_b16 a[30:31], v9 offset:29184
    ds_read_b64_tr_b16 a[32:33], v9 offset:32768
    ds_read_b64_tr_b16 a[34:35], v9 offset:33280
    ds_read_b64_tr_b16 a[36:37], v9 offset:36864
    ds_read_b64_tr_b16 a[38:39], v9 offset:37376
    s_waitcnt lgkmcnt(0)
    v_add_u32 v9, 40960, v14
    ds_read_b64_tr_b16 a[40:41], v9 offset:0
    ds_read_b64_tr_b16 a[42:43], v9 offset:512
    ds_read_b64_tr_b16 a[44:45], v9 offset:4096
    ds_read_b64_tr_b16 a[46:47], v9 offset:4608
    ds_read_b64_tr_b16 a[48:49], v9 offset:8192
    ds_read_b64_tr_b16 a[50:51], v9 offset:8704
    ds_read_b64_tr_b16 a[52:53], v9 offset:12288
    ds_read_b64_tr_b16 a[54:55], v9 offset:12800
    ds_read_b64_tr_b16 a[56:57], v9 offset:16384
    ds_read_b64_tr_b16 a[58:59], v9 offset:16896
    ds_read_b64_tr_b16 a[60:61], v9 offset:20480
    ds_read_b64_tr_b16 a[62:63], v9 offset:20992
    s_waitcnt lgkmcnt(0)
    ds_read_b64_tr_b16 a[64:65], v9 offset:24576
    ds_read_b64_tr_b16 a[66:67], v9 offset:25088
    ds_read_b64_tr_b16 a[68:69], v9 offset:28672
    ds_read_b64_tr_b16 a[70:71], v9 offset:29184
    ds_read_b64_tr_b16 a[72:73], v9 offset:32768
    ds_read_b64_tr_b16 a[74:75], v9 offset:33280
    ds_read_b64_tr_b16 a[76:77], v9 offset:36864
    ds_read_b64_tr_b16 a[78:79], v9 offset:37376
    s_waitcnt lgkmcnt(0)
    s_barrier
    s_mul_i32 s71, s74, 384
    s_add_u32 s71, s71, 256
    s_mul_i32 s69, s30, 98304
    s_add_u32 s69, s69, s71
    s_lshl_b32 s70, s30, 10
    s_add_u32 m0, s70, 0
    s_nop 0
    buffer_load_dwordx4 v12, s[12:15], s69 offen lds
    s_add_u32 m0, m0, 4096
    s_add_u32 s69, s69, 393216
    buffer_load_dwordx4 v12, s[12:15], s69 offen lds
    s_add_u32 m0, m0, 4096
    s_add_u32 s69, s69, 393216
    buffer_load_dwordx4 v12, s[12:15], s69 offen lds
    s_add_u32 m0, m0, 4096
    s_add_u32 s69, s69, 393216
    buffer_load_dwordx4 v12, s[12:15], s69 offen lds
    s_add_u32 m0, m0, 4096
    s_add_u32 s69, s69, 393216
    buffer_load_dwordx4 v12, s[12:15], s69 offen lds
    s_add_u32 m0, m0, 4096
    s_add_u32 s69, s69, 393216
    buffer_load_dwordx4 v12, s[12:15], s69 offen lds
    s_add_u32 m0, m0, 4096
    s_add_u32 s69, s69, 393216
    buffer_load_dwordx4 v12, s[12:15], s69 offen lds
    s_add_u32 m0, m0, 4096
    s_add_u32 s69, s69, 393216
    buffer_load_dwordx4 v12, s[12:15], s69 offen lds
    s_add_u32 m0, m0, 4096
    s_add_u32 s69, s69, 393216
    buffer_load_dwordx4 v12, s[12:15], s69 offen lds
    s_add_u32 m0, m0, 4096
    s_add_u32 s69, s69, 393216
    buffer_load_dwordx4 v12, s[12:15], s69 offen lds
    s_add_u32 m0, m0, 4096
    s_add_u32 s69, s69, 393216
    buffer_load_dwordx4 v12, s[12:15], s69 offen lds
    s_add_u32 m0, m0, 4096
    s_add_u32 s69, s69, 393216
    buffer_load_dwordx4 v12, s[12:15], s69 offen lds
    s_add_u32 m0, m0, 4096
    s_add_u32 s69, s69, 393216
    buffer_load_dwordx4 v12, s[12:15], s69 offen lds
    s_add_u32 m0, m0, 4096
    s_add_u32 s69, s69, 393216
    buffer_load_dwordx4 v12, s[12:15], s69 offen lds
    s_add_u32 m0, m0, 4096
    s_add_u32 s69, s69, 393216
    buffer_load_dwordx4 v12, s[12:15], s69 offen lds
    s_add_u32 m0, m0, 4096
    s_add_u32 s69, s69, 393216
    buffer_load_dwordx4 v12, s[12:15], s69 offen lds
    s_add_u32 m0, m0, 4096
    s_add_u32 s69, s69, 393216
    buffer_load_dwordx4 v12, s[12:15], s69 offen lds
    s_add_u32 m0, m0, 4096
    s_add_u32 s69, s69, 393216
    buffer_load_dwordx4 v12, s[12:15], s69 offen lds
    s_add_u32 m0, m0, 4096
    s_add_u32 s69, s69, 393216
    buffer_load_dwordx4 v12, s[12:15], s69 offen lds
    s_add_u32 m0, m0, 4096
    s_add_u32 s69, s69, 393216
    buffer_load_dwordx4 v12, s[12:15], s69 offen lds
    s_waitcnt vmcnt(20)
    s_barrier
    v_add_u32 v9, 81920, v14
    ds_read_b64_tr_b16 a[80:81], v9 offset:0
    ds_read_b64_tr_b16 a[82:83], v9 offset:512
    ds_read_b64_tr_b16 a[84:85], v9 offset:4096
    ds_read_b64_tr_b16 a[86:87], v9 offset:4608
    ds_read_b64_tr_b16 a[88:89], v9 offset:8192
    ds_read_b64_tr_b16 a[90:91], v9 offset:8704
    ds_read_b64_tr_b16 a[92:93], v9 offset:12288
    ds_read_b64_tr_b16 a[94:95], v9 offset:12800
    ds_read_b64_tr_b16 a[96:97], v9 offset:16384
    ds_read_b64_tr_b16 a[98:99], v9 offset:16896
    ds_read_b64_tr_b16 a[100:101], v9 offset:20480
    ds_read_b64_tr_b16 a[102:103], v9 offset:20992
    s_waitcnt lgkmcnt(0)
    ds_read_b64_tr_b16 a[104:105], v9 offset:24576
    ds_read_b64_tr_b16 a[106:107], v9 offset:25088
    ds_read_b64_tr_b16 a[108:109], v9 offset:28672
    ds_read_b64_tr_b16 a[110:111], v9 offset:29184
    ds_read_b64_tr_b16 a[112:113], v9 offset:32768
    ds_read_b64_tr_b16 a[114:115], v9 offset:33280
    ds_read_b64_tr_b16 a[116:117], v9 offset:36864
    ds_read_b64_tr_b16 a[118:119], v9 offset:37376
    s_waitcnt lgkmcnt(0)
    v_add_u32 v9, 122880, v14
    ds_read_b64_tr_b16 a[120:121], v9 offset:0
    ds_read_b64_tr_b16 a[122:123], v9 offset:512
    ds_read_b64_tr_b16 a[124:125], v9 offset:4096
    ds_read_b64_tr_b16 a[126:127], v9 offset:4608
    ds_read_b64_tr_b16 a[128:129], v9 offset:8192
    ds_read_b64_tr_b16 a[130:131], v9 offset:8704
    ds_read_b64_tr_b16 a[132:133], v9 offset:12288
    ds_read_b64_tr_b16 a[134:135], v9 offset:12800
    ds_read_b64_tr_b16 a[136:137], v9 offset:16384
    ds_read_b64_tr_b16 a[138:139], v9 offset:16896
    ds_read_b64_tr_b16 a[140:141], v9 offset:20480
    ds_read_b64_tr_b16 a[142:143], v9 offset:20992
    s_waitcnt lgkmcnt(0)
    ds_read_b64_tr_b16 a[144:145], v9 offset:24576
    ds_read_b64_tr_b16 a[146:147], v9 offset:25088
    ds_read_b64_tr_b16 a[148:149], v9 offset:28672
    ds_read_b64_tr_b16 a[150:151], v9 offset:29184
    ds_read_b64_tr_b16 a[152:153], v9 offset:32768
    ds_read_b64_tr_b16 a[154:155], v9 offset:33280
    ds_read_b64_tr_b16 a[156:157], v9 offset:36864
    ds_read_b64_tr_b16 a[158:159], v9 offset:37376
    s_waitcnt lgkmcnt(0)
    s_barrier
    s_waitcnt vmcnt(0)
    s_barrier
    v_add_u32 v9, 0, v14
    ds_read_b64_tr_b16 a[160:161], v9 offset:0
    ds_read_b64_tr_b16 a[162:163], v9 offset:512
    ds_read_b64_tr_b16 a[164:165], v9 offset:4096
    ds_read_b64_tr_b16 a[166:167], v9 offset:4608
    ds_read_b64_tr_b16 a[168:169], v9 offset:8192
    ds_read_b64_tr_b16 a[170:171], v9 offset:8704
    ds_read_b64_tr_b16 a[172:173], v9 offset:12288
    ds_read_b64_tr_b16 a[174:175], v9 offset:12800
    ds_read_b64_tr_b16 a[176:177], v9 offset:16384
    ds_read_b64_tr_b16 a[178:179], v9 offset:16896
    ds_read_b64_tr_b16 a[180:181], v9 offset:20480
    ds_read_b64_tr_b16 a[182:183], v9 offset:20992
    s_waitcnt lgkmcnt(0)
    ds_read_b64_tr_b16 a[184:185], v9 offset:24576
    ds_read_b64_tr_b16 a[186:187], v9 offset:25088
    ds_read_b64_tr_b16 a[188:189], v9 offset:28672
    ds_read_b64_tr_b16 a[190:191], v9 offset:29184
    ds_read_b64_tr_b16 a[192:193], v9 offset:32768
    ds_read_b64_tr_b16 a[194:195], v9 offset:33280
    ds_read_b64_tr_b16 a[196:197], v9 offset:36864
    ds_read_b64_tr_b16 a[198:199], v9 offset:37376
    s_waitcnt lgkmcnt(0)
    v_add_u32 v9, 40960, v14
    ds_read_b64_tr_b16 a[200:201], v9 offset:0
    ds_read_b64_tr_b16 a[202:203], v9 offset:512
    ds_read_b64_tr_b16 a[204:205], v9 offset:4096
    ds_read_b64_tr_b16 a[206:207], v9 offset:4608
    ds_read_b64_tr_b16 a[208:209], v9 offset:8192
    ds_read_b64_tr_b16 a[210:211], v9 offset:8704
    ds_read_b64_tr_b16 a[212:213], v9 offset:12288
    ds_read_b64_tr_b16 a[214:215], v9 offset:12800
    ds_read_b64_tr_b16 a[216:217], v9 offset:16384
    ds_read_b64_tr_b16 a[218:219], v9 offset:16896
    ds_read_b64_tr_b16 a[220:221], v9 offset:20480
    ds_read_b64_tr_b16 a[222:223], v9 offset:20992
    s_waitcnt lgkmcnt(0)
    ds_read_b64_tr_b16 a[224:225], v9 offset:24576
    ds_read_b64_tr_b16 a[226:227], v9 offset:25088
    ds_read_b64_tr_b16 a[228:229], v9 offset:28672
    ds_read_b64_tr_b16 a[230:231], v9 offset:29184
    ds_read_b64_tr_b16 a[232:233], v9 offset:32768
    ds_read_b64_tr_b16 a[234:235], v9 offset:33280
    ds_read_b64_tr_b16 a[236:237], v9 offset:36864
    ds_read_b64_tr_b16 a[238:239], v9 offset:37376
    s_waitcnt lgkmcnt(0)
    s_barrier
    v_mov_b32 v2, 128
wa_60:
    buffer_load_dword v3, v2, s[64:67], 0 offen sc1
    s_waitcnt vmcnt(0)
    v_cmp_ne_u32 vcc, 0x100, v3
    s_cbranch_vccz wad_61
    s_sub_u32 s68, s68, 1
    s_cbranch_scc0 ok_62
    s_mov_b32 s69, 1
    s_branch FAIL
ok_62:
    s_sleep 4
    s_branch wa_60
wad_61:
    v_and_b32 v2, 7, v0
    v_lshlrev_b32 v2, 2, v2
    buffer_load_dword v3, v2, s[64:67], 0 offen sc1
    s_waitcnt vmcnt(0)
    v_cmp_ne_u32 vcc, 32, v3
    s_cbranch_vccnz SAFEENTRY
    v_and_b32 v2, 15, v0
    v_lshrrev_b32 v3, 4, v0
    s_and_b32 s69, s30, 1
    s_lshl_b32 s69, s69, 4
    v_add_u32 v2, s69, v2
    s_mov_b32 s69, 1280
    v_mul_u32_u24 v2, s69, v2
    s_lshr_b32 s69, s30, 1
    s_mul_i32 s69, s69, 640
    v_lshl_add_u32 v2, v3, 4, v2
    v_add_u32 v10, s69, v2
    v_lshlrev_b32 v11, 4, v0
    s_lshr_b32 s69, s30, 1
    s_lshl_b32 s69, s69, 10
    s_and_b32 s70, s30, 1
    s_lshl_b32 s70, s70, 3
    s_add_u32 s69, s69, s70
    v_add_u32 v12, s69, v11
    s_lshl_b32 s69, s74, 7
    s_lshl_b32 s70, s30, 2
    s_add_u32 s69, s69, s70
    s_add_u32 s69, s69, 2097152
    v_mov_b32 v13, s69
    s_mul_i32 s75, s74, 786432
    s_add_u32 s75, s75, 4194304
    s_mov_b32 s31, 0
    s_mov_b32 s76, 0
    s_mul_i32 s69, s31, 40960
    s_and_b32 s70, s30, 1
    s_mul_i32 s70, s70, 20
    s_lshr_b32 s71, s30, 1
    s_mul_i32 s71, s71, 10
    s_add_u32 s70, s70, s71
    s_lshl_b32 s70, s70, 10
    s_add_u32 m0, s70, s76
    s_nop 0
    buffer_load_dwordx4 v10, s[8:11], s69 offen offset:0 lds
    s_add_u32 m0, m0, 960
    s_nop 0
    buffer_load_dwordx4 v10, s[8:11], s69 offen offset:64 lds
    s_add_u32 m0, m0, 960
    s_nop 0
    buffer_load_dwordx4 v10, s[8:11], s69 offen offset:128 lds
    s_add_u32 m0, m0, 960
    s_nop 0
    buffer_load_dwordx4 v10, s[8:11], s69 offen offset:192 lds
    s_add_u32 m0, m0, 960
    s_nop 0
    buffer_load_dwordx4 v10, s[8:11], s69 offen offset:256 lds
    s_add_u32 m0, m0, 960
    s_nop 0
    buffer_load_dwordx4 v10, s[8:11], s69 offen offset:320 lds
    s_add_u32 m0, m0, 960
    s_nop 0
    buffer_load_dwordx4 v10, s[8:11], s69 offen offset:384 lds
    s_add_u32 m0, m0, 960
    s_nop 0
    buffer_load_dwordx4 v10, s[8:11], s69 offen offset:448 lds
    s_add_u32 m0, m0, 960
    s_nop 0
    buffer_load_dwordx4 v10, s[8:11], s69 offen offset:512 lds
    s_add_u32 m0, m0, 960
    s_nop 0
    buffer_load_dwordx4 v10, s[8:11], s69 offen offset:576 lds
    s_waitcnt vmcnt(0)
kvloop_63:
    s_barrier
    v_add_u32 v14, s76, v11
    s_xor_b32 s76, s76, 40960
    s_add_u32 s77, s31, 1
    s_mul_i32 s78, s77, 40960
    s_and_b32 s70, s30, 1
    s_mul_i32 s70, s70, 20
    s_lshr_b32 s71, s30, 1
    s_mul_i32 s71, s71, 10
    s_add_u32 s70, s70, s71
    s_lshl_b32 s70, s70, 10
    s_add_u32 m0, s70, s76
    ds_read_b128 v[16:19], v14 offset:0
    ds_read_b128 v[20:23], v14 offset:1024
    ds_read_b128 v[24:27], v14 offset:2048
    ds_read_b128 v[28:31], v14 offset:3072
    ds_read_b128 v[32:35], v14 offset:4096
    s_waitcnt lgkmcnt(4)
    v_mfma_f32_16x16x32_bf16 v[40:43], a[0:3], v[16:19], 0
    v_mfma_f32_16x16x32_bf16 v[48:51], a[80:83], v[16:19], 0
    v_mfma_f32_16x16x32_bf16 v[56:59], a[160:163], v[16:19], 0
    buffer_load_dwordx4 v10, s[8:11], s78 offen offset:0 lds
    s_add_u32 m0, m0, 960
    ds_read_b128 v[36:39], v14 offset:5120
    s_waitcnt lgkmcnt(4)
    v_mfma_f32_16x16x32_bf16 v[40:43], a[4:7], v[20:23], v[40:43]
    v_mfma_f32_16x16x32_bf16 v[48:51], a[84:87], v[20:23], v[48:51]
    v_mfma_f32_16x16x32_bf16 v[56:59], a[164:167], v[20:23], v[56:59]
    ds_read_b128 v[16:19], v14 offset:6144
    s_waitcnt lgkmcnt(4)
    v_mfma_f32_16x16x32_bf16 v[40:43], a[8:11], v[24:27], v[40:43]
    v_mfma_f32_16x16x32_bf16 v[48:51], a[88:91], v[24:27], v[48:51]
    v_mfma_f32_16x16x32_bf16 v[56:59], a[168:171], v[24:27], v[56:59]
    ds_read_b128 v[20:23], v14 offset:7168
    s_waitcnt lgkmcnt(4)
    v_mfma_f32_16x16x32_bf16 v[40:43], a[12:15], v[28:31], v[40:43]
    v_mfma_f32_16x16x32_bf16 v[48:51], a[92:95], v[28:31], v[48:51]
    v_mfma_f32_16x16x32_bf16 v[56:59], a[172:175], v[28:31], v[56:59]
    buffer_load_dwordx4 v10, s[8:11], s78 offen offset:64 lds
    s_add_u32 m0, m0, 960
    ds_read_b128 v[24:27], v14 offset:8192
    s_waitcnt lgkmcnt(4)
    v_mfma_f32_16x16x32_bf16 v[40:43], a[16:19], v[32:35], v[40:43]
    v_mfma_f32_16x16x32_bf16 v[48:51], a[96:99], v[32:35], v[48:51]
    v_mfma_f32_16x16x32_bf16 v[56:59], a[176:179], v[32:35], v[56:59]
    ds_read_b128 v[28:31], v14 offset:9216
    s_waitcnt lgkmcnt(4)
    v_mfma_f32_16x16x32_bf16 v[40:43], a[20:23], v[36:39], v[40:43]
    v_mfma_f32_16x16x32_bf16 v[48:51], a[100:103], v[36:39], v[48:51]
    v_mfma_f32_16x16x32_bf16 v[56:59], a[180:183], v[36:39], v[56:59]
    ds_read_b128 v[32:35], v14 offset:10240
    s_waitcnt lgkmcnt(4)
    v_mfma_f32_16x16x32_bf16 v[40:43], a[24:27], v[16:19], v[40:43]
    v_mfma_f32_16x16x32_bf16 v[48:51], a[104:107], v[16:19], v[48:51]
    v_mfma_f32_16x16x32_bf16 v[56:59], a[184:187], v[16:19], v[56:59]
    buffer_load_dwordx4 v10, s[8:11], s78 offen offset:128 lds
    s_add_u32 m0, m0, 960
    ds_read_b128 v[36:39], v14 offset:11264
    s_waitcnt lgkmcnt(4)
    v_mfma_f32_16x16x32_bf16 v[40:43], a[28:31], v[20:23], v[40:43]
    v_mfma_f32_16x16x32_bf16 v[48:51], a[108:111], v[20:23], v[48:51]
    v_mfma_f32_16x16x32_bf16 v[56:59], a[188:191], v[20:23], v[56:59]
    ds_read_b128 v[16:19], v14 offset:12288
    s_waitcnt lgkmcnt(4)
    v_mfma_f32_16x16x32_bf16 v[40:43], a[32:35], v[24:27], v[40:43]
    v_mfma_f32_16x16x32_bf16 v[48:51], a[112:115], v[24:27], v[48:51]
    v_mfma_f32_16x16x32_bf16 v[56:59], a[192:195], v[24:27], v[56:59]
    ds_read_b128 v[20:23], v14 offset:13312
    s_waitcnt lgkmcnt(4)
    v_mfma_f32_16x16x32_bf16 v[40:43], a[36:39], v[28:31], v[40:43]
    v_mfma_f32_16x16x32_bf16 v[48:51], a[116:119], v[28:31], v[48:51]
    v_mfma_f32_16x16x32_bf16 v[56:59], a[196:199], v[28:31], v[56:59]
    buffer_load_dwordx4 v10, s[8:11], s78 offen offset:192 lds
    s_add_u32 m0, m0, 960
    ds_read_b128 v[24:27], v14 offset:14336
    s_waitcnt lgkmcnt(4)
    v_mfma_f32_16x16x32_bf16 v[40:43], a[40:43], v[32:35], v[40:43]
    v_mfma_f32_16x16x32_bf16 v[48:51], a[120:123], v[32:35], v[48:51]
    v_mfma_f32_16x16x32_bf16 v[56:59], a[200:203], v[32:35], v[56:59]
    ds_read_b128 v[28:31], v14 offset:15360
    s_waitcnt lgkmcnt(4)
    v_mfma_f32_16x16x32_bf16 v[40:43], a[44:47], v[36:39], v[40:43]
    v_mfma_f32_16x16x32_bf16 v[48:51], a[124:127], v[36:39], v[48:51]
    v_mfma_f32_16x16x32_bf16 v[56:59], a[204:207], v[36:39], v[56:59]
    ds_read_b128 v[32:35], v14 offset:16384
    s_waitcnt lgkmcnt(4)
    v_mfma_f32_16x16x32_bf16 v[40:43], a[48:51], v[16:19], v[40:43]
    v_mfma_f32_16x16x32_bf16 v[48:51], a[128:131], v[16:19], v[48:51]
    v_mfma_f32_16x16x32_bf16 v[56:59], a[208:211], v[16:19], v[56:59]
    buffer_load_dwordx4 v10, s[8:11], s78 offen offset:256 lds
    s_add_u32 m0, m0, 960
    ds_read_b128 v[36:39], v14 offset:17408
    s_waitcnt lgkmcnt(4)
    v_mfma_f32_16x16x32_bf16 v[40:43], a[52:55], v[20:23], v[40:43]
    v_mfma_f32_16x16x32_bf16 v[48:51], a[132:135], v[20:23], v[48:51]
    v_mfma_f32_16x16x32_bf16 v[56:59], a[212:215], v[20:23], v[56:59]
    ds_read_b128 v[16:19], v14 offset:18432
    s_waitcnt lgkmcnt(4)
    v_mfma_f32_16x16x32_bf16 v[40:43], a[56:59], v[24:27], v[40:43]
    v_mfma_f32_16x16x32_bf16 v[48:51], a[136:139], v[24:27], v[48:51]
    v_mfma_f32_16x16x32_bf16 v[56:59], a[216:219], v[24:27], v[56:59]
    ds_read_b128 v[20:23], v14 offset:19456
    s_waitcnt lgkmcnt(4)
    v_mfma_f32_16x16x32_bf16 v[40:43], a[60:63], v[28:31], v[40:43]
    v_mfma_f32_16x16x32_bf16 v[48:51], a[140:143], v[28:31], v[48:51]
    v_mfma_f32_16x16x32_bf16 v[56:59], a[220:223], v[28:31], v[56:59]
    buffer_load_dwordx4 v10, s[8:11], s78 offen offset:320 lds
    s_add_u32 m0, m0, 960
    ds_read_b128 v[24:27], v14 offset:20480
    s_waitcnt lgkmcnt(4)
    v_mfma_f32_16x16x32_bf16 v[40:43], a[64:67], v[32:35], v[40:43]
    v_mfma_f32_16x16x32_bf16 v[48:51], a[144:147], v[32:35], v[48:51]
    v_mfma_f32_16x16x32_bf16 v[56:59], a[224:227], v[32:35], v[56:59]
    ds_read_b128 v[28:31], v14 offset:21504
    s_waitcnt lgkmcnt(4)
    v_mfma_f32_16x16x32_bf16 v[40:43], a[68:71], v[36:39], v[40:43]
    v_mfma_f32_16x16x32_bf16 v[48:51], a[148:151], v[36:39], v[48:51]
    v_mfma_f32_16x16x32_bf16 v[56:59], a[228:231], v[36:39], v[56:59]
    ds_read_b128 v[32:35], v14 offset:22528
    s_waitcnt lgkmcnt(4)
    v_mfma_f32_16x16x32_bf16 v[40:43], a[72:75], v[16:19], v[40:43]
    v_mfma_f32_16x16x32_bf16 v[48:51], a[152:155], v[16:19], v[48:51]
    v_mfma_f32_16x16x32_bf16 v[56:59], a[232:235], v[16:19], v[56:59]
    buffer_load_dwordx4 v10, s[8:11], s78 offen offset:384 lds
    s_add_u32 m0, m0, 960
    ds_read_b128 v[36:39], v14 offset:23552
    s_waitcnt lgkmcnt(4)
    v_mfma_f32_16x16x32_bf16 v[40:43], a[76:79], v[20:23], v[40:43]
    v_mfma_f32_16x16x32_bf16 v[48:51], a[156:159], v[20:23], v[48:51]
    v_mfma_f32_16x16x32_bf16 v[56:59], a[236:239], v[20:23], v[56:59]
    ds_read_b128 v[16:19], v14 offset:24576
    s_waitcnt lgkmcnt(4)
    v_mfma_f32_16x16x32_bf16 v[44:47], a[0:3], v[24:27], 0
    v_mfma_f32_16x16x32_bf16 v[52:55], a[80:83], v[24:27], 0
    v_mfma_f32_16x16x32_bf16 v[60:63], a[160:163], v[24:27], 0
    ds_read_b128 v[20:23], v14 offset:25600
    s_waitcnt lgkmcnt(4)
    v_mfma_f32_16x16x32_bf16 v[44:47], a[4:7], v[28:31], v[44:47]
    v_mfma_f32_16x16x32_bf16 v[52:55], a[84:87], v[28:31], v[52:55]
    v_mfma_f32_16x16x32_bf16 v[60:63], a[164:167], v[28:31], v[60:63]
    buffer_load_dwordx4 v10, s[8:11], s78 offen offset:448 lds
    s_add_u32 m0, m0, 960
    ds_read_b128 v[24:27], v14 offset:26624
    s_waitcnt lgkmcnt(4)
    v_mfma_f32_16x16x32_bf16 v[44:47], a[8:11], v[32:35], v[44:47]
    v_mfma_f32_16x16x32_bf16 v[52:55], a[88:91], v[32:35], v[52:55]
    v_mfma_f32_16x16x32_bf16 v[60:63], a[168:171], v[32:35], v[60:63]
    ds_read_b128 v[28:31], v14 offset:27648
    s_waitcnt lgkmcnt(4)
    v_mfma_f32_16x16x32_bf16 v[44:47], a[12:15], v[36:39], v[44:47]
    v_mfma_f32_16x16x32_bf16 v[52:55], a[92:95], v[36:39], v[52:55]
    v_mfma_f32_16x16x32_bf16 v[60:63], a[172:175], v[36:39], v[60:63]
    ds_read_b128 v[32:35], v14 offset:28672
    s_waitcnt lgkmcnt(4)
    v_mfma_f32_16x16x32_bf16 v[44:47], a[16:19], v[16:19], v[44:47]
    v_mfma_f32_16x16x32_bf16 v[52:55], a[96:99], v[16:19], v[52:55]
    v_mfma_f32_16x16x32_bf16 v[60:63], a[176:179], v[16:19], v[60:63]
    buffer_load_dwordx4 v10, s[8:11], s78 offen offset:512 lds
    s_add_u32 m0, m0, 960
    ds_read_b128 v[36:39], v14 offset:29696
    s_waitcnt lgkmcnt(4)
    v_mfma_f32_16x16x32_bf16 v[44:47], a[20:23], v[20:23], v[44:47]
    v_mfma_f32_16x16x32_bf16 v[52:55], a[100:103], v[20:23], v[52:55]
    v_mfma_f32_16x16x32_bf16 v[60:63], a[180:183], v[20:23], v[60:63]
    ds_read_b128 v[16:19], v14 offset:30720
    s_waitcnt lgkmcnt(4)
    v_mfma_f32_16x16x32_bf16 v[44:47], a[24:27], v[24:27], v[44:47]
    v_mfma_f32_16x16x32_bf16 v[52:55], a[104:107], v[24:27], v[52:55]
    v_mfma_f32_16x16x32_bf16 v[60:63], a[184:187], v[24:27], v[60:63]
    ds_read_b128 v[20:23], v14 offset:31744
    s_waitcnt lgkmcnt(4)
    v_mfma_f32_16x16x32_bf16 v[44:47], a[28:31], v[28:31], v[44:47]
    v_mfma_f32_16x16x32_bf16 v[52:55], a[108:111], v[28:31], v[52:55]
    v_mfma_f32_16x16x32_bf16 v[60:63], a[188:191], v[28:31], v[60:63]
    buffer_load_dwordx4 v10, s[8:11], s78 offen offset:576 lds
    s_add_u32 m0, m0, 960
    ds_read_b128 v[24:27], v14 offset:32768
    s_waitcnt lgkmcnt(4)
    v_mfma_f32_16x16x32_bf16 v[44:47], a[32:35], v[32:35], v[44:47]
    v_mfma_f32_16x16x32_bf16 v[52:55], a[112:115], v[32:35], v[52:55]
    v_mfma_f32_16x16x32_bf16 v[60:63], a[192:195], v[32:35], v[60:63]
    ds_read_b128 v[28:31], v14 offset:33792
    s_waitcnt lgkmcnt(4)
    v_mfma_f32_16x16x32_bf16 v[44:47], a[36:39], v[36:39], v[44:47]
    v_mfma_f32_16x16x32_bf16 v[52:55], a[116:119], v[36:39], v[52:55]
    v_mfma_f32_16x16x32_bf16 v[60:63], a[196:199], v[36:39], v[60:63]
    ds_read_b128 v[32:35], v14 offset:34816
    s_waitcnt lgkmcnt(4)
    v_mfma_f32_16x16x32_bf16 v[44:47], a[40:43], v[16:19], v[44:47]
    v_mfma_f32_16x16x32_bf16 v[52:55], a[120:123], v[16:19], v[52:55]
    v_mfma_f32_16x16x32_bf16 v[60:63], a[200:203], v[16:19], v[60:63]
    ds_read_b128 v[36:39], v14 offset:35840
    s_waitcnt lgkmcnt(4)
    v_mfma_f32_16x16x32_bf16 v[44:47], a[44:47], v[20:23], v[44:47]
    v_mfma_f32_16x16x32_bf16 v[52:55], a[124:127], v[20:23], v[52:55]
    v_mfma_f32_16x16x32_bf16 v[60:63], a[204:207], v[20:23], v[60:63]
    ds_read_b128 v[16:19], v14 offset:36864
    s_waitcnt lgkmcnt(4)
    v_mfma_f32_16x16x32_bf16 v[44:47], a[48:51], v[24:27], v[44:47]
    v_mfma_f32_16x16x32_bf16 v[52:55], a[128:131], v[24:27], v[52:55]
    v_mfma_f32_16x16x32_bf16 v[60:63], a[208:211], v[24:27], v[60:63]
    ds_read_b128 v[20:23], v14 offset:37888
    s_waitcnt lgkmcnt(4)
    v_mfma_f32_16x16x32_bf16 v[44:47], a[52:55], v[28:31], v[44:47]
    v_mfma_f32_16x16x32_bf16 v[52:55], a[132:135], v[28:31], v[52:55]
    v_mfma_f32_16x16x32_bf16 v[60:63], a[212:215], v[28:31], v[60:63]
    ds_read_b128 v[24:27], v14 offset:38912
    s_waitcnt lgkmcnt(4)
    v_mfma_f32_16x16x32_bf16 v[44:47], a[56:59], v[32:35], v[44:47]
    v_mfma_f32_16x16x32_bf16 v[52:55], a[136:139], v[32:35], v[52:55]
    v_mfma_f32_16x16x32_bf16 v[60:63], a[216:219], v[32:35], v[60:63]
    ds_read_b128 v[28:31], v14 offset:39936
    s_waitcnt lgkmcnt(4)
    v_mfma_f32_16x16x32_bf16 v[44:47], a[60:63], v[36:39], v[44:47]
    v_mfma_f32_16x16x32_bf16 v[52:55], a[140:143], v[36:39], v[52:55]
    v_mfma_f32_16x16x32_bf16 v[60:63], a[220:223], v[36:39], v[60:63]
    s_waitcnt lgkmcnt(3)
    v_mfma_f32_16x16x32_bf16 v[44:47], a[64:67], v[16:19], v[44:47]
    v_mfma_f32_16x16x32_bf16 v[52:55], a[144:147], v[16:19], v[52:55]
    v_mfma_f32_16x16x32_bf16 v[60:63], a[224:227], v[16:19], v[60:63]
    s_waitcnt lgkmcnt(2)
    v_mfma_f32_16x16x32_bf16 v[44:47], a[68:71], v[20:23], v[44:47]
    v_mfma_f32_16x16x32_bf16 v[52:55], a[148:151], v[20:23], v[52:55]
    v_mfma_f32_16x16x32_bf16 v[60:63], a[228:231], v[20:23], v[60:63]
    s_waitcnt lgkmcnt(1)
    v_mfma_f32_16x16x32_bf16 v[44:47], a[72:75], v[24:27], v[44:47]
    v_mfma_f32_16x16x32_bf16 v[52:55], a[152:155], v[24:27], v[52:55]
    v_mfma_f32_16x16x32_bf16 v[60:63], a[232:235], v[24:27], v[60:63]
    s_waitcnt lgkmcnt(0)
    v_mfma_f32_16x16x32_bf16 v[44:47], a[76:79], v[28:31], v[44:47]
    v_mfma_f32_16x16x32_bf16 v[52:55], a[156:159], v[28:31], v[52:55]
    v_mfma_f32_16x16x32_bf16 v[60:63], a[236:239], v[28:31], v[60:63]
    v_cvt_pk_bf16_f32 v64, v40, v41
    v_cvt_pk_bf16_f32 v65, v42, v43
    s_add_u32 s69, s75, 0
    buffer_store_dwordx2 v[64:65], v12, s[4:7], s69 offen
    s_nop 1
    v_cvt_pk_bf16_f32 v66, v44, v45
    v_cvt_pk_bf16_f32 v67, v46, v47
    s_add_u32 s69, s75, 6144
    buffer_store_dwordx2 v[66:67], v12, s[4:7], s69 offen
    v_cvt_pk_bf16_f32 v68, v48, v49
    v_cvt_pk_bf16_f32 v69, v50, v51
    s_add_u32 s69, s75, 2048
    buffer_store_dwordx2 v[68:69], v12, s[4:7], s69 offen
    v_cvt_pk_bf16_f32 v70, v52, v53
    v_cvt_pk_bf16_f32 v71, v54, v55
    s_add_u32 s69, s75, 8192
    buffer_store_dwordx2 v[70:71], v12, s[4:7], s69 offen
    v_cvt_pk_bf16_f32 v72, v56, v57
    v_cvt_pk_bf16_f32 v73, v58, v59
    s_add_u32 s69, s75, 4096
    buffer_store_dwordx2 v[72:73], v12, s[4:7], s69 offen
    v_cvt_pk_bf16_f32 v74, v60, v61
    v_cvt_pk_bf16_f32 v75, v62, v63
    s_add_u32 s69, s75, 10240
    buffer_store_dwordx2 v[74:75], v12, s[4:7], s69 offen
    s_add_u32 s75, s75, 12288
    s_mov_b32 s31, s77
    s_waitcnt vmcnt(0)
    v_mov_b32 v15, s31
    s_mov_b64 exec, 1
    buffer_store_dword v15, v13, s[4:7], 0 offen
    s_mov_b64 exec, -1
    s_cmp_lt_u32 s31, 64
    s_cbranch_scc1 kvloop_63
    s_branch EXIT
ROLE_VF:
    s_mov_b32 s12, s40
    s_mov_b32 s13, s41
    s_mov_b32 s14, 7864320
    s_mov_b32 s15, 0x20000
    s_sub_u32 s73, s29, 16
    s_lshl_b32 s74, s28, 2
    s_add_u32 s74, s74, s73
    v_lshrrev_b32 v2, 3, v0
    v_and_b32 v3, 7, v0
    v_lshrrev_b32 v4, 4, v0
    v_and_b32 v4, 1, v4
    v_lshlrev_b32 v4, 1, v4
    s_and_b32 s69, s30, 1
    s_lshl_b32 s69, s69, 2
    v_or_b32 v4, s69, v4
    v_xor_b32 v3, v3, v4
    v_lshlrev_b32 v3, 4, v3
    s_mov_b32 s69, 12288
    v_mad_u32_u24 v12, v2, s69, v3
    v_lshrrev_b32 v2, 4, v0
    v_bfe_u32 v3, v0, 2, 2
    v_and_b32 v4, 3, v0
    v_lshrrev_b32 v5, 1, v3
    v_and_b32 v6, 1, v2
    v_lshl_or_b32 v5, v6, 1, v5
    v_lshlrev_b32 v5, 1, v5
    v_lshl_add_u32 v6, v2, 3, v3
    s_lshl_b32 s69, s30, 1
    v_lshrrev_b32 v7, 1, v4
    v_or_b32 v7, s69, v7
    v_xor_b32 v7, v7, v5
    v_lshlrev_b32 v7, 4, v7
    v_and_b32 v4, 1, v4
    v_lshl_or_b32 v7, v4, 3, v7
    v_lshl_add_u32 v14, v6, 7, v7
    s_mul_i32 s71, s74, 384
    s_add_u32 s71, s71, 0
    s_mul_i32 s69, s30, 98304
    s_add_u32 s69, s69, s71
    s_lshl_b32 s70, s30, 10
    s_add_u32 m0, s70, 0
    s_nop 0
    buffer_load_dwordx4 v12, s[12:15], s69 offen lds
    s_add_u32 m0, m0, 4096
    s_add_u32 s69, s69, 393216
    buffer_load_dwordx4 v12, s[12:15], s69 offen lds
    s_add_u32 m0, m0, 4096
    s_add_u32 s69, s69, 393216
    buffer_load_dwordx4 v12, s[12:15], s69 offen lds
    s_add_u32 m0, m0, 4096
    s_add_u32 s69, s69, 393216
    buffer_load_dwordx4 v12, s[12:15], s69 offen lds
    s_add_u32 m0, m0, 4096
    s_add_u32 s69, s69, 393216
    buffer_load_dwordx4 v12, s[12:15], s69 offen lds
    s_add_u32 m0, m0, 4096
    s_add_u32 s69, s69, 393216
    buffer_load_dwordx4 v12, s[12:15], s69 offen lds
    s_add_u32 m0, m0, 4096
    s_add_u32 s69, s69, 393216
    buffer_load_dwordx4 v12, s[12:15], s69 offen lds
    s_add_u32 m0, m0, 4096
    s_add_u32 s69, s69, 393216
    buffer_load_dwordx4 v12, s[12:15], s69 offen lds
    s_add_u32 m0, m0, 4096
    s_add_u32 s69, s69, 393216
    buffer_load_dwordx4 v12, s[12:15], s69 offen lds
    s_add_u32 m0, m0, 4096
    s_add_u32 s69, s69, 393216
    buffer_load_dwordx4 v12, s[12:15], s69 offen lds
    s_add_u32 m0, m0, 4096
    s_add_u32 s69, s69, 393216
    buffer_load_dwordx4 v12, s[12:15], s69 offen lds
    s_add_u32 m0, m0, 4096
    s_add_u32 s69, s69, 393216
    buffer_load_dwordx4 v12, s[12:15], s69 offen lds
    s_add_u32 m0, m0, 4096
    s_add_u32 s69, s69, 393216
    buffer_load_dwordx4 v12, s[12:15], s69 offen lds
    s_add_u32 m0, m0, 4096
    s_add_u32 s69, s69, 393216
    buffer_load_dwordx4 v12, s[12:15], s69 offen lds
    s_add_u32 m0, m0, 4096
    s_add_u32 s69, s69, 393216
    buffer_load_dwordx4 v12, s[12:15], s69 offen lds
    s_add_u32 m0, m0, 4096
    s_add_u32 s69, s69, 393216
    buffer_load_dwordx4 v12, s[12:15], s69 offen lds
    s_add_u32 m0, m0, 4096
    s_add_u32 s69, s69, 393216
    buffer_load_dwordx4 v12, s[12:15], s69 offen lds
    s_add_u32 m0, m0, 4096
    s_add_u32 s69, s69, 393216
    buffer_load_dwordx4 v12, s[12:15], s69 offen lds
    s_add_u32 m0, m0, 4096
    s_add_u32 s69, s69, 393216
    buffer_load_dwordx4 v12, s[12:15], s69 offen lds
    s_add_u32 m0, m0, 4096
    s_add_u32 s69, s69, 393216
    buffer_load_dwordx4 v12, s[12:15], s69 offen lds
    s_mul_i32 s71, s74, 384
    s_add_u32 s71, s71, 128
    s_mul_i32 s69, s30, 98304
    s_add_u32 s69, s69, s71
    s_lshl_b32 s70, s30, 10
    s_add_u32 m0, s70, 81920
    s_nop 0
    buffer_load_dwordx4 v12, s[12:15], s69 offen lds
    s_add_u32 m0, m0, 4096
    s_add_u32 s69, s69, 393216
    buffer_load_dwordx4 v12, s[12:15], s69 offen lds
    s_add_u32 m0, m0, 4096
    s_add_u32 s69, s69, 393216
    buffer_load_dwordx4 v12, s[12:15], s69 offen lds
    s_add_u32 m0, m0, 4096
    s_add_u32 s69, s69, 393216
    buffer_load_dwordx4 v12, s[12:15], s69 offen lds
    s_add_u32 m0, m0, 4096
    s_add_u32 s69, s69, 393216
    buffer_load_dwordx4 v12, s[12:15], s69 offen lds
    s_add_u32 m0, m0, 4096
    s_add_u32 s69, s69, 393216
    buffer_load_dwordx4 v12, s[12:15], s69 offen lds
    s_add_u32 m0, m0, 4096
    s_add_u32 s69, s69, 393216
    buffer_load_dwordx4 v12, s[12:15], s69 offen lds
    s_add_u32 m0, m0, 4096
    s_add_u32 s69, s69, 393216
    buffer_load_dwordx4 v12, s[12:15], s69 offen lds
    s_add_u32 m0, m0, 4096
    s_add_u32 s69, s69, 393216
    buffer_load_dwordx4 v12, s[12:15], s69 offen lds
    s_add_u32 m0, m0, 4096
    s_add_u32 s69, s69, 393216
    buffer_load_dwordx4 v12, s[12:15], s69 offen lds
    s_add_u32 m0, m0, 4096
    s_add_u32 s69, s69, 393216
    buffer_load_dwordx4 v12, s[12:15], s69 offen lds
    s_add_u32 m0, m0, 4096
    s_add_u32 s69, s69, 393216
    buffer_load_dwordx4 v12, s[12:15], s69 offen lds
    s_add_u32 m0, m0, 4096
    s_add_u32 s69, s69, 393216
    buffer_load_dwordx4 v12, s[12:15], s69 offen lds
    s_add_u32 m0, m0, 4096
    s_add_u32 s69, s69, 393216
    buffer_load_dwordx4 v12, s[12:15], s69 offen lds
    s_add_u32 m0, m0, 4096
    s_add_u32 s69, s69, 393216
    buffer_load_dwordx4 v12, s[12:15], s69 offen lds
    s_add_u32 m0, m0, 4096
    s_add_u32 s69, s69, 393216
    buffer_load_dwordx4 v12, s[12:15], s69 offen lds
    s_add_u32 m0, m0, 4096
    s_add_u32 s69, s69, 393216
    buffer_load_dwordx4 v12, s[12:15], s69 offen lds
    s_add_u32 m0, m0, 4096
    s_add_u32 s69, s69, 393216
    buffer_load_dwordx4 v12, s[12:15], s69 offen lds
    s_add_u32 m0, m0, 4096
    s_add_u32 s69, s69, 393216
    buffer_load_dwordx4 v12, s[12:15], s69 offen lds
    s_add_u32 m0, m0, 4096
    s_add_u32 s69, s69, 393216
    buffer_load_dwordx4 v12, s[12:15], s69 offen lds
    s_waitcnt vmcnt(20)
    s_barrier
    v_add_u32 v9, 0, v14
    ds_read_b64_tr_b16 a[0:1], v9 offset:0
    ds_read_b64_tr_b16 a[2:3], v9 offset:512
    ds_read_b64_tr_b16 a[4:5], v9 offset:4096
    ds_read_b64_tr_b16 a[6:7], v9 offset:4608
    ds_read_b64_tr_b16 a[8:9], v9 offset:8192
    ds_read_b64_tr_b16 a[10:11], v9 offset:8704
    ds_read_b64_tr_b16 a[12:13], v9 offset:12288
    ds_read_b64_tr_b16 a[14:15], v9 offset:12800
    ds_read_b64_tr_b16 a[16:17], v9 offset:16384
    ds_read_b64_tr_b16 a[18:19], v9 offset:16896
    ds_read_b64_tr_b16 a[20:21], v9 offset:20480
    ds_read_b64_tr_b16 a[22:23], v9 offset:20992
    s_waitcnt lgkmcnt(0)
    ds_read_b64_tr_b16 a[24:25], v9 offset:24576
    ds_read_b64_tr_b16 a[26:27], v9 offset:25088
    ds_read_b64_tr_b16 a[28:29], v9 offset:28672
    ds_read_b64_tr_b16 a[30:31], v9 offset:29184
    ds_read_b64_tr_b16 a[32:33], v9 offset:32768
    ds_read_b64_tr_b16 a[34:35], v9 offset:33280
    ds_read_b64_tr_b16 a[36:37], v9 offset:36864
    ds_read_b64_tr_b16 a[38:39], v9 offset:37376
    s_waitcnt lgkmcnt(0)
    v_add_u32 v9, 40960, v14
    ds_read_b64_tr_b16 a[40:41], v9 offset:0
    ds_read_b64_tr_b16 a[42:43], v9 offset:512
    ds_read_b64_tr_b16 a[44:45], v9 offset:4096
    ds_read_b64_tr_b16 a[46:47], v9 offset:4608
    ds_read_b64_tr_b16 a[48:49], v9 offset:8192
    ds_read_b64_tr_b16 a[50:51], v9 offset:8704
    ds_read_b64_tr_b16 a[52:53], v9 offset:12288
    ds_read_b64_tr_b16 a[54:55], v9 offset:12800
    ds_read_b64_tr_b16 a[56:57], v9 offset:16384
    ds_read_b64_tr_b16 a[58:59], v9 offset:16896
    ds_read_b64_tr_b16 a[60:61], v9 offset:20480
    ds_read_b64_tr_b16 a[62:63], v9 offset:20992
    s_waitcnt lgkmcnt(0)
    ds_read_b64_tr_b16 a[64:65], v9 offset:24576
    ds_read_b64_tr_b16 a[66:67], v9 offset:25088
    ds_read_b64_tr_b16 a[68:69], v9 offset:28672
    ds_read_b64_tr_b16 a[70:71], v9 offset:29184
    ds_read_b64_tr_b16 a[72:73], v9 offset:32768
    ds_read_b64_tr_b16 a[74:75], v9 offset:33280
    ds_read_b64_tr_b16 a[76:77], v9 offset:36864
    ds_read_b64_tr_b16 a[78:79], v9 offset:37376
    s_waitcnt lgkmcnt(0)
    s_barrier
    s_mul_i32 s71, s74, 384
    s_add_u32 s71, s71, 256
    s_mul_i32 s69, s30, 98304
    s_add_u32 s69, s69, s71
    s_lshl_b32 s70, s30, 10
    s_add_u32 m0, s70, 0
    s_nop 0
    buffer_load_dwordx4 v12, s[12:15], s69 offen lds
    s_add_u32 m0, m0, 4096
    s_add_u32 s69, s69, 393216
    buffer_load_dwordx4 v12, s[12:15], s69 offen lds
    s_add_u32 m0, m0, 4096
    s_add_u32 s69, s69, 393216
    buffer_load_dwordx4 v12, s[12:15], s69 offen lds
    s_add_u32 m0, m0, 4096
    s_add_u32 s69, s69, 393216
    buffer_load_dwordx4 v12, s[12:15], s69 offen lds
    s_add_u32 m0, m0, 4096
    s_add_u32 s69, s69, 393216
    buffer_load_dwordx4 v12, s[12:15], s69 offen lds
    s_add_u32 m0, m0, 4096
    s_add_u32 s69, s69, 393216
    buffer_load_dwordx4 v12, s[12:15], s69 offen lds
    s_add_u32 m0, m0, 4096
    s_add_u32 s69, s69, 393216
    buffer_load_dwordx4 v12, s[12:15], s69 offen lds
    s_add_u32 m0, m0, 4096
    s_add_u32 s69, s69, 393216
    buffer_load_dwordx4 v12, s[12:15], s69 offen lds
    s_add_u32 m0, m0, 4096
    s_add_u32 s69, s69, 393216
    buffer_load_dwordx4 v12, s[12:15], s69 offen lds
    s_add_u32 m0, m0, 4096
    s_add_u32 s69, s69, 393216
    buffer_load_dwordx4 v12, s[12:15], s69 offen lds
    s_add_u32 m0, m0, 4096
    s_add_u32 s69, s69, 393216
    buffer_load_dwordx4 v12, s[12:15], s69 offen lds
    s_add_u32 m0, m0, 4096
    s_add_u32 s69, s69, 393216
    buffer_load_dwordx4 v12, s[12:15], s69 offen lds
    s_add_u32 m0, m0, 4096
    s_add_u32 s69, s69, 393216
    buffer_load_dwordx4 v12, s[12:15], s69 offen lds
    s_add_u32 m0, m0, 4096
    s_add_u32 s69, s69, 393216
    buffer_load_dwordx4 v12, s[12:15], s69 offen lds
    s_add_u32 m0, m0, 4096
    s_add_u32 s69, s69, 393216
    buffer_load_dwordx4 v12, s[12:15], s69 offen lds
    s_add_u32 m0, m0, 4096
    s_add_u32 s69, s69, 393216
    buffer_load_dwordx4 v12, s[12:15], s69 offen lds
    s_add_u32 m0, m0, 4096
    s_add_u32 s69, s69, 393216
    buffer_load_dwordx4 v12, s[12:15], s69 offen lds
    s_add_u32 m0, m0, 4096
    s_add_u32 s69, s69, 393216
    buffer_load_dwordx4 v12, s[12:15], s69 offen lds
    s_add_u32 m0, m0, 4096
    s_add_u32 s69, s69, 393216
    buffer_load_dwordx4 v12, s[12:15], s69 offen lds
    s_add_u32 m0, m0, 4096
    s_add_u32 s69, s69, 393216
    buffer_load_dwordx4 v12, s[12:15], s69 offen lds
    s_waitcnt vmcnt(20)
    s_barrier
    v_add_u32 v9, 81920, v14
    ds_read_b64_tr_b16 a[80:81], v9 offset:0
    ds_read_b64_tr_b16 a[82:83], v9 offset:512
    ds_read_b64_tr_b16 a[84:85], v9 offset:4096
    ds_read_b64_tr_b16 a[86:87], v9 offset:4608
    ds_read_b64_tr_b16 a[88:89], v9 offset:8192
    ds_read_b64_tr_b16 a[90:91], v9 offset:8704
    ds_read_b64_tr_b16 a[92:93], v9 offset:12288
    ds_read_b64_tr_b16 a[94:95], v9 offset:12800
    ds_read_b64_tr_b16 a[96:97], v9 offset:16384
    ds_read_b64_tr_b16 a[98:99], v9 offset:16896
    ds_read_b64_tr_b16 a[100:101], v9 offset:20480
    ds_read_b64_tr_b16 a[102:103], v9 offset:20992
    s_waitcnt lgkmcnt(0)
    ds_read_b64_tr_b16 a[104:105], v9 offset:24576
    ds_read_b64_tr_b16 a[106:107], v9 offset:25088
    ds_read_b64_tr_b16 a[108:109], v9 offset:28672
    ds_read_b64_tr_b16 a[110:111], v9 offset:29184
    ds_read_b64_tr_b16 a[112:113], v9 offset:32768
    ds_read_b64_tr_b16 a[114:115], v9 offset:33280
    ds_read_b64_tr_b16 a[116:117], v9 offset:36864
    ds_read_b64_tr_b16 a[118:119], v9 offset:37376
    s_waitcnt lgkmcnt(0)
    v_add_u32 v9, 122880, v14
    ds_read_b64_tr_b16 a[120:121], v9 offset:0
    ds_read_b64_tr_b16 a[122:123], v9 offset:512
    ds_read_b64_tr_b16 a[124:125], v9 offset:4096
    ds_read_b64_tr_b16 a[126:127], v9 offset:4608
    ds_read_b64_tr_b16 a[128:129], v9 offset:8192
    ds_read_b64_tr_b16 a[130:131], v9 offset:8704
    ds_read_b64_tr_b16 a[132:133], v9 offset:12288
    ds_read_b64_tr_b16 a[134:135], v9 offset:12800
    ds_read_b64_tr_b16 a[136:137], v9 offset:16384
    ds_read_b64_tr_b16 a[138:139], v9 offset:16896
    ds_read_b64_tr_b16 a[140:141], v9 offset:20480
    ds_read_b64_tr_b16 a[142:143], v9 offset:20992
    s_waitcnt lgkmcnt(0)
    ds_read_b64_tr_b16 a[144:145], v9 offset:24576
    ds_read_b64_tr_b16 a[146:147], v9 offset:25088
    ds_read_b64_tr_b16 a[148:149], v9 offset:28672
    ds_read_b64_tr_b16 a[150:151], v9 offset:29184
    ds_read_b64_tr_b16 a[152:153], v9 offset:32768
    ds_read_b64_tr_b16 a[154:155], v9 offset:33280
    ds_read_b64_tr_b16 a[156:157], v9 offset:36864
    ds_read_b64_tr_b16 a[158:159], v9 offset:37376
    s_waitcnt lgkmcnt(0)
    s_barrier
    s_waitcnt vmcnt(0)
    s_barrier
    v_add_u32 v9, 0, v14
    ds_read_b64_tr_b16 a[160:161], v9 offset:0
    ds_read_b64_tr_b16 a[162:163], v9 offset:512
    ds_read_b64_tr_b16 a[164:165], v9 offset:4096
    ds_read_b64_tr_b16 a[166:167], v9 offset:4608
    ds_read_b64_tr_b16 a[168:169], v9 offset:8192
    ds_read_b64_tr_b16 a[170:171], v9 offset:8704
    ds_read_b64_tr_b16 a[172:173], v9 offset:12288
    ds_read_b64_tr_b16 a[174:175], v9 offset:12800
    ds_read_b64_tr_b16 a[176:177], v9 offset:16384
    ds_read_b64_tr_b16 a[178:179], v9 offset:16896
    ds_read_b64_tr_b16 a[180:181], v9 offset:20480
    ds_read_b64_tr_b16 a[182:183], v9 offset:20992
    s_waitcnt lgkmcnt(0)
    ds_read_b64_tr_b16 a[184:185], v9 offset:24576
    ds_read_b64_tr_b16 a[186:187], v9 offset:25088
    ds_read_b64_tr_b16 a[188:189], v9 offset:28672
    ds_read_b64_tr_b16 a[190:191], v9 offset:29184
    ds_read_b64_tr_b16 a[192:193], v9 offset:32768
    ds_read_b64_tr_b16 a[194:195], v9 offset:33280
    ds_read_b64_tr_b16 a[196:197], v9 offset:36864
    ds_read_b64_tr_b16 a[198:199], v9 offset:37376
    s_waitcnt lgkmcnt(0)
    v_add_u32 v9, 40960, v14
    ds_read_b64_tr_b16 a[200:201], v9 offset:0
    ds_read_b64_tr_b16 a[202:203], v9 offset:512
    ds_read_b64_tr_b16 a[204:205], v9 offset:4096
    ds_read_b64_tr_b16 a[206:207], v9 offset:4608
    ds_read_b64_tr_b16 a[208:209], v9 offset:8192
    ds_read_b64_tr_b16 a[210:211], v9 offset:8704
    ds_read_b64_tr_b16 a[212:213], v9 offset:12288
    ds_read_b64_tr_b16 a[214:215], v9 offset:12800
    ds_read_b64_tr_b16 a[216:217], v9 offset:16384
    ds_read_b64_tr_b16 a[218:219], v9 offset:16896
    ds_read_b64_tr_b16 a[220:221], v9 offset:20480
    ds_read_b64_tr_b16 a[222:223], v9 offset:20992
    s_waitcnt lgkmcnt(0)
    ds_read_b64_tr_b16 a[224:225], v9 offset:24576
    ds_read_b64_tr_b16 a[226:227], v9 offset:25088
    ds_read_b64_tr_b16 a[228:229], v9 offset:28672
    ds_read_b64_tr_b16 a[230:231], v9 offset:29184
    ds_read_b64_tr_b16 a[232:233], v9 offset:32768
    ds_read_b64_tr_b16 a[234:235], v9 offset:33280
    ds_read_b64_tr_b16 a[236:237], v9 offset:36864
    ds_read_b64_tr_b16 a[238:239], v9 offset:37376
    s_waitcnt lgkmcnt(0)
    s_barrier
    v_mov_b32 v2, 128
wa_64:
    buffer_load_dword v3, v2, s[64:67], 0 offen sc1
    s_waitcnt vmcnt(0)
    v_cmp_ne_u32 vcc, 0x100, v3
    s_cbranch_vccz wad_65
    s_sub_u32 s68, s68, 1
    s_cbranch_scc0 ok_66
    s_mov_b32 s69, 1
    s_branch FAIL
ok_66:
    s_sleep 4
    s_branch wa_64
wad_65:
    v_and_b32 v2, 7, v0
    v_lshlrev_b32 v2, 2, v2
    buffer_load_dword v3, v2, s[64:67], 0 offen sc1
    s_waitcnt vmcnt(0)
    v_cmp_ne_u32 vcc, 32, v3
    s_cbranch_vccnz SAFEENTRY
    v_and_b32 v2, 15, v0
    v_lshrrev_b32 v3, 4, v0
    s_and_b32 s69, s30, 1
    s_lshl_b32 s69, s69, 4
    v_add_u32 v2, s69, v2
    s_mov_b32 s69, 1280
    v_mul_u32_u24 v2, s69, v2
    s_lshr_b32 s69, s30, 1
    s_mul_i32 s69, s69, 640
    v_lshl_add_u32 v2, v3, 4, v2
    v_add_u32 v10, s69, v2
    v_lshlrev_b32 v11, 4, v0
    s_lshl_b32 s69, s30, 10
    v_add_u32 v12, s69, v11
    s_lshl_b32 s69, s74, 7
    s_lshl_b32 s70, s30, 2
    s_add_u32 s69, s69, s70
    s_add_u32 s69, s69, 2097168
    v_mov_b32 v13, s69
    s_mul_i32 s75, s74, 786432
    s_add_u32 s75, s75, 29360128
    s_mov_b32 s31, 0
    s_mov_b32 s76, 0
    s_mul_i32 s69, s31, 40960
    s_and_b32 s70, s30, 1
    s_mul_i32 s70, s70, 20
    s_lshr_b32 s71, s30, 1
    s_mul_i32 s71, s71, 10
    s_add_u32 s70, s70, s71
    s_lshl_b32 s70, s70, 10
    s_add_u32 m0, s70, s76
    s_nop 0
    buffer_load_dwordx4 v10, s[8:11], s69 offen offset:0 lds
    s_add_u32 m0, m0, 960
    s_nop 0
    buffer_load_dwordx4 v10, s[8:11], s69 offen offset:64 lds
    s_add_u32 m0, m0, 960
    s_nop 0
    buffer_load_dwordx4 v10, s[8:11], s69 offen offset:128 lds
    s_add_u32 m0, m0, 960
    s_nop 0
    buffer_load_dwordx4 v10, s[8:11], s69 offen offset:192 lds
    s_add_u32 m0, m0, 960
    s_nop 0
    buffer_load_dwordx4 v10, s[8:11], s69 offen offset:256 lds
    s_add_u32 m0, m0, 960
    s_nop 0
    buffer_load_dwordx4 v10, s[8:11], s69 offen offset:320 lds
    s_add_u32 m0, m0, 960
    s_nop 0
    buffer_load_dwordx4 v10, s[8:11], s69 offen offset:384 lds
    s_add_u32 m0, m0, 960
    s_nop 0
    buffer_load_dwordx4 v10, s[8:11], s69 offen offset:448 lds
    s_add_u32 m0, m0, 960
    s_nop 0
    buffer_load_dwordx4 v10, s[8:11], s69 offen offset:512 lds
    s_add_u32 m0, m0, 960
    s_nop 0
    buffer_load_dwordx4 v10, s[8:11], s69 offen offset:576 lds
    s_waitcnt vmcnt(0)
kvloop_67:
    s_barrier
    v_add_u32 v14, s76, v11
    s_xor_b32 s76, s76, 40960
    s_add_u32 s77, s31, 1
    s_mul_i32 s78, s77, 40960
    s_and_b32 s70, s30, 1
    s_mul_i32 s70, s70, 20
    s_lshr_b32 s71, s30, 1
    s_mul_i32 s71, s71, 10
    s_add_u32 s70, s70, s71
    s_lshl_b32 s70, s70, 10
    s_add_u32 m0, s70, s76
    ds_read_b128 v[16:19], v14 offset:0
    ds_read_b128 v[20:23], v14 offset:1024
    ds_read_b128 v[24:27], v14 offset:2048
    ds_read_b128 v[28:31], v14 offset:3072
    ds_read_b128 v[32:35], v14 offset:4096
    s_waitcnt lgkmcnt(4)
    v_mfma_f32_16x16x32_bf16 v[40:43], v[16:19], a[0:3], 0
    v_mfma_f32_16x16x32_bf16 v[48:51], v[16:19], a[80:83], 0
    v_mfma_f32_16x16x32_bf16 v[56:59], v[16:19], a[160:163], 0
    buffer_load_dwordx4 v10, s[8:11], s78 offen offset:0 lds
    s_add_u32 m0, m0, 960
    ds_read_b128 v[36:39], v14 offset:5120
    s_waitcnt lgkmcnt(4)
    v_mfma_f32_16x16x32_bf16 v[40:43], v[20:23], a[4:7], v[40:43]
    v_mfma_f32_16x16x32_bf16 v[48:51], v[20:23], a[84:87], v[48:51]
    v_mfma_f32_16x16x32_bf16 v[56:59], v[20:23], a[164:167], v[56:59]
    ds_read_b128 v[16:19], v14 offset:6144
    s_waitcnt lgkmcnt(4)
    v_mfma_f32_16x16x32_bf16 v[40:43], v[24:27], a[8:11], v[40:43]
    v_mfma_f32_16x16x32_bf16 v[48:51], v[24:27], a[88:91], v[48:51]
    v_mfma_f32_16x16x32_bf16 v[56:59], v[24:27], a[168:171], v[56:59]
    ds_read_b128 v[20:23], v14 offset:7168
    s_waitcnt lgkmcnt(4)
    v_mfma_f32_16x16x32_bf16 v[40:43], v[28:31], a[12:15], v[40:43]
    v_mfma_f32_16x16x32_bf16 v[48:51], v[28:31], a[92:95], v[48:51]
    v_mfma_f32_16x16x32_bf16 v[56:59], v[28:31], a[172:175], v[56:59]
    buffer_load_dwordx4 v10, s[8:11], s78 offen offset:64 lds
    s_add_u32 m0, m0, 960
    ds_read_b128 v[24:27], v14 offset:8192
    s_waitcnt lgkmcnt(4)
    v_mfma_f32_16x16x32_bf16 v[40:43], v[32:35], a[16:19], v[40:43]
    v_mfma_f32_16x16x32_bf16 v[48:51], v[32:35], a[96:99], v[48:51]
    v_mfma_f32_16x16x32_bf16 v[56:59], v[32:35], a[176:179], v[56:59]
    ds_read_b128 v[28:31], v14 offset:9216
    s_waitcnt lgkmcnt(4)
    v_mfma_f32_16x16x32_bf16 v[40:43], v[36:39], a[20:23], v[40:43]
    v_mfma_f32_16x16x32_bf16 v[48:51], v[36:39], a[100:103], v[48:51]
    v_mfma_f32_16x16x32_bf16 v[56:59], v[36:39], a[180:183], v[56:59]
    ds_read_b128 v[32:35], v14 offset:10240
    s_waitcnt lgkmcnt(4)
    v_mfma_f32_16x16x32_bf16 v[40:43], v[16:19], a[24:27], v[40:43]
    v_mfma_f32_16x16x32_bf16 v[48:51], v[16:19], a[104:107], v[48:51]
    v_mfma_f32_16x16x32_bf16 v[56:59], v[16:19], a[184:187], v[56:59]
    buffer_load_dwordx4 v10, s[8:11], s78 offen offset:128 lds
    s_add_u32 m0, m0, 960
    ds_read_b128 v[36:39], v14 offset:11264
    s_waitcnt lgkmcnt(4)
    v_mfma_f32_16x16x32_bf16 v[40:43], v[20:23], a[28:31], v[40:43]
    v_mfma_f32_16x16x32_bf16 v[48:51], v[20:23], a[108:111], v[48:51]
    v_mfma_f32_16x16x32_bf16 v[56:59], v[20:23], a[188:191], v[56:59]
    ds_read_b128 v[16:19], v14 offset:12288
    s_waitcnt lgkmcnt(4)
    v_mfma_f32_16x16x32_bf16 v[40:43], v[24:27], a[32:35], v[40:43]
    v_mfma_f32_16x16x32_bf16 v[48:51], v[24:27], a[112:115], v[48:51]
    v_mfma_f32_16x16x32_bf16 v[56:59], v[24:27], a[192:195], v[56:59]
    ds_read_b128 v[20:23], v14 offset:13312
    s_waitcnt lgkmcnt(4)
    v_mfma_f32_16x16x32_bf16 v[40:43], v[28:31], a[36:39], v[40:43]
    v_mfma_f32_16x16x32_bf16 v[48:51], v[28:31], a[116:119], v[48:51]
    v_mfma_f32_16x16x32_bf16 v[56:59], v[28:31], a[196:199], v[56:59]
    buffer_load_dwordx4 v10, s[8:11], s78 offen offset:192 lds
    s_add_u32 m0, m0, 960
    ds_read_b128 v[24:27], v14 offset:14336
    s_waitcnt lgkmcnt(4)
    v_mfma_f32_16x16x32_bf16 v[40:43], v[32:35], a[40:43], v[40:43]
    v_mfma_f32_16x16x32_bf16 v[48:51], v[32:35], a[120:123], v[48:51]
    v_mfma_f32_16x16x32_bf16 v[56:59], v[32:35], a[200:203], v[56:59]
    ds_read_b128 v[28:31], v14 offset:15360
    s_waitcnt lgkmcnt(4)
    v_mfma_f32_16x16x32_bf16 v[40:43], v[36:39], a[44:47], v[40:43]
    v_mfma_f32_16x16x32_bf16 v[48:51], v[36:39], a[124:127], v[48:51]
    v_mfma_f32_16x16x32_bf16 v[56:59], v[36:39], a[204:207], v[56:59]
    ds_read_b128 v[32:35], v14 offset:16384
    s_waitcnt lgkmcnt(4)
    v_mfma_f32_16x16x32_bf16 v[40:43], v[16:19], a[48:51], v[40:43]
    v_mfma_f32_16x16x32_bf16 v[48:51], v[16:19], a[128:131], v[48:51]
    v_mfma_f32_16x16x32_bf16 v[56:59], v[16:19], a[208:211], v[56:59]
    buffer_load_dwordx4 v10, s[8:11], s78 offen offset:256 lds
    s_add_u32 m0, m0, 960
    ds_read_b128 v[36:39], v14 offset:17408
    s_waitcnt lgkmcnt(4)
    v_mfma_f32_16x16x32_bf16 v[40:43], v[20:23], a[52:55], v[40:43]
    v_mfma_f32_16x16x32_bf16 v[48:51], v[20:23], a[132:135], v[48:51]
    v_mfma_f32_16x16x32_bf16 v[56:59], v[20:23], a[212:215], v[56:59]
    ds_read_b128 v[16:19], v14 offset:18432
    s_waitcnt lgkmcnt(4)
    v_mfma_f32_16x16x32_bf16 v[40:43], v[24:27], a[56:59], v[40:43]
    v_mfma_f32_16x16x32_bf16 v[48:51], v[24:27], a[136:139], v[48:51]
    v_mfma_f32_16x16x32_bf16 v[56:59], v[24:27], a[216:219], v[56:59]
    ds_read_b128 v[20:23], v14 offset:19456
    s_waitcnt lgkmcnt(4)
    v_mfma_f32_16x16x32_bf16 v[40:43], v[28:31], a[60:63], v[40:43]
    v_mfma_f32_16x16x32_bf16 v[48:51], v[28:31], a[140:143], v[48:51]
    v_mfma_f32_16x16x32_bf16 v[56:59], v[28:31], a[220:223], v[56:59]
    buffer_load_dwordx4 v10, s[8:11], s78 offen offset:320 lds
    s_add_u32 m0, m0, 960
    ds_read_b128 v[24:27], v14 offset:20480
    s_waitcnt lgkmcnt(4)
    v_mfma_f32_16x16x32_bf16 v[40:43], v[32:35], a[64:67], v[40:43]
    v_mfma_f32_16x16x32_bf16 v[48:51], v[32:35], a[144:147], v[48:51]
    v_mfma_f32_16x16x32_bf16 v[56:59], v[32:35], a[224:227], v[56:59]
    ds_read_b128 v[28:31], v14 offset:21504
    s_waitcnt lgkmcnt(4)
    v_mfma_f32_16x16x32_bf16 v[40:43], v[36:39], a[68:71], v[40:43]
    v_mfma_f32_16x16x32_bf16 v[48:51], v[36:39], a[148:151], v[48:51]
    v_mfma_f32_16x16x32_bf16 v[56:59], v[36:39], a[228:231], v[56:59]
    ds_read_b128 v[32:35], v14 offset:22528
    s_waitcnt lgkmcnt(4)
    v_mfma_f32_16x16x32_bf16 v[40:43], v[16:19], a[72:75], v[40:43]
    v_mfma_f32_16x16x32_bf16 v[48:51], v[16:19], a[152:155], v[48:51]
    v_mfma_f32_16x16x32_bf16 v[56:59], v[16:19], a[232:235], v[56:59]
    buffer_load_dwordx4 v10, s[8:11], s78 offen offset:384 lds
    s_add_u32 m0, m0, 960
    ds_read_b128 v[36:39], v14 offset:23552
    s_waitcnt lgkmcnt(4)
    v_mfma_f32_16x16x32_bf16 v[40:43], v[20:23], a[76:79], v[40:43]
    v_mfma_f32_16x16x32_bf16 v[48:51], v[20:23], a[156:159], v[48:51]
    v_mfma_f32_16x16x32_bf16 v[56:59], v[20:23], a[236:239], v[56:59]
    ds_read_b128 v[16:19], v14 offset:24576
    s_waitcnt lgkmcnt(4)
    v_mfma_f32_16x16x32_bf16 v[44:47], v[24:27], a[0:3], 0
    v_mfma_f32_16x16x32_bf16 v[52:55], v[24:27], a[80:83], 0
    v_mfma_f32_16x16x32_bf16 v[60:63], v[24:27], a[160:163], 0
    ds_read_b128 v[20:23], v14 offset:25600
    s_waitcnt lgkmcnt(4)
    v_mfma_f32_16x16x32_bf16 v[44:47], v[28:31], a[4:7], v[44:47]
    v_mfma_f32_16x16x32_bf16 v[52:55], v[28:31], a[84:87], v[52:55]
    v_mfma_f32_16x16x32_bf16 v[60:63], v[28:31], a[164:167], v[60:63]
    buffer_load_dwordx4 v10, s[8:11], s78 offen offset:448 lds
    s_add_u32 m0, m0, 960
    ds_read_b128 v[24:27], v14 offset:26624
    s_waitcnt lgkmcnt(4)
    v_mfma_f32_16x16x32_bf16 v[44:47], v[32:35], a[8:11], v[44:47]
    v_mfma_f32_16x16x32_bf16 v[52:55], v[32:35], a[88:91], v[52:55]
    v_mfma_f32_16x16x32_bf16 v[60:63], v[32:35], a[168:171], v[60:63]
    ds_read_b128 v[28:31], v14 offset:27648
    s_waitcnt lgkmcnt(4)
    v_mfma_f32_16x16x32_bf16 v[44:47], v[36:39], a[12:15], v[44:47]
    v_mfma_f32_16x16x32_bf16 v[52:55], v[36:39], a[92:95], v[52:55]
    v_mfma_f32_16x16x32_bf16 v[60:63], v[36:39], a[172:175], v[60:63]
    ds_read_b128 v[32:35], v14 offset:28672
    s_waitcnt lgkmcnt(4)
    v_mfma_f32_16x16x32_bf16 v[44:47], v[16:19], a[16:19], v[44:47]
    v_mfma_f32_16x16x32_bf16 v[52:55], v[16:19], a[96:99], v[52:55]
    v_mfma_f32_16x16x32_bf16 v[60:63], v[16:19], a[176:179], v[60:63]
    buffer_load_dwordx4 v10, s[8:11], s78 offen offset:512 lds
    s_add_u32 m0, m0, 960
    ds_read_b128 v[36:39], v14 offset:29696
    s_waitcnt lgkmcnt(4)
    v_mfma_f32_16x16x32_bf16 v[44:47], v[20:23], a[20:23], v[44:47]
    v_mfma_f32_16x16x32_bf16 v[52:55], v[20:23], a[100:103], v[52:55]
    v_mfma_f32_16x16x32_bf16 v[60:63], v[20:23], a[180:183], v[60:63]
    ds_read_b128 v[16:19], v14 offset:30720
    s_waitcnt lgkmcnt(4)
    v_mfma_f32_16x16x32_bf16 v[44:47], v[24:27], a[24:27], v[44:47]
    v_mfma_f32_16x16x32_bf16 v[52:55], v[24:27], a[104:107], v[52:55]
    v_mfma_f32_16x16x32_bf16 v[60:63], v[24:27], a[184:187], v[60:63]
    ds_read_b128 v[20:23], v14 offset:31744
    s_waitcnt lgkmcnt(4)
    v_mfma_f32_16x16x32_bf16 v[44:47], v[28:31], a[28:31], v[44:47]
    v_mfma_f32_16x16x32_bf16 v[52:55], v[28:31], a[108:111], v[52:55]
    v_mfma_f32_16x16x32_bf16 v[60:63], v[28:31], a[188:191], v[60:63]
    buffer_load_dwordx4 v10, s[8:11], s78 offen offset:576 lds
    s_add_u32 m0, m0, 960
    ds_read_b128 v[24:27], v14 offset:32768
    s_waitcnt lgkmcnt(4)
    v_mfma_f32_16x16x32_bf16 v[44:47], v[32:35], a[32:35], v[44:47]
    v_mfma_f32_16x16x32_bf16 v[52:55], v[32:35], a[112:115], v[52:55]
    v_mfma_f32_16x16x32_bf16 v[60:63], v[32:35], a[192:195], v[60:63]
    ds_read_b128 v[28:31], v14 offset:33792
    s_waitcnt lgkmcnt(4)
    v_mfma_f32_16x16x32_bf16 v[44:47], v[36:39], a[36:39], v[44:47]
    v_mfma_f32_16x16x32_bf16 v[52:55], v[36:39], a[116:119], v[52:55]
    v_mfma_f32_16x16x32_bf16 v[60:63], v[36:39], a[196:199], v[60:63]
    ds_read_b128 v[32:35], v14 offset:34816
    s_waitcnt lgkmcnt(4)
    v_mfma_f32_16x16x32_bf16 v[44:47], v[16:19], a[40:43], v[44:47]
    v_mfma_f32_16x16x32_bf16 v[52:55], v[16:19], a[120:123], v[52:55]
    v_mfma_f32_16x16x32_bf16 v[60:63], v[16:19], a[200:203], v[60:63]
    ds_read_b128 v[36:39], v14 offset:35840
    s_waitcnt lgkmcnt(4)
    v_mfma_f32_16x16x32_bf16 v[44:47], v[20:23], a[44:47], v[44:47]
    v_mfma_f32_16x16x32_bf16 v[52:55], v[20:23], a[124:127], v[52:55]
    v_mfma_f32_16x16x32_bf16 v[60:63], v[20:23], a[204:207], v[60:63]
    ds_read_b128 v[16:19], v14 offset:36864
    s_waitcnt lgkmcnt(4)
    v_mfma_f32_16x16x32_bf16 v[44:47], v[24:27], a[48:51], v[44:47]
    v_mfma_f32_16x16x32_bf16 v[52:55], v[24:27], a[128:131], v[52:55]
    v_mfma_f32_16x16x32_bf16 v[60:63], v[24:27], a[208:211], v[60:63]
    ds_read_b128 v[20:23], v14 offset:37888
    s_waitcnt lgkmcnt(4)
    v_mfma_f32_16x16x32_bf16 v[44:47], v[28:31], a[52:55], v[44:47]
    v_mfma_f32_16x16x32_bf16 v[52:55], v[28:31], a[132:135], v[52:55]
    v_mfma_f32_16x16x32_bf16 v[60:63], v[28:31], a[212:215], v[60:63]
    ds_read_b128 v[24:27], v14 offset:38912
    s_waitcnt lgkmcnt(4)
    v_mfma_f32_16x16x32_bf16 v[44:47], v[32:35], a[56:59], v[44:47]
    v_mfma_f32_16x16x32_bf16 v[52:55], v[32:35], a[136:139], v[52:55]
    v_mfma_f32_16x16x32_bf16 v[60:63], v[32:35], a[216:219], v[60:63]
    ds_read_b128 v[28:31], v14 offset:39936
    s_waitcnt lgkmcnt(4)
    v_mfma_f32_16x16x32_bf16 v[44:47], v[36:39], a[60:63], v[44:47]
    v_mfma_f32_16x16x32_bf16 v[52:55], v[36:39], a[140:143], v[52:55]
    v_mfma_f32_16x16x32_bf16 v[60:63], v[36:39], a[220:223], v[60:63]
    s_waitcnt lgkmcnt(3)
    v_mfma_f32_16x16x32_bf16 v[44:47], v[16:19], a[64:67], v[44:47]
    v_mfma_f32_16x16x32_bf16 v[52:55], v[16:19], a[144:147], v[52:55]
    v_mfma_f32_16x16x32_bf16 v[60:63], v[16:19], a[224:227], v[60:63]
    s_waitcnt lgkmcnt(2)
    v_mfma_f32_16x16x32_bf16 v[44:47], v[20:23], a[68:71], v[44:47]
    v_mfma_f32_16x16x32_bf16 v[52:55], v[20:23], a[148:151], v[52:55]
    v_mfma_f32_16x16x32_bf16 v[60:63], v[20:23], a[228:231], v[60:63]
    s_waitcnt lgkmcnt(1)
    v_mfma_f32_16x16x32_bf16 v[44:47], v[24:27], a[72:75], v[44:47]
    v_mfma_f32_16x16x32_bf16 v[52:55], v[24:27], a[152:155], v[52:55]
    v_mfma_f32_16x16x32_bf16 v[60:63], v[24:27], a[232:235], v[60:63]
    s_waitcnt lgkmcnt(0)
    v_mfma_f32_16x16x32_bf16 v[44:47], v[28:31], a[76:79], v[44:47]
    v_mfma_f32_16x16x32_bf16 v[52:55], v[28:31], a[156:159], v[52:55]
    v_mfma_f32_16x16x32_bf16 v[60:63], v[28:31], a[236:239], v[60:63]
    v_cvt_pk_bf16_f32 v64, v40, v41
    v_cvt_pk_bf16_f32 v65, v42, v43
    s_nop 3
    v_cvt_pk_bf16_f32 v66, v44, v45
    v_cvt_pk_bf16_f32 v67, v46, v47
    s_add_u32 s69, s75, 0
    buffer_store_dwordx4 v[64:67], v12, s[4:7], s69 offen
    v_cvt_pk_bf16_f32 v68, v48, v49
    v_cvt_pk_bf16_f32 v69, v50, v51
    v_cvt_pk_bf16_f32 v70, v52, v53
    v_cvt_pk_bf16_f32 v71, v54, v55
    s_add_u32 s69, s75, 4096
    buffer_store_dwordx4 v[68:71], v12, s[4:7], s69 offen
    v_cvt_pk_bf16_f32 v72, v56, v57
    v_cvt_pk_bf16_f32 v73, v58, v59
    v_cvt_pk_bf16_f32 v74, v60, v61
    v_cvt_pk_bf16_f32 v75, v62, v63
    s_add_u32 s69, s75, 8192
    buffer_store_dwordx4 v[72:75], v12, s[4:7], s69 offen
    s_add_u32 s75, s75, 12288
    s_mov_b32 s31, s77
    s_waitcnt vmcnt(0)
    v_mov_b32 v15, s31
    s_mov_b64 exec, 1
    buffer_store_dword v15, v13, s[4:7], 0 offen
    s_mov_b64 exec, -1
    s_cmp_lt_u32 s31, 64
    s_cbranch_scc1 kvloop_67
    s_branch EXIT
ROLE_QF:
    s_mov_b32 s12, s36
    s_mov_b32 s13, s37
    s_mov_b32 s14, 7864320
    s_mov_b32 s15, 0x20000
    s_sub_u32 s73, s29, 20
    s_lshl_b32 s74, s28, 2
    s_add_u32 s74, s74, s73
    v_lshrrev_b32 v2, 3, v0
    v_and_b32 v3, 7, v0
    v_lshrrev_b32 v4, 4, v0
    v_and_b32 v4, 1, v4
    v_lshlrev_b32 v4, 1, v4
    s_and_b32 s69, s30, 1
    s_lshl_b32 s69, s69, 2
    v_or_b32 v4, s69, v4
    v_xor_b32 v3, v3, v4
    v_lshlrev_b32 v3, 4, v3
    s_mov_b32 s69, 12288
    v_mad_u32_u24 v12, v2, s69, v3
    v_lshrrev_b32 v2, 4, v0
    v_bfe_u32 v3, v0, 2, 2
    v_and_b32 v4, 3, v0
    v_lshrrev_b32 v5, 1, v3
    v_and_b32 v6, 1, v2
    v_lshl_or_b32 v5, v6, 1, v5
    v_lshlrev_b32 v5, 1, v5
    v_lshl_add_u32 v6, v2, 3, v3
    s_lshl_b32 s69, s30, 1
    v_lshrrev_b32 v7, 1, v4
    v_or_b32 v7, s69, v7
    v_xor_b32 v7, v7, v5
    v_lshlrev_b32 v7, 4, v7
    v_and_b32 v4, 1, v4
    v_lshl_or_b32 v7, v4, 3, v7
    v_lshl_add_u32 v14, v6, 7, v7
    s_mul_i32 s71, s74, 384
    s_add_u32 s71, s71, 0
    s_mul_i32 s69, s30, 98304
    s_add_u32 s69, s69, s71
    s_lshl_b32 s70, s30, 10
    s_add_u32 m0, s70, 0
    s_nop 0
    buffer_load_dwordx4 v12, s[12:15], s69 offen lds
    s_add_u32 m0, m0, 4096
    s_add_u32 s69, s69, 393216
    buffer_load_dwordx4 v12, s[12:15], s69 offen lds
    s_add_u32 m0, m0, 4096
    s_add_u32 s69, s69, 393216
    buffer_load_dwordx4 v12, s[12:15], s69 offen lds
    s_add_u32 m0, m0, 4096
    s_add_u32 s69, s69, 393216
    buffer_load_dwordx4 v12, s[12:15], s69 offen lds
    s_add_u32 m0, m0, 4096
    s_add_u32 s69, s69, 393216
    buffer_load_dwordx4 v12, s[12:15], s69 offen lds
    s_add_u32 m0, m0, 4096
    s_add_u32 s69, s69, 393216
    buffer_load_dwordx4 v12, s[12:15], s69 offen lds
    s_add_u32 m0, m0, 4096
    s_add_u32 s69, s69, 393216
    buffer_load_dwordx4 v12, s[12:15], s69 offen lds
    s_add_u32 m0, m0, 4096
    s_add_u32 s69, s69, 393216
    buffer_load_dwordx4 v12, s[12:15], s69 offen lds
    s_add_u32 m0, m0, 4096
    s_add_u32 s69, s69, 393216
    buffer_load_dwordx4 v12, s[12:15], s69 offen lds
    s_add_u32 m0, m0, 4096
    s_add_u32 s69, s69, 393216
    buffer_load_dwordx4 v12, s[12:15], s69 offen lds
    s_add_u32 m0, m0, 4096
    s_add_u32 s69, s69, 393216
    buffer_load_dwordx4 v12, s[12:15], s69 offen lds
    s_add_u32 m0, m0, 4096
    s_add_u32 s69, s69, 393216
    buffer_load_dwordx4 v12, s[12:15], s69 offen lds
    s_add_u32 m0, m0, 4096
    s_add_u32 s69, s69, 393216
    buffer_load_dwordx4 v12, s[12:15], s69 offen lds
    s_add_u32 m0, m0, 4096
    s_add_u32 s69, s69, 393216
    buffer_load_dwordx4 v12, s[12:15], s69 offen lds
    s_add_u32 m0, m0, 4096
    s_add_u32 s69, s69, 393216
    buffer_load_dwordx4 v12, s[12:15], s69 offen lds
    s_add_u32 m0, m0, 4096
    s_add_u32 s69, s69, 393216
    buffer_load_dwordx4 v12, s[12:15], s69 offen lds
    s_add_u32 m0, m0, 4096
    s_add_u32 s69, s69, 393216
    buffer_load_dwordx4 v12, s[12:15], s69 offen lds
    s_add_u32 m0, m0, 4096
    s_add_u32 s69, s69, 393216
    buffer_load_dwordx4 v12, s[12:15], s69 offen lds
    s_add_u32 m0, m0, 4096
    s_add_u32 s69, s69, 393216
    buffer_load_dwordx4 v12, s[12:15], s69 offen lds
    s_add_u32 m0, m0, 4096
    s_add_u32 s69, s69, 393216
    buffer_load_dwordx4 v12, s[12:15], s69 offen lds
    s_mul_i32 s71, s74, 384
    s_add_u32 s71, s71, 128
    s_mul_i32 s69, s30, 98304
    s_add_u32 s69, s69, s71
    s_lshl_b32 s70, s30, 10
    s_add_u32 m0, s70, 81920
    s_nop 0
    buffer_load_dwordx4 v12, s[12:15], s69 offen lds
    s_add_u32 m0, m0, 4096
    s_add_u32 s69, s69, 393216
    buffer_load_dwordx4 v12, s[12:15], s69 offen lds
    s_add_u32 m0, m0, 4096
    s_add_u32 s69, s69, 393216
    buffer_load_dwordx4 v12, s[12:15], s69 offen lds
    s_add_u32 m0, m0, 4096
    s_add_u32 s69, s69, 393216
    buffer_load_dwordx4 v12, s[12:15], s69 offen lds
    s_add_u32 m0, m0, 4096
    s_add_u32 s69, s69, 393216
    buffer_load_dwordx4 v12, s[12:15], s69 offen lds
    s_add_u32 m0, m0, 4096
    s_add_u32 s69, s69, 393216
    buffer_load_dwordx4 v12, s[12:15], s69 offen lds
    s_add_u32 m0, m0, 4096
    s_add_u32 s69, s69, 393216
    buffer_load_dwordx4 v12, s[12:15], s69 offen lds
    s_add_u32 m0, m0, 4096
    s_add_u32 s69, s69, 393216
    buffer_load_dwordx4 v12, s[12:15], s69 offen lds
    s_add_u32 m0, m0, 4096
    s_add_u32 s69, s69, 393216
    buffer_load_dwordx4 v12, s[12:15], s69 offen lds
    s_add_u32 m0, m0, 4096
    s_add_u32 s69, s69, 393216
    buffer_load_dwordx4 v12, s[12:15], s69 offen lds
    s_add_u32 m0, m0, 4096
    s_add_u32 s69, s69, 393216
    buffer_load_dwordx4 v12, s[12:15], s69 offen lds
    s_add_u32 m0, m0, 4096
    s_add_u32 s69, s69, 393216
    buffer_load_dwordx4 v12, s[12:15], s69 offen lds
    s_add_u32 m0, m0, 4096
    s_add_u32 s69, s69, 393216
    buffer_load_dwordx4 v12, s[12:15], s69 offen lds
    s_add_u32 m0, m0, 4096
    s_add_u32 s69, s69, 393216
    buffer_load_dwordx4 v12, s[12:15], s69 offen lds
    s_add_u32 m0, m0, 4096
    s_add_u32 s69, s69, 393216
    buffer_load_dwordx4 v12, s[12:15], s69 offen lds
    s_add_u32 m0, m0, 4096
    s_add_u32 s69, s69, 393216
    buffer_load_dwordx4 v12, s[12:15], s69 offen lds
    s_add_u32 m0, m0, 4096
    s_add_u32 s69, s69, 393216
    buffer_load_dwordx4 v12, s[12:15], s69 offen lds
    s_add_u32 m0, m0, 4096
    s_add_u32 s69, s69, 393216
    buffer_load_dwordx4 v12, s[12:15], s69 offen lds
    s_add_u32 m0, m0, 4096
    s_add_u32 s69, s69, 393216
    buffer_load_dwordx4 v12, s[12:15], s69 offen lds
    s_add_u32 m0, m0, 4096
    s_add_u32 s69, s69, 393216
    buffer_load_dwordx4 v12, s[12:15], s69 offen lds
    s_waitcnt vmcnt(20)
    s_barrier
    v_add_u32 v9, 0, v14
    ds_read_b64_tr_b16 a[0:1], v9 offset:0
    ds_read_b64_tr_b16 a[2:3], v9 offset:512
    ds_read_b64_tr_b16 a[4:5], v9 offset:4096
    ds_read_b64_tr_b16 a[6:7], v9 offset:4608
    ds_read_b64_tr_b16 a[8:9], v9 offset:8192
    ds_read_b64_tr_b16 a[10:11], v9 offset:8704
    ds_read_b64_tr_b16 a[12:13], v9 offset:12288
    ds_read_b64_tr_b16 a[14:15], v9 offset:12800
    ds_read_b64_tr_b16 a[16:17], v9 offset:16384
    ds_read_b64_tr_b16 a[18:19], v9 offset:16896
    ds_read_b64_tr_b16 a[20:21], v9 offset:20480
    ds_read_b64_tr_b16 a[22:23], v9 offset:20992
    s_waitcnt lgkmcnt(0)
    ds_read_b64_tr_b16 a[24:25], v9 offset:24576
    ds_read_b64_tr_b16 a[26:27], v9 offset:25088
    ds_read_b64_tr_b16 a[28:29], v9 offset:28672
    ds_read_b64_tr_b16 a[30:31], v9 offset:29184
    ds_read_b64_tr_b16 a[32:33], v9 offset:32768
    ds_read_b64_tr_b16 a[34:35], v9 offset:33280
    ds_read_b64_tr_b16 a[36:37], v9 offset:36864
    ds_read_b64_tr_b16 a[38:39], v9 offset:37376
    s_waitcnt lgkmcnt(0)
    v_add_u32 v9, 40960, v14
    ds_read_b64_tr_b16 a[40:41], v9 offset:0
    ds_read_b64_tr_b16 a[42:43], v9 offset:512
    ds_read_b64_tr_b16 a[44:45], v9 offset:4096
    ds_read_b64_tr_b16 a[46:47], v9 offset:4608
    ds_read_b64_tr_b16 a[48:49], v9 offset:8192
    ds_read_b64_tr_b16 a[50:51], v9 offset:8704
    ds_read_b64_tr_b16 a[52:53], v9 offset:12288
    ds_read_b64_tr_b16 a[54:55], v9 offset:12800
    ds_read_b64_tr_b16 a[56:57], v9 offset:16384
    ds_read_b64_tr_b16 a[58:59], v9 offset:16896
    ds_read_b64_tr_b16 a[60:61], v9 offset:20480
    ds_read_b64_tr_b16 a[62:63], v9 offset:20992
    s_waitcnt lgkmcnt(0)
    ds_read_b64_tr_b16 a[64:65], v9 offset:24576
    ds_read_b64_tr_b16 a[66:67], v9 offset:25088
    ds_read_b64_tr_b16 a[68:69], v9 offset:28672
    ds_read_b64_tr_b16 a[70:71], v9 offset:29184
    ds_read_b64_tr_b16 a[72:73], v9 offset:32768
    ds_read_b64_tr_b16 a[74:75], v9 offset:33280
    ds_read_b64_tr_b16 a[76:77], v9 offset:36864
    ds_read_b64_tr_b16 a[78:79], v9 offset:37376
    s_waitcnt lgkmcnt(0)
    s_barrier
    s_mul_i32 s71, s74, 384
    s_add_u32 s71, s71, 256
    s_mul_i32 s69, s30, 98304
    s_add_u32 s69, s69, s71
    s_lshl_b32 s70, s30, 10
    s_add_u32 m0, s70, 0
    s_nop 0
    buffer_load_dwordx4 v12, s[12:15], s69 offen lds
    s_add_u32 m0, m0, 4096
    s_add_u32 s69, s69, 393216
    buffer_load_dwordx4 v12, s[12:15], s69 offen lds
    s_add_u32 m0, m0, 4096
    s_add_u32 s69, s69, 393216
    buffer_load_dwordx4 v12, s[12:15], s69 offen lds
    s_add_u32 m0, m0, 4096
    s_add_u32 s69, s69, 393216
    buffer_load_dwordx4 v12, s[12:15], s69 offen lds
    s_add_u32 m0, m0, 4096
    s_add_u32 s69, s69, 393216
    buffer_load_dwordx4 v12, s[12:15], s69 offen lds
    s_add_u32 m0, m0, 4096
    s_add_u32 s69, s69, 393216
    buffer_load_dwordx4 v12, s[12:15], s69 offen lds
    s_add_u32 m0, m0, 4096
    s_add_u32 s69, s69, 393216
    buffer_load_dwordx4 v12, s[12:15], s69 offen lds
    s_add_u32 m0, m0, 4096
    s_add_u32 s69, s69, 393216
    buffer_load_dwordx4 v12, s[12:15], s69 offen lds
    s_add_u32 m0, m0, 4096
    s_add_u32 s69, s69, 393216
    buffer_load_dwordx4 v12, s[12:15], s69 offen lds
    s_add_u32 m0, m0, 4096
    s_add_u32 s69, s69, 393216
    buffer_load_dwordx4 v12, s[12:15], s69 offen lds
    s_add_u32 m0, m0, 4096
    s_add_u32 s69, s69, 393216
    buffer_load_dwordx4 v12, s[12:15], s69 offen lds
    s_add_u32 m0, m0, 4096
    s_add_u32 s69, s69, 393216
    buffer_load_dwordx4 v12, s[12:15], s69 offen lds
    s_add_u32 m0, m0, 4096
    s_add_u32 s69, s69, 393216
    buffer_load_dwordx4 v12, s[12:15], s69 offen lds
    s_add_u32 m0, m0, 4096
    s_add_u32 s69, s69, 393216
    buffer_load_dwordx4 v12, s[12:15], s69 offen lds
    s_add_u32 m0, m0, 4096
    s_add_u32 s69, s69, 393216
    buffer_load_dwordx4 v12, s[12:15], s69 offen lds
    s_add_u32 m0, m0, 4096
    s_add_u32 s69, s69, 393216
    buffer_load_dwordx4 v12, s[12:15], s69 offen lds
    s_add_u32 m0, m0, 4096
    s_add_u32 s69, s69, 393216
    buffer_load_dwordx4 v12, s[12:15], s69 offen lds
    s_add_u32 m0, m0, 4096
    s_add_u32 s69, s69, 393216
    buffer_load_dwordx4 v12, s[12:15], s69 offen lds
    s_add_u32 m0, m0, 4096
    s_add_u32 s69, s69, 393216
    buffer_load_dwordx4 v12, s[12:15], s69 offen lds
    s_add_u32 m0, m0, 4096
    s_add_u32 s69, s69, 393216
    buffer_load_dwordx4 v12, s[12:15], s69 offen lds
    s_waitcnt vmcnt(20)
    s_barrier
    v_add_u32 v9, 81920, v14
    ds_read_b64_tr_b16 a[80:81], v9 offset:0
    ds_read_b64_tr_b16 a[82:83], v9 offset:512
    ds_read_b64_tr_b16 a[84:85], v9 offset:4096
    ds_read_b64_tr_b16 a[86:87], v9 offset:4608
    ds_read_b64_tr_b16 a[88:89], v9 offset:8192
    ds_read_b64_tr_b16 a[90:91], v9 offset:8704
    ds_read_b64_tr_b16 a[92:93], v9 offset:12288
    ds_read_b64_tr_b16 a[94:95], v9 offset:12800
    ds_read_b64_tr_b16 a[96:97], v9 offset:16384
    ds_read_b64_tr_b16 a[98:99], v9 offset:16896
    ds_read_b64_tr_b16 a[100:101], v9 offset:20480
    ds_read_b64_tr_b16 a[102:103], v9 offset:20992
    s_waitcnt lgkmcnt(0)
    ds_read_b64_tr_b16 a[104:105], v9 offset:24576
    ds_read_b64_tr_b16 a[106:107], v9 offset:25088
    ds_read_b64_tr_b16 a[108:109], v9 offset:28672
    ds_read_b64_tr_b16 a[110:111], v9 offset:29184
    ds_read_b64_tr_b16 a[112:113], v9 offset:32768
    ds_read_b64_tr_b16 a[114:115], v9 offset:33280
    ds_read_b64_tr_b16 a[116:117], v9 offset:36864
    ds_read_b64_tr_b16 a[118:119], v9 offset:37376
    s_waitcnt lgkmcnt(0)
    v_add_u32 v9, 122880, v14
    ds_read_b64_tr_b16 a[120:121], v9 offset:0
    ds_read_b64_tr_b16 a[122:123], v9 offset:512
    ds_read_b64_tr_b16 a[124:125], v9 offset:4096
    ds_read_b64_tr_b16 a[126:127], v9 offset:4608
    ds_read_b64_tr_b16 a[128:129], v9 offset:8192
    ds_read_b64_tr_b16 a[130:131], v9 offset:8704
    ds_read_b64_tr_b16 a[132:133], v9 offset:12288
    ds_read_b64_tr_b16 a[134:135], v9 offset:12800
    ds_read_b64_tr_b16 a[136:137], v9 offset:16384
    ds_read_b64_tr_b16 a[138:139], v9 offset:16896
    ds_read_b64_tr_b16 a[140:141], v9 offset:20480
    ds_read_b64_tr_b16 a[142:143], v9 offset:20992
    s_waitcnt lgkmcnt(0)
    ds_read_b64_tr_b16 a[144:145], v9 offset:24576
    ds_read_b64_tr_b16 a[146:147], v9 offset:25088
    ds_read_b64_tr_b16 a[148:149], v9 offset:28672
    ds_read_b64_tr_b16 a[150:151], v9 offset:29184
    ds_read_b64_tr_b16 a[152:153], v9 offset:32768
    ds_read_b64_tr_b16 a[154:155], v9 offset:33280
    ds_read_b64_tr_b16 a[156:157], v9 offset:36864
    ds_read_b64_tr_b16 a[158:159], v9 offset:37376
    s_waitcnt lgkmcnt(0)
    s_barrier
    s_waitcnt vmcnt(0)
    s_barrier
    v_add_u32 v9, 0, v14
    ds_read_b64_tr_b16 a[160:161], v9 offset:0
    ds_read_b64_tr_b16 a[162:163], v9 offset:512
    ds_read_b64_tr_b16 a[164:165], v9 offset:4096
    ds_read_b64_tr_b16 a[166:167], v9 offset:4608
    ds_read_b64_tr_b16 a[168:169], v9 offset:8192
    ds_read_b64_tr_b16 a[170:171], v9 offset:8704
    ds_read_b64_tr_b16 a[172:173], v9 offset:12288
    ds_read_b64_tr_b16 a[174:175], v9 offset:12800
    ds_read_b64_tr_b16 a[176:177], v9 offset:16384
    ds_read_b64_tr_b16 a[178:179], v9 offset:16896
    ds_read_b64_tr_b16 a[180:181], v9 offset:20480
    ds_read_b64_tr_b16 a[182:183], v9 offset:20992
    s_waitcnt lgkmcnt(0)
    ds_read_b64_tr_b16 a[184:185], v9 offset:24576
    ds_read_b64_tr_b16 a[186:187], v9 offset:25088
    ds_read_b64_tr_b16 a[188:189], v9 offset:28672
    ds_read_b64_tr_b16 a[190:191], v9 offset:29184
    ds_read_b64_tr_b16 a[192:193], v9 offset:32768
    ds_read_b64_tr_b16 a[194:195], v9 offset:33280
    ds_read_b64_tr_b16 a[196:197], v9 offset:36864
    ds_read_b64_tr_b16 a[198:199], v9 offset:37376
    s_waitcnt lgkmcnt(0)
    v_add_u32 v9, 40960, v14
    ds_read_b64_tr_b16 a[200:201], v9 offset:0
    ds_read_b64_tr_b16 a[202:203], v9 offset:512
    ds_read_b64_tr_b16 a[204:205], v9 offset:4096
    ds_read_b64_tr_b16 a[206:207], v9 offset:4608
    ds_read_b64_tr_b16 a[208:209], v9 offset:8192
    ds_read_b64_tr_b16 a[210:211], v9 offset:8704
    ds_read_b64_tr_b16 a[212:213], v9 offset:12288
    ds_read_b64_tr_b16 a[214:215], v9 offset:12800
    ds_read_b64_tr_b16 a[216:217], v9 offset:16384
    ds_read_b64_tr_b16 a[218:219], v9 offset:16896
    ds_read_b64_tr_b16 a[220:221], v9 offset:20480
    ds_read_b64_tr_b16 a[222:223], v9 offset:20992
    s_waitcnt lgkmcnt(0)
    ds_read_b64_tr_b16 a[224:225], v9 offset:24576
    ds_read_b64_tr_b16 a[226:227], v9 offset:25088
    ds_read_b64_tr_b16 a[228:229], v9 offset:28672
    ds_read_b64_tr_b16 a[230:231], v9 offset:29184
    ds_read_b64_tr_b16 a[232:233], v9 offset:32768
    ds_read_b64_tr_b16 a[234:235], v9 offset:33280
    ds_read_b64_tr_b16 a[236:237], v9 offset:36864
    ds_read_b64_tr_b16 a[238:239], v9 offset:37376
    s_waitcnt lgkmcnt(0)
    s_barrier
    v_mov_b32 v2, 128
wa_68:
    buffer_load_dword v3, v2, s[64:67], 0 offen sc1
    s_waitcnt vmcnt(0)
    v_cmp_ne_u32 vcc, 0x100, v3
    s_cbranch_vccz wad_69
    s_sub_u32 s68, s68, 1
    s_cbranch_scc0 ok_70
    s_mov_b32 s69, 1
    s_branch FAIL
ok_70:
    s_sleep 4
    s_branch wa_68
wad_69:
    v_and_b32 v2, 7, v0
    v_lshlrev_b32 v2, 2, v2
    buffer_load_dword v3, v2, s[64:67], 0 offen sc1
    s_waitcnt vmcnt(0)
    v_cmp_ne_u32 vcc, 32, v3
    s_cbranch_vccnz SAFEENTRY
    v_and_b32 v2, 15, v0
    v_lshrrev_b32 v3, 4, v0
    s_and_b32 s69, s30, 1
    s_lshl_b32 s69, s69, 4
    v_add_u32 v2, s69, v2
    s_mov_b32 s69, 1280
    v_mul_u32_u24 v2, s69, v2
    s_lshr_b32 s69, s30, 1
    s_mul_i32 s69, s69, 640
    v_lshl_add_u32 v2, v3, 4, v2
    v_add_u32 v10, s69, v2
    v_lshlrev_b32 v11, 4, v0
    v_and_b32 v16, 15, v0
    v_lshrrev_b32 v17, 4, v0
    v_and_b32 v18, 7, v0
    s_lshr_b32 s69, s30, 1
    s_lshl_b32 s69, s69, 10
    s_and_b32 s70, s30, 1
    s_lshl_b32 s70, s70, 3
    s_add_u32 s69, s69, s70
    s_add_u32 s69, s69, 81920
    v_add_u32 v12, s69, v11
    s_and_b32 s69, s30, 1
    s_mul_i32 s69, s69, 6144
    s_add_u32 s69, s69, 81920
    v_add_u32 v9, s69, v11
    v_add_u32 v8, 94208, v11
    v_bfe_u32 v19, v0, 2, 2
    v_lshlrev_b32 v19, 4, v19
    v_lshl_add_u32 v19, v17, 6, v19
    v_and_b32 v78, 1, v0
    v_lshl_add_u32 v78, v78, 3, v19
    v_add_u32 v78, 118784, v78
    s_lshr_b32 s69, s30, 1
    s_mul_i32 s69, s69, 1536
    s_add_u32 s69, s69, 121856
    v_and_b32 v19, 1, v17
    v_lshlrev_b32 v19, 7, v19
    v_lshl_add_u32 v19, v16, 3, v19
    v_add_u32 v79, s69, v19
    v_mov_b32 v20, 0xff800000
    v_mov_b32 v21, 0
    v_cmp_le_u32 vcc, 2, v17
    s_nop 1
    v_cndmask_b32 v188, v21, v20, vcc
    v_cndmask_b32 v189, v21, v20, vcc
    v_cndmask_b32 v190, v21, v20, vcc
    v_cndmask_b32 v191, v21, v20, vcc
    s_and_b32 s69, s30, 1
    s_lshl_b32 s69, s69, 4
    v_add_u32 v22, s69, v16
    v_lshl_add_u32 v23, v17, 2, 0
    v_cmp_gt_u32 vcc, v23, v22
    s_nop 1
    v_cndmask_b32 v192, v21, v20, vcc
    v_lshl_add_u32 v23, v17, 2, 1
    v_cmp_gt_u32 vcc, v23, v22
    s_nop 1
    v_cndmask_b32 v193, v21, v20, vcc
    v_lshl_add_u32 v23, v17, 2, 2
    v_cmp_gt_u32 vcc, v23, v22
    s_nop 1
    v_cndmask_b32 v194, v21, v20, vcc
    v_lshl_add_u32 v23, v17, 2, 3
    v_cmp_gt_u32 vcc, v23, v22
    s_nop 1
    v_cndmask_b32 v195, v21, v20, vcc
    v_lshl_add_u32 v23, v17, 2, 16
    v_cmp_gt_u32 vcc, v23, v22
    s_nop 1
    v_cndmask_b32 v196, v21, v20, vcc
    v_lshl_add_u32 v23, v17, 2, 17
    v_cmp_gt_u32 vcc, v23, v22
    s_nop 1
    v_cndmask_b32 v197, v21, v20, vcc
    v_lshl_add_u32 v23, v17, 2, 18
    v_cmp_gt_u32 vcc, v23, v22
    s_nop 1
    v_cndmask_b32 v198, v21, v20, vcc
    v_lshl_add_u32 v23, v17, 2, 19
    v_cmp_gt_u32 vcc, v23, v22
    s_nop 1
    v_cndmask_b32 v199, v21, v20, vcc
    v_mov_b32 v246, 0
    v_mov_b32 v247, 0
    v_mov_b32 v224, 0
    v_mov_b32 v225, 0
    v_mov_b32 v226, 0
    v_mov_b32 v227, 0
    v_mov_b32 v228, 0
    v_mov_b32 v229, 0
    v_mov_b32 v230, 0
    v_mov_b32 v231, 0
    v_mov_b32 v232, 0
    v_mov_b32 v233, 0
    v_mov_b32 v234, 0
    v_mov_b32 v235, 0
    v_mov_b32 v236, 0
    v_mov_b32 v237, 0
    v_mov_b32 v238, 0
    v_mov_b32 v239, 0
    s_lshl_b32 s69, s74, 7
    s_add_u32 s69, s69, 2097152
    v_min_u32 v19, 19, v0
    v_lshlrev_b32 v19, 2, v19
    v_add_u32 v76, s69, v19
    s_lshl_b32 s69, s28, 7
    s_lshl_b32 s70, s73, 4
    s_add_u32 s69, s69, s70
    s_lshl_b32 s70, s30, 2
    s_add_u32 s69, s69, s70
    s_add_u32 s69, s69, 2101248
    v_mov_b32 v13, s69
    s_mul_i32 s71, s30, 3072
    s_mul_i32 s75, s74, 786432
    s_add_u32 s75, s75, 4194304
    s_add_u32 s75, s75, s71
    s_add_u32 s79, s75, 25165824
    s_mul_i32 s80, s74, 196608
    s_add_u32 s80, s80, 79691776
    s_add_u32 s81, s80, 6291456
    s_mul_i32 s82, s28, 3145728
    s_add_u32 s82, s82, 54525952
    s_and_b32 s69, s30, 1
    s_mul_i32 s69, s69, 24576
    s_add_u32 s82, s82, s69
    s_mul_i32 s69, s73, 6
    s_lshr_b32 s70, s30, 1
    s_mul_i32 s70, s70, 3
    s_add_u32 s69, s69, s70
    s_lshl_b32 s69, s69, 10
    s_add_u32 s82, s82, s69
    s_mov_b32 s84, 0x3dd53b95
    s_mov_b32 s31, 0
    s_mov_b32 s76, 0
    s_mul_i32 s69, s31, 40960
    s_and_b32 s70, s30, 1
    s_mul_i32 s70, s70, 20
    s_lshr_b32 s71, s30, 1
    s_mul_i32 s71, s71, 10
    s_add_u32 s70, s70, s71
    s_lshl_b32 s70, s70, 10
    s_add_u32 m0, s70, s76
    s_nop 0
    buffer_load_dwordx4 v10, s[8:11], s69 offen offset:0 lds
    s_add_u32 m0, m0, 960
    s_nop 0
    buffer_load_dwordx4 v10, s[8:11], s69 offen offset:64 lds
    s_add_u32 m0, m0, 960
    s_nop 0
    buffer_load_dwordx4 v10, s[8:11], s69 offen offset:128 lds
    s_add_u32 m0, m0, 960
    s_nop 0
    buffer_load_dwordx4 v10, s[8:11], s69 offen offset:192 lds
    s_add_u32 m0, m0, 960
    s_nop 0
    buffer_load_dwordx4 v10, s[8:11], s69 offen offset:256 lds
    s_add_u32 m0, m0, 960
    s_nop 0
    buffer_load_dwordx4 v10, s[8:11], s69 offen offset:320 lds
    s_add_u32 m0, m0, 960
    s_nop 0
    buffer_load_dwordx4 v10, s[8:11], s69 offen offset:384 lds
    s_add_u32 m0, m0, 960
    s_nop 0
    buffer_load_dwordx4 v10, s[8:11], s69 offen offset:448 lds
    s_add_u32 m0, m0, 960
    s_nop 0
    buffer_load_dwordx4 v10, s[8:11], s69 offen offset:512 lds
    s_add_u32 m0, m0, 960
    s_nop 0
    buffer_load_dwordx4 v10, s[8:11], s69 offen offset:576 lds
    buffer_load_dword v77, v76, s[4:7], 0 offen sc1
    s_waitcnt vmcnt(0)
qloop_71:
    s_barrier
    s_add_u32 s85, s31, 1
fw_72:
    v_cmp_gt_u32 vcc, s85, v77
    s_and_b32 s69, vcc_lo, 0xff
    s_cbranch_scc0 fwd_73
    s_sub_u32 s68, s68, 1
    s_cbranch_scc0 ok_74
    s_mov_b32 s69, 30
    s_branch FAIL
ok_74:
    buffer_load_dword v77, v76, s[4:7], 0 offen sc1
    s_waitcnt vmcnt(0)
    s_branch fw_72
fwd_73:
    s_mul_i32 s70, s30, 3072
    s_add_u32 m0, s70, 94208
    s_nop 0
    buffer_load_dwordx4 v11, s[4:7], s75 offen offset:0 sc1 lds
    buffer_load_dwordx4 v11, s[4:7], s75 offen offset:1024 sc1 lds
    buffer_load_dwordx4 v11, s[4:7], s75 offen offset:2048 sc1 lds
    s_add_u32 m0, s70, 106496
    s_nop 0
    buffer_load_dwordx4 v11, s[4:7], s79 offen offset:0 sc1 lds
    buffer_load_dwordx4 v11, s[4:7], s79 offen offset:1024 sc1 lds
    buffer_load_dwordx4 v11, s[4:7], s79 offen offset:2048 sc1 lds
    v_cmp_gt_u32 vcc, s85, v77
    s_and_b32 s83, vcc_lo, 0xfff00
    s_cbranch_scc1 qlate_75
    s_lshl_b32 s70, s30, 10
    s_cmp_eq_u32 s30, 3
    s_cbranch_scc1 md_76
    s_add_u32 m0, s70, 118784
    s_add_u32 s71, s80, s70
    buffer_load_dwordx4 v11, s[4:7], s71 offen sc1 lds
md_76:
    s_cmp_eq_u32 s30, 0
    s_cbranch_scc1 mdd_77
    s_sub_u32 s70, s70, 1024
    s_add_u32 m0, s70, 121856
    s_add_u32 s71, s81, s70
    buffer_load_dwordx4 v11, s[4:7], s71 offen sc1 lds
mdd_77:
qlate_75:
    v_add_u32 v14, s76, v11
    s_xor_b32 s76, s76, 40960
    s_add_u32 s77, s31, 1
    s_mul_i32 s78, s77, 40960
    s_and_b32 s70, s30, 1
    s_mul_i32 s70, s70, 20
    s_lshr_b32 s71, s30, 1
    s_mul_i32 s71, s71, 10
    s_add_u32 s70, s70, s71
    s_lshl_b32 s70, s70, 10
    s_add_u32 m0, s70, s76
    ds_read_b128 v[16:19], v14 offset:0
    ds_read_b128 v[20:23], v14 offset:1024
    ds_read_b128 v[24:27], v14 offset:2048
    ds_read_b128 v[28:31], v14 offset:3072
    ds_read_b128 v[32:35], v14 offset:4096
    s_waitcnt lgkmcnt(4)
    v_mfma_f32_16x16x32_bf16 v[40:43], a[0:3], v[16:19], 0
    v_mfma_f32_16x16x32_bf16 v[48:51], a[80:83], v[16:19], 0
    v_mfma_f32_16x16x32_bf16 v[56:59], a[160:163], v[16:19], 0
    buffer_load_dwordx4 v10, s[8:11], s78 offen offset:0 lds
    s_add_u32 m0, m0, 960
    ds_read_b128 v[36:39], v14 offset:5120
    s_waitcnt lgkmcnt(4)
    v_mfma_f32_16x16x32_bf16 v[40:43], a[4:7], v[20:23], v[40:43]
    v_mfma_f32_16x16x32_bf16 v[48:51], a[84:87], v[20:23], v[48:51]
    v_mfma_f32_16x16x32_bf16 v[56:59], a[164:167], v[20:23], v[56:59]
    ds_read_b128 v[16:19], v14 offset:6144
    s_waitcnt lgkmcnt(4)
    v_mfma_f32_16x16x32_bf16 v[40:43], a[8:11], v[24:27], v[40:43]
    v_mfma_f32_16x16x32_bf16 v[48:51], a[88:91], v[24:27], v[48:51]
    v_mfma_f32_16x16x32_bf16 v[56:59], a[168:171], v[24:27], v[56:59]
    ds_read_b128 v[20:23], v14 offset:7168
    s_waitcnt lgkmcnt(4)
    v_mfma_f32_16x16x32_bf16 v[40:43], a[12:15], v[28:31], v[40:43]
    v_mfma_f32_16x16x32_bf16 v[48:51], a[92:95], v[28:31], v[48:51]
    v_mfma_f32_16x16x32_bf16 v[56:59], a[172:175], v[28:31], v[56:59]
    buffer_load_dwordx4 v10, s[8:11], s78 offen offset:64 lds
    s_add_u32 m0, m0, 960
    ds_read_b128 v[24:27], v14 offset:8192
    s_waitcnt lgkmcnt(4)
    v_mfma_f32_16x16x32_bf16 v[40:43], a[16:19], v[32:35], v[40:43]
    v_mfma_f32_16x16x32_bf16 v[48:51], a[96:99], v[32:35], v[48:51]
    v_mfma_f32_16x16x32_bf16 v[56:59], a[176:179], v[32:35], v[56:59]
    ds_read_b128 v[28:31], v14 offset:9216
    s_waitcnt lgkmcnt(4)
    v_mfma_f32_16x16x32_bf16 v[40:43], a[20:23], v[36:39], v[40:43]
    v_mfma_f32_16x16x32_bf16 v[48:51], a[100:103], v[36:39], v[48:51]
    v_mfma_f32_16x16x32_bf16 v[56:59], a[180:183], v[36:39], v[56:59]
    ds_read_b128 v[32:35], v14 offset:10240
    s_waitcnt lgkmcnt(4)
    v_mfma_f32_16x16x32_bf16 v[40:43], a[24:27], v[16:19], v[40:43]
    v_mfma_f32_16x16x32_bf16 v[48:51], a[104:107], v[16:19], v[48:51]
    v_mfma_f32_16x16x32_bf16 v[56:59], a[184:187], v[16:19], v[56:59]
    buffer_load_dwordx4 v10, s[8:11], s78 offen offset:128 lds
    s_add_u32 m0, m0, 960
    ds_read_b128 v[36:39], v14 offset:11264
    s_waitcnt lgkmcnt(4)
    v_mfma_f32_16x16x32_bf16 v[40:43], a[28:31], v[20:23], v[40:43]
    v_mfma_f32_16x16x32_bf16 v[48:51], a[108:111], v[20:23], v[48:51]
    v_mfma_f32_16x16x32_bf16 v[56:59], a[188:191], v[20:23], v[56:59]
    ds_read_b128 v[16:19], v14 offset:12288
    s_waitcnt lgkmcnt(4)
    v_mfma_f32_16x16x32_bf16 v[40:43], a[32:35], v[24:27], v[40:43]
    v_mfma_f32_16x16x32_bf16 v[48:51], a[112:115], v[24:27], v[48:51]
    v_mfma_f32_16x16x32_bf16 v[56:59], a[192:195], v[24:27], v[56:59]
    ds_read_b128 v[20:23], v14 offset:13312
    s_waitcnt lgkmcnt(4)
    v_mfma_f32_16x16x32_bf16 v[40:43], a[36:39], v[28:31], v[40:43]
    v_mfma_f32_16x16x32_bf16 v[48:51], a[116:119], v[28:31], v[48:51]
    v_mfma_f32_16x16x32_bf16 v[56:59], a[196:199], v[28:31], v[56:59]
    buffer_load_dwordx4 v10, s[8:11], s78 offen offset:192 lds
    s_add_u32 m0, m0, 960
    ds_read_b128 v[24:27], v14 offset:14336
    s_waitcnt lgkmcnt(4)
    v_mfma_f32_16x16x32_bf16 v[40:43], a[40:43], v[32:35], v[40:43]
    v_mfma_f32_16x16x32_bf16 v[48:51], a[120:123], v[32:35], v[48:51]
    v_mfma_f32_16x16x32_bf16 v[56:59], a[200:203], v[32:35], v[56:59]
    ds_read_b128 v[28:31], v14 offset:15360
    s_waitcnt lgkmcnt(4)
    v_mfma_f32_16x16x32_bf16 v[40:43], a[44:47], v[36:39], v[40:43]
    v_mfma_f32_16x16x32_bf16 v[48:51], a[124:127], v[36:39], v[48:51]
    v_mfma_f32_16x16x32_bf16 v[56:59], a[204:207], v[36:39], v[56:59]
    ds_read_b128 v[32:35], v14 offset:16384
    s_waitcnt lgkmcnt(4)
    v_mfma_f32_16x16x32_bf16 v[40:43], a[48:51], v[16:19], v[40:43]
    v_mfma_f32_16x16x32_bf16 v[48:51], a[128:131], v[16:19], v[48:51]
    v_mfma_f32_16x16x32_bf16 v[56:59], a[208:211], v[16:19], v[56:59]
    buffer_load_dwordx4 v10, s[8:11], s78 offen offset:256 lds
    s_add_u32 m0, m0, 960
    ds_read_b128 v[36:39], v14 offset:17408
    s_waitcnt lgkmcnt(4)
    v_mfma_f32_16x16x32_bf16 v[40:43], a[52:55], v[20:23], v[40:43]
    v_mfma_f32_16x16x32_bf16 v[48:51], a[132:135], v[20:23], v[48:51]
    v_mfma_f32_16x16x32_bf16 v[56:59], a[212:215], v[20:23], v[56:59]
    ds_read_b128 v[16:19], v14 offset:18432
    s_waitcnt lgkmcnt(4)
    v_mfma_f32_16x16x32_bf16 v[40:43], a[56:59], v[24:27], v[40:43]
    v_mfma_f32_16x16x32_bf16 v[48:51], a[136:139], v[24:27], v[48:51]
    v_mfma_f32_16x16x32_bf16 v[56:59], a[216:219], v[24:27], v[56:59]
    ds_read_b128 v[20:23], v14 offset:19456
    s_waitcnt lgkmcnt(4)
    v_mfma_f32_16x16x32_bf16 v[40:43], a[60:63], v[28:31], v[40:43]
    v_mfma_f32_16x16x32_bf16 v[48:51], a[140:143], v[28:31], v[48:51]
    v_mfma_f32_16x16x32_bf16 v[56:59], a[220:223], v[28:31], v[56:59]
    buffer_load_dwordx4 v10, s[8:11], s78 offen offset:320 lds
    s_add_u32 m0, m0, 960
    ds_read_b128 v[24:27], v14 offset:20480
    s_waitcnt lgkmcnt(4)
    v_mfma_f32_16x16x32_bf16 v[40:43], a[64:67], v[32:35], v[40:43]
    v_mfma_f32_16x16x32_bf16 v[48:51], a[144:147], v[32:35], v[48:51]
    v_mfma_f32_16x16x32_bf16 v[56:59], a[224:227], v[32:35], v[56:59]
    ds_read_b128 v[28:31], v14 offset:21504
    s_waitcnt lgkmcnt(4)
    v_mfma_f32_16x16x32_bf16 v[40:43], a[68:71], v[36:39], v[40:43]
    v_mfma_f32_16x16x32_bf16 v[48:51], a[148:151], v[36:39], v[48:51]
    v_mfma_f32_16x16x32_bf16 v[56:59], a[228:231], v[36:39], v[56:59]
    ds_read_b128 v[32:35], v14 offset:22528
    s_waitcnt lgkmcnt(4)
    v_mfma_f32_16x16x32_bf16 v[40:43], a[72:75], v[16:19], v[40:43]
    v_mfma_f32_16x16x32_bf16 v[48:51], a[152:155], v[16:19], v[48:51]
    v_mfma_f32_16x16x32_bf16 v[56:59], a[232:235], v[16:19], v[56:59]
    buffer_load_dwordx4 v10, s[8:11], s78 offen offset:384 lds
    s_add_u32 m0, m0, 960
    ds_read_b128 v[36:39], v14 offset:23552
    s_waitcnt lgkmcnt(4)
    v_mfma_f32_16x16x32_bf16 v[40:43], a[76:79], v[20:23], v[40:43]
    v_mfma_f32_16x16x32_bf16 v[48:51], a[156:159], v[20:23], v[48:51]
    v_mfma_f32_16x16x32_bf16 v[56:59], a[236:239], v[20:23], v[56:59]
    ds_read_b128 v[16:19], v14 offset:24576
    s_waitcnt lgkmcnt(4)
    v_mfma_f32_16x16x32_bf16 v[44:47], a[0:3], v[24:27], 0
    v_mfma_f32_16x16x32_bf16 v[52:55], a[80:83], v[24:27], 0
    v_mfma_f32_16x16x32_bf16 v[60:63], a[160:163], v[24:27], 0
    ds_read_b128 v[20:23], v14 offset:25600
    s_waitcnt lgkmcnt(4)
    v_mfma_f32_16x16x32_bf16 v[44:47], a[4:7], v[28:31], v[44:47]
    v_mfma_f32_16x16x32_bf16 v[52:55], a[84:87], v[28:31], v[52:55]
    v_mfma_f32_16x16x32_bf16 v[60:63], a[164:167], v[28:31], v[60:63]
    buffer_load_dwordx4 v10, s[8:11], s78 offen offset:448 lds
    s_add_u32 m0, m0, 960
    ds_read_b128 v[24:27], v14 offset:26624
    s_waitcnt lgkmcnt(4)
    v_mfma_f32_16x16x32_bf16 v[44:47], a[8:11], v[32:35], v[44:47]
    v_mfma_f32_16x16x32_bf16 v[52:55], a[88:91], v[32:35], v[52:55]
    v_mfma_f32_16x16x32_bf16 v[60:63], a[168:171], v[32:35], v[60:63]
    ds_read_b128 v[28:31], v14 offset:27648
    s_waitcnt lgkmcnt(4)
    v_mfma_f32_16x16x32_bf16 v[44:47], a[12:15], v[36:39], v[44:47]
    v_mfma_f32_16x16x32_bf16 v[52:55], a[92:95], v[36:39], v[52:55]
    v_mfma_f32_16x16x32_bf16 v[60:63], a[172:175], v[36:39], v[60:63]
    ds_read_b128 v[32:35], v14 offset:28672
    s_waitcnt lgkmcnt(4)
    v_mfma_f32_16x16x32_bf16 v[44:47], a[16:19], v[16:19], v[44:47]
    v_mfma_f32_16x16x32_bf16 v[52:55], a[96:99], v[16:19], v[52:55]
    v_mfma_f32_16x16x32_bf16 v[60:63], a[176:179], v[16:19], v[60:63]
    buffer_load_dwordx4 v10, s[8:11], s78 offen offset:512 lds
    s_add_u32 m0, m0, 960
    ds_read_b128 v[36:39], v14 offset:29696
    s_waitcnt lgkmcnt(4)
    v_mfma_f32_16x16x32_bf16 v[44:47], a[20:23], v[20:23], v[44:47]
    v_mfma_f32_16x16x32_bf16 v[52:55], a[100:103], v[20:23], v[52:55]
    v_mfma_f32_16x16x32_bf16 v[60:63], a[180:183], v[20:23], v[60:63]
    ds_read_b128 v[16:19], v14 offset:30720
    s_waitcnt lgkmcnt(4)
    v_mfma_f32_16x16x32_bf16 v[44:47], a[24:27], v[24:27], v[44:47]
    v_mfma_f32_16x16x32_bf16 v[52:55], a[104:107], v[24:27], v[52:55]
    v_mfma_f32_16x16x32_bf16 v[60:63], a[184:187], v[24:27], v[60:63]
    ds_read_b128 v[20:23], v14 offset:31744
    s_waitcnt lgkmcnt(4)
    v_mfma_f32_16x16x32_bf16 v[44:47], a[28:31], v[28:31], v[44:47]
    v_mfma_f32_16x16x32_bf16 v[52:55], a[108:111], v[28:31], v[52:55]
    v_mfma_f32_16x16x32_bf16 v[60:63], a[188:191], v[28:31], v[60:63]
    buffer_load_dwordx4 v10, s[8:11], s78 offen offset:576 lds
    s_add_u32 m0, m0, 960
    ds_read_b128 v[24:27], v14 offset:32768
    s_waitcnt lgkmcnt(4)
    v_mfma_f32_16x16x32_bf16 v[44:47], a[32:35], v[32:35], v[44:47]
    v_mfma_f32_16x16x32_bf16 v[52:55], a[112:115], v[32:35], v[52:55]
    v_mfma_f32_16x16x32_bf16 v[60:63], a[192:195], v[32:35], v[60:63]
    ds_read_b128 v[28:31], v14 offset:33792
    s_waitcnt lgkmcnt(4)
    v_mfma_f32_16x16x32_bf16 v[44:47], a[36:39], v[36:39], v[44:47]
    v_mfma_f32_16x16x32_bf16 v[52:55], a[116:119], v[36:39], v[52:55]
    v_mfma_f32_16x16x32_bf16 v[60:63], a[196:199], v[36:39], v[60:63]
    ds_read_b128 v[32:35], v14 offset:34816
    s_waitcnt lgkmcnt(4)
    v_mfma_f32_16x16x32_bf16 v[44:47], a[40:43], v[16:19], v[44:47]
    v_mfma_f32_16x16x32_bf16 v[52:55], a[120:123], v[16:19], v[52:55]
    v_mfma_f32_16x16x32_bf16 v[60:63], a[200:203], v[16:19], v[60:63]
    ds_read_b128 v[36:39], v14 offset:35840
    s_waitcnt lgkmcnt(4)
    v_mfma_f32_16x16x32_bf16 v[44:47], a[44:47], v[20:23], v[44:47]
    v_mfma_f32_16x16x32_bf16 v[52:55], a[124:127], v[20:23], v[52:55]
    v_mfma_f32_16x16x32_bf16 v[60:63], a[204:207], v[20:23], v[60:63]
    ds_read_b128 v[16:19], v14 offset:36864
    s_waitcnt lgkmcnt(4)
    v_mfma_f32_16x16x32_bf16 v[44:47], a[48:51], v[24:27], v[44:47]
    v_mfma_f32_16x16x32_bf16 v[52:55], a[128:131], v[24:27], v[52:55]
    v_mfma_f32_16x16x32_bf16 v[60:63], a[208:211], v[24:27], v[60:63]
    ds_read_b128 v[20:23], v14 offset:37888
    s_waitcnt lgkmcnt(4)
    v_mfma_f32_16x16x32_bf16 v[44:47], a[52:55], v[28:31], v[44:47]
    v_mfma_f32_16x16x32_bf16 v[52:55], a[132:135], v[28:31], v[52:55]
    v_mfma_f32_16x16x32_bf16 v[60:63], a[212:215], v[28:31], v[60:63]
    ds_read_b128 v[24:27], v14 offset:38912
    s_waitcnt lgkmcnt(4)
    v_mfma_f32_16x16x32_bf16 v[44:47], a[56:59], v[32:35], v[44:47]
    v_mfma_f32_16x16x32_bf16 v[52:55], a[136:139], v[32:35], v[52:55]
    v_mfma_f32_16x16x32_bf16 v[60:63], a[216:219], v[32:35], v[60:63]
    ds_read_b128 v[28:31], v14 offset:39936
    s_waitcnt lgkmcnt(4)
    v_mfma_f32_16x16x32_bf16 v[44:47], a[60:63], v[36:39], v[44:47]
    v_mfma_f32_16x16x32_bf16 v[52:55], a[140:143], v[36:39], v[52:55]
    v_mfma_f32_16x16x32_bf16 v[60:63], a[220:223], v[36:39], v[60:63]
    s_waitcnt lgkmcnt(3)
    v_mfma_f32_16x16x32_bf16 v[44:47], a[64:67], v[16:19], v[44:47]
    v_mfma_f32_16x16x32_bf16 v[52:55], a[144:147], v[16:19], v[52:55]
    v_mfma_f32_16x16x32_bf16 v[60:63], a[224:227], v[16:19], v[60:63]
    s_waitcnt lgkmcnt(2)
    v_mfma_f32_16x16x32_bf16 v[44:47], a[68:71], v[20:23], v[44:47]
    v_mfma_f32_16x16x32_bf16 v[52:55], a[148:151], v[20:23], v[52:55]
    v_mfma_f32_16x16x32_bf16 v[60:63], a[228:231], v[20:23], v[60:63]
    s_waitcnt lgkmcnt(1)
    v_mfma_f32_16x16x32_bf16 v[44:47], a[72:75], v[24:27], v[44:47]
    v_mfma_f32_16x16x32_bf16 v[52:55], a[152:155], v[24:27], v[52:55]
    v_mfma_f32_16x16x32_bf16 v[60:63], a[232:235], v[24:27], v[60:63]
    s_waitcnt lgkmcnt(0)
    v_mfma_f32_16x16x32_bf16 v[44:47], a[76:79], v[28:31], v[44:47]
    v_mfma_f32_16x16x32_bf16 v[52:55], a[156:159], v[28:31], v[52:55]
    v_mfma_f32_16x16x32_bf16 v[60:63], a[236:239], v[28:31], v[60:63]
    v_cvt_pk_bf16_f32 v64, v40, v41
    v_cvt_pk_bf16_f32 v65, v42, v43
    ds_write_b64 v12, v[64:65] offset:0
    s_nop 2
    v_cvt_pk_bf16_f32 v66, v44, v45
    v_cvt_pk_bf16_f32 v67, v46, v47
    ds_write_b64 v12, v[66:67] offset:6144
    v_cvt_pk_bf16_f32 v68, v48, v49
    v_cvt_pk_bf16_f32 v69, v50, v51
    ds_write_b64 v12, v[68:69] offset:2048
    v_cvt_pk_bf16_f32 v70, v52, v53
    v_cvt_pk_bf16_f32 v71, v54, v55
    ds_write_b64 v12, v[70:71] offset:8192
    v_cvt_pk_bf16_f32 v72, v56, v57
    v_cvt_pk_bf16_f32 v73, v58, v59
    ds_write_b64 v12, v[72:73] offset:4096
    v_cvt_pk_bf16_f32 v74, v60, v61
    v_cvt_pk_bf16_f32 v75, v62, v63
    ds_write_b64 v12, v[74:75] offset:10240
    s_cmp_eq_u32 s83, 0
    s_cbranch_scc1 qmem_78
    buffer_load_dword v77, v76, s[4:7], 0 offen sc1
    s_waitcnt vmcnt(0)
fw_79:
    v_cmp_gt_u32 vcc, s85, v77
    s_and_b32 s69, vcc_lo, 0xfff00
    s_cbranch_scc0 fwd_80
    s_sub_u32 s68, s68, 1
    s_cbranch_scc0 ok_81
    s_mov_b32 s69, 31
    s_branch FAIL
ok_81:
    buffer_load_dword v77, v76, s[4:7], 0 offen sc1
    s_waitcnt vmcnt(0)
    s_branch fw_79
fwd_80:
    s_lshl_b32 s70, s30, 10
    s_cmp_eq_u32 s30, 3
    s_cbranch_scc1 md_82
    s_add_u32 m0, s70, 118784
    s_add_u32 s71, s80, s70
    buffer_load_dwordx4 v11, s[4:7], s71 offen sc1 lds
md_82:
    s_cmp_eq_u32 s30, 0
    s_cbranch_scc1 mdd_83
    s_sub_u32 s70, s70, 1024
    s_add_u32 m0, s70, 121856
    s_add_u32 s71, s81, s70
    buffer_load_dwordx4 v11, s[4:7], s71 offen sc1 lds
mdd_83:
qmem_78:
    s_waitcnt vmcnt(0) lgkmcnt(0)
    s_barrier
    ds_read_b128 v[80:83], v9 offset:0
    ds_read_b64_tr_b16 v[152:153], v78 offset:0
    ds_read_b64_tr_b16 v[154:155], v78 offset:256
    ds_read_b128 v[104:107], v8 offset:0
    ds_read_b128 v[128:131], v8 offset:6144
    ds_read_b128 v[84:87], v9 offset:1024
    ds_read_b64_tr_b16 v[156:157], v78 offset:512
    ds_read_b64_tr_b16 v[158:159], v78 offset:768
    ds_read_b128 v[108:111], v8 offset:1024
    ds_read_b128 v[132:135], v8 offset:7168
    ds_read_b128 v[88:91], v9 offset:2048
    ds_read_b64_tr_b16 v[160:161], v78 offset:1024
    ds_read_b64_tr_b16 v[162:163], v78 offset:1280
    ds_read_b128 v[112:115], v8 offset:2048
    ds_read_b128 v[136:139], v8 offset:8192
    s_waitcnt lgkmcnt(10)
    v_mfma_f32_16x16x32_bf16 v[176:179], v[152:155], v[80:83], v[188:191]
    v_mfma_f32_16x16x32_bf16 v[180:183], v[104:107], v[80:83], v[192:195]
    v_mfma_f32_16x16x32_bf16 v[184:187], v[128:131], v[80:83], v[196:199]
    ds_read_b128 v[92:95], v9 offset:3072
    ds_read_b64_tr_b16 v[164:165], v78 offset:1536
    ds_read_b64_tr_b16 v[166:167], v78 offset:1792
    ds_read_b128 v[116:119], v8 offset:3072
    ds_read_b128 v[140:143], v8 offset:9216
    s_waitcnt lgkmcnt(10)
    v_mfma_f32_16x16x32_bf16 v[176:179], v[156:159], v[84:87], v[176:179]
    v_mfma_f32_16x16x32_bf16 v[180:183], v[108:111], v[84:87], v[180:183]
    v_mfma_f32_16x16x32_bf16 v[184:187], v[132:135], v[84:87], v[184:187]
    ds_read_b128 v[96:99], v9 offset:4096
    ds_read_b64_tr_b16 v[168:169], v78 offset:2048
    ds_read_b64_tr_b16 v[170:171], v78 offset:2304
    ds_read_b128 v[120:123], v8 offset:4096
    ds_read_b128 v[144:147], v8 offset:10240
    s_waitcnt lgkmcnt(10)
    v_mfma_f32_16x16x32_bf16 v[176:179], v[160:163], v[88:91], v[176:179]
    v_mfma_f32_16x16x32_bf16 v[180:183], v[112:115], v[88:91], v[180:183]
    v_mfma_f32_16x16x32_bf16 v[184:187], v[136:139], v[88:91], v[184:187]
    ds_read_b128 v[100:103], v9 offset:5120
    ds_read_b64_tr_b16 v[172:173], v78 offset:2560
    ds_read_b64_tr_b16 v[174:175], v78 offset:2816
    ds_read_b128 v[124:127], v8 offset:5120
    ds_read_b128 v[148:151], v8 offset:11264
    s_waitcnt lgkmcnt(10)
    v_mfma_f32_16x16x32_bf16 v[176:179], v[164:167], v[92:95], v[176:179]
    v_mfma_f32_16x16x32_bf16 v[180:183], v[116:119], v[92:95], v[180:183]
    v_mfma_f32_16x16x32_bf16 v[184:187], v[140:143], v[92:95], v[184:187]
    s_waitcnt lgkmcnt(5)
    v_mfma_f32_16x16x32_bf16 v[176:179], v[168:171], v[96:99], v[176:179]
    v_mfma_f32_16x16x32_bf16 v[180:183], v[120:123], v[96:99], v[180:183]
    v_mfma_f32_16x16x32_bf16 v[184:187], v[144:147], v[96:99], v[184:187]
    s_waitcnt lgkmcnt(0)
    v_mfma_f32_16x16x32_bf16 v[176:179], v[172:175], v[100:103], v[176:179]
    v_mfma_f32_16x16x32_bf16 v[180:183], v[124:127], v[100:103], v[180:183]
    v_mfma_f32_16x16x32_bf16 v[184:187], v[148:151], v[100:103], v[184:187]
    s_lshr_b32 s69, s30, 1
    s_mul_i32 s69, s69, 6144
    s_add_u32 s69, s69, 106496
    v_add_u32 v16, s69, v11
    ds_read_b128 v[200:203], v16 offset:0
    ds_read_b64 v[224:225], v79 offset:0
    ds_read_b128 v[204:207], v16 offset:1024
    ds_read_b64 v[226:227], v79 offset:256
    ds_read_b128 v[208:211], v16 offset:2048
    ds_read_b64 v[228:229], v79 offset:512
    ds_read_b128 v[212:215], v16 offset:3072
    ds_read_b64 v[230:231], v79 offset:768
    ds_read_b128 v[216:219], v16 offset:4096
    ds_read_b64 v[232:233], v79 offset:1024
    ds_read_b128 v[220:223], v16 offset:5120
    ds_read_b64 v[234:235], v79 offset:1280
    v_max3_f32 v24, v176, v177, v178
    v_max3_f32 v25, v179, v180, v181
    v_max3_f32 v24, v24, v182, v183
    v_max3_f32 v25, v25, v184, v185
    v_max3_f32 v24, v24, v186, v187
    v_max_f32 v24, v24, v25
    v_mov_b32 v25, v24
    s_nop 1
    v_permlane32_swap_b32 v24, v25
    v_max_f32 v24, v24, v25
    v_mov_b32 v25, v24
    s_nop 1
    v_permlane16_swap_b32 v24, v25
    v_max_f32 v24, v24, v25
    v_mul_f32 v24, s84, v24
    v_fma_f32 v176, v176, s84, -v24
    v_fma_f32 v177, v177, s84, -v24
    v_fma_f32 v178, v178, s84, -v24
    v_fma_f32 v179, v179, s84, -v24
    v_fma_f32 v180, v180, s84, -v24
    v_fma_f32 v181, v181, s84, -v24
    v_fma_f32 v182, v182, s84, -v24
    v_fma_f32 v183, v183, s84, -v24
    v_fma_f32 v184, v184, s84, -v24
    v_fma_f32 v185, v185, s84, -v24
    v_fma_f32 v186, v186, s84, -v24
    v_fma_f32 v187, v187, s84, -v24
    v_exp_f32 v176, v176
    v_exp_f32 v177, v177
    v_exp_f32 v178, v178
    v_exp_f32 v179, v179
    v_exp_f32 v180, v180
    v_exp_f32 v181, v181
    v_exp_f32 v182, v182
    v_exp_f32 v183, v183
    v_exp_f32 v184, v184
    v_exp_f32 v185, v185
    v_exp_f32 v186, v186
    v_exp_f32 v187, v187
    v_add_f32 v24, v176, v177
    v_add_f32 v25, v178, v179
    v_add_f32 v26, v180, v181
    v_add_f32 v27, v182, v183
    v_add_f32 v28, v184, v185
    v_add_f32 v29, v186, v187
    v_add_f32 v24, v24, v25
    v_add_f32 v26, v26, v27
    v_add_f32 v28, v28, v29
    v_add_f32 v24, v24, v26
    v_add_f32 v24, v24, v28
    v_mov_b32 v25, v24
    s_nop 1
    v_permlane32_swap_b32 v24, v25
    v_add_f32 v24, v24, v25
    v_mov_b32 v25, v24
    s_nop 1
    v_permlane16_swap_b32 v24, v25
    v_add_f32 v24, v24, v25
    v_rcp_f32 v24, v24
    s_nop 0
    v_mul_f32 v176, v176, v24
    v_mul_f32 v177, v177, v24
    v_mul_f32 v178, v178, v24
    v_mul_f32 v179, v179, v24
    v_mul_f32 v180, v180, v24
    v_mul_f32 v181, v181, v24
    v_mul_f32 v182, v182, v24
    v_mul_f32 v183, v183, v24
    v_mul_f32 v184, v184, v24
    v_mul_f32 v185, v185, v24
    v_mul_f32 v186, v186, v24
    v_mul_f32 v187, v187, v24
    v_cvt_pk_bf16_f32 v244, v176, v177
    v_cvt_pk_bf16_f32 v245, v178, v179
    v_cvt_pk_bf16_f32 v240, v180, v181
    v_cvt_pk_bf16_f32 v241, v182, v183
    v_cvt_pk_bf16_f32 v242, v184, v185
    v_cvt_pk_bf16_f32 v243, v186, v187
    s_waitcnt lgkmcnt(0)
    s_nop 0
    v_mfma_f32_16x16x32_bf16 v[40:43], v[200:203], v[240:243], 0
    v_mfma_f32_16x16x32_bf16 v[44:47], v[204:207], v[240:243], 0
    v_mfma_f32_16x16x32_bf16 v[48:51], v[208:211], v[240:243], 0
    v_mfma_f32_16x16x32_bf16 v[52:55], v[212:215], v[240:243], 0
    v_mfma_f32_16x16x32_bf16 v[56:59], v[216:219], v[240:243], 0
    v_mfma_f32_16x16x32_bf16 v[60:63], v[220:223], v[240:243], 0
    v_mfma_f32_16x16x32_bf16 v[40:43], v[224:227], v[244:247], v[40:43]
    v_mfma_f32_16x16x32_bf16 v[44:47], v[226:229], v[244:247], v[44:47]
    v_mfma_f32_16x16x32_bf16 v[48:51], v[228:231], v[244:247], v[48:51]
    v_mfma_f32_16x16x32_bf16 v[52:55], v[230:233], v[244:247], v[52:55]
    v_mfma_f32_16x16x32_bf16 v[56:59], v[232:235], v[244:247], v[56:59]
    v_mfma_f32_16x16x32_bf16 v[60:63], v[234:237], v[244:247], v[60:63]
    s_nop 2
    v_cvt_pk_bf16_f32 v64, v40, v41
    v_cvt_pk_bf16_f32 v65, v42, v43
    v_cvt_pk_bf16_f32 v66, v44, v45
    v_cvt_pk_bf16_f32 v67, v46, v47
    buffer_store_dwordx4 v[64:67], v11, s[4:7], s82 offen offset:0
    v_cvt_pk_bf16_f32 v68, v48, v49
    v_cvt_pk_bf16_f32 v69, v50, v51
    v_cvt_pk_bf16_f32 v70, v52, v53
    v_cvt_pk_bf16_f32 v71, v54, v55
    buffer_store_dwordx4 v[68:71], v11, s[4:7], s82 offen offset:1024
    v_cvt_pk_bf16_f32 v72, v56, v57
    v_cvt_pk_bf16_f32 v73, v58, v59
    v_cvt_pk_bf16_f32 v74, v60, v61
    v_cvt_pk_bf16_f32 v75, v62, v63
    buffer_store_dwordx4 v[72:75], v11, s[4:7], s82 offen offset:2048
    buffer_load_dword v77, v76, s[4:7], 0 offen sc1
    s_add_u32 s75, s75, 12288
    s_add_u32 s79, s79, 12288
    s_add_u32 s80, s80, 3072
    s_add_u32 s81, s81, 3072
    s_add_u32 s82, s82, 49152
    s_mov_b32 s31, s77
    s_waitcnt vmcnt(0)
    v_mov_b32 v15, s31
    s_mov_b64 exec, 1
    buffer_store_dword v15, v13, s[4:7], 0 offen
    s_mov_b64 exec, -1
    s_cmp_lt_u32 s31, 64
    s_cbranch_scc1 qloop_71
    s_branch EXIT
ROLE_FF:
    s_mov_b32 s12, s48
    s_mov_b32 s13, s49
    s_mov_b32 s14, 1966080
    s_mov_b32 s15, 0x20000
    s_mov_b32 s16, s50
    s_mov_b32 s17, s51
    s_mov_b32 s18, 1966080
    s_mov_b32 s19, 0x20000
    s_mov_b32 s20, s54
    s_mov_b32 s21, s55
    s_mov_b32 s22, 1280
    s_mov_b32 s23, 0x20000
    s_sub_u32 s73, s29, 24
    s_mul_i32 s74, s28, 3
    s_add_u32 s74, s74, s73
    v_lshrrev_b32 v2, 4, v0
    v_lshlrev_b32 v2, 4, v2
    buffer_load_dwordx4 a[160:163], v2, s[20:23], 0 offen offset:0
    buffer_load_dwordx4 a[164:167], v2, s[20:23], 0 offen offset:64
    buffer_load_dwordx4 a[168:171], v2, s[20:23], 0 offen offset:128
    buffer_load_dwordx4 a[172:175], v2, s[20:23], 0 offen offset:192
    buffer_load_dwordx4 a[176:179], v2, s[20:23], 0 offen offset:256
    buffer_load_dwordx4 a[180:183], v2, s[20:23], 0 offen offset:320
    buffer_load_dwordx4 a[184:187], v2, s[20:23], 0 offen offset:384
    buffer_load_dwordx4 a[188:191], v2, s[20:23], 0 offen offset:448
    buffer_load_dwordx4 a[192:195], v2, s[20:23], 0 offen offset:512
    buffer_load_dwordx4 a[196:199], v2, s[20:23], 0 offen offset:576
    buffer_load_dwordx4 a[200:203], v2, s[20:23], 0 offen offset:640
    buffer_load_dwordx4 a[204:207], v2, s[20:23], 0 offen offset:704
    buffer_load_dwordx4 a[208:211], v2, s[20:23], 0 offen offset:768
    buffer_load_dwordx4 a[212:215], v2, s[20:23], 0 offen offset:832
    buffer_load_dwordx4 a[216:219], v2, s[20:23], 0 offen offset:896
    buffer_load_dwordx4 a[220:223], v2, s[20:23], 0 offen offset:960
    buffer_load_dwordx4 a[224:227], v2, s[20:23], 0 offen offset:1024
    buffer_load_dwordx4 a[228:231], v2, s[20:23], 0 offen offset:1088
    buffer_load_dwordx4 a[232:235], v2, s[20:23], 0 offen offset:1152
    buffer_load_dwordx4 a[236:239], v2, s[20:23], 0 offen offset:1216
    v_lshrrev_b32 v2, 3, v0
    v_and_b32 v3, 7, v0
    v_lshrrev_b32 v4, 4, v0
    v_and_b32 v4, 1, v4
    v_lshlrev_b32 v4, 1, v4
    s_and_b32 s69, s30, 1
    s_lshl_b32 s69, s69, 2
    v_or_b32 v4, s69, v4
    v_xor_b32 v3, v3, v4
    v_lshlrev_b32 v3, 4, v3
    s_mov_b32 s69, 3072
    v_mad_u32_u24 v12, v2, s69, v3
    v_lshrrev_b32 v2, 4, v0
    v_bfe_u32 v3, v0, 2, 2
    v_and_b32 v4, 3, v0
    v_lshrrev_b32 v5, 1, v3
    v_and_b32 v6, 1, v2
    v_lshl_or_b32 v5, v6, 1, v5
    v_lshlrev_b32 v5, 1, v5
    v_lshl_add_u32 v6, v2, 3, v3
    s_lshl_b32 s69, s30, 1
    v_lshrrev_b32 v7, 1, v4
    v_or_b32 v7, s69, v7
    v_xor_b32 v7, v7, v5
    v_lshlrev_b32 v7, 4, v7
    v_and_b32 v4, 1, v4
    v_lshl_or_b32 v7, v4, 3, v7
    v_lshl_add_u32 v14, v6, 7, v7
    s_lshl_b32 s71, s74, 7
    s_mul_i32 s69, s30, 24576
    s_add_u32 s69, s69, s71
    s_lshl_b32 s70, s30, 10
    s_add_u32 m0, s70, 0
    s_nop 0
    buffer_load_dwordx4 v12, s[12:15], s69 offen lds
    s_add_u32 m0, m0, 4096
    s_add_u32 s69, s69, 98304
    buffer_load_dwordx4 v12, s[12:15], s69 offen lds
    s_add_u32 m0, m0, 4096
    s_add_u32 s69, s69, 98304
    buffer_load_dwordx4 v12, s[12:15], s69 offen lds
    s_add_u32 m0, m0, 4096
    s_add_u32 s69, s69, 98304
    buffer_load_dwordx4 v12, s[12:15], s69 offen lds
    s_add_u32 m0, m0, 4096
    s_add_u32 s69, s69, 98304
    buffer_load_dwordx4 v12, s[12:15], s69 offen lds
    s_add_u32 m0, m0, 4096
    s_add_u32 s69, s69, 98304
    buffer_load_dwordx4 v12, s[12:15], s69 offen lds
    s_add_u32 m0, m0, 4096
    s_add_u32 s69, s69, 98304
    buffer_load_dwordx4 v12, s[12:15], s69 offen lds
    s_add_u32 m0, m0, 4096
    s_add_u32 s69, s69, 98304
    buffer_load_dwordx4 v12, s[12:15], s69 offen lds
    s_add_u32 m0, m0, 4096
    s_add_u32 s69, s69, 98304
    buffer_load_dwordx4 v12, s[12:15], s69 offen lds
    s_add_u32 m0, m0, 4096
    s_add_u32 s69, s69, 98304
    buffer_load_dwordx4 v12, s[12:15], s69 offen lds
    s_add_u32 m0, m0, 4096
    s_add_u32 s69, s69, 98304
    buffer_load_dwordx4 v12, s[12:15], s69 offen lds
    s_add_u32 m0, m0, 4096
    s_add_u32 s69, s69, 98304
    buffer_load_dwordx4 v12, s[12:15], s69 offen lds
    s_add_u32 m0, m0, 4096
    s_add_u32 s69, s69, 98304
    buffer_load_dwordx4 v12, s[12:15], s69 offen lds
    s_add_u32 m0, m0, 4096
    s_add_u32 s69, s69, 98304
    buffer_load_dwordx4 v12, s[12:15], s69 offen lds
    s_add_u32 m0, m0, 4096
    s_add_u32 s69, s69, 98304
    buffer_load_dwordx4 v12, s[12:15], s69 offen lds
    s_add_u32 m0, m0, 4096
    s_add_u32 s69, s69, 98304
    buffer_load_dwordx4 v12, s[12:15], s69 offen lds
    s_add_u32 m0, m0, 4096
    s_add_u32 s69, s69, 98304
    buffer_load_dwordx4 v12, s[12:15], s69 offen lds
    s_add_u32 m0, m0, 4096
    s_add_u32 s69, s69, 98304
    buffer_load_dwordx4 v12, s[12:15], s69 offen lds
    s_add_u32 m0, m0, 4096
    s_add_u32 s69, s69, 98304
    buffer_load_dwordx4 v12, s[12:15], s69 offen lds
    s_add_u32 m0, m0, 4096
    s_add_u32 s69, s69, 98304
    buffer_load_dwordx4 v12, s[12:15], s69 offen lds
    s_lshl_b32 s71, s74, 7
    s_mul_i32 s69, s30, 24576
    s_add_u32 s69, s69, s71
    s_lshl_b32 s70, s30, 10
    s_add_u32 m0, s70, 81920
    s_nop 0
    buffer_load_dwordx4 v12, s[16:19], s69 offen lds
    s_add_u32 m0, m0, 4096
    s_add_u32 s69, s69, 98304
    buffer_load_dwordx4 v12, s[16:19], s69 offen lds
    s_add_u32 m0, m0, 4096
    s_add_u32 s69, s69, 98304
    buffer_load_dwordx4 v12, s[16:19], s69 offen lds
    s_add_u32 m0, m0, 4096
    s_add_u32 s69, s69, 98304
    buffer_load_dwordx4 v12, s[16:19], s69 offen lds
    s_add_u32 m0, m0, 4096
    s_add_u32 s69, s69, 98304
    buffer_load_dwordx4 v12, s[16:19], s69 offen lds
    s_add_u32 m0, m0, 4096
    s_add_u32 s69, s69, 98304
    buffer_load_dwordx4 v12, s[16:19], s69 offen lds
    s_add_u32 m0, m0, 4096
    s_add_u32 s69, s69, 98304
    buffer_load_dwordx4 v12, s[16:19], s69 offen lds
    s_add_u32 m0, m0, 4096
    s_add_u32 s69, s69, 98304
    buffer_load_dwordx4 v12, s[16:19], s69 offen lds
    s_add_u32 m0, m0, 4096
    s_add_u32 s69, s69, 98304
    buffer_load_dwordx4 v12, s[16:19], s69 offen lds
    s_add_u32 m0, m0, 4096
    s_add_u32 s69, s69, 98304
    buffer_load_dwordx4 v12, s[16:19], s69 offen lds
    s_add_u32 m0, m0, 4096
    s_add_u32 s69, s69, 98304
    buffer_load_dwordx4 v12, s[16:19], s69 offen lds
    s_add_u32 m0, m0, 4096
    s_add_u32 s69, s69, 98304
    buffer_load_dwordx4 v12, s[16:19], s69 offen lds
    s_add_u32 m0, m0, 4096
    s_add_u32 s69, s69, 98304
    buffer_load_dwordx4 v12, s[16:19], s69 offen lds
    s_add_u32 m0, m0, 4096
    s_add_u32 s69, s69, 98304
    buffer_load_dwordx4 v12, s[16:19], s69 offen lds
    s_add_u32 m0, m0, 4096
    s_add_u32 s69, s69, 98304
    buffer_load_dwordx4 v12, s[16:19], s69 offen lds
    s_add_u32 m0, m0, 4096
    s_add_u32 s69, s69, 98304
    buffer_load_dwordx4 v12, s[16:19], s69 offen lds
    s_add_u32 m0, m0, 4096
    s_add_u32 s69, s69, 98304
    buffer_load_dwordx4 v12, s[16:19], s69 offen lds
    s_add_u32 m0, m0, 4096
    s_add_u32 s69, s69, 98304
    buffer_load_dwordx4 v12, s[16:19], s69 offen lds
    s_add_u32 m0, m0, 4096
    s_add_u32 s69, s69, 98304
    buffer_load_dwordx4 v12, s[16:19], s69 offen lds
    s_add_u32 m0, m0, 4096
    s_add_u32 s69, s69, 98304
    buffer_load_dwordx4 v12, s[16:19], s69 offen lds
    s_waitcnt vmcnt(20)
    s_barrier
    v_add_u32 v9, 0, v14
    ds_read_b64_tr_b16 a[0:1], v9 offset:0
    ds_read_b64_tr_b16 a[2:3], v9 offset:512
    ds_read_b64_tr_b16 a[4:5], v9 offset:4096
    ds_read_b64_tr_b16 a[6:7], v9 offset:4608
    ds_read_b64_tr_b16 a[8:9], v9 offset:8192
    ds_read_b64_tr_b16 a[10:11], v9 offset:8704
    ds_read_b64_tr_b16 a[12:13], v9 offset:12288
    ds_read_b64_tr_b16 a[14:15], v9 offset:12800
    ds_read_b64_tr_b16 a[16:17], v9 offset:16384
    ds_read_b64_tr_b16 a[18:19], v9 offset:16896
    ds_read_b64_tr_b16 a[20:21], v9 offset:20480
    ds_read_b64_tr_b16 a[22:23], v9 offset:20992
    s_waitcnt lgkmcnt(0)
    ds_read_b64_tr_b16 a[24:25], v9 offset:24576
    ds_read_b64_tr_b16 a[26:27], v9 offset:25088
    ds_read_b64_tr_b16 a[28:29], v9 offset:28672
    ds_read_b64_tr_b16 a[30:31], v9 offset:29184
    ds_read_b64_tr_b16 a[32:33], v9 offset:32768
    ds_read_b64_tr_b16 a[34:35], v9 offset:33280
    ds_read_b64_tr_b16 a[36:37], v9 offset:36864
    ds_read_b64_tr_b16 a[38:39], v9 offset:37376
    s_waitcnt lgkmcnt(0)
    v_add_u32 v9, 40960, v14
    ds_read_b64_tr_b16 a[40:41], v9 offset:0
    ds_read_b64_tr_b16 a[42:43], v9 offset:512
    ds_read_b64_tr_b16 a[44:45], v9 offset:4096
    ds_read_b64_tr_b16 a[46:47], v9 offset:4608
    ds_read_b64_tr_b16 a[48:49], v9 offset:8192
    ds_read_b64_tr_b16 a[50:51], v9 offset:8704
    ds_read_b64_tr_b16 a[52:53], v9 offset:12288
    ds_read_b64_tr_b16 a[54:55], v9 offset:12800
    ds_read_b64_tr_b16 a[56:57], v9 offset:16384
    ds_read_b64_tr_b16 a[58:59], v9 offset:16896
    ds_read_b64_tr_b16 a[60:61], v9 offset:20480
    ds_read_b64_tr_b16 a[62:63], v9 offset:20992
    s_waitcnt lgkmcnt(0)
    ds_read_b64_tr_b16 a[64:65], v9 offset:24576
    ds_read_b64_tr_b16 a[66:67], v9 offset:25088
    ds_read_b64_tr_b16 a[68:69], v9 offset:28672
    ds_read_b64_tr_b16 a[70:71], v9 offset:29184
    ds_read_b64_tr_b16 a[72:73], v9 offset:32768
    ds_read_b64_tr_b16 a[74:75], v9 offset:33280
    ds_read_b64_tr_b16 a[76:77], v9 offset:36864
    ds_read_b64_tr_b16 a[78:79], v9 offset:37376
    s_waitcnt lgkmcnt(0)
    s_barrier
    s_waitcnt vmcnt(0)
    s_barrier
    v_add_u32 v9, 81920, v14
    ds_read_b64_tr_b16 a[80:81], v9 offset:0
    ds_read_b64_tr_b16 a[82:83], v9 offset:512
    ds_read_b64_tr_b16 a[84:85], v9 offset:4096
    ds_read_b64_tr_b16 a[86:87], v9 offset:4608
    ds_read_b64_tr_b16 a[88:89], v9 offset:8192
    ds_read_b64_tr_b16 a[90:91], v9 offset:8704
    ds_read_b64_tr_b16 a[92:93], v9 offset:12288
    ds_read_b64_tr_b16 a[94:95], v9 offset:12800
    ds_read_b64_tr_b16 a[96:97], v9 offset:16384
    ds_read_b64_tr_b16 a[98:99], v9 offset:16896
    ds_read_b64_tr_b16 a[100:101], v9 offset:20480
    ds_read_b64_tr_b16 a[102:103], v9 offset:20992
    s_waitcnt lgkmcnt(0)
    ds_read_b64_tr_b16 a[104:105], v9 offset:24576
    ds_read_b64_tr_b16 a[106:107], v9 offset:25088
    ds_read_b64_tr_b16 a[108:109], v9 offset:28672
    ds_read_b64_tr_b16 a[110:111], v9 offset:29184
    ds_read_b64_tr_b16 a[112:113], v9 offset:32768
    ds_read_b64_tr_b16 a[114:115], v9 offset:33280
    ds_read_b64_tr_b16 a[116:117], v9 offset:36864
    ds_read_b64_tr_b16 a[118:119], v9 offset:37376
    s_waitcnt lgkmcnt(0)
    v_add_u32 v9, 122880, v14
    ds_read_b64_tr_b16 a[120:121], v9 offset:0
    ds_read_b64_tr_b16 a[122:123], v9 offset:512
    ds_read_b64_tr_b16 a[124:125], v9 offset:4096
    ds_read_b64_tr_b16 a[126:127], v9 offset:4608
    ds_read_b64_tr_b16 a[128:129], v9 offset:8192
    ds_read_b64_tr_b16 a[130:131], v9 offset:8704
    ds_read_b64_tr_b16 a[132:133], v9 offset:12288
    ds_read_b64_tr_b16 a[134:135], v9 offset:12800
    ds_read_b64_tr_b16 a[136:137], v9 offset:16384
    ds_read_b64_tr_b16 a[138:139], v9 offset:16896
    ds_read_b64_tr_b16 a[140:141], v9 offset:20480
    ds_read_b64_tr_b16 a[142:143], v9 offset:20992
    s_waitcnt lgkmcnt(0)
    ds_read_b64_tr_b16 a[144:145], v9 offset:24576
    ds_read_b64_tr_b16 a[146:147], v9 offset:25088
    ds_read_b64_tr_b16 a[148:149], v9 offset:28672
    ds_read_b64_tr_b16 a[150:151], v9 offset:29184
    ds_read_b64_tr_b16 a[152:153], v9 offset:32768
    ds_read_b64_tr_b16 a[154:155], v9 offset:33280
    ds_read_b64_tr_b16 a[156:157], v9 offset:36864
    ds_read_b64_tr_b16 a[158:159], v9 offset:37376
    s_waitcnt lgkmcnt(0)
    s_barrier
    v_mov_b32 v2, 128
wa_84:
    buffer_load_dword v3, v2, s[64:67], 0 offen sc1
    s_waitcnt vmcnt(0)
    v_cmp_ne_u32 vcc, 0x100, v3
    s_cbranch_vccz wad_85
    s_sub_u32 s68, s68, 1
    s_cbranch_scc0 ok_86
    s_mov_b32 s69, 1
    s_branch FAIL
ok_86:
    s_sleep 4
    s_branch wa_84
wad_85:
    v_and_b32 v2, 7, v0
    v_lshlrev_b32 v2, 2, v2
    buffer_load_dword v3, v2, s[64:67], 0 offen sc1
    s_waitcnt vmcnt(0)
    v_cmp_ne_u32 vcc, 32, v3
    s_cbranch_vccnz SAFEENTRY
    v_and_b32 v2, 15, v0
    v_lshrrev_b32 v3, 4, v0
    s_and_b32 s69, s30, 1
    s_lshl_b32 s69, s69, 4
    v_add_u32 v2, s69, v2
    s_mov_b32 s69, 1280
    v_mul_u32_u24 v2, s69, v2
    s_lshr_b32 s69, s30, 1
    s_mul_i32 s69, s69, 640
    v_lshl_add_u32 v2, v3, 4, v2
    v_add_u32 v10, s69, v2
    v_lshlrev_b32 v11, 4, v0
    s_lshr_b32 s69, s30, 1
    s_lshl_b32 s69, s69, 10
    s_and_b32 s70, s30, 1
    s_lshl_b32 s70, s70, 3
    s_add_u32 s69, s69, s70
    v_add_u32 v12, s69, v11
    s_lshl_b32 s69, s28, 7
    s_lshl_b32 s70, s73, 4
    s_add_u32 s69, s69, s70
    s_lshl_b32 s70, s30, 2
    s_add_u32 s69, s69, s70
    s_add_u32 s69, s69, 2101312
    v_mov_b32 v13, s69
    s_mul_i32 s75, s28, 786432
    s_add_u32 s75, s75, 92274688
    s_lshl_b32 s69, s73, 11
    s_add_u32 s75, s75, s69
    s_lshl_b32 s79, s28, 13
    s_add_u32 s79, s79, 98566144
    s_add_u32 s80, s73, s30
    v_and_b32 v9, 15, v0
    v_lshlrev_b32 v9, 2, v9
    s_mov_b32 s31, 0
    s_mov_b32 s76, 0
    s_mul_i32 s69, s31, 40960
    s_and_b32 s70, s30, 1
    s_mul_i32 s70, s70, 20
    s_lshr_b32 s71, s30, 1
    s_mul_i32 s71, s71, 10
    s_add_u32 s70, s70, s71
    s_lshl_b32 s70, s70, 10
    s_add_u32 m0, s70, s76
    s_nop 0
    buffer_load_dwordx4 v10, s[8:11], s69 offen offset:0 lds
    s_add_u32 m0, m0, 960
    s_nop 0
    buffer_load_dwordx4 v10, s[8:11], s69 offen offset:64 lds
    s_add_u32 m0, m0, 960
    s_nop 0
    buffer_load_dwordx4 v10, s[8:11], s69 offen offset:128 lds
    s_add_u32 m0, m0, 960
    s_nop 0
    buffer_load_dwordx4 v10, s[8:11], s69 offen offset:192 lds
    s_add_u32 m0, m0, 960
    s_nop 0
    buffer_load_dwordx4 v10, s[8:11], s69 offen offset:256 lds
    s_add_u32 m0, m0, 960
    s_nop 0
    buffer_load_dwordx4 v10, s[8:11], s69 offen offset:320 lds
    s_add_u32 m0, m0, 960
    s_nop 0
    buffer_load_dwordx4 v10, s[8:11], s69 offen offset:384 lds
    s_add_u32 m0, m0, 960
    s_nop 0
    buffer_load_dwordx4 v10, s[8:11], s69 offen offset:448 lds
    s_add_u32 m0, m0, 960
    s_nop 0
    buffer_load_dwordx4 v10, s[8:11], s69 offen offset:512 lds
    s_add_u32 m0, m0, 960
    s_nop 0
    buffer_load_dwordx4 v10, s[8:11], s69 offen offset:576 lds
    s_waitcnt vmcnt(0)
floop_87:
    s_barrier
    v_add_u32 v14, s76, v11
    s_xor_b32 s76, s76, 40960
    s_add_u32 s77, s31, 1
    s_mul_i32 s78, s77, 40960
    s_and_b32 s70, s30, 1
    s_mul_i32 s70, s70, 20
    s_lshr_b32 s71, s30, 1
    s_mul_i32 s71, s71, 10
    s_add_u32 s70, s70, s71
    s_lshl_b32 s70, s70, 10
    s_add_u32 m0, s70, s76
    ds_read_b128 v[16:19], v14 offset:0
    ds_read_b128 v[20:23], v14 offset:1024
    ds_read_b128 v[24:27], v14 offset:2048
    ds_read_b128 v[28:31], v14 offset:3072
    ds_read_b128 v[32:35], v14 offset:4096
    s_waitcnt lgkmcnt(4)
    v_mfma_f32_16x16x32_bf16 v[40:43], a[0:3], v[16:19], 0
    v_mfma_f32_16x16x32_bf16 v[48:51], a[80:83], v[16:19], 0
    v_mfma_f32_16x16x32_bf16 v[56:59], a[160:163], v[16:19], 0
    buffer_load_dwordx4 v10, s[8:11], s78 offen offset:0 lds
    s_add_u32 m0, m0, 960
    ds_read_b128 v[36:39], v14 offset:5120
    s_waitcnt lgkmcnt(4)
    v_mfma_f32_16x16x32_bf16 v[40:43], a[4:7], v[20:23], v[40:43]
    v_mfma_f32_16x16x32_bf16 v[48:51], a[84:87], v[20:23], v[48:51]
    v_mfma_f32_16x16x32_bf16 v[56:59], a[164:167], v[20:23], v[56:59]
    ds_read_b128 v[16:19], v14 offset:6144
    s_waitcnt lgkmcnt(4)
    v_mfma_f32_16x16x32_bf16 v[40:43], a[8:11], v[24:27], v[40:43]
    v_mfma_f32_16x16x32_bf16 v[48:51], a[88:91], v[24:27], v[48:51]
    v_mfma_f32_16x16x32_bf16 v[56:59], a[168:171], v[24:27], v[56:59]
    ds_read_b128 v[20:23], v14 offset:7168
    s_waitcnt lgkmcnt(4)
    v_mfma_f32_16x16x32_bf16 v[40:43], a[12:15], v[28:31], v[40:43]
    v_mfma_f32_16x16x32_bf16 v[48:51], a[92:95], v[28:31], v[48:51]
    v_mfma_f32_16x16x32_bf16 v[56:59], a[172:175], v[28:31], v[56:59]
    buffer_load_dwordx4 v10, s[8:11], s78 offen offset:64 lds
    s_add_u32 m0, m0, 960
    ds_read_b128 v[24:27], v14 offset:8192
    s_waitcnt lgkmcnt(4)
    v_mfma_f32_16x16x32_bf16 v[40:43], a[16:19], v[32:35], v[40:43]
    v_mfma_f32_16x16x32_bf16 v[48:51], a[96:99], v[32:35], v[48:51]
    v_mfma_f32_16x16x32_bf16 v[56:59], a[176:179], v[32:35], v[56:59]
    ds_read_b128 v[28:31], v14 offset:9216
    s_waitcnt lgkmcnt(4)
    v_mfma_f32_16x16x32_bf16 v[40:43], a[20:23], v[36:39], v[40:43]
    v_mfma_f32_16x16x32_bf16 v[48:51], a[100:103], v[36:39], v[48:51]
    v_mfma_f32_16x16x32_bf16 v[56:59], a[180:183], v[36:39], v[56:59]
    ds_read_b128 v[32:35], v14 offset:10240
    s_waitcnt lgkmcnt(4)
    v_mfma_f32_16x16x32_bf16 v[40:43], a[24:27], v[16:19], v[40:43]
    v_mfma_f32_16x16x32_bf16 v[48:51], a[104:107], v[16:19], v[48:51]
    v_mfma_f32_16x16x32_bf16 v[56:59], a[184:187], v[16:19], v[56:59]
    buffer_load_dwordx4 v10, s[8:11], s78 offen offset:128 lds
    s_add_u32 m0, m0, 960
    ds_read_b128 v[36:39], v14 offset:11264
    s_waitcnt lgkmcnt(4)
    v_mfma_f32_16x16x32_bf16 v[40:43], a[28:31], v[20:23], v[40:43]
    v_mfma_f32_16x16x32_bf16 v[48:51], a[108:111], v[20:23], v[48:51]
    v_mfma_f32_16x16x32_bf16 v[56:59], a[188:191], v[20:23], v[56:59]
    ds_read_b128 v[16:19], v14 offset:12288
    s_waitcnt lgkmcnt(4)
    v_mfma_f32_16x16x32_bf16 v[40:43], a[32:35], v[24:27], v[40:43]
    v_mfma_f32_16x16x32_bf16 v[48:51], a[112:115], v[24:27], v[48:51]
    v_mfma_f32_16x16x32_bf16 v[56:59], a[192:195], v[24:27], v[56:59]
    ds_read_b128 v[20:23], v14 offset:13312
    s_waitcnt lgkmcnt(4)
    v_mfma_f32_16x16x32_bf16 v[40:43], a[36:39], v[28:31], v[40:43]
    v_mfma_f32_16x16x32_bf16 v[48:51], a[116:119], v[28:31], v[48:51]
    v_mfma_f32_16x16x32_bf16 v[56:59], a[196:199], v[28:31], v[56:59]
    buffer_load_dwordx4 v10, s[8:11], s78 offen offset:192 lds
    s_add_u32 m0, m0, 960
    ds_read_b128 v[24:27], v14 offset:14336
    s_waitcnt lgkmcnt(4)
    v_mfma_f32_16x16x32_bf16 v[40:43], a[40:43], v[32:35], v[40:43]
    v_mfma_f32_16x16x32_bf16 v[48:51], a[120:123], v[32:35], v[48:51]
    v_mfma_f32_16x16x32_bf16 v[56:59], a[200:203], v[32:35], v[56:59]
    ds_read_b128 v[28:31], v14 offset:15360
    s_waitcnt lgkmcnt(4)
    v_mfma_f32_16x16x32_bf16 v[40:43], a[44:47], v[36:39], v[40:43]
    v_mfma_f32_16x16x32_bf16 v[48:51], a[124:127], v[36:39], v[48:51]
    v_mfma_f32_16x16x32_bf16 v[56:59], a[204:207], v[36:39], v[56:59]
    ds_read_b128 v[32:35], v14 offset:16384
    s_waitcnt lgkmcnt(4)
    v_mfma_f32_16x16x32_bf16 v[40:43], a[48:51], v[16:19], v[40:43]
    v_mfma_f32_16x16x32_bf16 v[48:51], a[128:131], v[16:19], v[48:51]
    v_mfma_f32_16x16x32_bf16 v[56:59], a[208:211], v[16:19], v[56:59]
    buffer_load_dwordx4 v10, s[8:11], s78 offen offset:256 lds
    s_add_u32 m0, m0, 960
    ds_read_b128 v[36:39], v14 offset:17408
    s_waitcnt lgkmcnt(4)
    v_mfma_f32_16x16x32_bf16 v[40:43], a[52:55], v[20:23], v[40:43]
    v_mfma_f32_16x16x32_bf16 v[48:51], a[132:135], v[20:23], v[48:51]
    v_mfma_f32_16x16x32_bf16 v[56:59], a[212:215], v[20:23], v[56:59]
    ds_read_b128 v[16:19], v14 offset:18432
    s_waitcnt lgkmcnt(4)
    v_mfma_f32_16x16x32_bf16 v[40:43], a[56:59], v[24:27], v[40:43]
    v_mfma_f32_16x16x32_bf16 v[48:51], a[136:139], v[24:27], v[48:51]
    v_mfma_f32_16x16x32_bf16 v[56:59], a[216:219], v[24:27], v[56:59]
    ds_read_b128 v[20:23], v14 offset:19456
    s_waitcnt lgkmcnt(4)
    v_mfma_f32_16x16x32_bf16 v[40:43], a[60:63], v[28:31], v[40:43]
    v_mfma_f32_16x16x32_bf16 v[48:51], a[140:143], v[28:31], v[48:51]
    v_mfma_f32_16x16x32_bf16 v[56:59], a[220:223], v[28:31], v[56:59]
    buffer_load_dwordx4 v10, s[8:11], s78 offen offset:320 lds
    s_add_u32 m0, m0, 960
    ds_read_b128 v[24:27], v14 offset:20480
    s_waitcnt lgkmcnt(4)
    v_mfma_f32_16x16x32_bf16 v[40:43], a[64:67], v[32:35], v[40:43]
    v_mfma_f32_16x16x32_bf16 v[48:51], a[144:147], v[32:35], v[48:51]
    v_mfma_f32_16x16x32_bf16 v[56:59], a[224:227], v[32:35], v[56:59]
    ds_read_b128 v[28:31], v14 offset:21504
    s_waitcnt lgkmcnt(4)
    v_mfma_f32_16x16x32_bf16 v[40:43], a[68:71], v[36:39], v[40:43]
    v_mfma_f32_16x16x32_bf16 v[48:51], a[148:151], v[36:39], v[48:51]
    v_mfma_f32_16x16x32_bf16 v[56:59], a[228:231], v[36:39], v[56:59]
    ds_read_b128 v[32:35], v14 offset:22528
    s_waitcnt lgkmcnt(4)
    v_mfma_f32_16x16x32_bf16 v[40:43], a[72:75], v[16:19], v[40:43]
    v_mfma_f32_16x16x32_bf16 v[48:51], a[152:155], v[16:19], v[48:51]
    v_mfma_f32_16x16x32_bf16 v[56:59], a[232:235], v[16:19], v[56:59]
    buffer_load_dwordx4 v10, s[8:11], s78 offen offset:384 lds
    s_add_u32 m0, m0, 960
    ds_read_b128 v[36:39], v14 offset:23552
    s_waitcnt lgkmcnt(4)
    v_mfma_f32_16x16x32_bf16 v[40:43], a[76:79], v[20:23], v[40:43]
    v_mfma_f32_16x16x32_bf16 v[48:51], a[156:159], v[20:23], v[48:51]
    v_mfma_f32_16x16x32_bf16 v[56:59], a[236:239], v[20:23], v[56:59]
    ds_read_b128 v[16:19], v14 offset:24576
    s_waitcnt lgkmcnt(4)
    v_mfma_f32_16x16x32_bf16 v[44:47], a[0:3], v[24:27], 0
    v_mfma_f32_16x16x32_bf16 v[52:55], a[80:83], v[24:27], 0
    v_mfma_f32_16x16x32_bf16 v[60:63], a[160:163], v[24:27], 0
    ds_read_b128 v[20:23], v14 offset:25600
    s_waitcnt lgkmcnt(4)
    v_mfma_f32_16x16x32_bf16 v[44:47], a[4:7], v[28:31], v[44:47]
    v_mfma_f32_16x16x32_bf16 v[52:55], a[84:87], v[28:31], v[52:55]
    v_mfma_f32_16x16x32_bf16 v[60:63], a[164:167], v[28:31], v[60:63]
    buffer_load_dwordx4 v10, s[8:11], s78 offen offset:448 lds
    s_add_u32 m0, m0, 960
    ds_read_b128 v[24:27], v14 offset:26624
    s_waitcnt lgkmcnt(4)
    v_mfma_f32_16x16x32_bf16 v[44:47], a[8:11], v[32:35], v[44:47]
    v_mfma_f32_16x16x32_bf16 v[52:55], a[88:91], v[32:35], v[52:55]
    v_mfma_f32_16x16x32_bf16 v[60:63], a[168:171], v[32:35], v[60:63]
    ds_read_b128 v[28:31], v14 offset:27648
    s_waitcnt lgkmcnt(4)
    v_mfma_f32_16x16x32_bf16 v[44:47], a[12:15], v[36:39], v[44:47]
    v_mfma_f32_16x16x32_bf16 v[52:55], a[92:95], v[36:39], v[52:55]
    v_mfma_f32_16x16x32_bf16 v[60:63], a[172:175], v[36:39], v[60:63]
    ds_read_b128 v[32:35], v14 offset:28672
    s_waitcnt lgkmcnt(4)
    v_mfma_f32_16x16x32_bf16 v[44:47], a[16:19], v[16:19], v[44:47]
    v_mfma_f32_16x16x32_bf16 v[52:55], a[96:99], v[16:19], v[52:55]
    v_mfma_f32_16x16x32_bf16 v[60:63], a[176:179], v[16:19], v[60:63]
    buffer_load_dwordx4 v10, s[8:11], s78 offen offset:512 lds
    s_add_u32 m0, m0, 960
    ds_read_b128 v[36:39], v14 offset:29696
    s_waitcnt lgkmcnt(4)
    v_mfma_f32_16x16x32_bf16 v[44:47], a[20:23], v[20:23], v[44:47]
    v_mfma_f32_16x16x32_bf16 v[52:55], a[100:103], v[20:23], v[52:55]
    v_mfma_f32_16x16x32_bf16 v[60:63], a[180:183], v[20:23], v[60:63]
    ds_read_b128 v[16:19], v14 offset:30720
    s_waitcnt lgkmcnt(4)
    v_mfma_f32_16x16x32_bf16 v[44:47], a[24:27], v[24:27], v[44:47]
    v_mfma_f32_16x16x32_bf16 v[52:55], a[104:107], v[24:27], v[52:55]
    v_mfma_f32_16x16x32_bf16 v[60:63], a[184:187], v[24:27], v[60:63]
    ds_read_b128 v[20:23], v14 offset:31744
    s_waitcnt lgkmcnt(4)
    v_mfma_f32_16x16x32_bf16 v[44:47], a[28:31], v[28:31], v[44:47]
    v_mfma_f32_16x16x32_bf16 v[52:55], a[108:111], v[28:31], v[52:55]
    v_mfma_f32_16x16x32_bf16 v[60:63], a[188:191], v[28:31], v[60:63]
    buffer_load_dwordx4 v10, s[8:11], s78 offen offset:576 lds
    s_add_u32 m0, m0, 960
    ds_read_b128 v[24:27], v14 offset:32768
    s_waitcnt lgkmcnt(4)
    v_mfma_f32_16x16x32_bf16 v[44:47], a[32:35], v[32:35], v[44:47]
    v_mfma_f32_16x16x32_bf16 v[52:55], a[112:115], v[32:35], v[52:55]
    v_mfma_f32_16x16x32_bf16 v[60:63], a[192:195], v[32:35], v[60:63]
    ds_read_b128 v[28:31], v14 offset:33792
    s_waitcnt lgkmcnt(4)
    v_mfma_f32_16x16x32_bf16 v[44:47], a[36:39], v[36:39], v[44:47]
    v_mfma_f32_16x16x32_bf16 v[52:55], a[116:119], v[36:39], v[52:55]
    v_mfma_f32_16x16x32_bf16 v[60:63], a[196:199], v[36:39], v[60:63]
    ds_read_b128 v[32:35], v14 offset:34816
    s_waitcnt lgkmcnt(4)
    v_mfma_f32_16x16x32_bf16 v[44:47], a[40:43], v[16:19], v[44:47]
    v_mfma_f32_16x16x32_bf16 v[52:55], a[120:123], v[16:19], v[52:55]
    v_mfma_f32_16x16x32_bf16 v[60:63], a[200:203], v[16:19], v[60:63]
    ds_read_b128 v[36:39], v14 offset:35840
    s_waitcnt lgkmcnt(4)
    v_mfma_f32_16x16x32_bf16 v[44:47], a[44:47], v[20:23], v[44:47]
    v_mfma_f32_16x16x32_bf16 v[52:55], a[124:127], v[20:23], v[52:55]
    v_mfma_f32_16x16x32_bf16 v[60:63], a[204:207], v[20:23], v[60:63]
    ds_read_b128 v[16:19], v14 offset:36864
    s_waitcnt lgkmcnt(4)
    v_mfma_f32_16x16x32_bf16 v[44:47], a[48:51], v[24:27], v[44:47]
    v_mfma_f32_16x16x32_bf16 v[52:55], a[128:131], v[24:27], v[52:55]
    v_mfma_f32_16x16x32_bf16 v[60:63], a[208:211], v[24:27], v[60:63]
    ds_read_b128 v[20:23], v14 offset:37888
    s_waitcnt lgkmcnt(4)
    v_mfma_f32_16x16x32_bf16 v[44:47], a[52:55], v[28:31], v[44:47]
    v_mfma_f32_16x16x32_bf16 v[52:55], a[132:135], v[28:31], v[52:55]
    v_mfma_f32_16x16x32_bf16 v[60:63], a[212:215], v[28:31], v[60:63]
    ds_read_b128 v[24:27], v14 offset:38912
    s_waitcnt lgkmcnt(4)
    v_mfma_f32_16x16x32_bf16 v[44:47], a[56:59], v[32:35], v[44:47]
    v_mfma_f32_16x16x32_bf16 v[52:55], a[136:139], v[32:35], v[52:55]
    v_mfma_f32_16x16x32_bf16 v[60:63], a[216:219], v[32:35], v[60:63]
    ds_read_b128 v[28:31], v14 offset:39936
    s_waitcnt lgkmcnt(4)
    v_mfma_f32_16x16x32_bf16 v[44:47], a[60:63], v[36:39], v[44:47]
    v_mfma_f32_16x16x32_bf16 v[52:55], a[140:143], v[36:39], v[52:55]
    v_mfma_f32_16x16x32_bf16 v[60:63], a[220:223], v[36:39], v[60:63]
    s_waitcnt lgkmcnt(3)
    v_mfma_f32_16x16x32_bf16 v[44:47], a[64:67], v[16:19], v[44:47]
    v_mfma_f32_16x16x32_bf16 v[52:55], a[144:147], v[16:19], v[52:55]
    v_mfma_f32_16x16x32_bf16 v[60:63], a[224:227], v[16:19], v[60:63]
    s_waitcnt lgkmcnt(2)
    v_mfma_f32_16x16x32_bf16 v[44:47], a[68:71], v[20:23], v[44:47]
    v_mfma_f32_16x16x32_bf16 v[52:55], a[148:151], v[20:23], v[52:55]
    v_mfma_f32_16x16x32_bf16 v[60:63], a[228:231], v[20:23], v[60:63]
    s_waitcnt lgkmcnt(1)
    v_mfma_f32_16x16x32_bf16 v[44:47], a[72:75], v[24:27], v[44:47]
    v_mfma_f32_16x16x32_bf16 v[52:55], a[152:155], v[24:27], v[52:55]
    v_mfma_f32_16x16x32_bf16 v[60:63], a[232:235], v[24:27], v[60:63]
    s_waitcnt lgkmcnt(0)
    v_mfma_f32_16x16x32_bf16 v[44:47], a[76:79], v[28:31], v[44:47]
    v_mfma_f32_16x16x32_bf16 v[52:55], a[156:159], v[28:31], v[52:55]
    v_mfma_f32_16x16x32_bf16 v[60:63], a[236:239], v[28:31], v[60:63]
    v_mul_f32 v40, 0xbfb8aa3b, v40
    v_mul_f32 v41, 0xbfb8aa3b, v41
    v_mul_f32 v42, 0xbfb8aa3b, v42
    v_mul_f32 v43, 0xbfb8aa3b, v43
    v_exp_f32 v40, v40
    v_exp_f32 v41, v41
    v_exp_f32 v42, v42
    v_exp_f32 v43, v43
    v_add_f32 v40, 1.0, v40
    v_add_f32 v41, 1.0, v41
    v_add_f32 v42, 1.0, v42
    v_add_f32 v43, 1.0, v43
    v_rcp_f32 v40, v40
    v_rcp_f32 v41, v41
    v_rcp_f32 v42, v42
    v_rcp_f32 v43, v43
    v_mul_f32 v40, v40, v48
    v_mul_f32 v41, v41, v49
    v_mul_f32 v42, v42, v50
    v_mul_f32 v43, v43, v51
    v_cvt_pk_bf16_f32 v64, v40, v41
    v_cvt_pk_bf16_f32 v65, v42, v43
    s_add_u32 s69, s75, 0
    buffer_store_dwordx2 v[64:65], v12, s[4:7], s69 offen
    v_mul_f32 v44, 0xbfb8aa3b, v44
    v_mul_f32 v45, 0xbfb8aa3b, v45
    v_mul_f32 v46, 0xbfb8aa3b, v46
    v_mul_f32 v47, 0xbfb8aa3b, v47
    v_exp_f32 v44, v44
    v_exp_f32 v45, v45
    v_exp_f32 v46, v46
    v_exp_f32 v47, v47
    v_add_f32 v44, 1.0, v44
    v_add_f32 v45, 1.0, v45
    v_add_f32 v46, 1.0, v46
    v_add_f32 v47, 1.0, v47
    v_rcp_f32 v44, v44
    v_rcp_f32 v45, v45
    v_rcp_f32 v46, v46
    v_rcp_f32 v47, v47
    v_mul_f32 v44, v44, v52
    v_mul_f32 v45, v45, v53
    v_mul_f32 v46, v46, v54
    v_mul_f32 v47, v47, v55
    v_cvt_pk_bf16_f32 v66, v44, v45
    v_cvt_pk_bf16_f32 v67, v46, v47
    s_add_u32 s69, s75, 6144
    buffer_store_dwordx2 v[66:67], v12, s[4:7], s69 offen
    s_cmp_lg_u32 s80, 0
    s_cbranch_scc1 nogate_88
    v_mul_f32 v70, 0xbfb8aa3b, v56
    v_exp_f32 v70, v70
    s_nop 0
    v_add_f32 v70, 1.0, v70
    v_rcp_f32 v70, v70
    v_mul_f32 v71, 0xbfb8aa3b, v60
    v_exp_f32 v71, v71
    s_nop 0
    v_add_f32 v71, 1.0, v71
    v_rcp_f32 v71, v71
    s_mov_b64 exec, 0xffff
    buffer_store_dword v70, v9, s[4:7], s79 offen offset:0
    buffer_store_dword v71, v9, s[4:7], s79 offen offset:64
    s_mov_b64 exec, -1
nogate_88:
    s_add_u32 s75, s75, 12288
    s_add_u32 s79, s79, 128
    s_mov_b32 s31, s77
    s_waitcnt vmcnt(0)
    v_mov_b32 v15, s31
    s_mov_b64 exec, 1
    buffer_store_dword v15, v13, s[4:7], 0 offen
    s_mov_b64 exec, -1
    s_cmp_lt_u32 s31, 64
    s_cbranch_scc1 floop_87
    s_branch EXIT
ROLE_WF:
    s_mov_b32 s12, s42
    s_mov_b32 s13, s43
    s_mov_b32 s14, 7864320
    s_mov_b32 s15, 0x20000
    s_mov_b32 s16, s52
    s_mov_b32 s17, s53
    s_mov_b32 s18, 1966080
    s_mov_b32 s19, 0x20000
    s_mov_b32 s24, s56
    s_mov_b32 s25, s57
    s_mov_b32 s26, 2621440
    s_mov_b32 s27, 0x20000
    s_sub_u32 s73, s29, 27
    v_lshrrev_b32 v2, 3, v0
    v_and_b32 v3, 7, v0
    v_lshrrev_b32 v4, 4, v0
    v_lshlrev_b32 v4, 1, v4
    v_xor_b32 v3, v3, v4
    v_lshlrev_b32 v3, 4, v3
    s_mov_b32 s69, 1280
    v_mad_u32_u24 v12, v2, s69, v3
    v_lshrrev_b32 v2, 4, v0
    v_bfe_u32 v3, v0, 2, 2
    v_and_b32 v4, 3, v0
    v_lshrrev_b32 v5, 1, v3
    v_and_b32 v6, 1, v2
    v_lshl_or_b32 v5, v6, 1, v5
    v_lshlrev_b32 v5, 1, v5
    v_lshl_add_u32 v6, v2, 2, v3
    s_lshl_b32 s69, s30, 1
    v_lshrrev_b32 v7, 1, v4
    v_or_b32 v7, s69, v7
    v_xor_b32 v7, v7, v5
    v_lshlrev_b32 v7, 4, v7
    v_and_b32 v4, 1, v4
    v_lshl_or_b32 v7, v4, 3, v7
    v_lshl_add_u32 v14, v6, 7, v7
    s_mul_i32 s71, s28, 983040
    s_lshl_b32 s72, s73, 8
    s_add_u32 s71, s71, s72
    s_add_u32 s71, s71, 0
    s_mul_i32 s69, s30, 10240
    s_add_u32 s69, s69, s71
    s_lshl_b32 s70, s30, 10
    s_add_u32 m0, s70, 0
    s_nop 0
    buffer_load_dwordx4 v12, s[12:15], s69 offen lds
    s_add_u32 m0, m0, 4096
    s_add_u32 s69, s69, 40960
    buffer_load_dwordx4 v12, s[12:15], s69 offen lds
    s_add_u32 m0, m0, 4096
    s_add_u32 s69, s69, 40960
    buffer_load_dwordx4 v12, s[12:15], s69 offen lds
    s_add_u32 m0, m0, 4096
    s_add_u32 s69, s69, 40960
    buffer_load_dwordx4 v12, s[12:15], s69 offen lds
    s_add_u32 m0, m0, 4096
    s_add_u32 s69, s69, 40960
    buffer_load_dwordx4 v12, s[12:15], s69 offen lds
    s_add_u32 m0, m0, 4096
    s_add_u32 s69, s69, 40960
    buffer_load_dwordx4 v12, s[12:15], s69 offen lds
    s_add_u32 m0, m0, 4096
    s_add_u32 s69, s69, 40960
    buffer_load_dwordx4 v12, s[12:15], s69 offen lds
    s_add_u32 m0, m0, 4096
    s_add_u32 s69, s69, 40960
    buffer_load_dwordx4 v12, s[12:15], s69 offen lds
    s_add_u32 m0, m0, 4096
    s_add_u32 s69, s69, 40960
    buffer_load_dwordx4 v12, s[12:15], s69 offen lds
    s_add_u32 m0, m0, 4096
    s_add_u32 s69, s69, 40960
    buffer_load_dwordx4 v12, s[12:15], s69 offen lds
    s_add_u32 m0, m0, 4096
    s_add_u32 s69, s69, 40960
    buffer_load_dwordx4 v12, s[12:15], s69 offen lds
    s_add_u32 m0, m0, 4096
    s_add_u32 s69, s69, 40960
    buffer_load_dwordx4 v12, s[12:15], s69 offen lds
    s_mul_i32 s71, s28, 983040
    s_lshl_b32 s72, s73, 8
    s_add_u32 s71, s71, s72
    s_add_u32 s71, s71, 491520
    s_mul_i32 s69, s30, 10240
    s_add_u32 s69, s69, s71
    s_lshl_b32 s70, s30, 10
    s_add_u32 m0, s70, 81920
    s_nop 0
    buffer_load_dwordx4 v12, s[12:15], s69 offen lds
    s_add_u32 m0, m0, 4096
    s_add_u32 s69, s69, 40960
    buffer_load_dwordx4 v12, s[12:15], s69 offen lds
    s_add_u32 m0, m0, 4096
    s_add_u32 s69, s69, 40960
    buffer_load_dwordx4 v12, s[12:15], s69 offen lds
    s_add_u32 m0, m0, 4096
    s_add_u32 s69, s69, 40960
    buffer_load_dwordx4 v12, s[12:15], s69 offen lds
    s_add_u32 m0, m0, 4096
    s_add_u32 s69, s69, 40960
    buffer_load_dwordx4 v12, s[12:15], s69 offen lds
    s_add_u32 m0, m0, 4096
    s_add_u32 s69, s69, 40960
    buffer_load_dwordx4 v12, s[12:15], s69 offen lds
    s_add_u32 m0, m0, 4096
    s_add_u32 s69, s69, 40960
    buffer_load_dwordx4 v12, s[12:15], s69 offen lds
    s_add_u32 m0, m0, 4096
    s_add_u32 s69, s69, 40960
    buffer_load_dwordx4 v12, s[12:15], s69 offen lds
    s_add_u32 m0, m0, 4096
    s_add_u32 s69, s69, 40960
    buffer_load_dwordx4 v12, s[12:15], s69 offen lds
    s_add_u32 m0, m0, 4096
    s_add_u32 s69, s69, 40960
    buffer_load_dwordx4 v12, s[12:15], s69 offen lds
    s_add_u32 m0, m0, 4096
    s_add_u32 s69, s69, 40960
    buffer_load_dwordx4 v12, s[12:15], s69 offen lds
    s_add_u32 m0, m0, 4096
    s_add_u32 s69, s69, 40960
    buffer_load_dwordx4 v12, s[12:15], s69 offen lds
    s_waitcnt vmcnt(12)
    s_barrier
    v_add_u32 v9, 0, v14
    ds_read_b64_tr_b16 a[0:1], v9 offset:0
    ds_read_b64_tr_b16 a[2:3], v9 offset:2048
    ds_read_b64_tr_b16 a[4:5], v9 offset:4096
    ds_read_b64_tr_b16 a[6:7], v9 offset:6144
    ds_read_b64_tr_b16 a[8:9], v9 offset:8192
    ds_read_b64_tr_b16 a[10:11], v9 offset:10240
    ds_read_b64_tr_b16 a[12:13], v9 offset:12288
    ds_read_b64_tr_b16 a[14:15], v9 offset:14336
    ds_read_b64_tr_b16 a[16:17], v9 offset:16384
    ds_read_b64_tr_b16 a[18:19], v9 offset:18432
    ds_read_b64_tr_b16 a[20:21], v9 offset:20480
    ds_read_b64_tr_b16 a[22:23], v9 offset:22528
    s_waitcnt lgkmcnt(0)
    ds_read_b64_tr_b16 a[24:25], v9 offset:24576
    ds_read_b64_tr_b16 a[26:27], v9 offset:26624
    ds_read_b64_tr_b16 a[28:29], v9 offset:28672
    ds_read_b64_tr_b16 a[30:31], v9 offset:30720
    ds_read_b64_tr_b16 a[32:33], v9 offset:32768
    ds_read_b64_tr_b16 a[34:35], v9 offset:34816
    ds_read_b64_tr_b16 a[36:37], v9 offset:36864
    ds_read_b64_tr_b16 a[38:39], v9 offset:38912
    s_waitcnt lgkmcnt(0)
    v_add_u32 v9, 40960, v14
    ds_read_b64_tr_b16 a[40:41], v9 offset:0
    ds_read_b64_tr_b16 a[42:43], v9 offset:2048
    ds_read_b64_tr_b16 a[44:45], v9 offset:4096
    ds_read_b64_tr_b16 a[46:47], v9 offset:6144
    s_waitcnt lgkmcnt(0)
    s_barrier
    s_mul_i32 s71, s28, 983040
    s_lshl_b32 s72, s73, 8
    s_add_u32 s71, s71, s72
    s_add_u32 s71, s71, 128
    s_mul_i32 s69, s30, 10240
    s_add_u32 s69, s69, s71
    s_lshl_b32 s70, s30, 10
    s_add_u32 m0, s70, 0
    s_nop 0
    buffer_load_dwordx4 v12, s[12:15], s69 offen lds
    s_add_u32 m0, m0, 4096
    s_add_u32 s69, s69, 40960
    buffer_load_dwordx4 v12, s[12:15], s69 offen lds
    s_add_u32 m0, m0, 4096
    s_add_u32 s69, s69, 40960
    buffer_load_dwordx4 v12, s[12:15], s69 offen lds
    s_add_u32 m0, m0, 4096
    s_add_u32 s69, s69, 40960
    buffer_load_dwordx4 v12, s[12:15], s69 offen lds
    s_add_u32 m0, m0, 4096
    s_add_u32 s69, s69, 40960
    buffer_load_dwordx4 v12, s[12:15], s69 offen lds
    s_add_u32 m0, m0, 4096
    s_add_u32 s69, s69, 40960
    buffer_load_dwordx4 v12, s[12:15], s69 offen lds
    s_add_u32 m0, m0, 4096
    s_add_u32 s69, s69, 40960
    buffer_load_dwordx4 v12, s[12:15], s69 offen lds
    s_add_u32 m0, m0, 4096
    s_add_u32 s69, s69, 40960
    buffer_load_dwordx4 v12, s[12:15], s69 offen lds
    s_add_u32 m0, m0, 4096
    s_add_u32 s69, s69, 40960
    buffer_load_dwordx4 v12, s[12:15], s69 offen lds
    s_add_u32 m0, m0, 4096
    s_add_u32 s69, s69, 40960
    buffer_load_dwordx4 v12, s[12:15], s69 offen lds
    s_add_u32 m0, m0, 4096
    s_add_u32 s69, s69, 40960
    buffer_load_dwordx4 v12, s[12:15], s69 offen lds
    s_add_u32 m0, m0, 4096
    s_add_u32 s69, s69, 40960
    buffer_load_dwordx4 v12, s[12:15], s69 offen lds
    s_waitcnt vmcnt(12)
    s_barrier
    v_add_u32 v9, 81920, v14
    ds_read_b64_tr_b16 a[48:49], v9 offset:0
    ds_read_b64_tr_b16 a[50:51], v9 offset:2048
    ds_read_b64_tr_b16 a[52:53], v9 offset:4096
    ds_read_b64_tr_b16 a[54:55], v9 offset:6144
    ds_read_b64_tr_b16 a[56:57], v9 offset:8192
    ds_read_b64_tr_b16 a[58:59], v9 offset:10240
    ds_read_b64_tr_b16 a[60:61], v9 offset:12288
    ds_read_b64_tr_b16 a[62:63], v9 offset:14336
    ds_read_b64_tr_b16 a[64:65], v9 offset:16384
    ds_read_b64_tr_b16 a[66:67], v9 offset:18432
    ds_read_b64_tr_b16 a[68:69], v9 offset:20480
    ds_read_b64_tr_b16 a[70:71], v9 offset:22528
    s_waitcnt lgkmcnt(0)
    ds_read_b64_tr_b16 a[72:73], v9 offset:24576
    ds_read_b64_tr_b16 a[74:75], v9 offset:26624
    ds_read_b64_tr_b16 a[76:77], v9 offset:28672
    ds_read_b64_tr_b16 a[78:79], v9 offset:30720
    ds_read_b64_tr_b16 a[80:81], v9 offset:32768
    ds_read_b64_tr_b16 a[82:83], v9 offset:34816
    ds_read_b64_tr_b16 a[84:85], v9 offset:36864
    ds_read_b64_tr_b16 a[86:87], v9 offset:38912
    s_waitcnt lgkmcnt(0)
    v_add_u32 v9, 122880, v14
    ds_read_b64_tr_b16 a[88:89], v9 offset:0
    ds_read_b64_tr_b16 a[90:91], v9 offset:2048
    ds_read_b64_tr_b16 a[92:93], v9 offset:4096
    ds_read_b64_tr_b16 a[94:95], v9 offset:6144
    s_waitcnt lgkmcnt(0)
    s_barrier
    s_mul_i32 s71, s28, 983040
    s_lshl_b32 s72, s73, 8
    s_add_u32 s71, s71, s72
    s_add_u32 s71, s71, 491648
    s_mul_i32 s69, s30, 10240
    s_add_u32 s69, s69, s71
    s_lshl_b32 s70, s30, 10
    s_add_u32 m0, s70, 81920
    s_nop 0
    buffer_load_dwordx4 v12, s[12:15], s69 offen lds
    s_add_u32 m0, m0, 4096
    s_add_u32 s69, s69, 40960
    buffer_load_dwordx4 v12, s[12:15], s69 offen lds
    s_add_u32 m0, m0, 4096
    s_add_u32 s69, s69, 40960
    buffer_load_dwordx4 v12, s[12:15], s69 offen lds
    s_add_u32 m0, m0, 4096
    s_add_u32 s69, s69, 40960
    buffer_load_dwordx4 v12, s[12:15], s69 offen lds
    s_add_u32 m0, m0, 4096
    s_add_u32 s69, s69, 40960
    buffer_load_dwordx4 v12, s[12:15], s69 offen lds
    s_add_u32 m0, m0, 4096
    s_add_u32 s69, s69, 40960
    buffer_load_dwordx4 v12, s[12:15], s69 offen lds
    s_add_u32 m0, m0, 4096
    s_add_u32 s69, s69, 40960
    buffer_load_dwordx4 v12, s[12:15], s69 offen lds
    s_add_u32 m0, m0, 4096
    s_add_u32 s69, s69, 40960
    buffer_load_dwordx4 v12, s[12:15], s69 offen lds
    s_add_u32 m0, m0, 4096
    s_add_u32 s69, s69, 40960
    buffer_load_dwordx4 v12, s[12:15], s69 offen lds
    s_add_u32 m0, m0, 4096
    s_add_u32 s69, s69, 40960
    buffer_load_dwordx4 v12, s[12:15], s69 offen lds
    s_add_u32 m0, m0, 4096
    s_add_u32 s69, s69, 40960
    buffer_load_dwordx4 v12, s[12:15], s69 offen lds
    s_add_u32 m0, m0, 4096
    s_add_u32 s69, s69, 40960
    buffer_load_dwordx4 v12, s[12:15], s69 offen lds
    s_waitcnt vmcnt(12)
    s_barrier
    v_add_u32 v9, 0, v14
    ds_read_b64_tr_b16 a[96:97], v9 offset:0
    ds_read_b64_tr_b16 a[98:99], v9 offset:2048
    ds_read_b64_tr_b16 a[100:101], v9 offset:4096
    ds_read_b64_tr_b16 a[102:103], v9 offset:6144
    ds_read_b64_tr_b16 a[104:105], v9 offset:8192
    ds_read_b64_tr_b16 a[106:107], v9 offset:10240
    ds_read_b64_tr_b16 a[108:109], v9 offset:12288
    ds_read_b64_tr_b16 a[110:111], v9 offset:14336
    ds_read_b64_tr_b16 a[112:113], v9 offset:16384
    ds_read_b64_tr_b16 a[114:115], v9 offset:18432
    ds_read_b64_tr_b16 a[116:117], v9 offset:20480
    ds_read_b64_tr_b16 a[118:119], v9 offset:22528
    s_waitcnt lgkmcnt(0)
    ds_read_b64_tr_b16 a[120:121], v9 offset:24576
    ds_read_b64_tr_b16 a[122:123], v9 offset:26624
    ds_read_b64_tr_b16 a[124:125], v9 offset:28672
    ds_read_b64_tr_b16 a[126:127], v9 offset:30720
    ds_read_b64_tr_b16 a[128:129], v9 offset:32768
    ds_read_b64_tr_b16 a[130:131], v9 offset:34816
    ds_read_b64_tr_b16 a[132:133], v9 offset:36864
    ds_read_b64_tr_b16 a[134:135], v9 offset:38912
    s_waitcnt lgkmcnt(0)
    v_add_u32 v9, 40960, v14
    ds_read_b64_tr_b16 a[136:137], v9 offset:0
    ds_read_b64_tr_b16 a[138:139], v9 offset:2048
    ds_read_b64_tr_b16 a[140:141], v9 offset:4096
    ds_read_b64_tr_b16 a[142:143], v9 offset:6144
    s_waitcnt lgkmcnt(0)
    s_barrier
    s_mul_i32 s71, s28, 245760
    s_lshl_b32 s72, s73, 8
    s_add_u32 s71, s71, s72
    s_add_u32 s71, s71, 0
    s_mul_i32 s69, s30, 10240
    s_add_u32 s69, s69, s71
    s_lshl_b32 s70, s30, 10
    s_add_u32 m0, s70, 0
    s_nop 0
    buffer_load_dwordx4 v12, s[16:19], s69 offen lds
    s_add_u32 m0, m0, 4096
    s_add_u32 s69, s69, 40960
    buffer_load_dwordx4 v12, s[16:19], s69 offen lds
    s_add_u32 m0, m0, 4096
    s_add_u32 s69, s69, 40960
    buffer_load_dwordx4 v12, s[16:19], s69 offen lds
    s_add_u32 m0, m0, 4096
    s_add_u32 s69, s69, 40960
    buffer_load_dwordx4 v12, s[16:19], s69 offen lds
    s_add_u32 m0, m0, 4096
    s_add_u32 s69, s69, 40960
    buffer_load_dwordx4 v12, s[16:19], s69 offen lds
    s_add_u32 m0, m0, 4096
    s_add_u32 s69, s69, 40960
    buffer_load_dwordx4 v12, s[16:19], s69 offen lds
    s_waitcnt vmcnt(6)
    s_barrier
    v_add_u32 v9, 81920, v14
    ds_read_b64_tr_b16 a[144:145], v9 offset:0
    ds_read_b64_tr_b16 a[146:147], v9 offset:2048
    ds_read_b64_tr_b16 a[148:149], v9 offset:4096
    ds_read_b64_tr_b16 a[150:151], v9 offset:6144
    ds_read_b64_tr_b16 a[152:153], v9 offset:8192
    ds_read_b64_tr_b16 a[154:155], v9 offset:10240
    ds_read_b64_tr_b16 a[156:157], v9 offset:12288
    ds_read_b64_tr_b16 a[158:159], v9 offset:14336
    ds_read_b64_tr_b16 a[160:161], v9 offset:16384
    ds_read_b64_tr_b16 a[162:163], v9 offset:18432
    ds_read_b64_tr_b16 a[164:165], v9 offset:20480
    ds_read_b64_tr_b16 a[166:167], v9 offset:22528
    s_waitcnt lgkmcnt(0)
    ds_read_b64_tr_b16 a[168:169], v9 offset:24576
    ds_read_b64_tr_b16 a[170:171], v9 offset:26624
    ds_read_b64_tr_b16 a[172:173], v9 offset:28672
    ds_read_b64_tr_b16 a[174:175], v9 offset:30720
    ds_read_b64_tr_b16 a[176:177], v9 offset:32768
    ds_read_b64_tr_b16 a[178:179], v9 offset:34816
    ds_read_b64_tr_b16 a[180:181], v9 offset:36864
    ds_read_b64_tr_b16 a[182:183], v9 offset:38912
    s_waitcnt lgkmcnt(0)
    v_add_u32 v9, 122880, v14
    ds_read_b64_tr_b16 a[184:185], v9 offset:0
    ds_read_b64_tr_b16 a[186:187], v9 offset:2048
    ds_read_b64_tr_b16 a[188:189], v9 offset:4096
    ds_read_b64_tr_b16 a[190:191], v9 offset:6144
    s_waitcnt lgkmcnt(0)
    s_barrier
    s_mul_i32 s71, s28, 245760
    s_lshl_b32 s72, s73, 8
    s_add_u32 s71, s71, s72
    s_add_u32 s71, s71, 128
    s_mul_i32 s69, s30, 10240
    s_add_u32 s69, s69, s71
    s_lshl_b32 s70, s30, 10
    s_add_u32 m0, s70, 81920
    s_nop 0
    buffer_load_dwordx4 v12, s[16:19], s69 offen lds
    s_add_u32 m0, m0, 4096
    s_add_u32 s69, s69, 40960
    buffer_load_dwordx4 v12, s[16:19], s69 offen lds
    s_add_u32 m0, m0, 4096
    s_add_u32 s69, s69, 40960
    buffer_load_dwordx4 v12, s[16:19], s69 offen lds
    s_add_u32 m0, m0, 4096
    s_add_u32 s69, s69, 40960
    buffer_load_dwordx4 v12, s[16:19], s69 offen lds
    s_add_u32 m0, m0, 4096
    s_add_u32 s69, s69, 40960
    buffer_load_dwordx4 v12, s[16:19], s69 offen lds
    s_add_u32 m0, m0, 4096
    s_add_u32 s69, s69, 40960
    buffer_load_dwordx4 v12, s[16:19], s69 offen lds
    s_waitcnt vmcnt(6)
    s_barrier
    v_add_u32 v9, 0, v14
    ds_read_b64_tr_b16 a[192:193], v9 offset:0
    ds_read_b64_tr_b16 a[194:195], v9 offset:2048
    ds_read_b64_tr_b16 a[196:197], v9 offset:4096
    ds_read_b64_tr_b16 a[198:199], v9 offset:6144
    ds_read_b64_tr_b16 a[200:201], v9 offset:8192
    ds_read_b64_tr_b16 a[202:203], v9 offset:10240
    ds_read_b64_tr_b16 a[204:205], v9 offset:12288
    ds_read_b64_tr_b16 a[206:207], v9 offset:14336
    ds_read_b64_tr_b16 a[208:209], v9 offset:16384
    ds_read_b64_tr_b16 a[210:211], v9 offset:18432
    ds_read_b64_tr_b16 a[212:213], v9 offset:20480
    ds_read_b64_tr_b16 a[214:215], v9 offset:22528
    s_waitcnt lgkmcnt(0)
    s_barrier
    s_waitcnt vmcnt(0)
    s_barrier
    v_add_u32 v9, 81920, v14
    ds_read_b64_tr_b16 a[216:217], v9 offset:0
    ds_read_b64_tr_b16 a[218:219], v9 offset:2048
    ds_read_b64_tr_b16 a[220:221], v9 offset:4096
    ds_read_b64_tr_b16 a[222:223], v9 offset:6144
    ds_read_b64_tr_b16 a[224:225], v9 offset:8192
    ds_read_b64_tr_b16 a[226:227], v9 offset:10240
    ds_read_b64_tr_b16 a[228:229], v9 offset:12288
    ds_read_b64_tr_b16 a[230:231], v9 offset:14336
    ds_read_b64_tr_b16 a[232:233], v9 offset:16384
    ds_read_b64_tr_b16 a[234:235], v9 offset:18432
    ds_read_b64_tr_b16 a[236:237], v9 offset:20480
    ds_read_b64_tr_b16 a[238:239], v9 offset:22528
    s_waitcnt lgkmcnt(0)
    s_barrier
    v_mov_b32 v2, 128
wa_89:
    buffer_load_dword v3, v2, s[64:67], 0 offen sc1
    s_waitcnt vmcnt(0)
    v_cmp_ne_u32 vcc, 0x100, v3
    s_cbranch_vccz wad_90
    s_sub_u32 s68, s68, 1
    s_cbranch_scc0 ok_91
    s_mov_b32 s69, 1
    s_branch FAIL
ok_91:
    s_sleep 4
    s_branch wa_89
wad_90:
    v_and_b32 v2, 7, v0
    v_lshlrev_b32 v2, 2, v2
    buffer_load_dword v3, v2, s[64:67], 0 offen sc1
    s_waitcnt vmcnt(0)
    v_cmp_ne_u32 vcc, 32, v3
    s_cbranch_vccnz SAFEENTRY
    v_lshlrev_b32 v10, 4, v0
    v_and_b32 v16, 15, v0
    v_lshrrev_b32 v17, 4, v0
    v_and_b32 v18, 31, v0
    v_lshrrev_b32 v19, 5, v0
    s_lshl_b32 s69, s28, 7
    s_add_u32 s69, s69, 2101248
    v_min_u32 v20, 27, v0
    v_lshlrev_b32 v20, 2, v20
    v_add_u32 v11, s69, v20
    s_lshl_b32 s69, s73, 7
    s_add_u32 s69, s69, 2102272
    v_lshlrev_b32 v20, 2, v18
    v_add_u32 v12, s69, v20
    s_lshl_b32 s70, s28, 4
    s_lshl_b32 s71, s30, 2
    s_add_u32 s69, s69, s70
    s_add_u32 s69, s69, s71
    v_mov_b32 v13, s69
    v_lshrrev_b32 v20, 2, v16
    v_lshlrev_b32 v20, 14, v20
    v_and_b32 v21, 3, v16
    v_lshl_add_u32 v20, v21, 9, v20
    v_lshl_add_u32 v20, v17, 4, v20
    s_lshl_b32 s69, s30, 6
    v_add_u32 v14, s69, v20
    v_lshlrev_b32 v20, 11, v19
    v_lshl_add_u32 v20, v18, 4, v20
    s_lshl_b32 s69, s30, 9
    v_add_u32 v15, s69, v20
    v_lshlrev_b32 v8, 3, v18
    v_lshlrev_b32 v9, 2, v16
    s_mul_i32 s75, s28, 3145728
    s_add_u32 s75, s75, 54525952
    s_mul_i32 s69, s30, 12288
    s_add_u32 s75, s75, s69
    s_mul_i32 s76, s28, 786432
    s_add_u32 s76, s76, 92274688
    s_mul_i32 s69, s30, 3072
    s_add_u32 s76, s76, s69
    s_lshl_b32 s77, s28, 13
    s_add_u32 s77, s77, 98566144
    s_lshl_b32 s78, s73, 17
    s_add_u32 s78, s78, 98631680
    s_lshl_b32 s69, s28, 14
    s_add_u32 s79, s78, s69
    s_sub_u32 s79, s79, 1310720
    s_lshl_b32 s69, s28, 11
    s_add_u32 s78, s78, s69
    s_lshl_b32 s69, s28, 2
    s_add_u32 s69, s69, s30
    s_mul_i32 s69, s69, 1280
    s_lshl_b32 s70, s73, 8
    s_add_u32 s80, s69, s70
    s_sub_u32 s80, s80, 81920
    s_mov_b32 s31, 0
    buffer_load_dword v76, v11, s[4:7], 0 offen sc1
    s_waitcnt vmcnt(0)
wloop_92:
    s_add_u32 s81, s31, 1
fw_94:
    v_cmp_gt_u32 vcc, s81, v76
    s_and_b32 s69, vcc_lo, 0xfffffff
    s_cbranch_scc0 fwd_95
    s_sub_u32 s68, s68, 1
    s_cbranch_scc0 ok_96
    s_mov_b32 s69, 40
    s_branch FAIL
ok_96:
    buffer_load_dword v76, v11, s[4:7], 0 offen sc1
    s_waitcnt vmcnt(0)
    s_branch fw_94
fwd_95:
    s_barrier
    s_mul_i32 s70, s30, 12288
    s_add_u32 m0, s70, 0
    s_mov_b32 s71, s75
    buffer_load_dwordx4 v10, s[4:7], s71 offen offset:0 sc1 lds
    buffer_load_dwordx4 v10, s[4:7], s71 offen offset:1024 sc1 lds
    buffer_load_dwordx4 v10, s[4:7], s71 offen offset:2048 sc1 lds
    buffer_load_dwordx4 v10, s[4:7], s71 offen offset:3072 sc1 lds
    s_add_u32 m0, m0, 4096
    s_add_u32 s71, s71, 4096
    buffer_load_dwordx4 v10, s[4:7], s71 offen offset:0 sc1 lds
    buffer_load_dwordx4 v10, s[4:7], s71 offen offset:1024 sc1 lds
    buffer_load_dwordx4 v10, s[4:7], s71 offen offset:2048 sc1 lds
    buffer_load_dwordx4 v10, s[4:7], s71 offen offset:3072 sc1 lds
    s_add_u32 m0, m0, 4096
    s_add_u32 s71, s71, 4096
    buffer_load_dwordx4 v10, s[4:7], s71 offen offset:0 sc1 lds
    buffer_load_dwordx4 v10, s[4:7], s71 offen offset:1024 sc1 lds
    buffer_load_dwordx4 v10, s[4:7], s71 offen offset:2048 sc1 lds
    buffer_load_dwordx4 v10, s[4:7], s71 offen offset:3072 sc1 lds
    s_mul_i32 s70, s30, 3072
    s_add_u32 m0, s70, 49152
    s_nop 0
    buffer_load_dwordx4 v10, s[4:7], s76 offen offset:0 sc1 lds
    buffer_load_dwordx4 v10, s[4:7], s76 offen offset:1024 sc1 lds
    buffer_load_dwordx4 v10, s[4:7], s76 offen offset:2048 sc1 lds
    buffer_load_dword v78, v9, s[4:7], s77 offen offset:0 sc1
    buffer_load_dword v79, v9, s[4:7], s77 offen offset:64 sc1
    s_waitcnt vmcnt(0)
wdma_93:
    s_barrier
    buffer_load_dword v77, v12, s[4:7], 0 offen sc1
    ds_read_b128 v[16:19], v10 offset:0
    ds_read_b128 v[20:23], v10 offset:24576
    ds_read_b128 v[24:27], v10 offset:1024
    ds_read_b128 v[28:31], v10 offset:25600
    ds_read_b128 v[32:35], v10 offset:2048
    s_waitcnt lgkmcnt(4)
    v_mfma_f32_16x16x32_bf16 v[40:43], a[0:3], v[16:19], 0
    v_mfma_f32_16x16x32_bf16 v[44:47], a[96:99], v[16:19], 0
    ds_read_b128 v[36:39], v10 offset:26624
    s_waitcnt lgkmcnt(4)
    v_mfma_f32_16x16x32_bf16 v[48:51], a[0:3], v[20:23], 0
    v_mfma_f32_16x16x32_bf16 v[52:55], a[96:99], v[20:23], 0
    ds_read_b128 v[16:19], v10 offset:3072
    s_waitcnt lgkmcnt(4)
    v_mfma_f32_16x16x32_bf16 v[40:43], a[4:7], v[24:27], v[40:43]
    v_mfma_f32_16x16x32_bf16 v[44:47], a[100:103], v[24:27], v[44:47]
    ds_read_b128 v[20:23], v10 offset:27648
    s_waitcnt lgkmcnt(4)
    v_mfma_f32_16x16x32_bf16 v[48:51], a[4:7], v[28:31], v[48:51]
    v_mfma_f32_16x16x32_bf16 v[52:55], a[100:103], v[28:31], v[52:55]
    ds_read_b128 v[24:27], v10 offset:4096
    s_waitcnt lgkmcnt(4)
    v_mfma_f32_16x16x32_bf16 v[40:43], a[8:11], v[32:35], v[40:43]
    v_mfma_f32_16x16x32_bf16 v[44:47], a[104:107], v[32:35], v[44:47]
    ds_read_b128 v[28:31], v10 offset:28672
    s_waitcnt lgkmcnt(4)
    v_mfma_f32_16x16x32_bf16 v[48:51], a[8:11], v[36:39], v[48:51]
    v_mfma_f32_16x16x32_bf16 v[52:55], a[104:107], v[36:39], v[52:55]
    ds_read_b128 v[32:35], v10 offset:5120
    s_waitcnt lgkmcnt(4)
    v_mfma_f32_16x16x32_bf16 v[40:43], a[12:15], v[16:19], v[40:43]
    v_mfma_f32_16x16x32_bf16 v[44:47], a[108:111], v[16:19], v[44:47]
    ds_read_b128 v[36:39], v10 offset:29696
    s_waitcnt lgkmcnt(4)
    v_mfma_f32_16x16x32_bf16 v[48:51], a[12:15], v[20:23], v[48:51]
    v_mfma_f32_16x16x32_bf16 v[52:55], a[108:111], v[20:23], v[52:55]
    ds_read_b128 v[16:19], v10 offset:6144
    s_waitcnt lgkmcnt(4)
    v_mfma_f32_16x16x32_bf16 v[40:43], a[16:19], v[24:27], v[40:43]
    v_mfma_f32_16x16x32_bf16 v[44:47], a[112:115], v[24:27], v[44:47]
    ds_read_b128 v[20:23], v10 offset:30720
    s_waitcnt lgkmcnt(4)
    v_mfma_f32_16x16x32_bf16 v[48:51], a[16:19], v[28:31], v[48:51]
    v_mfma_f32_16x16x32_bf16 v[52:55], a[112:115], v[28:31], v[52:55]
    ds_read_b128 v[24:27], v10 offset:7168
    s_waitcnt lgkmcnt(4)
    v_mfma_f32_16x16x32_bf16 v[40:43], a[20:23], v[32:35], v[40:43]
    v_mfma_f32_16x16x32_bf16 v[44:47], a[116:119], v[32:35], v[44:47]
    ds_read_b128 v[28:31], v10 offset:31744
    s_waitcnt lgkmcnt(4)
    v_mfma_f32_16x16x32_bf16 v[48:51], a[20:23], v[36:39], v[48:51]
    v_mfma_f32_16x16x32_bf16 v[52:55], a[116:119], v[36:39], v[52:55]
    ds_read_b128 v[32:35], v10 offset:8192
    s_waitcnt lgkmcnt(4)
    v_mfma_f32_16x16x32_bf16 v[40:43], a[24:27], v[16:19], v[40:43]
    v_mfma_f32_16x16x32_bf16 v[44:47], a[120:123], v[16:19], v[44:47]
    ds_read_b128 v[36:39], v10 offset:32768
    s_waitcnt lgkmcnt(4)
    v_mfma_f32_16x16x32_bf16 v[48:51], a[24:27], v[20:23], v[48:51]
    v_mfma_f32_16x16x32_bf16 v[52:55], a[120:123], v[20:23], v[52:55]
    ds_read_b128 v[16:19], v10 offset:9216
    s_waitcnt lgkmcnt(4)
    v_mfma_f32_16x16x32_bf16 v[40:43], a[28:31], v[24:27], v[40:43]
    v_mfma_f32_16x16x32_bf16 v[44:47], a[124:127], v[24:27], v[44:47]
    ds_read_b128 v[20:23], v10 offset:33792
    s_waitcnt lgkmcnt(4)
    v_mfma_f32_16x16x32_bf16 v[48:51], a[28:31], v[28:31], v[48:51]
    v_mfma_f32_16x16x32_bf16 v[52:55], a[124:127], v[28:31], v[52:55]
    ds_read_b128 v[24:27], v10 offset:10240
    s_waitcnt lgkmcnt(4)
    v_mfma_f32_16x16x32_bf16 v[40:43], a[32:35], v[32:35], v[40:43]
    v_mfma_f32_16x16x32_bf16 v[44:47], a[128:131], v[32:35], v[44:47]
    ds_read_b128 v[28:31], v10 offset:34816
    s_waitcnt lgkmcnt(4)
    v_mfma_f32_16x16x32_bf16 v[48:51], a[32:35], v[36:39], v[48:51]
    v_mfma_f32_16x16x32_bf16 v[52:55], a[128:131], v[36:39], v[52:55]
    ds_read_b128 v[32:35], v10 offset:11264
    s_waitcnt lgkmcnt(4)
    v_mfma_f32_16x16x32_bf16 v[40:43], a[36:39], v[16:19], v[40:43]
    v_mfma_f32_16x16x32_bf16 v[44:47], a[132:135], v[16:19], v[44:47]
    ds_read_b128 v[36:39], v10 offset:35840
    s_waitcnt lgkmcnt(4)
    v_mfma_f32_16x16x32_bf16 v[48:51], a[36:39], v[20:23], v[48:51]
    v_mfma_f32_16x16x32_bf16 v[52:55], a[132:135], v[20:23], v[52:55]
    ds_read_b128 v[16:19], v10 offset:12288
    s_waitcnt lgkmcnt(4)
    v_mfma_f32_16x16x32_bf16 v[40:43], a[40:43], v[24:27], v[40:43]
    v_mfma_f32_16x16x32_bf16 v[44:47], a[136:139], v[24:27], v[44:47]
    ds_read_b128 v[20:23], v10 offset:36864
    s_waitcnt lgkmcnt(4)
    v_mfma_f32_16x16x32_bf16 v[48:51], a[40:43], v[28:31], v[48:51]
    v_mfma_f32_16x16x32_bf16 v[52:55], a[136:139], v[28:31], v[52:55]
    ds_read_b128 v[24:27], v10 offset:13312
    s_waitcnt lgkmcnt(4)
    v_mfma_f32_16x16x32_bf16 v[40:43], a[44:47], v[32:35], v[40:43]
    v_mfma_f32_16x16x32_bf16 v[44:47], a[140:143], v[32:35], v[44:47]
    ds_read_b128 v[28:31], v10 offset:37888
    s_waitcnt lgkmcnt(4)
    v_mfma_f32_16x16x32_bf16 v[48:51], a[44:47], v[36:39], v[48:51]
    v_mfma_f32_16x16x32_bf16 v[52:55], a[140:143], v[36:39], v[52:55]
    ds_read_b128 v[32:35], v10 offset:14336
    s_waitcnt lgkmcnt(4)
    s_cmp_eq_u32 s31, 0
    s_cbranch_scc1 nored_97
    s_waitcnt vmcnt(0)
    v_mov_b32 v75, s31
    s_mov_b64 exec, 1
    buffer_store_dword v75, v13, s[4:7], 0 offen sc1
    s_mov_b64 exec, -1
    s_cmp_eq_u32 s31, 1
    s_cbranch_scc1 nored_97
    s_sub_u32 s81, s31, 1
fw_98:
    v_cmp_gt_u32 vcc, s81, v77
    s_and_b32 s69, vcc_lo, 0xffffffff
    s_cbranch_scc0 fwd_99
    s_sub_u32 s68, s68, 1
    s_cbranch_scc0 ok_100
    s_mov_b32 s69, 41
    s_branch FAIL
ok_100:
    buffer_load_dword v77, v12, s[4:7], 0 offen sc1
    s_waitcnt vmcnt(0)
    s_branch fw_98
fwd_99:
    s_add_u32 s69, s79, 0
    buffer_load_dwordx4 v[80:83], v15, s[4:7], s69 offen sc1
    s_add_u32 s69, s79, 4096
    buffer_load_dwordx4 v[84:87], v15, s[4:7], s69 offen sc1
    s_add_u32 s69, s79, 8192
    buffer_load_dwordx4 v[88:91], v15, s[4:7], s69 offen sc1
    s_add_u32 s69, s79, 12288
    buffer_load_dwordx4 v[92:95], v15, s[4:7], s69 offen sc1
nored_97:
    v_mfma_f32_16x16x32_bf16 v[40:43], a[48:51], v[16:19], v[40:43]
    v_mfma_f32_16x16x32_bf16 v[44:47], a[144:147], v[16:19], v[44:47]
    ds_read_b128 v[36:39], v10 offset:38912
    s_waitcnt lgkmcnt(4)
    v_mfma_f32_16x16x32_bf16 v[48:51], a[48:51], v[20:23], v[48:51]
    v_mfma_f32_16x16x32_bf16 v[52:55], a[144:147], v[20:23], v[52:55]
    ds_read_b128 v[16:19], v10 offset:15360
    s_waitcnt lgkmcnt(4)
    v_mfma_f32_16x16x32_bf16 v[40:43], a[52:55], v[24:27], v[40:43]
    v_mfma_f32_16x16x32_bf16 v[44:47], a[148:151], v[24:27], v[44:47]
    ds_read_b128 v[20:23], v10 offset:39936
    s_waitcnt lgkmcnt(4)
    v_mfma_f32_16x16x32_bf16 v[48:51], a[52:55], v[28:31], v[48:51]
    v_mfma_f32_16x16x32_bf16 v[52:55], a[148:151], v[28:31], v[52:55]
    ds_read_b128 v[24:27], v10 offset:16384
    s_waitcnt lgkmcnt(4)
    v_mfma_f32_16x16x32_bf16 v[40:43], a[56:59], v[32:35], v[40:43]
    v_mfma_f32_16x16x32_bf16 v[44:47], a[152:155], v[32:35], v[44:47]
    ds_read_b128 v[28:31], v10 offset:40960
    s_waitcnt lgkmcnt(4)
    v_mfma_f32_16x16x32_bf16 v[48:51], a[56:59], v[36:39], v[48:51]
    v_mfma_f32_16x16x32_bf16 v[52:55], a[152:155], v[36:39], v[52:55]
    ds_read_b128 v[32:35], v10 offset:17408
    s_waitcnt lgkmcnt(4)
    v_mfma_f32_16x16x32_bf16 v[40:43], a[60:63], v[16:19], v[40:43]
    v_mfma_f32_16x16x32_bf16 v[44:47], a[156:159], v[16:19], v[44:47]
    ds_read_b128 v[36:39], v10 offset:41984
    s_waitcnt lgkmcnt(4)
    v_mfma_f32_16x16x32_bf16 v[48:51], a[60:63], v[20:23], v[48:51]
    v_mfma_f32_16x16x32_bf16 v[52:55], a[156:159], v[20:23], v[52:55]
    ds_read_b128 v[16:19], v10 offset:18432
    s_waitcnt lgkmcnt(4)
    v_mfma_f32_16x16x32_bf16 v[40:43], a[64:67], v[24:27], v[40:43]
    v_mfma_f32_16x16x32_bf16 v[44:47], a[160:163], v[24:27], v[44:47]
    ds_read_b128 v[20:23], v10 offset:43008
    s_waitcnt lgkmcnt(4)
    v_mfma_f32_16x16x32_bf16 v[48:51], a[64:67], v[28:31], v[48:51]
    v_mfma_f32_16x16x32_bf16 v[52:55], a[160:163], v[28:31], v[52:55]
    ds_read_b128 v[24:27], v10 offset:19456
    s_waitcnt lgkmcnt(4)
    v_mfma_f32_16x16x32_bf16 v[40:43], a[68:71], v[32:35], v[40:43]
    v_mfma_f32_16x16x32_bf16 v[44:47], a[164:167], v[32:35], v[44:47]
    ds_read_b128 v[28:31], v10 offset:44032
    s_waitcnt lgkmcnt(4)
    v_mfma_f32_16x16x32_bf16 v[48:51], a[68:71], v[36:39], v[48:51]
    v_mfma_f32_16x16x32_bf16 v[52:55], a[164:167], v[36:39], v[52:55]
    ds_read_b128 v[32:35], v10 offset:20480
    s_waitcnt lgkmcnt(4)
    v_mfma_f32_16x16x32_bf16 v[40:43], a[72:75], v[16:19], v[40:43]
    v_mfma_f32_16x16x32_bf16 v[44:47], a[168:171], v[16:19], v[44:47]
    ds_read_b128 v[36:39], v10 offset:45056
    s_waitcnt lgkmcnt(4)
    v_mfma_f32_16x16x32_bf16 v[48:51], a[72:75], v[20:23], v[48:51]
    v_mfma_f32_16x16x32_bf16 v[52:55], a[168:171], v[20:23], v[52:55]
    ds_read_b128 v[16:19], v10 offset:21504
    s_waitcnt lgkmcnt(4)
    v_mfma_f32_16x16x32_bf16 v[40:43], a[76:79], v[24:27], v[40:43]
    v_mfma_f32_16x16x32_bf16 v[44:47], a[172:175], v[24:27], v[44:47]
    ds_read_b128 v[20:23], v10 offset:46080
    s_waitcnt lgkmcnt(4)
    v_mfma_f32_16x16x32_bf16 v[48:51], a[76:79], v[28:31], v[48:51]
    v_mfma_f32_16x16x32_bf16 v[52:55], a[172:175], v[28:31], v[52:55]
    ds_read_b128 v[24:27], v10 offset:22528
    s_waitcnt lgkmcnt(4)
    v_mfma_f32_16x16x32_bf16 v[40:43], a[80:83], v[32:35], v[40:43]
    v_mfma_f32_16x16x32_bf16 v[44:47], a[176:179], v[32:35], v[44:47]
    ds_read_b128 v[28:31], v10 offset:47104
    s_waitcnt lgkmcnt(4)
    v_mfma_f32_16x16x32_bf16 v[48:51], a[80:83], v[36:39], v[48:51]
    v_mfma_f32_16x16x32_bf16 v[52:55], a[176:179], v[36:39], v[52:55]
    ds_read_b128 v[32:35], v10 offset:23552
    s_waitcnt lgkmcnt(4)
    v_mfma_f32_16x16x32_bf16 v[40:43], a[84:87], v[16:19], v[40:43]
    v_mfma_f32_16x16x32_bf16 v[44:47], a[180:183], v[16:19], v[44:47]
    ds_read_b128 v[36:39], v10 offset:48128
    s_waitcnt lgkmcnt(4)
    v_mfma_f32_16x16x32_bf16 v[48:51], a[84:87], v[20:23], v[48:51]
    v_mfma_f32_16x16x32_bf16 v[52:55], a[180:183], v[20:23], v[52:55]
    ds_read_b128 v[16:19], v10 offset:49152
    s_waitcnt lgkmcnt(4)
    buffer_load_dword v76, v11, s[4:7], 0 offen sc1
    v_mfma_f32_16x16x32_bf16 v[40:43], a[88:91], v[24:27], v[40:43]
    v_mfma_f32_16x16x32_bf16 v[44:47], a[184:187], v[24:27], v[44:47]
    ds_read_b128 v[20:23], v10 offset:55296
    s_waitcnt lgkmcnt(4)
    v_mfma_f32_16x16x32_bf16 v[48:51], a[88:91], v[28:31], v[48:51]
    v_mfma_f32_16x16x32_bf16 v[52:55], a[184:187], v[28:31], v[52:55]
    ds_read_b128 v[24:27], v10 offset:50176
    s_waitcnt lgkmcnt(4)
    v_mfma_f32_16x16x32_bf16 v[40:43], a[92:95], v[32:35], v[40:43]
    v_mfma_f32_16x16x32_bf16 v[44:47], a[188:191], v[32:35], v[44:47]
    ds_read_b128 v[28:31], v10 offset:56320
    s_waitcnt lgkmcnt(4)
    v_mfma_f32_16x16x32_bf16 v[48:51], a[92:95], v[36:39], v[48:51]
    v_mfma_f32_16x16x32_bf16 v[52:55], a[188:191], v[36:39], v[52:55]
    ds_read_b128 v[32:35], v10 offset:51200
    s_waitcnt lgkmcnt(4)
    v_mfma_f32_16x16x32_bf16 v[56:59], a[192:195], v[16:19], 0
    v_mfma_f32_16x16x32_bf16 v[60:63], a[216:219], v[16:19], 0
    ds_read_b128 v[36:39], v10 offset:57344
    s_waitcnt lgkmcnt(4)
    v_mfma_f32_16x16x32_bf16 v[64:67], a[192:195], v[20:23], 0
    v_mfma_f32_16x16x32_bf16 v[68:71], a[216:219], v[20:23], 0
    ds_read_b128 v[16:19], v10 offset:52224
    s_waitcnt lgkmcnt(4)
    v_mfma_f32_16x16x32_bf16 v[56:59], a[196:199], v[24:27], v[56:59]
    v_mfma_f32_16x16x32_bf16 v[60:63], a[220:223], v[24:27], v[60:63]
    ds_read_b128 v[20:23], v10 offset:58368
    s_waitcnt lgkmcnt(4)
    v_mfma_f32_16x16x32_bf16 v[64:67], a[196:199], v[28:31], v[64:67]
    v_mfma_f32_16x16x32_bf16 v[68:71], a[220:223], v[28:31], v[68:71]
    ds_read_b128 v[24:27], v10 offset:53248
    s_waitcnt lgkmcnt(4)
    v_mfma_f32_16x16x32_bf16 v[56:59], a[200:203], v[32:35], v[56:59]
    v_mfma_f32_16x16x32_bf16 v[60:63], a[224:227], v[32:35], v[60:63]
    ds_read_b128 v[28:31], v10 offset:59392
    s_waitcnt lgkmcnt(4)
    v_mfma_f32_16x16x32_bf16 v[64:67], a[200:203], v[36:39], v[64:67]
    v_mfma_f32_16x16x32_bf16 v[68:71], a[224:227], v[36:39], v[68:71]
    ds_read_b128 v[32:35], v10 offset:54272
    s_waitcnt lgkmcnt(4)
    v_mfma_f32_16x16x32_bf16 v[56:59], a[204:207], v[16:19], v[56:59]
    v_mfma_f32_16x16x32_bf16 v[60:63], a[228:231], v[16:19], v[60:63]
    ds_read_b128 v[36:39], v10 offset:60416
    s_waitcnt lgkmcnt(4)
    v_mfma_f32_16x16x32_bf16 v[64:67], a[204:207], v[20:23], v[64:67]
    v_mfma_f32_16x16x32_bf16 v[68:71], a[228:231], v[20:23], v[68:71]
    s_waitcnt lgkmcnt(3)
    v_mfma_f32_16x16x32_bf16 v[56:59], a[208:211], v[24:27], v[56:59]
    v_mfma_f32_16x16x32_bf16 v[60:63], a[232:235], v[24:27], v[60:63]
    s_waitcnt lgkmcnt(2)
    v_mfma_f32_16x16x32_bf16 v[64:67], a[208:211], v[28:31], v[64:67]
    v_mfma_f32_16x16x32_bf16 v[68:71], a[232:235], v[28:31], v[68:71]
    s_waitcnt lgkmcnt(1)
    v_mfma_f32_16x16x32_bf16 v[56:59], a[212:215], v[32:35], v[56:59]
    v_mfma_f32_16x16x32_bf16 v[60:63], a[236:239], v[32:35], v[60:63]
    s_waitcnt lgkmcnt(0)
    v_mfma_f32_16x16x32_bf16 v[64:67], a[212:215], v[36:39], v[64:67]
    v_mfma_f32_16x16x32_bf16 v[68:71], a[236:239], v[36:39], v[68:71]
    s_waitcnt vmcnt(0)
    v_mov_b32 v72, v78
    v_mov_b32 v73, v79
    s_add_u32 s75, s75, 49152
    s_add_u32 s76, s76, 12288
    s_add_u32 s77, s77, 128
    s_add_u32 s81, s31, 2
    s_cmp_ge_u32 s31, 63
    s_cbranch_scc1 wlate_101
    v_cmp_gt_u32 vcc, s81, v76
    s_and_b32 s69, vcc_lo, 0xfffffff
    s_cbranch_scc1 wlate_101
    s_barrier
    s_mul_i32 s70, s30, 12288
    s_add_u32 m0, s70, 0
    s_mov_b32 s71, s75
    buffer_load_dwordx4 v10, s[4:7], s71 offen offset:0 sc1 lds
    buffer_load_dwordx4 v10, s[4:7], s71 offen offset:1024 sc1 lds
    buffer_load_dwordx4 v10, s[4:7], s71 offen offset:2048 sc1 lds
    buffer_load_dwordx4 v10, s[4:7], s71 offen offset:3072 sc1 lds
    s_add_u32 m0, m0, 4096
    s_add_u32 s71, s71, 4096
    buffer_load_dwordx4 v10, s[4:7], s71 offen offset:0 sc1 lds
    buffer_load_dwordx4 v10, s[4:7], s71 offen offset:1024 sc1 lds
    buffer_load_dwordx4 v10, s[4:7], s71 offen offset:2048 sc1 lds
    buffer_load_dwordx4 v10, s[4:7], s71 offen offset:3072 sc1 lds
    s_add_u32 m0, m0, 4096
    s_add_u32 s71, s71, 4096
    buffer_load_dwordx4 v10, s[4:7], s71 offen offset:0 sc1 lds
    buffer_load_dwordx4 v10, s[4:7], s71 offen offset:1024 sc1 lds
    buffer_load_dwordx4 v10, s[4:7], s71 offen offset:2048 sc1 lds
    buffer_load_dwordx4 v10, s[4:7], s71 offen offset:3072 sc1 lds
    s_mul_i32 s70, s30, 3072
    s_add_u32 m0, s70, 49152
    s_nop 0
    buffer_load_dwordx4 v10, s[4:7], s76 offen offset:0 sc1 lds
    buffer_load_dwordx4 v10, s[4:7], s76 offen offset:1024 sc1 lds
    buffer_load_dwordx4 v10, s[4:7], s76 offen offset:2048 sc1 lds
    buffer_load_dword v78, v9, s[4:7], s77 offen offset:0 sc1
    buffer_load_dword v79, v9, s[4:7], s77 offen offset:64 sc1
    s_cmp_lt_u32 s31, 2
    s_cbranch_scc1 nored_102
    v_add_f32 v80, v80, v84
    v_add_f32 v88, v88, v92
    v_add_f32 v81, v81, v85
    v_add_f32 v89, v89, v93
    v_add_f32 v82, v82, v86
    v_add_f32 v90, v90, v94
    v_add_f32 v83, v83, v87
    v_add_f32 v91, v91, v95
    v_add_f32 v80, v80, v88
    v_add_f32 v81, v81, v89
    v_add_f32 v82, v82, v90
    v_add_f32 v83, v83, v91
    v_mov_b32 v84, v80
    v_mov_b32 v85, v81
    v_mov_b32 v86, v82
    v_mov_b32 v87, v83
    v_permlane32_swap_b32 v80, v84
    v_permlane32_swap_b32 v81, v85
    v_permlane32_swap_b32 v82, v86
    v_permlane32_swap_b32 v83, v87
    v_add_f32 v80, v80, v84
    v_add_f32 v81, v81, v85
    v_add_f32 v82, v82, v86
    v_add_f32 v83, v83, v87
    v_cvt_pk_bf16_f32 v84, v80, v81
    v_cvt_pk_bf16_f32 v85, v82, v83
    s_mov_b32 exec_hi, 0
    buffer_store_dwordx2 v[84:85], v8, s[24:27], s80 offen
    s_mov_b32 exec_hi, -1
nored_102:
    v_sub_f32 v40, v40, v56
    v_sub_f32 v41, v41, v57
    v_sub_f32 v42, v42, v58
    v_sub_f32 v43, v43, v59
    v_fma_f32 v40, v40, v72, v56
    v_fma_f32 v41, v41, v72, v57
    v_fma_f32 v42, v42, v72, v58
    v_fma_f32 v43, v43, v72, v59
    s_add_u32 s69, s78, 0
    buffer_store_dwordx4 v[40:43], v14, s[4:7], s69 offen sc1
    v_sub_f32 v44, v44, v60
    v_sub_f32 v45, v45, v61
    v_sub_f32 v46, v46, v62
    v_sub_f32 v47, v47, v63
    v_fma_f32 v44, v44, v72, v60
    v_fma_f32 v45, v45, v72, v61
    v_fma_f32 v46, v46, v72, v62
    v_fma_f32 v47, v47, v72, v63
    s_add_u32 s69, s78, 256
    buffer_store_dwordx4 v[44:47], v14, s[4:7], s69 offen sc1
    v_sub_f32 v48, v48, v64
    v_sub_f32 v49, v49, v65
    v_sub_f32 v50, v50, v66
    v_sub_f32 v51, v51, v67
    v_fma_f32 v48, v48, v73, v64
    v_fma_f32 v49, v49, v73, v65
    v_fma_f32 v50, v50, v73, v66
    v_fma_f32 v51, v51, v73, v67
    s_add_u32 s69, s78, 65536
    buffer_store_dwordx4 v[48:51], v14, s[4:7], s69 offen sc1
    v_sub_f32 v52, v52, v68
    v_sub_f32 v53, v53, v69
    v_sub_f32 v54, v54, v70
    v_sub_f32 v55, v55, v71
    v_fma_f32 v52, v52, v73, v68
    v_fma_f32 v53, v53, v73, v69
    v_fma_f32 v54, v54, v73, v70
    v_fma_f32 v55, v55, v73, v71
    s_add_u32 s69, s78, 65792
    buffer_store_dwordx4 v[52:55], v14, s[4:7], s69 offen sc1
    s_add_u32 s78, s78, 655360
    s_add_u32 s79, s79, 655360
    s_add_u32 s80, s80, 40960
    s_add_u32 s31, s31, 1
    s_waitcnt vmcnt(4)
    s_branch wdma_93
wlate_101:
    s_cmp_lt_u32 s31, 2
    s_cbranch_scc1 nored_103
    v_add_f32 v80, v80, v84
    v_add_f32 v88, v88, v92
    v_add_f32 v81, v81, v85
    v_add_f32 v89, v89, v93
    v_add_f32 v82, v82, v86
    v_add_f32 v90, v90, v94
    v_add_f32 v83, v83, v87
    v_add_f32 v91, v91, v95
    v_add_f32 v80, v80, v88
    v_add_f32 v81, v81, v89
    v_add_f32 v82, v82, v90
    v_add_f32 v83, v83, v91
    v_mov_b32 v84, v80
    v_mov_b32 v85, v81
    v_mov_b32 v86, v82
    v_mov_b32 v87, v83
    v_permlane32_swap_b32 v80, v84
    v_permlane32_swap_b32 v81, v85
    v_permlane32_swap_b32 v82, v86
    v_permlane32_swap_b32 v83, v87
    v_add_f32 v80, v80, v84
    v_add_f32 v81, v81, v85
    v_add_f32 v82, v82, v86
    v_add_f32 v83, v83, v87
    v_cvt_pk_bf16_f32 v84, v80, v81
    v_cvt_pk_bf16_f32 v85, v82, v83
    s_mov_b32 exec_hi, 0
    buffer_store_dwordx2 v[84:85], v8, s[24:27], s80 offen
    s_mov_b32 exec_hi, -1
nored_103:
    v_sub_f32 v40, v40, v56
    v_sub_f32 v41, v41, v57
    v_sub_f32 v42, v42, v58
    v_sub_f32 v43, v43, v59
    v_fma_f32 v40, v40, v72, v56
    v_fma_f32 v41, v41, v72, v57
    v_fma_f32 v42, v42, v72, v58
    v_fma_f32 v43, v43, v72, v59
    s_add_u32 s69, s78, 0
    buffer_store_dwordx4 v[40:43], v14, s[4:7], s69 offen sc1
    v_sub_f32 v44, v44, v60
    v_sub_f32 v45, v45, v61
    v_sub_f32 v46, v46, v62
    v_sub_f32 v47, v47, v63
    v_fma_f32 v44, v44, v72, v60
    v_fma_f32 v45, v45, v72, v61
    v_fma_f32 v46, v46, v72, v62
    v_fma_f32 v47, v47, v72, v63
    s_add_u32 s69, s78, 256
    buffer_store_dwordx4 v[44:47], v14, s[4:7], s69 offen sc1
    v_sub_f32 v48, v48, v64
    v_sub_f32 v49, v49, v65
    v_sub_f32 v50, v50, v66
    v_sub_f32 v51, v51, v67
    v_fma_f32 v48, v48, v73, v64
    v_fma_f32 v49, v49, v73, v65
    v_fma_f32 v50, v50, v73, v66
    v_fma_f32 v51, v51, v73, v67
    s_add_u32 s69, s78, 65536
    buffer_store_dwordx4 v[48:51], v14, s[4:7], s69 offen sc1
    v_sub_f32 v52, v52, v68
    v_sub_f32 v53, v53, v69
    v_sub_f32 v54, v54, v70
    v_sub_f32 v55, v55, v71
    v_fma_f32 v52, v52, v73, v68
    v_fma_f32 v53, v53, v73, v69
    v_fma_f32 v54, v54, v73, v70
    v_fma_f32 v55, v55, v73, v71
    s_add_u32 s69, s78, 65792
    buffer_store_dwordx4 v[52:55], v14, s[4:7], s69 offen sc1
    s_add_u32 s78, s78, 655360
    s_add_u32 s79, s79, 655360
    s_add_u32 s80, s80, 40960
    s_add_u32 s31, s31, 1
    s_cmp_lt_u32 s31, 64
    s_cbranch_scc1 wloop_92
    buffer_load_dword v77, v12, s[4:7], 0 offen sc1
    s_waitcnt vmcnt(0)
    v_mov_b32 v75, s31
    s_mov_b64 exec, 1
    buffer_store_dword v75, v13, s[4:7], 0 offen sc1
    s_mov_b64 exec, -1
    s_sub_u32 s81, s31, 1
fw_104:
    v_cmp_gt_u32 vcc, s81, v77
    s_and_b32 s69, vcc_lo, 0xffffffff
    s_cbranch_scc0 fwd_105
    s_sub_u32 s68, s68, 1
    s_cbranch_scc0 ok_106
    s_mov_b32 s69, 43
    s_branch FAIL
ok_106:
    buffer_load_dword v77, v12, s[4:7], 0 offen sc1
    s_waitcnt vmcnt(0)
    s_branch fw_104
fwd_105:
    s_sub_u32 s82, s79, 0
    s_add_u32 s69, s82, 0
    buffer_load_dwordx4 v[96:99], v15, s[4:7], s69 offen sc1
    s_add_u32 s69, s82, 4096
    buffer_load_dwordx4 v[100:103], v15, s[4:7], s69 offen sc1
    s_add_u32 s69, s82, 8192
    buffer_load_dwordx4 v[104:107], v15, s[4:7], s69 offen sc1
    s_add_u32 s69, s82, 12288
    buffer_load_dwordx4 v[108:111], v15, s[4:7], s69 offen sc1
    s_add_u32 s82, s79, 655360
    s_add_u32 s83, s80, 40960
    buffer_load_dword v77, v12, s[4:7], 0 offen sc1
    s_waitcnt vmcnt(0)
    v_add_f32 v96, v96, v100
    v_add_f32 v104, v104, v108
    v_add_f32 v97, v97, v101
    v_add_f32 v105, v105, v109
    v_add_f32 v98, v98, v102
    v_add_f32 v106, v106, v110
    v_add_f32 v99, v99, v103
    v_add_f32 v107, v107, v111
    v_add_f32 v96, v96, v104
    v_add_f32 v97, v97, v105
    v_add_f32 v98, v98, v106
    v_add_f32 v99, v99, v107
    v_mov_b32 v100, v96
    v_mov_b32 v101, v97
    v_mov_b32 v102, v98
    v_mov_b32 v103, v99
    v_permlane32_swap_b32 v96, v100
    v_permlane32_swap_b32 v97, v101
    v_permlane32_swap_b32 v98, v102
    v_permlane32_swap_b32 v99, v103
    v_add_f32 v96, v96, v100
    v_add_f32 v97, v97, v101
    v_add_f32 v98, v98, v102
    v_add_f32 v99, v99, v103
    v_cvt_pk_bf16_f32 v100, v96, v97
    v_cvt_pk_bf16_f32 v101, v98, v99
    s_mov_b32 exec_hi, 0
    buffer_store_dwordx2 v[100:101], v8, s[24:27], s80 offen
    s_mov_b32 exec_hi, -1
fw_107:
    v_cmp_gt_u32 vcc, s31, v77
    s_and_b32 s69, vcc_lo, 0xffffffff
    s_cbranch_scc0 fwd_108
    s_sub_u32 s68, s68, 1
    s_cbranch_scc0 ok_109
    s_mov_b32 s69, 42
    s_branch FAIL
ok_109:
    buffer_load_dword v77, v12, s[4:7], 0 offen sc1
    s_waitcnt vmcnt(0)
    s_branch fw_107
fwd_108:
    s_add_u32 s69, s82, 0
    buffer_load_dwordx4 v[80:83], v15, s[4:7], s69 offen sc1
    s_add_u32 s69, s82, 4096
    buffer_load_dwordx4 v[84:87], v15, s[4:7], s69 offen sc1
    s_add_u32 s69, s82, 8192
    buffer_load_dwordx4 v[88:91], v15, s[4:7], s69 offen sc1
    s_add_u32 s69, s82, 12288
    buffer_load_dwordx4 v[92:95], v15, s[4:7], s69 offen sc1
    s_waitcnt vmcnt(0)
    v_add_f32 v80, v80, v84
    v_add_f32 v88, v88, v92
    v_add_f32 v81, v81, v85
    v_add_f32 v89, v89, v93
    v_add_f32 v82, v82, v86
    v_add_f32 v90, v90, v94
    v_add_f32 v83, v83, v87
    v_add_f32 v91, v91, v95
    v_add_f32 v80, v80, v88
    v_add_f32 v81, v81, v89
    v_add_f32 v82, v82, v90
    v_add_f32 v83, v83, v91
    v_mov_b32 v84, v80
    v_mov_b32 v85, v81
    v_mov_b32 v86, v82
    v_mov_b32 v87, v83
    v_permlane32_swap_b32 v80, v84
    v_permlane32_swap_b32 v81, v85
    v_permlane32_swap_b32 v82, v86
    v_permlane32_swap_b32 v83, v87
    v_add_f32 v80, v80, v84
    v_add_f32 v81, v81, v85
    v_add_f32 v82, v82, v86
    v_add_f32 v83, v83, v87
    v_cvt_pk_bf16_f32 v84, v80, v81
    v_cvt_pk_bf16_f32 v85, v82, v83
    s_mov_b32 exec_hi, 0
    buffer_store_dwordx2 v[84:85], v8, s[24:27], s83 offen
    s_mov_b32 exec_hi, -1
    s_waitcnt vmcnt(0)
    s_branch EXIT
SAFEWAIT:
    v_mov_b32 v2, 128
wa_110:
    buffer_load_dword v3, v2, s[64:67], 0 offen sc1
    s_waitcnt vmcnt(0)
    v_cmp_ne_u32 vcc, 0x100, v3
    s_cbranch_vccz wad_111
    s_sub_u32 s68, s68, 1
    s_cbranch_scc0 ok_112
    s_mov_b32 s69, 1
    s_branch FAIL
ok_112:
    s_sleep 4
    s_branch wa_110
wad_111:
SAFEENTRY:
    s_and_b32 s28, s2, 7
    s_lshr_b32 s29, s2, 3
    s_barrier
    s_cmp_lt_u32 s29, 12
    s_cbranch_scc1 ROLE_CS
    s_cmp_lt_u32 s29, 16
    s_cbranch_scc1 ROLE_KS
    s_cmp_lt_u32 s29, 20
    s_cbranch_scc1 ROLE_VS
    s_cmp_lt_u32 s29, 24
    s_cbranch_scc1 ROLE_QS
    s_cmp_lt_u32 s29, 27
    s_cbranch_scc1 ROLE_FS
    s_branch ROLE_WS
ROLE_CS:
    s_mov_b32 s12, s36
    s_mov_b32 s13, s37
    s_mov_b32 s14, 7864320
    s_mov_b32 s15, 0x20000
    s_mov_b32 s16, s38
    s_mov_b32 s17, s39
    s_mov_b32 s18, 7864320
    s_mov_b32 s19, 0x20000
    s_mov_b32 s20, s40
    s_mov_b32 s21, s41
    s_mov_b32 s22, 7864320
    s_mov_b32 s23, 0x20000
    s_mov_b32 s24, s42
    s_mov_b32 s25, s43
    s_mov_b32 s26, 7864320
    s_mov_b32 s27, 0x20000
    s_mul_i32 s73, s29, 0x5556
    s_lshr_b32 s73, s73, 16
    s_mul_i32 s75, s73, 3
    s_sub_u32 s75, s29, s75
    s_lshl_b32 s74, s28, 2
    s_add_u32 s74, s74, s73
    s_min_u32 s86, s29, 9
    v_lshrrev_b32 v2, 3, v0
    v_and_b32 v3, 7, v0
    v_lshrrev_b32 v4, 4, v0
    v_lshrrev_b32 v4, 1, v4
    v_and_b32 v4, 1, v4
    v_lshlrev_b32 v4, 1, v4
    s_and_b32 s69, s30, 1
    s_lshl_b32 s69, s69, 2
    v_or_b32 v4, s69, v4
    v_xor_b32 v3, v3, v4
    v_lshlrev_b32 v3, 4, v3
    s_mov_b32 s69, 1280
    v_mad_u32_u24 v12, v2, s69, v3
    v_lshrrev_b32 v2, 3, v0
    v_and_b32 v3, 7, v0
    v_lshrrev_b32 v4, 4, v0
    v_lshrrev_b32 v4, 1, v4
    v_and_b32 v4, 1, v4
    v_lshlrev_b32 v4, 1, v4
    s_and_b32 s69, s30, 1
    s_lshl_b32 s69, s69, 2
    v_or_b32 v4, s69, v4
    v_xor_b32 v3, v3, v4
    v_lshlrev_b32 v3, 4, v3
    s_mov_b32 s69, 12288
    v_mad_u32_u24 v13, v2, s69, v3
    v_lshrrev_b32 v2, 4, v0
    v_bfe_u32 v3, v0, 2, 2
    v_and_b32 v4, 3, v0
    v_lshrrev_b32 v5, 1, v3
    v_and_b32 v6, 1, v2
    v_lshl_or_b32 v8, v5, 1, v6
    v_lshlrev_b32 v7, 2, v8
    v_lshlrev_b32 v5, 1, v8
    v_lshrrev_b32 v6, 1, v2
    v_lshl_add_u32 v6, v6, 4, v7
    v_and_b32 v7, 1, v3
    v_add_u32 v6, v6, v7
    s_lshl_b32 s69, s30, 1
    v_lshrrev_b32 v7, 1, v4
    v_or_b32 v7, s69, v7
    v_xor_b32 v7, v7, v5
    v_lshlrev_b32 v7, 4, v7
    v_and_b32 v4, 1, v4
    v_lshl_or_b32 v7, v4, 3, v7
    v_lshl_add_u32 v14, v6, 7, v7
    s_mul_i32 s71, s74, 384
    s_lshl_b32 s72, s75, 7
    s_add_u32 s71, s71, s72
    s_mul_i32 s69, s30, 98304
    s_add_u32 s69, s69, s71
    s_lshl_b32 s70, s30, 10
    s_add_u32 m0, s70, 0
    s_nop 0
    buffer_load_dwordx4 v13, s[16:19], s69 offen lds
    s_add_u32 m0, m0, 4096
    s_add_u32 s69, s69, 393216
    buffer_load_dwordx4 v13, s[16:19], s69 offen lds
    s_add_u32 m0, m0, 4096
    s_add_u32 s69, s69, 393216
    buffer_load_dwordx4 v13, s[16:19], s69 offen lds
    s_add_u32 m0, m0, 4096
    s_add_u32 s69, s69, 393216
    buffer_load_dwordx4 v13, s[16:19], s69 offen lds
    s_add_u32 m0, m0, 4096
    s_add_u32 s69, s69, 393216
    buffer_load_dwordx4 v13, s[16:19], s69 offen lds
    s_add_u32 m0, m0, 4096
    s_add_u32 s69, s69, 393216
    buffer_load_dwordx4 v13, s[16:19], s69 offen lds
    s_add_u32 m0, m0, 4096
    s_add_u32 s69, s69, 393216
    buffer_load_dwordx4 v13, s[16:19], s69 offen lds
    s_add_u32 m0, m0, 4096
    s_add_u32 s69, s69, 393216
    buffer_load_dwordx4 v13, s[16:19], s69 offen lds
    s_add_u32 m0, m0, 4096
    s_add_u32 s69, s69, 393216
    buffer_load_dwordx4 v13, s[16:19], s69 offen lds
    s_add_u32 m0, m0, 4096
    s_add_u32 s69, s69, 393216
    buffer_load_dwordx4 v13, s[16:19], s69 offen lds
    s_add_u32 m0, m0, 4096
    s_add_u32 s69, s69, 393216
    buffer_load_dwordx4 v13, s[16:19], s69 offen lds
    s_add_u32 m0, m0, 4096
    s_add_u32 s69, s69, 393216
    buffer_load_dwordx4 v13, s[16:19], s69 offen lds
    s_add_u32 m0, m0, 4096
    s_add_u32 s69, s69, 393216
    buffer_load_dwordx4 v13, s[16:19], s69 offen lds
    s_add_u32 m0, m0, 4096
    s_add_u32 s69, s69, 393216
    buffer_load_dwordx4 v13, s[16:19], s69 offen lds
    s_add_u32 m0, m0, 4096
    s_add_u32 s69, s69, 393216
    buffer_load_dwordx4 v13, s[16:19], s69 offen lds
    s_add_u32 m0, m0, 4096
    s_add_u32 s69, s69, 393216
    buffer_load_dwordx4 v13, s[16:19], s69 offen lds
    s_add_u32 m0, m0, 4096
    s_add_u32 s69, s69, 393216
    buffer_load_dwordx4 v13, s[16:19], s69 offen lds
    s_add_u32 m0, m0, 4096
    s_add_u32 s69, s69, 393216
    buffer_load_dwordx4 v13, s[16:19], s69 offen lds
    s_add_u32 m0, m0, 4096
    s_add_u32 s69, s69, 393216
    buffer_load_dwordx4 v13, s[16:19], s69 offen lds
    s_add_u32 m0, m0, 4096
    s_add_u32 s69, s69, 393216
    buffer_load_dwordx4 v13, s[16:19], s69 offen lds
    s_mul_i32 s71, s74, 384
    s_lshl_b32 s72, s75, 7
    s_add_u32 s71, s71, s72
    s_mul_i32 s69, s30, 98304
    s_add_u32 s69, s69, s71
    s_lshl_b32 s70, s30, 10
    s_add_u32 m0, s70, 81920
    s_nop 0
    buffer_load_dwordx4 v13, s[20:23], s69 offen lds
    s_add_u32 m0, m0, 4096
    s_add_u32 s69, s69, 393216
    buffer_load_dwordx4 v13, s[20:23], s69 offen lds
    s_add_u32 m0, m0, 4096
    s_add_u32 s69, s69, 393216
    buffer_load_dwordx4 v13, s[20:23], s69 offen lds
    s_add_u32 m0, m0, 4096
    s_add_u32 s69, s69, 393216
    buffer_load_dwordx4 v13, s[20:23], s69 offen lds
    s_add_u32 m0, m0, 4096
    s_add_u32 s69, s69, 393216
    buffer_load_dwordx4 v13, s[20:23], s69 offen lds
    s_add_u32 m0, m0, 4096
    s_add_u32 s69, s69, 393216
    buffer_load_dwordx4 v13, s[20:23], s69 offen lds
    s_add_u32 m0, m0, 4096
    s_add_u32 s69, s69, 393216
    buffer_load_dwordx4 v13, s[20:23], s69 offen lds
    s_add_u32 m0, m0, 4096
    s_add_u32 s69, s69, 393216
    buffer_load_dwordx4 v13, s[20:23], s69 offen lds
    s_add_u32 m0, m0, 4096
    s_add_u32 s69, s69, 393216
    buffer_load_dwordx4 v13, s[20:23], s69 offen lds
    s_add_u32 m0, m0, 4096
    s_add_u32 s69, s69, 393216
    buffer_load_dwordx4 v13, s[20:23], s69 offen lds
    s_add_u32 m0, m0, 4096
    s_add_u32 s69, s69, 393216
    buffer_load_dwordx4 v13, s[20:23], s69 offen lds
    s_add_u32 m0, m0, 4096
    s_add_u32 s69, s69, 393216
    buffer_load_dwordx4 v13, s[20:23], s69 offen lds
    s_add_u32 m0, m0, 4096
    s_add_u32 s69, s69, 393216
    buffer_load_dwordx4 v13, s[20:23], s69 offen lds
    s_add_u32 m0, m0, 4096
    s_add_u32 s69, s69, 393216
    buffer_load_dwordx4 v13, s[20:23], s69 offen lds
    s_add_u32 m0, m0, 4096
    s_add_u32 s69, s69, 393216
    buffer_load_dwordx4 v13, s[20:23], s69 offen lds
    s_add_u32 m0, m0, 4096
    s_add_u32 s69, s69, 393216
    buffer_load_dwordx4 v13, s[20:23], s69 offen lds
    s_add_u32 m0, m0, 4096
    s_add_u32 s69, s69, 393216
    buffer_load_dwordx4 v13, s[20:23], s69 offen lds
    s_add_u32 m0, m0, 4096
    s_add_u32 s69, s69, 393216
    buffer_load_dwordx4 v13, s[20:23], s69 offen lds
    s_add_u32 m0, m0, 4096
    s_add_u32 s69, s69, 393216
    buffer_load_dwordx4 v13, s[20:23], s69 offen lds
    s_add_u32 m0, m0, 4096
    s_add_u32 s69, s69, 393216
    buffer_load_dwordx4 v13, s[20:23], s69 offen lds
    s_waitcnt vmcnt(20)
    s_barrier
    v_add_u32 v9, 0, v14
    ds_read_b64_tr_b16 a[80:81], v9 offset:0
    ds_read_b64_tr_b16 a[82:83], v9 offset:256
    ds_read_b64_tr_b16 a[84:85], v9 offset:4096
    ds_read_b64_tr_b16 a[86:87], v9 offset:4352
    ds_read_b64_tr_b16 a[88:89], v9 offset:8192
    ds_read_b64_tr_b16 a[90:91], v9 offset:8448
    ds_read_b64_tr_b16 a[92:93], v9 offset:12288
    ds_read_b64_tr_b16 a[94:95], v9 offset:12544
    ds_read_b64_tr_b16 a[96:97], v9 offset:16384
    ds_read_b64_tr_b16 a[98:99], v9 offset:16640
    ds_read_b64_tr_b16 a[100:101], v9 offset:20480
    ds_read_b64_tr_b16 a[102:103], v9 offset:20736
    s_waitcnt lgkmcnt(0)
    ds_read_b64_tr_b16 a[104:105], v9 offset:24576
    ds_read_b64_tr_b16 a[106:107], v9 offset:24832
    ds_read_b64_tr_b16 a[108:109], v9 offset:28672
    ds_read_b64_tr_b16 a[110:111], v9 offset:28928
    ds_read_b64_tr_b16 a[112:113], v9 offset:32768
    ds_read_b64_tr_b16 a[114:115], v9 offset:33024
    ds_read_b64_tr_b16 a[116:117], v9 offset:36864
    ds_read_b64_tr_b16 a[118:119], v9 offset:37120
    s_waitcnt lgkmcnt(0)
    v_add_u32 v9, 40960, v14
    ds_read_b64_tr_b16 a[120:121], v9 offset:0
    ds_read_b64_tr_b16 a[122:123], v9 offset:256
    ds_read_b64_tr_b16 a[124:125], v9 offset:4096
    ds_read_b64_tr_b16 a[126:127], v9 offset:4352
    ds_read_b64_tr_b16 a[128:129], v9 offset:8192
    ds_read_b64_tr_b16 a[130:131], v9 offset:8448
    ds_read_b64_tr_b16 a[132:133], v9 offset:12288
    ds_read_b64_tr_b16 a[134:135], v9 offset:12544
    ds_read_b64_tr_b16 a[136:137], v9 offset:16384
    ds_read_b64_tr_b16 a[138:139], v9 offset:16640
    ds_read_b64_tr_b16 a[140:141], v9 offset:20480
    ds_read_b64_tr_b16 a[142:143], v9 offset:20736
    s_waitcnt lgkmcnt(0)
    ds_read_b64_tr_b16 a[144:145], v9 offset:24576
    ds_read_b64_tr_b16 a[146:147], v9 offset:24832
    ds_read_b64_tr_b16 a[148:149], v9 offset:28672
    ds_read_b64_tr_b16 a[150:151], v9 offset:28928
    ds_read_b64_tr_b16 a[152:153], v9 offset:32768
    ds_read_b64_tr_b16 a[154:155], v9 offset:33024
    ds_read_b64_tr_b16 a[156:157], v9 offset:36864
    ds_read_b64_tr_b16 a[158:159], v9 offset:37120
    s_waitcnt lgkmcnt(0)
    s_barrier
    s_mul_i32 s71, s74, 384
    s_lshl_b32 s72, s75, 7
    s_add_u32 s71, s71, s72
    s_mul_i32 s69, s30, 98304
    s_add_u32 s69, s69, s71
    s_lshl_b32 s70, s30, 10
    s_add_u32 m0, s70, 0
    s_nop 0
    buffer_load_dwordx4 v13, s[12:15], s69 offen lds
    s_add_u32 m0, m0, 4096
    s_add_u32 s69, s69, 393216
    buffer_load_dwordx4 v13, s[12:15], s69 offen lds
    s_add_u32 m0, m0, 4096
    s_add_u32 s69, s69, 393216
    buffer_load_dwordx4 v13, s[12:15], s69 offen lds
    s_add_u32 m0, m0, 4096
    s_add_u32 s69, s69, 393216
    buffer_load_dwordx4 v13, s[12:15], s69 offen lds
    s_add_u32 m0, m0, 4096
    s_add_u32 s69, s69, 393216
    buffer_load_dwordx4 v13, s[12:15], s69 offen lds
    s_add_u32 m0, m0, 4096
    s_add_u32 s69, s69, 393216
    buffer_load_dwordx4 v13, s[12:15], s69 offen lds
    s_add_u32 m0, m0, 4096
    s_add_u32 s69, s69, 393216
    buffer_load_dwordx4 v13, s[12:15], s69 offen lds
    s_add_u32 m0, m0, 4096
    s_add_u32 s69, s69, 393216
    buffer_load_dwordx4 v13, s[12:15], s69 offen lds
    s_add_u32 m0, m0, 4096
    s_add_u32 s69, s69, 393216
    buffer_load_dwordx4 v13, s[12:15], s69 offen lds
    s_add_u32 m0, m0, 4096
    s_add_u32 s69, s69, 393216
    buffer_load_dwordx4 v13, s[12:15], s69 offen lds
    s_add_u32 m0, m0, 4096
    s_add_u32 s69, s69, 393216
    buffer_load_dwordx4 v13, s[12:15], s69 offen lds
    s_add_u32 m0, m0, 4096
    s_add_u32 s69, s69, 393216
    buffer_load_dwordx4 v13, s[12:15], s69 offen lds
    s_add_u32 m0, m0, 4096
    s_add_u32 s69, s69, 393216
    buffer_load_dwordx4 v13, s[12:15], s69 offen lds
    s_add_u32 m0, m0, 4096
    s_add_u32 s69, s69, 393216
    buffer_load_dwordx4 v13, s[12:15], s69 offen lds
    s_add_u32 m0, m0, 4096
    s_add_u32 s69, s69, 393216
    buffer_load_dwordx4 v13, s[12:15], s69 offen lds
    s_add_u32 m0, m0, 4096
    s_add_u32 s69, s69, 393216
    buffer_load_dwordx4 v13, s[12:15], s69 offen lds
    s_add_u32 m0, m0, 4096
    s_add_u32 s69, s69, 393216
    buffer_load_dwordx4 v13, s[12:15], s69 offen lds
    s_add_u32 m0, m0, 4096
    s_add_u32 s69, s69, 393216
    buffer_load_dwordx4 v13, s[12:15], s69 offen lds
    s_add_u32 m0, m0, 4096
    s_add_u32 s69, s69, 393216
    buffer_load_dwordx4 v13, s[12:15], s69 offen lds
    s_add_u32 m0, m0, 4096
    s_add_u32 s69, s69, 393216
    buffer_load_dwordx4 v13, s[12:15], s69 offen lds
    s_waitcnt vmcnt(20)
    s_barrier
    v_add_u32 v9, 81920, v14
    ds_read_b64_tr_b16 v[176:177], v9 offset:0
    ds_read_b64_tr_b16 v[178:179], v9 offset:256
    ds_read_b64_tr_b16 v[180:181], v9 offset:4096
    ds_read_b64_tr_b16 v[182:183], v9 offset:4352
    ds_read_b64_tr_b16 v[184:185], v9 offset:8192
    ds_read_b64_tr_b16 v[186:187], v9 offset:8448
    ds_read_b64_tr_b16 v[188:189], v9 offset:12288
    ds_read_b64_tr_b16 v[190:191], v9 offset:12544
    ds_read_b64_tr_b16 v[192:193], v9 offset:16384
    ds_read_b64_tr_b16 v[194:195], v9 offset:16640
    ds_read_b64_tr_b16 v[196:197], v9 offset:20480
    ds_read_b64_tr_b16 v[198:199], v9 offset:20736
    s_waitcnt lgkmcnt(0)
    ds_read_b64_tr_b16 v[200:201], v9 offset:24576
    ds_read_b64_tr_b16 v[202:203], v9 offset:24832
    ds_read_b64_tr_b16 v[204:205], v9 offset:28672
    ds_read_b64_tr_b16 v[206:207], v9 offset:28928
    ds_read_b64_tr_b16 v[208:209], v9 offset:32768
    ds_read_b64_tr_b16 v[210:211], v9 offset:33024
    ds_read_b64_tr_b16 v[212:213], v9 offset:36864
    ds_read_b64_tr_b16 v[214:215], v9 offset:37120
    s_waitcnt lgkmcnt(0)
    v_add_u32 v9, 122880, v14
    ds_read_b64_tr_b16 v[216:217], v9 offset:0
    ds_read_b64_tr_b16 v[218:219], v9 offset:256
    ds_read_b64_tr_b16 v[220:221], v9 offset:4096
    ds_read_b64_tr_b16 v[222:223], v9 offset:4352
    ds_read_b64_tr_b16 v[224:225], v9 offset:8192
    ds_read_b64_tr_b16 v[226:227], v9 offset:8448
    ds_read_b64_tr_b16 v[228:229], v9 offset:12288
    ds_read_b64_tr_b16 v[230:231], v9 offset:12544
    ds_read_b64_tr_b16 v[232:233], v9 offset:16384
    ds_read_b64_tr_b16 v[234:235], v9 offset:16640
    ds_read_b64_tr_b16 v[236:237], v9 offset:20480
    ds_read_b64_tr_b16 v[238:239], v9 offset:20736
    s_waitcnt lgkmcnt(0)
    ds_read_b64_tr_b16 v[240:241], v9 offset:24576
    ds_read_b64_tr_b16 v[242:243], v9 offset:24832
    ds_read_b64_tr_b16 v[244:245], v9 offset:28672
    ds_read_b64_tr_b16 v[246:247], v9 offset:28928
    ds_read_b64_tr_b16 v[248:249], v9 offset:32768
    ds_read_b64_tr_b16 v[250:251], v9 offset:33024
    ds_read_b64_tr_b16 v[252:253], v9 offset:36864
    ds_read_b64_tr_b16 v[254:255], v9 offset:37120
    s_waitcnt lgkmcnt(0)
    s_barrier
    s_mul_i32 s71, s28, 983040
    s_lshl_b32 s72, s86, 7
    s_add_u32 s71, s71, s72
    s_mul_i32 s69, s30, 10240
    s_add_u32 s69, s69, s71
    s_lshl_b32 s70, s30, 10
    s_add_u32 m0, s70, 81920
    s_nop 0
    buffer_load_dwordx4 v12, s[24:27], s69 offen lds
    s_add_u32 m0, m0, 4096
    s_add_u32 s69, s69, 40960
    buffer_load_dwordx4 v12, s[24:27], s69 offen lds
    s_add_u32 m0, m0, 4096
    s_add_u32 s69, s69, 40960
    buffer_load_dwordx4 v12, s[24:27], s69 offen lds
    s_add_u32 m0, m0, 4096
    s_add_u32 s69, s69, 40960
    buffer_load_dwordx4 v12, s[24:27], s69 offen lds
    s_add_u32 m0, m0, 4096
    s_add_u32 s69, s69, 40960
    buffer_load_dwordx4 v12, s[24:27], s69 offen lds
    s_add_u32 m0, m0, 4096
    s_add_u32 s69, s69, 40960
    buffer_load_dwordx4 v12, s[24:27], s69 offen lds
    s_add_u32 m0, m0, 4096
    s_add_u32 s69, s69, 40960
    buffer_load_dwordx4 v12, s[24:27], s69 offen lds
    s_add_u32 m0, m0, 4096
    s_add_u32 s69, s69, 40960
    buffer_load_dwordx4 v12, s[24:27], s69 offen lds
    s_add_u32 m0, m0, 4096
    s_add_u32 s69, s69, 40960
    buffer_load_dwordx4 v12, s[24:27], s69 offen lds
    s_add_u32 m0, m0, 4096
    s_add_u32 s69, s69, 40960
    buffer_load_dwordx4 v12, s[24:27], s69 offen lds
    s_add_u32 m0, m0, 4096
    s_add_u32 s69, s69, 40960
    buffer_load_dwordx4 v12, s[24:27], s69 offen lds
    s_add_u32 m0, m0, 4096
    s_add_u32 s69, s69, 40960
    buffer_load_dwordx4 v12, s[24:27], s69 offen lds
    s_waitcnt vmcnt(12)
    s_barrier
    v_add_u32 v9, 0, v14
    ds_read_b64_tr_b16 a[0:1], v9 offset:0
    ds_read_b64_tr_b16 a[2:3], v9 offset:256
    ds_read_b64_tr_b16 a[4:5], v9 offset:4096
    ds_read_b64_tr_b16 a[6:7], v9 offset:4352
    ds_read_b64_tr_b16 a[8:9], v9 offset:8192
    ds_read_b64_tr_b16 a[10:11], v9 offset:8448
    ds_read_b64_tr_b16 a[12:13], v9 offset:12288
    ds_read_b64_tr_b16 a[14:15], v9 offset:12544
    ds_read_b64_tr_b16 a[16:17], v9 offset:16384
    ds_read_b64_tr_b16 a[18:19], v9 offset:16640
    ds_read_b64_tr_b16 a[20:21], v9 offset:20480
    ds_read_b64_tr_b16 a[22:23], v9 offset:20736
    s_waitcnt lgkmcnt(0)
    ds_read_b64_tr_b16 a[24:25], v9 offset:24576
    ds_read_b64_tr_b16 a[26:27], v9 offset:24832
    ds_read_b64_tr_b16 a[28:29], v9 offset:28672
    ds_read_b64_tr_b16 a[30:31], v9 offset:28928
    ds_read_b64_tr_b16 a[32:33], v9 offset:32768
    ds_read_b64_tr_b16 a[34:35], v9 offset:33024
    ds_read_b64_tr_b16 a[36:37], v9 offset:36864
    ds_read_b64_tr_b16 a[38:39], v9 offset:37120
    s_waitcnt lgkmcnt(0)
    v_add_u32 v9, 40960, v14
    ds_read_b64_tr_b16 a[40:41], v9 offset:0
    ds_read_b64_tr_b16 a[42:43], v9 offset:256
    ds_read_b64_tr_b16 a[44:45], v9 offset:4096
    ds_read_b64_tr_b16 a[46:47], v9 offset:4352
    ds_read_b64_tr_b16 a[48:49], v9 offset:8192
    ds_read_b64_tr_b16 a[50:51], v9 offset:8448
    ds_read_b64_tr_b16 a[52:53], v9 offset:12288
    ds_read_b64_tr_b16 a[54:55], v9 offset:12544
    ds_read_b64_tr_b16 a[56:57], v9 offset:16384
    ds_read_b64_tr_b16 a[58:59], v9 offset:16640
    ds_read_b64_tr_b16 a[60:61], v9 offset:20480
    ds_read_b64_tr_b16 a[62:63], v9 offset:20736
    s_waitcnt lgkmcnt(0)
    ds_read_b64_tr_b16 a[64:65], v9 offset:24576
    ds_read_b64_tr_b16 a[66:67], v9 offset:24832
    ds_read_b64_tr_b16 a[68:69], v9 offset:28672
    ds_read_b64_tr_b16 a[70:71], v9 offset:28928
    ds_read_b64_tr_b16 a[72:73], v9 offset:32768
    ds_read_b64_tr_b16 a[74:75], v9 offset:33024
    ds_read_b64_tr_b16 a[76:77], v9 offset:36864
    ds_read_b64_tr_b16 a[78:79], v9 offset:37120
    s_waitcnt lgkmcnt(0)
    s_barrier
    s_mul_i32 s71, s28, 983040
    s_lshl_b32 s72, s86, 7
    s_add_u32 s71, s71, s72
    s_add_u32 s71, s71, 491520
    s_mul_i32 s69, s30, 10240
    s_add_u32 s69, s69, s71
    s_lshl_b32 s70, s30, 10
    s_add_u32 m0, s70, 0
    s_nop 0
    buffer_load_dwordx4 v12, s[24:27], s69 offen lds
    s_add_u32 m0, m0, 4096
    s_add_u32 s69, s69, 40960
    buffer_load_dwordx4 v12, s[24:27], s69 offen lds
    s_add_u32 m0, m0, 4096
    s_add_u32 s69, s69, 40960
    buffer_load_dwordx4 v12, s[24:27], s69 offen lds
    s_add_u32 m0, m0, 4096
    s_add_u32 s69, s69, 40960
    buffer_load_dwordx4 v12, s[24:27], s69 offen lds
    s_add_u32 m0, m0, 4096
    s_add_u32 s69, s69, 40960
    buffer_load_dwordx4 v12, s[24:27], s69 offen lds
    s_add_u32 m0, m0, 4096
    s_add_u32 s69, s69, 40960
    buffer_load_dwordx4 v12, s[24:27], s69 offen lds
    s_add_u32 m0, m0, 4096
    s_add_u32 s69, s69, 40960
    buffer_load_dwordx4 v12, s[24:27], s69 offen lds
    s_add_u32 m0, m0, 4096
    s_add_u32 s69, s69, 40960
    buffer_load_dwordx4 v12, s[24:27], s69 offen lds
    s_add_u32 m0, m0, 4096
    s_add_u32 s69, s69, 40960
    buffer_load_dwordx4 v12, s[24:27], s69 offen lds
    s_add_u32 m0, m0, 4096
    s_add_u32 s69, s69, 40960
    buffer_load_dwordx4 v12, s[24:27], s69 offen lds
    s_add_u32 m0, m0, 4096
    s_add_u32 s69, s69, 40960
    buffer_load_dwordx4 v12, s[24:27], s69 offen lds
    s_add_u32 m0, m0, 4096
    s_add_u32 s69, s69, 40960
    buffer_load_dwordx4 v12, s[24:27], s69 offen lds
    s_waitcnt vmcnt(12)
    s_barrier
    v_add_u32 v9, 81920, v14
    ds_read_b64_tr_b16 a[160:161], v9 offset:0
    ds_read_b64_tr_b16 a[162:163], v9 offset:256
    ds_read_b64_tr_b16 a[164:165], v9 offset:4096
    ds_read_b64_tr_b16 a[166:167], v9 offset:4352
    ds_read_b64_tr_b16 a[168:169], v9 offset:8192
    ds_read_b64_tr_b16 a[170:171], v9 offset:8448
    ds_read_b64_tr_b16 a[172:173], v9 offset:12288
    ds_read_b64_tr_b16 a[174:175], v9 offset:12544
    ds_read_b64_tr_b16 a[176:177], v9 offset:16384
    ds_read_b64_tr_b16 a[178:179], v9 offset:16640
    ds_read_b64_tr_b16 a[180:181], v9 offset:20480
    ds_read_b64_tr_b16 a[182:183], v9 offset:20736
    s_waitcnt lgkmcnt(0)
    ds_read_b64_tr_b16 a[184:185], v9 offset:24576
    ds_read_b64_tr_b16 a[186:187], v9 offset:24832
    ds_read_b64_tr_b16 a[188:189], v9 offset:28672
    ds_read_b64_tr_b16 a[190:191], v9 offset:28928
    ds_read_b64_tr_b16 a[192:193], v9 offset:32768
    ds_read_b64_tr_b16 a[194:195], v9 offset:33024
    ds_read_b64_tr_b16 a[196:197], v9 offset:36864
    ds_read_b64_tr_b16 a[198:199], v9 offset:37120
    s_waitcnt lgkmcnt(0)
    v_add_u32 v9, 122880, v14
    ds_read_b64_tr_b16 a[200:201], v9 offset:0
    ds_read_b64_tr_b16 a[202:203], v9 offset:256
    ds_read_b64_tr_b16 a[204:205], v9 offset:4096
    ds_read_b64_tr_b16 a[206:207], v9 offset:4352
    s_waitcnt lgkmcnt(0)
    s_barrier
    s_waitcnt vmcnt(0)
    s_barrier
    v_add_u32 v9, 0, v14
    ds_read_b64_tr_b16 a[208:209], v9 offset:0
    ds_read_b64_tr_b16 a[210:211], v9 offset:256
    ds_read_b64_tr_b16 a[212:213], v9 offset:4096
    ds_read_b64_tr_b16 a[214:215], v9 offset:4352
    ds_read_b64_tr_b16 a[216:217], v9 offset:8192
    ds_read_b64_tr_b16 a[218:219], v9 offset:8448
    ds_read_b64_tr_b16 a[220:221], v9 offset:12288
    ds_read_b64_tr_b16 a[222:223], v9 offset:12544
    ds_read_b64_tr_b16 a[224:225], v9 offset:16384
    ds_read_b64_tr_b16 a[226:227], v9 offset:16640
    ds_read_b64_tr_b16 a[228:229], v9 offset:20480
    ds_read_b64_tr_b16 a[230:231], v9 offset:20736
    s_waitcnt lgkmcnt(0)
    ds_read_b64_tr_b16 a[232:233], v9 offset:24576
    ds_read_b64_tr_b16 a[234:235], v9 offset:24832
    ds_read_b64_tr_b16 a[236:237], v9 offset:28672
    ds_read_b64_tr_b16 a[238:239], v9 offset:28928
    ds_read_b64_tr_b16 a[240:241], v9 offset:32768
    ds_read_b64_tr_b16 a[242:243], v9 offset:33024
    ds_read_b64_tr_b16 a[244:245], v9 offset:36864
    ds_read_b64_tr_b16 a[246:247], v9 offset:37120
    s_waitcnt lgkmcnt(0)
    v_add_u32 v9, 40960, v14
    ds_read_b64_tr_b16 a[248:249], v9 offset:0
    ds_read_b64_tr_b16 a[250:251], v9 offset:256
    ds_read_b64_tr_b16 a[252:253], v9 offset:4096
    ds_read_b64_tr_b16 a[254:255], v9 offset:4352
    s_waitcnt lgkmcnt(0)
    s_barrier
    v_mov_b32 v2, 128
wa_113:
    buffer_load_dword v3, v2, s[64:67], 0 offen sc1
    s_waitcnt vmcnt(0)
    v_cmp_ne_u32 vcc, 0x100, v3
    s_cbranch_vccz wad_114
    s_sub_u32 s68, s68, 1
    s_cbranch_scc0 ok_115
    s_mov_b32 s69, 1
    s_branch FAIL
ok_115:
    s_sleep 4
    s_branch wa_113
wad_114:
    s_mov_b32 s12, s34
    s_mov_b32 s13, s35
    s_mov_b32 s14, 10240
    s_mov_b32 s15, 0x20000
    s_lshl_b32 s69, s30, 6
    v_add_u32 v16, s69, v0
    v_lshlrev_b32 v17, 1, v16
    s_mov_b32 s69, 0
    buffer_load_ushort v80, v17, s[12:15], s69 offen offset:0
    buffer_load_ushort v88, v17, s[12:15], s69 offen offset:512
    buffer_load_ushort v96, v17, s[12:15], s69 offen offset:1024
    s_mov_b32 s69, 1280
    buffer_load_ushort v81, v17, s[12:15], s69 offen offset:0
    buffer_load_ushort v89, v17, s[12:15], s69 offen offset:512
    buffer_load_ushort v97, v17, s[12:15], s69 offen offset:1024
    s_mov_b32 s69, 2560
    buffer_load_ushort v82, v17, s[12:15], s69 offen offset:0
    buffer_load_ushort v90, v17, s[12:15], s69 offen offset:512
    buffer_load_ushort v98, v17, s[12:15], s69 offen offset:1024
    s_mov_b32 s69, 3840
    buffer_load_ushort v83, v17, s[12:15], s69 offen offset:0
    buffer_load_ushort v91, v17, s[12:15], s69 offen offset:512
    buffer_load_ushort v99, v17, s[12:15], s69 offen offset:1024
    s_mov_b32 s69, 5120
    buffer_load_ushort v84, v17, s[12:15], s69 offen offset:0
    buffer_load_ushort v92, v17, s[12:15], s69 offen offset:512
    buffer_load_ushort v100, v17, s[12:15], s69 offen offset:1024
    s_mov_b32 s69, 6400
    buffer_load_ushort v85, v17, s[12:15], s69 offen offset:0
    buffer_load_ushort v93, v17, s[12:15], s69 offen offset:512
    buffer_load_ushort v101, v17, s[12:15], s69 offen offset:1024
    s_mov_b32 s69, 7680
    buffer_load_ushort v86, v17, s[12:15], s69 offen offset:0
    buffer_load_ushort v94, v17, s[12:15], s69 offen offset:512
    buffer_load_ushort v102, v17, s[12:15], s69 offen offset:1024
    s_mov_b32 s69, 8960
    buffer_load_ushort v87, v17, s[12:15], s69 offen offset:0
    buffer_load_ushort v95, v17, s[12:15], s69 offen offset:512
    buffer_load_ushort v103, v17, s[12:15], s69 offen offset:1024
    v_and_b32 v18, 0xeb, v16
    v_bfe_u32 v19, v16, 2, 1
    v_lshl_or_b32 v18, v19, 4, v18
    v_bfe_u32 v19, v16, 4, 1
    v_lshl_or_b32 v18, v19, 2, v18
    v_lshlrev_b32 v17, 4, v18
    v_and_b32 v30, 15, v0
    v_lshrrev_b32 v31, 4, v0
    v_and_b32 v32, 7, v0
    v_bfe_u32 v33, v0, 3, 1
    v_and_b32 v20, 1, v31
    v_lshrrev_b32 v21, 1, v31
    v_bfe_u32 v22, v0, 2, 2
    v_and_b32 v23, 1, v0
    v_bfe_u32 v24, v0, 1, 1
    v_lshlrev_b32 v38, 4, v32
    v_lshl_add_u32 v38, v31, 7, v38
    v_lshlrev_b32 v25, 4, v22
    v_lshl_add_u32 v25, v23, 3, v25
    v_lshl_add_u32 v75, v31, 6, v25
    v_lshl_add_u32 v1, v20, 6, v25
    v_lshl_add_u32 v1, v24, 7, v1
    v_lshl_add_u32 v1, v21, 9, v1
    v_lshlrev_b32 v26, 3, v20
    v_lshl_add_u32 v26, v21, 2, v26
    s_lshl_b32 s69, s30, 8
    v_lshl_add_u32 v2, v30, 4, v26
    v_add_u32 v2, s69, v2
    v_mov_b32 v43, 0x4444
    v_mov_b32 v34, 0xeeee
    v_cmp_eq_u32 vcc, 1, v33
    s_nop 1
    v_cndmask_b32 v43, v43, v34, vcc
    v_lshlrev_b32 v5, 4, v0
    v_lshl_add_u32 v15, v33, 9, v38
    s_mul_i32 s71, s74, 4608
    s_add_u32 s71, s71, 245760
    v_lshrrev_b32 v34, 1, v31
    v_lshl_add_u32 v34, v34, 1, v33
    s_mov_b32 s72, 1536
    v_mul_u32_u24 v35, s72, v34
    v_and_b32 v68, 1, v31
    v_lshlrev_b32 v68, 7, v68
    v_lshl_add_u32 v68, v32, 4, v68
    v_add_u32 v68, v68, v35
    v_add_u32 v68, s71, v68
    v_cmp_eq_u32 vcc, 3, v34
    v_mov_b32 v35, 0x80000000
    s_nop 0
    v_cndmask_b32 v68, v68, v35, vcc
    v_lshlrev_b32 v34, 4, v30
    v_lshl_add_u32 v34, v31, 8, v34
    v_add_u32 v34, 512, v34
    v_add_u32 v4, s71, v34
    s_mul_i32 s72, s75, 1536
    s_add_u32 s71, s71, s72
    s_cmp_eq_u32 s30, 0
    s_cbranch_scc1 cw0_116
    s_sub_u32 s72, s30, 1
    s_and_b32 s72, s72, 1
    s_lshl_b32 s72, s72, 7
    s_add_u32 s71, s71, s72
    s_add_u32 s71, s71, 512
    v_lshlrev_b32 v34, 4, v32
    v_lshl_add_u32 v34, v31, 8, v34
    v_add_u32 v3, s71, v34
    s_mov_b32 s62, 0x00ff00ff
    s_mov_b32 s63, 0x00ff00ff
    s_branch cw1_117
cw0_116:
    v_add_u32 v3, s71, v38
    s_mov_b32 s62, 0x00ff00ff
    s_mov_b32 s63, 0
cw1_117:
    s_cmp_lg_u32 s30, 3
    s_cbranch_scc1 nw3_118
    v_mov_b32 v3, 0x80000000
nw3_118:
    v_mov_b32 v60, -1
    v_mov_b32 v61, -1
    v_mov_b32 v62, -1
    v_mov_b32 v63, -1
    s_lshl_b32 s69, s75, 2
    s_add_u32 s69, s69, s30
    s_lshl_b32 s69, s69, 8
    v_lshlrev_b32 v34, 7, v20
    v_lshl_add_u32 v34, v30, 3, v34
    v_lshl_add_u32 v34, v21, 2, v34
    v_add_u32 v6, s69, v34
    s_mul_i32 s71, s28, 12288
    s_add_u32 s71, s71, 393216
    s_mul_i32 s69, s30, 3072
    v_add_u32 v7, s69, v5
    v_add_u32 v69, s71, v7
    s_lshl_b32 s69, s29, 10
    s_lshl_b32 s70, s30, 7
    s_add_u32 s69, s69, s70
    s_add_u32 s69, s69, s71
    v_lshlrev_b32 v34, 4, v32
    v_lshl_add_u32 v34, v21, 9, v34
    v_lshl_add_u32 v34, v20, 3, v34
    v_add_u32 v67, s69, v34
    s_lshl_b32 s69, s86, 2
    s_add_u32 s69, s69, s30
    s_lshl_b32 s69, s69, 12
    v_and_b32 v36, 31, v0
    v_lshlrev_b32 v36, 4, v36
    v_lshrrev_b32 v37, 5, v0
    v_lshl_add_u32 v34, v37, 11, v36
    v_add_u32 v8, s69, v34
    v_mov_b32 v35, 0x80000000
    v_lshl_add_u32 v34, v37, 2, 1
    v_cmp_eq_u32 vcc, s28, v34
    v_add_u32 v34, 512, v8
    s_nop 0
    v_cndmask_b32 v40, v34, v35, vcc
    v_lshl_add_u32 v34, v37, 2, 2
    v_cmp_eq_u32 vcc, s28, v34
    v_add_u32 v34, 1024, v8
    s_nop 0
    v_cndmask_b32 v41, v34, v35, vcc
    v_lshl_add_u32 v34, v37, 2, 3
    v_cmp_eq_u32 vcc, s28, v34
    v_add_u32 v34, 1536, v8
    s_nop 0
    v_cndmask_b32 v42, v34, v35, vcc
    v_lshl_add_u32 v34, v37, 2, 0
    v_cmp_eq_u32 vcc, s28, v34
    v_add_u32 v34, 0, v8
    s_nop 0
    v_cndmask_b32 v8, v34, v35, vcc
    s_lshl_b32 s70, s28, 9
    s_add_u32 s69, s69, s70
    v_lshl_add_u32 v34, v37, 3, v36
    v_add_u32 v11, s69, v34
    s_lshr_b32 s71, s30, 1
    s_lshl_b32 s71, s71, 1
    s_lshl_b32 s72, s86, 2
    s_add_u32 s71, s71, s72
    s_lshl_b32 s71, s71, 12
    s_lshl_b32 s72, s28, 9
    s_add_u32 s71, s71, s72
    s_add_u32 s71, s71, 0
    v_lshl_add_u32 v34, v37, 12, v36
    v_add_u32 v76, s71, v34
    s_mul_i32 s71, s28, 10240
    s_add_u32 s71, s71, 163840
    s_lshl_b32 s69, s86, 10
    s_add_u32 s69, s69, s71
    s_lshr_b32 s70, s30, 1
    s_lshl_b32 s70, s70, 9
    s_add_u32 s69, s69, s70
    s_and_b32 s70, s30, 1
    s_lshl_b32 s70, s70, 6
    s_add_u32 s69, s69, s70
    v_and_b32 v34, 3, v0
    v_lshl_add_u32 v34, v34, 4, v26
    v_lshl_add_u32 v34, v33, 7, v34
    v_bfe_u32 v35, v0, 2, 1
    v_lshl_add_u32 v34, v35, 8, v34
    v_add_u32 v12, s69, v34
    s_mul_i32 s69, s30, 2560
    v_add_u32 v9, s69, v5
    v_and_b32 v34, 31, v0
    v_lshlrev_b32 v34, 4, v34
    s_add_u32 s69, s69, 2048
    v_add_u32 v10, s69, v34
    v_add_u32 v70, s71, v9
    v_add_u32 v71, s71, v10
    s_mul_i32 s71, s74, 4608
    s_mul_i32 s72, s75, 1536
    s_add_u32 s71, s71, s72
    s_add_u32 s71, s71, 245760
    s_cmp_eq_u32 s30, 1
    s_cbranch_scc1 rw1_119
    s_add_u32 s71, s71, 512
    v_add_u32 v74, s71, v5
    s_mul_i32 s71, s28, 12288
    s_lshl_b32 s72, s29, 10
    s_add_u32 s71, s71, s72
    s_add_u32 s71, s71, 393216
    v_add_u32 v64, s71, v5
    s_branch rwd_120
rw1_119:
    v_add_u32 v74, s71, v5
    v_mov_b32 v34, 0x80000000
    v_cmp_le_u32 vcc, 16, v0
    s_nop 1
    v_cndmask_b32 v74, v74, v34, vcc
    s_mul_i32 s71, s28, 10240
    s_lshl_b32 s72, s86, 10
    s_add_u32 s71, s71, s72
    s_add_u32 s71, s71, 163840
    v_add_u32 v64, s71, v5
    s_cmp_lt_u32 s29, 10
    s_cbranch_scc1 rwd_120
    v_mov_b32 v64, 0x80000000
rwd_120:
    s_cmp_lt_u32 s29, 10
    s_cbranch_scc1 nooob_121
    v_mov_b32 v11, 0x80000000
    v_mov_b32 v12, 0x80000000
nooob_121:
    s_lshl_b32 s69, s74, 7
    s_add_u32 s69, s69, 2097152
    v_lshlrev_b32 v34, 2, v32
    v_add_u32 v13, s69, v34
    s_lshl_b32 s70, s75, 2
    s_add_u32 s70, s70, s30
    s_lshl_b32 s70, s70, 2
    s_add_u32 s69, s69, s70
    s_add_u32 s69, s69, 32
    v_mov_b32 v65, s69
    s_mul_i32 s78, s74, 786432
    s_add_u32 s78, s78, 4194304
    s_sub_u32 s69, s30, 1
    s_and_b32 s69, s69, 1
    s_mul_i32 s69, s69, 6144
    s_lshl_b32 s70, s75, 11
    s_add_u32 s69, s69, s70
    s_add_u32 s78, s78, s69
    s_mul_i32 s79, s74, 786432
    s_add_u32 s79, s79, 29360128
    s_lshl_b32 s69, s75, 2
    s_add_u32 s69, s69, s30
    s_lshl_b32 s69, s69, 10
    s_add_u32 s79, s79, s69
    s_mul_i32 s80, s74, 196608
    s_add_u32 s80, s80, 79691776
    s_lshl_b32 s69, s75, 10
    s_add_u32 s80, s80, s69
    s_mul_i32 s81, s74, 196608
    s_add_u32 s81, s81, 85983232
    s_mov_b32 s82, 0x00ff00ff
    s_mov_b32 s83, 0x00ff00ff
    s_mov_b32 s84, 0x3dd53b95
    s_mov_b32 s31, 0
    s_mov_b32 s76, 0
    s_mov_b32 s77, 1048576
    s_waitcnt vmcnt(0)
    v_lshl_or_b32 v104, v81, 16, v80
    v_lshl_or_b32 v105, v83, 16, v82
    v_lshl_or_b32 v106, v85, 16, v84
    v_lshl_or_b32 v107, v87, 16, v86
    ds_write_b128 v17, v[104:107] offset:0
    v_lshl_or_b32 v108, v89, 16, v88
    v_lshl_or_b32 v109, v91, 16, v90
    v_lshl_or_b32 v110, v93, 16, v92
    v_lshl_or_b32 v111, v95, 16, v94
    ds_write_b128 v17, v[108:111] offset:4096
    s_cmp_ge_u32 s30, 2
    s_cbranch_scc1 nw2_122
    v_lshl_or_b32 v112, v97, 16, v96
    v_lshl_or_b32 v113, v99, 16, v98
    v_lshl_or_b32 v114, v101, 16, v100
    v_lshl_or_b32 v115, v103, 16, v102
    ds_write_b128 v17, v[112:115] offset:8192
nw2_122:
    s_mov_b32 s85, 1
pf_123:
    buffer_load_dword v72, v13, s[4:7], 0 offen sc1
    s_waitcnt vmcnt(0)
    v_cmp_gt_u32 vcc, s85, v72
    s_cbranch_vccz pfd_124
    s_sub_u32 s68, s68, 1
    s_cbranch_scc0 ok_125
    s_mov_b32 s69, 20
    s_branch FAIL
ok_125:
    s_sleep 1
    s_branch pf_123
pfd_124:
    s_sub_u32 s69, s30, 1
    s_cmp_ge_u32 s69, 2
    s_cbranch_scc1 nk_126
    buffer_load_dwordx4 v[44:47], v5, s[4:7], s78 offen sc1
    buffer_load_dwordx4 v[48:51], v5, s[4:7], s78 offen offset:1024 sc1
nk_126:
    buffer_load_dwordx4 v[52:55], v5, s[4:7], s79 offen sc1
    buffer_load_dword v72, v13, s[4:7], 0 offen sc1
    s_add_u32 s78, s78, 12288
    s_add_u32 s79, s79, 12288
    v_mov_b32 v16, 0
    v_mov_b32 v17, 0
    v_mov_b32 v18, 0
    v_mov_b32 v19, 0
    v_mov_b32 v20, 0
    v_mov_b32 v21, 0
    v_mov_b32 v22, 0
    v_mov_b32 v23, 0
    v_mov_b32 v24, 0
    v_mov_b32 v25, 0
    v_mov_b32 v26, 0
    v_mov_b32 v27, 0
    v_mov_b32 v32, 0
    v_mov_b32 v33, 0
    v_mov_b32 v34, 0
    v_mov_b32 v35, 0
    v_mov_b32 v36, 0
    v_mov_b32 v37, 0
    v_mov_b32 v38, 0
    v_mov_b32 v39, 0
    s_waitcnt vmcnt(0) lgkmcnt(0)
cloop_127:
    s_barrier
    ds_read_b64_tr_b16 v[80:81], v1 offset:0
    ds_read_b64_tr_b16 v[82:83], v1 offset:256
    ds_read_b64_tr_b16 v[84:85], v1 offset:1024
    ds_read_b64_tr_b16 v[86:87], v1 offset:1280
    ds_read_b64_tr_b16 v[88:89], v1 offset:2048
    ds_read_b64_tr_b16 v[90:91], v1 offset:2304
    ds_read_b64_tr_b16 v[92:93], v1 offset:3072
    ds_read_b64_tr_b16 v[94:95], v1 offset:3328
    ds_read_b64_tr_b16 v[96:97], v1 offset:4096
    ds_read_b64_tr_b16 v[98:99], v1 offset:4352
    ds_read_b64_tr_b16 v[100:101], v1 offset:5120
    ds_read_b64_tr_b16 v[102:103], v1 offset:5376
    s_waitcnt lgkmcnt(10)
    v_smfmac_f32_16x16x64_bf16 v[16:19], v[80:83], a[0:7], v43
    v_smfmac_f32_16x16x64_bf16 v[20:23], v[80:83], a[80:87], v43
    ds_read_b64_tr_b16 v[104:105], v1 offset:6144
    ds_read_b64_tr_b16 v[106:107], v1 offset:6400
    s_waitcnt lgkmcnt(10)
    v_smfmac_f32_16x16x64_bf16 v[16:19], v[84:87], a[8:15], v43
    v_smfmac_f32_16x16x64_bf16 v[20:23], v[84:87], a[88:95], v43
    ds_read_b64_tr_b16 v[108:109], v1 offset:7168
    ds_read_b64_tr_b16 v[110:111], v1 offset:7424
    s_waitcnt lgkmcnt(10)
    v_smfmac_f32_16x16x64_bf16 v[16:19], v[88:91], a[16:23], v43
    v_smfmac_f32_16x16x64_bf16 v[20:23], v[88:91], a[96:103], v43
    ds_read_b64_tr_b16 v[112:113], v1 offset:8192
    ds_read_b64_tr_b16 v[114:115], v1 offset:8448
    s_waitcnt lgkmcnt(10)
    v_smfmac_f32_16x16x64_bf16 v[16:19], v[92:95], a[24:31], v43
    v_smfmac_f32_16x16x64_bf16 v[20:23], v[92:95], a[104:111], v43
    ds_read_b64_tr_b16 v[116:117], v1 offset:9216
    ds_read_b64_tr_b16 v[118:119], v1 offset:9472
    s_waitcnt lgkmcnt(10)
    v_smfmac_f32_16x16x64_bf16 v[16:19], v[96:99], a[32:39], v43
    v_smfmac_f32_16x16x64_bf16 v[20:23], v[96:99], a[112:119], v43
    s_cmp_ge_u32 s30, 2
    s_cbranch_scc1 rj_128
    buffer_store_dwordx4 v[60:63], v64, s[4:7], s77 offen sc1
    buffer_store_dwordx4 v[60:63], v74, s[4:7], s77 offen sc1
rj_128:
    s_waitcnt lgkmcnt(8)
    v_smfmac_f32_16x16x64_bf16 v[16:19], v[100:103], a[40:47], v43
    v_smfmac_f32_16x16x64_bf16 v[20:23], v[100:103], a[120:127], v43
    s_waitcnt lgkmcnt(6)
    v_smfmac_f32_16x16x64_bf16 v[16:19], v[104:107], a[48:55], v43
    v_smfmac_f32_16x16x64_bf16 v[20:23], v[104:107], a[128:135], v43
    s_waitcnt lgkmcnt(4)
    v_smfmac_f32_16x16x64_bf16 v[16:19], v[108:111], a[56:63], v43
    v_smfmac_f32_16x16x64_bf16 v[20:23], v[108:111], a[136:143], v43
    s_waitcnt lgkmcnt(2)
    v_smfmac_f32_16x16x64_bf16 v[16:19], v[112:115], a[64:71], v43
    v_smfmac_f32_16x16x64_bf16 v[20:23], v[112:115], a[144:151], v43
    s_waitcnt lgkmcnt(0)
    v_smfmac_f32_16x16x64_bf16 v[16:19], v[116:119], a[72:79], v43
    v_smfmac_f32_16x16x64_bf16 v[20:23], v[116:119], a[152:159], v43
    s_nop 10
    v_permlane32_swap_b32 v16, v18
    v_permlane32_swap_b32 v17, v19
    v_add_f32 v16, v16, v18
    v_add_f32 v17, v17, v19
    v_permlane32_swap_b32 v20, v22
    v_permlane32_swap_b32 v21, v23
    v_add_f32 v20, v20, v22
    v_add_f32 v21, v21, v23
    v_cvt_pk_bf16_f32 v28, v16, v17
    v_cvt_pk_bf16_f32 v30, v20, v21
    ds_write_b32 v2, v28 offset:10240
    ds_write_b32 v2, v30 offset:11264
    s_waitcnt lgkmcnt(0)
    s_barrier
    s_cmp_eq_u32 s30, 3
    s_cbranch_scc1 nosc_129
    ds_read_b64_tr_b16 v[160:161], v75 offset:10240
    ds_read_b64_tr_b16 v[162:163], v75 offset:10496
    ds_read_b64_tr_b16 v[164:165], v75 offset:10752
    ds_read_b64_tr_b16 v[166:167], v75 offset:11008
    s_cmp_lg_u32 s30, 0
    s_cbranch_scc1 tok_130
    ds_read_b64_tr_b16 v[44:45], v75 offset:11264
    ds_read_b64_tr_b16 v[46:47], v75 offset:11520
    ds_read_b64_tr_b16 v[48:49], v75 offset:11776
    ds_read_b64_tr_b16 v[50:51], v75 offset:12032
tok_130:
    buffer_store_dword v30, v2, s[4:7], s80 offen sc1
    v_smfmac_f32_16x16x64_bf16 v[24:27], v[80:83], v[176:183], v43
    v_smfmac_f32_16x16x64_bf16 v[24:27], v[84:87], v[184:191], v43
    v_smfmac_f32_16x16x64_bf16 v[24:27], v[88:91], v[192:199], v43
    s_waitcnt lgkmcnt(0)
    v_mfma_f32_16x16x32_bf16 v[56:59], v[44:47], v[160:163], 0
    v_mfma_f32_16x16x32_bf16 v[56:59], v[48:51], v[164:167], v[56:59]
    v_smfmac_f32_16x16x64_bf16 v[24:27], v[92:95], v[200:207], v43
    v_smfmac_f32_16x16x64_bf16 v[24:27], v[96:99], v[208:215], v43
    s_nop 5
    v_min_u32 v56, -2, v56
    s_mov_b64 exec, s[62:63]
    buffer_store_dwordx4 v[56:59], v3, s[4:7], s76 offen sc1
    s_mov_b64 exec, -1
    s_branch v2_131
nosc_129:
    buffer_store_dword v30, v2, s[4:7], s80 offen sc1
    v_smfmac_f32_16x16x64_bf16 v[24:27], v[80:83], v[176:183], v43
    v_smfmac_f32_16x16x64_bf16 v[24:27], v[84:87], v[184:191], v43
    v_smfmac_f32_16x16x64_bf16 v[24:27], v[88:91], v[192:199], v43
    v_smfmac_f32_16x16x64_bf16 v[24:27], v[92:95], v[200:207], v43
    v_smfmac_f32_16x16x64_bf16 v[24:27], v[96:99], v[208:215], v43
v2_131:
    v_smfmac_f32_16x16x64_bf16 v[24:27], v[100:103], v[216:223], v43
    v_smfmac_f32_16x16x64_bf16 v[24:27], v[104:107], v[224:231], v43
    v_smfmac_f32_16x16x64_bf16 v[24:27], v[108:111], v[232:239], v43
    v_smfmac_f32_16x16x64_bf16 v[24:27], v[112:115], v[240:247], v43
    v_smfmac_f32_16x16x64_bf16 v[24:27], v[116:119], v[248:255], v43
    s_nop 11
    v_permlane32_swap_b32 v24, v26
    v_permlane32_swap_b32 v25, v27
    v_add_f32 v24, v24, v26
    v_add_f32 v25, v25, v27
    v_cvt_pk_bf16_f32 v32, v24, v25
    s_waitcnt vmcnt(0)
    buffer_load_dwordx4 v[120:123], v4, s[4:7], s76 offen offset:0 sc1
    buffer_load_dwordx4 v[124:127], v4, s[4:7], s76 offen offset:1536 sc1
    buffer_load_dwordx4 v[128:131], v4, s[4:7], s76 offen offset:3072 sc1
    buffer_load_dwordx4 v[132:135], v68, s[4:7], s76 offen sc1
pl_132:
    s_waitcnt vmcnt(0)
    v_max3_u32 v73, v120, v124, v128
    v_max_u32 v73, v73, v132
    v_cmp_eq_u32 vcc, -1, v73
    s_cbranch_vccz pd_133
    v_cmp_eq_u32 vcc, -1, v120
    s_cbranch_vccz ps_134
    buffer_load_dwordx4 v[120:123], v4, s[4:7], s76 offen offset:0 sc1
ps_134:
    v_cmp_eq_u32 vcc, -1, v124
    s_cbranch_vccz ps_135
    buffer_load_dwordx4 v[124:127], v4, s[4:7], s76 offen offset:1536 sc1
ps_135:
    v_cmp_eq_u32 vcc, -1, v128
    s_cbranch_vccz ps_136
    buffer_load_dwordx4 v[128:131], v4, s[4:7], s76 offen offset:3072 sc1
ps_136:
    v_cmp_eq_u32 vcc, -1, v132
    s_cbranch_vccz ps_137
    buffer_load_dwordx4 v[132:135], v68, s[4:7], s76 offen sc1
ps_137:
    s_sub_u32 s68, s68, 1
    s_cbranch_scc0 ok_138
    s_mov_b32 s69, 21
    s_branch FAIL
ok_138:
    s_branch pl_132
pd_133:
    v_pk_add_f32 v[16:17], v[120:121], v[124:125]
    v_pk_add_f32 v[18:19], v[122:123], v[126:127]
    v_permlane32_swap_b32 v132, v134
    v_permlane32_swap_b32 v133, v135
    v_pk_add_f32 v[16:17], v[16:17], v[128:129]
    v_pk_add_f32 v[18:19], v[18:19], v[130:131]
    v_add_f32 v20, v132, v134
    v_add_f32 v21, v133, v135
    v_max3_f32 v24, v16, v17, v18
    v_add_f32_dpp v20, v20, v20 row_ror:8 row_mask:0xf bank_mask:0xf
    v_add_f32_dpp v21, v21, v21 row_ror:8 row_mask:0xf bank_mask:0xf
    v_max_f32 v24, v24, v19
    v_max3_f32 v24, v24, v20, v21
    s_nop 1
    v_max_f32_dpp v24, v24, v24 row_ror:8 row_mask:0xf bank_mask:0xf
    v_mov_b32 v25, v24
    s_nop 1
    v_permlane32_swap_b32 v24, v25
    v_max_f32 v24, v24, v25
    v_mov_b32 v25, v24
    s_nop 1
    v_permlane16_swap_b32 v24, v25
    v_max_f32 v24, v24, v25
    v_mul_f32 v24, s84, v24
    v_fma_f32 v16, v16, s84, -v24
    v_fma_f32 v17, v17, s84, -v24
    v_fma_f32 v18, v18, s84, -v24
    v_fma_f32 v19, v19, s84, -v24
    v_fma_f32 v20, v20, s84, -v24
    v_fma_f32 v21, v21, s84, -v24
    v_exp_f32 v16, v16
    v_exp_f32 v17, v17
    v_exp_f32 v18, v18
    v_exp_f32 v19, v19
    v_exp_f32 v20, v20
    v_exp_f32 v21, v21
    v_cvt_pk_bf16_f32 v28, v16, v17
    v_cvt_pk_bf16_f32 v29, v18, v19
    v_cvt_pk_bf16_f32 v36, v20, v21
    v_mov_b32_dpp v30, v28 row_ror:8 row_mask:0xf bank_mask:0xf
    v_mov_b32_dpp v31, v29 row_ror:8 row_mask:0xf bank_mask:0xf
    v_mfma_f32_16x16x32_bf16 v[56:59], v[32:35], v[36:39], 0
    s_nop 0
    v_mfma_f32_16x16x32_bf16 v[56:59], v[52:55], v[28:31], v[56:59]
    s_add_u32 s80, s80, 3072
    s_add_u32 s85, s31, 1
    v_add_f32 v24, v16, v17
    v_add_f32 v25, v18, v19
    v_add_f32 v26, v20, v21
    v_add_f32 v24, v24, v25
    v_fma_f32 v24, v26, 0.5, v24
    s_nop 1
    v_add_f32_dpp v24, v24, v24 row_ror:8 row_mask:0xf bank_mask:0xf
    v_mov_b32 v25, v24
    s_nop 1
    v_permlane32_swap_b32 v24, v25
    v_add_f32 v24, v24, v25
    v_mov_b32 v25, v24
    s_nop 1
    v_permlane16_swap_b32 v24, v25
    v_add_f32 v24, v24, v25
    v_rcp_f32 v24, v24
    s_nop 0
    v_mul_f32 v56, v56, v24
    v_mul_f32 v57, v57, v24
    v_mul_f32 v58, v58, v24
    v_mul_f32 v59, v59, v24
    v_cvt_pk_bf16_f32 v28, v56, v57
    v_cvt_pk_bf16_f32 v29, v58, v59
    v_min_u32 v28, -2, v28
    s_mov_b64 exec, s[82:83]
    buffer_store_dwordx2 v[28:29], v67, s[4:7], s76 offen sc1
    s_mov_b64 exec, -1
    buffer_store_dword v32, v6, s[4:7], s81 offen sc1
    s_add_u32 s81, s81, 3072
    v_mov_b32 v56, 0
    v_mov_b32 v57, 0
    v_mov_b32 v58, 0
    v_mov_b32 v59, 0
    s_cmp_ge_u32 s29, 10
    s_cbranch_scc1 nowo_139
    s_barrier
    buffer_load_dwordx4 v[128:131], v69, s[4:7], s76 offen offset:0 sc1
    buffer_load_dwordx4 v[132:135], v69, s[4:7], s76 offen offset:1024 sc1
    buffer_load_dwordx4 v[136:139], v69, s[4:7], s76 offen offset:2048 sc1
pl_141:
    s_waitcnt vmcnt(0)
    v_max3_u32 v73, v128, v130, v132
    v_max3_u32 v73, v73, v134, v136
    v_max_u32 v73, v73, v138
    v_cmp_eq_u32 vcc, -1, v73
    s_cbranch_vccz pd_142
    v_max_u32 v73, v128, v130
    v_cmp_eq_u32 vcc, -1, v73
    s_cbranch_vccz ps_143
    buffer_load_dwordx4 v[128:131], v69, s[4:7], s76 offen offset:0 sc1
ps_143:
    v_max_u32 v73, v132, v134
    v_cmp_eq_u32 vcc, -1, v73
    s_cbranch_vccz ps_144
    buffer_load_dwordx4 v[132:135], v69, s[4:7], s76 offen offset:1024 sc1
ps_144:
    v_max_u32 v73, v136, v138
    v_cmp_eq_u32 vcc, -1, v73
    s_cbranch_vccz ps_145
    buffer_load_dwordx4 v[136:139], v69, s[4:7], s76 offen offset:2048 sc1
ps_145:
    s_sub_u32 s68, s68, 1
    s_cbranch_scc0 ok_146
    s_mov_b32 s69, 22
    s_branch FAIL
ok_146:
    s_branch pl_141
pd_142:
    ds_write_b128 v7, v[128:131] offset:12288
    ds_write_b128 v7, v[132:135] offset:13312
    ds_write_b128 v7, v[136:139] offset:14336
    v_mov_b32 v66, s85
    s_mov_b64 exec, 1
    buffer_store_dword v66, v65, s[4:7], 0 offen sc1
    s_mov_b64 exec, -1
    s_waitcnt lgkmcnt(0)
    s_barrier
    ds_read_b128 v[80:83], v15 offset:12288
    ds_read_b128 v[84:87], v15 offset:13312
    ds_read_b128 v[88:91], v15 offset:14336
    ds_read_b128 v[92:95], v15 offset:15360
    ds_read_b128 v[96:99], v15 offset:16384
    ds_read_b128 v[100:103], v15 offset:17408
    ds_read_b128 v[104:107], v15 offset:18432
    ds_read_b128 v[108:111], v15 offset:19456
    ds_read_b128 v[112:115], v15 offset:20480
    ds_read_b128 v[116:119], v15 offset:21504
    ds_read_b128 v[120:123], v15 offset:22528
    ds_read_b128 v[124:127], v15 offset:23552
    s_waitcnt lgkmcnt(11)
    v_smfmac_f32_16x16x64_bf16 v[56:59], v[80:83], a[160:167], v43
    s_add_u32 s85, s31, 2
    v_cmp_gt_u32 vcc, s85, v72
    s_cbranch_vccz rdy_147
pf_148:
    buffer_load_dword v72, v13, s[4:7], 0 offen sc1
    s_waitcnt vmcnt(0)
    v_cmp_gt_u32 vcc, s85, v72
    s_cbranch_vccz pfd_149
    s_sub_u32 s68, s68, 1
    s_cbranch_scc0 ok_150
    s_mov_b32 s69, 23
    s_branch FAIL
ok_150:
    s_sleep 1
    s_branch pf_148
pfd_149:
rdy_147:
    s_sub_u32 s69, s30, 1
    s_cmp_lt_u32 s69, 2
    s_cbranch_scc1 nr_151
    buffer_store_dwordx4 v[60:63], v76, s[4:7], s77 offen sc1
nr_151:
    s_sub_u32 s69, s30, 1
    s_cmp_ge_u32 s69, 2
    s_cbranch_scc1 nk_152
    buffer_load_dwordx4 v[44:47], v5, s[4:7], s78 offen sc1
    buffer_load_dwordx4 v[48:51], v5, s[4:7], s78 offen offset:1024 sc1
nk_152:
    s_waitcnt lgkmcnt(10)
    v_smfmac_f32_16x16x64_bf16 v[56:59], v[84:87], a[168:175], v43
    s_waitcnt lgkmcnt(9)
    v_smfmac_f32_16x16x64_bf16 v[56:59], v[88:91], a[176:183], v43
    s_waitcnt lgkmcnt(8)
    v_smfmac_f32_16x16x64_bf16 v[56:59], v[92:95], a[184:191], v43
    buffer_load_dwordx4 v[52:55], v5, s[4:7], s79 offen sc1
    buffer_load_dword v72, v13, s[4:7], 0 offen sc1
    s_add_u32 s78, s78, 12288
    s_add_u32 s79, s79, 12288
    s_waitcnt lgkmcnt(7)
    v_smfmac_f32_16x16x64_bf16 v[56:59], v[96:99], a[192:199], v43
    s_waitcnt lgkmcnt(6)
    v_smfmac_f32_16x16x64_bf16 v[56:59], v[100:103], a[200:207], v43
    s_waitcnt lgkmcnt(5)
    v_smfmac_f32_16x16x64_bf16 v[56:59], v[104:107], a[208:215], v43
    s_waitcnt lgkmcnt(4)
    v_smfmac_f32_16x16x64_bf16 v[56:59], v[108:111], a[216:223], v43
    s_waitcnt lgkmcnt(3)
    v_smfmac_f32_16x16x64_bf16 v[56:59], v[112:115], a[224:231], v43
    s_waitcnt lgkmcnt(2)
    v_smfmac_f32_16x16x64_bf16 v[56:59], v[116:119], a[232:239], v43
    s_waitcnt lgkmcnt(1)
    v_smfmac_f32_16x16x64_bf16 v[56:59], v[120:123], a[240:247], v43
    s_waitcnt lgkmcnt(0)
    v_smfmac_f32_16x16x64_bf16 v[56:59], v[124:127], a[248:255], v43
    s_nop 11
    v_permlane32_swap_b32 v56, v58
    v_permlane32_swap_b32 v57, v59
    v_add_f32 v24, v56, v58
    v_add_f32 v25, v57, v59
    v_min_u32 v24, -2, v24
    buffer_store_dwordx2 v[24:25], v11, s[4:7], s76 offen sc1
    s_waitcnt vmcnt(0)
    buffer_load_dwordx4 v[80:83], v8, s[4:7], s76 offen sc1
    buffer_load_dwordx4 v[84:87], v40, s[4:7], s76 offen sc1
    buffer_load_dwordx4 v[88:91], v41, s[4:7], s76 offen sc1
    buffer_load_dwordx4 v[92:95], v42, s[4:7], s76 offen sc1
pl_154:
    s_waitcnt vmcnt(0)
    v_max3_u32 v73, v80, v82, v84
    v_max3_u32 v73, v73, v86, v88
    v_max3_u32 v73, v73, v90, v92
    v_max_u32 v73, v73, v94
    v_cmp_eq_u32 vcc, -1, v73
    s_cbranch_vccz pd_155
    v_max_u32 v73, v80, v82
    v_cmp_eq_u32 vcc, -1, v73
    s_cbranch_vccz ps_156
    buffer_load_dwordx4 v[80:83], v8, s[4:7], s76 offen sc1
ps_156:
    v_max_u32 v73, v84, v86
    v_cmp_eq_u32 vcc, -1, v73
    s_cbranch_vccz ps_157
    buffer_load_dwordx4 v[84:87], v40, s[4:7], s76 offen sc1
ps_157:
    v_max_u32 v73, v88, v90
    v_cmp_eq_u32 vcc, -1, v73
    s_cbranch_vccz ps_158
    buffer_load_dwordx4 v[88:91], v41, s[4:7], s76 offen sc1
ps_158:
    v_max_u32 v73, v92, v94
    v_cmp_eq_u32 vcc, -1, v73
    s_cbranch_vccz ps_159
    buffer_load_dwordx4 v[92:95], v42, s[4:7], s76 offen sc1
ps_159:
    s_sub_u32 s68, s68, 1
    s_cbranch_scc0 ok_160
    s_mov_b32 s69, 24
    s_branch FAIL
ok_160:
    s_branch pl_154
pd_155:
    v_pk_add_f32 v[16:17], v[80:81], v[84:85]
    v_pk_add_f32 v[18:19], v[82:83], v[86:87]
    v_pk_add_f32 v[20:21], v[88:89], v[92:93]
    v_pk_add_f32 v[22:23], v[90:91], v[94:95]
sumd_153:
    v_pk_add_f32 v[16:17], v[16:17], v[20:21]
    v_pk_add_f32 v[18:19], v[18:19], v[22:23]
    s_nop 1
    v_permlane32_swap_b32 v16, v18
    v_permlane32_swap_b32 v17, v19
    v_pk_add_f32 v[16:17], v[16:17], v[24:25]
    v_pk_add_f32 v[16:17], v[16:17], v[18:19]
    v_cvt_pk_bf16_f32 v28, v16, v17
    v_min_u32 v28, -2, v28
    buffer_store_dword v28, v12, s[4:7], s76 offen sc1
    v_mov_b32 v16, 0
    v_mov_b32 v17, 0
    v_mov_b32 v18, 0
    v_mov_b32 v19, 0
    v_mov_b32 v20, 0
    v_mov_b32 v21, 0
    v_mov_b32 v22, 0
    v_mov_b32 v23, 0
    v_mov_b32 v24, 0
    v_mov_b32 v25, 0
    v_mov_b32 v26, 0
    v_mov_b32 v27, 0
    s_barrier
    s_branch h2_140
nowo_139:
    s_waitcnt vmcnt(0)
    v_mov_b32 v66, s85
    s_mov_b64 exec, 1
    buffer_store_dword v66, v65, s[4:7], 0 offen sc1
    s_mov_b64 exec, -1
    s_add_u32 s85, s31, 2
    v_cmp_gt_u32 vcc, s85, v72
    s_cbranch_vccz rdy_161
pf_162:
    buffer_load_dword v72, v13, s[4:7], 0 offen sc1
    s_waitcnt vmcnt(0)
    v_cmp_gt_u32 vcc, s85, v72
    s_cbranch_vccz pfd_163
    s_sub_u32 s68, s68, 1
    s_cbranch_scc0 ok_164
    s_mov_b32 s69, 26
    s_branch FAIL
ok_164:
    s_sleep 1
    s_branch pf_162
pfd_163:
rdy_161:
    s_sub_u32 s69, s30, 1
    s_cmp_ge_u32 s69, 2
    s_cbranch_scc1 nk_165
    buffer_load_dwordx4 v[44:47], v5, s[4:7], s78 offen sc1
    buffer_load_dwordx4 v[48:51], v5, s[4:7], s78 offen offset:1024 sc1
nk_165:
    buffer_load_dwordx4 v[52:55], v5, s[4:7], s79 offen sc1
    buffer_load_dword v72, v13, s[4:7], 0 offen sc1
    s_add_u32 s78, s78, 12288
    s_add_u32 s79, s79, 12288
    v_mov_b32 v16, 0
    v_mov_b32 v17, 0
    v_mov_b32 v18, 0
    v_mov_b32 v19, 0
    v_mov_b32 v20, 0
    v_mov_b32 v21, 0
    v_mov_b32 v22, 0
    v_mov_b32 v23, 0
    v_mov_b32 v24, 0
    v_mov_b32 v25, 0
    v_mov_b32 v26, 0
    v_mov_b32 v27, 0
h2_140:
    buffer_load_dwordx4 v[160:163], v70, s[4:7], s76 offen offset:0 sc1
    buffer_load_dwordx4 v[164:167], v70, s[4:7], s76 offen offset:1024 sc1
    buffer_load_dwordx4 v[168:171], v71, s[4:7], s76 offen sc1
pl_166:
    s_waitcnt vmcnt(0)
    v_max3_u32 v73, v160, v161, v162
    v_max3_u32 v73, v73, v163, v164
    v_max3_u32 v73, v73, v165, v166
    v_max3_u32 v73, v73, v167, v168
    v_max3_u32 v73, v73, v169, v170
    v_max_u32 v73, v73, v171
    v_cmp_eq_u32 vcc, -1, v73
    s_cbranch_vccz pd_167
    v_max3_u32 v73, v160, v161, v162
    v_max_u32 v73, v73, v163
    v_cmp_eq_u32 vcc, -1, v73
    s_cbranch_vccz ps_168
    buffer_load_dwordx4 v[160:163], v70, s[4:7], s76 offen offset:0 sc1
ps_168:
    v_max3_u32 v73, v164, v165, v166
    v_max_u32 v73, v73, v167
    v_cmp_eq_u32 vcc, -1, v73
    s_cbranch_vccz ps_169
    buffer_load_dwordx4 v[164:167], v70, s[4:7], s76 offen offset:1024 sc1
ps_169:
    v_max3_u32 v73, v168, v169, v170
    v_max_u32 v73, v73, v171
    v_cmp_eq_u32 vcc, -1, v73
    s_cbranch_vccz ps_170
    buffer_load_dwordx4 v[168:171], v71, s[4:7], s76 offen sc1
ps_170:
    s_sub_u32 s68, s68, 1
    s_cbranch_scc0 ok_171
    s_mov_b32 s69, 25
    s_branch FAIL
ok_171:
    s_branch pl_166
pd_167:
    ds_write_b128 v9, v[160:163] offset:0
    ds_write_b128 v9, v[164:167] offset:1024
    ds_write_b128 v10, v[168:171] offset:0
    s_add_u32 s31, s31, 1
    s_and_b32 s76, s31, 3
    s_lshl_b32 s76, s76, 19
    s_xor_b32 s77, s76, 1048576
    s_waitcnt lgkmcnt(0)
    s_cmp_lt_u32 s31, 63
    s_cbranch_scc1 cloop_127
    s_barrier
    ds_read_b64_tr_b16 v[80:81], v1 offset:0
    ds_read_b64_tr_b16 v[82:83], v1 offset:256
    ds_read_b64_tr_b16 v[84:85], v1 offset:1024
    ds_read_b64_tr_b16 v[86:87], v1 offset:1280
    ds_read_b64_tr_b16 v[88:89], v1 offset:2048
    ds_read_b64_tr_b16 v[90:91], v1 offset:2304
    ds_read_b64_tr_b16 v[92:93], v1 offset:3072
    ds_read_b64_tr_b16 v[94:95], v1 offset:3328
    ds_read_b64_tr_b16 v[96:97], v1 offset:4096
    ds_read_b64_tr_b16 v[98:99], v1 offset:4352
    ds_read_b64_tr_b16 v[100:101], v1 offset:5120
    ds_read_b64_tr_b16 v[102:103], v1 offset:5376
    s_waitcnt lgkmcnt(10)
    v_smfmac_f32_16x16x64_bf16 v[20:23], v[80:83], a[80:87], v43
    v_smfmac_f32_16x16x64_bf16 v[24:27], v[80:83], v[176:183], v43
    ds_read_b64_tr_b16 v[104:105], v1 offset:6144
    ds_read_b64_tr_b16 v[106:107], v1 offset:6400
    s_waitcnt lgkmcnt(10)
    v_smfmac_f32_16x16x64_bf16 v[20:23], v[84:87], a[88:95], v43
    v_smfmac_f32_16x16x64_bf16 v[24:27], v[84:87], v[184:191], v43
    ds_read_b64_tr_b16 v[108:109], v1 offset:7168
    ds_read_b64_tr_b16 v[110:111], v1 offset:7424
    s_waitcnt lgkmcnt(10)
    v_smfmac_f32_16x16x64_bf16 v[20:23], v[88:91], a[96:103], v43
    v_smfmac_f32_16x16x64_bf16 v[24:27], v[88:91], v[192:199], v43
    ds_read_b64_tr_b16 v[112:113], v1 offset:8192
    ds_read_b64_tr_b16 v[114:115], v1 offset:8448
    s_waitcnt lgkmcnt(10)
    v_smfmac_f32_16x16x64_bf16 v[20:23], v[92:95], a[104:111], v43
    v_smfmac_f32_16x16x64_bf16 v[24:27], v[92:95], v[200:207], v43
    ds_read_b64_tr_b16 v[116:117], v1 offset:9216
    ds_read_b64_tr_b16 v[118:119], v1 offset:9472
    s_waitcnt lgkmcnt(10)
    v_smfmac_f32_16x16x64_bf16 v[20:23], v[96:99], a[112:119], v43
    v_smfmac_f32_16x16x64_bf16 v[24:27], v[96:99], v[208:215], v43
    s_waitcnt lgkmcnt(8)
    v_smfmac_f32_16x16x64_bf16 v[20:23], v[100:103], a[120:127], v43
    v_smfmac_f32_16x16x64_bf16 v[24:27], v[100:103], v[216:223], v43
    s_waitcnt lgkmcnt(6)
    v_smfmac_f32_16x16x64_bf16 v[20:23], v[104:107], a[128:135], v43
    v_smfmac_f32_16x16x64_bf16 v[24:27], v[104:107], v[224:231], v43
    s_waitcnt lgkmcnt(4)
    v_smfmac_f32_16x16x64_bf16 v[20:23], v[108:111], a[136:143], v43
    v_smfmac_f32_16x16x64_bf16 v[24:27], v[108:111], v[232:239], v43
    s_waitcnt lgkmcnt(2)
    v_smfmac_f32_16x16x64_bf16 v[20:23], v[112:115], a[144:151], v43
    v_smfmac_f32_16x16x64_bf16 v[24:27], v[112:115], v[240:247], v43
    s_waitcnt lgkmcnt(0)
    v_smfmac_f32_16x16x64_bf16 v[20:23], v[116:119], a[152:159], v43
    v_smfmac_f32_16x16x64_bf16 v[24:27], v[116:119], v[248:255], v43
    s_nop 10
    v_permlane32_swap_b32 v20, v22
    v_permlane32_swap_b32 v21, v23
    v_add_f32 v20, v20, v22
    v_add_f32 v21, v21, v23
    v_permlane32_swap_b32 v24, v26
    v_permlane32_swap_b32 v25, v27
    v_add_f32 v24, v24, v26
    v_add_f32 v25, v25, v27
    v_cvt_pk_bf16_f32 v30, v20, v21
    v_cvt_pk_bf16_f32 v32, v24, v25
    buffer_store_dword v30, v2, s[4:7], s80 offen sc1
    buffer_store_dword v32, v6, s[4:7], s81 offen sc1
    s_add_u32 s85, s31, 1
    s_waitcnt vmcnt(0)
    v_mov_b32 v66, s85
    s_mov_b64 exec, 1
    buffer_store_dword v66, v65, s[4:7], 0 offen sc1
    s_mov_b64 exec, -1
    s_branch EXIT
ROLE_KS:
    s_mov_b32 s12, s38
    s_mov_b32 s13, s39
    s_mov_b32 s14, 7864320
    s_mov_b32 s15, 0x20000
    s_sub_u32 s73, s29, 12
    s_lshl_b32 s74, s28, 2
    s_add_u32 s74, s74, s73
    s_mul_i32 s69, s30, 10240
    v_lshlrev_b32 v2, 4, v0
    v_add_u32 v2, s69, v2
    buffer_load_dwordx4 v[96:99], v2, s[8:11], 0 offen offset:0
    buffer_load_dwordx4 v[100:103], v2, s[8:11], 0 offen offset:1024
    buffer_load_dwordx4 v[104:107], v2, s[8:11], 0 offen offset:2048
    buffer_load_dwordx4 v[108:111], v2, s[8:11], 0 offen offset:3072
    v_add_u32 v2, 4096, v2
    buffer_load_dwordx4 v[112:115], v2, s[8:11], 0 offen offset:0
    buffer_load_dwordx4 v[116:119], v2, s[8:11], 0 offen offset:1024
    buffer_load_dwordx4 v[120:123], v2, s[8:11], 0 offen offset:2048
    buffer_load_dwordx4 v[124:127], v2, s[8:11], 0 offen offset:3072
    v_add_u32 v2, 4096, v2
    buffer_load_dwordx4 v[128:131], v2, s[8:11], 0 offen offset:0
    buffer_load_dwordx4 v[132:135], v2, s[8:11], 0 offen offset:1024
    v_lshrrev_b32 v2, 3, v0
    v_and_b32 v3, 7, v0
    v_lshrrev_b32 v4, 4, v0
    v_and_b32 v4, 1, v4
    v_lshlrev_b32 v4, 1, v4
    s_and_b32 s69, s30, 1
    s_lshl_b32 s69, s69, 2
    v_or_b32 v4, s69, v4
    v_xor_b32 v3, v3, v4
    v_lshlrev_b32 v3, 4, v3
    s_mov_b32 s69, 12288
    v_mad_u32_u24 v12, v2, s69, v3
    v_lshrrev_b32 v2, 4, v0
    v_bfe_u32 v3, v0, 2, 2
    v_and_b32 v4, 3, v0
    v_lshrrev_b32 v5, 1, v3
    v_and_b32 v6, 1, v2
    v_lshl_or_b32 v5, v6, 1, v5
    v_lshlrev_b32 v5, 1, v5
    v_lshl_add_u32 v6, v2, 3, v3
    s_lshl_b32 s69, s30, 1
    v_lshrrev_b32 v7, 1, v4
    v_or_b32 v7, s69, v7
    v_xor_b32 v7, v7, v5
    v_lshlrev_b32 v7, 4, v7
    v_and_b32 v4, 1, v4
    v_lshl_or_b32 v7, v4, 3, v7
    v_lshl_add_u32 v14, v6, 7, v7
    s_mul_i32 s71, s74, 384
    s_add_u32 s71, s71, 0
    s_mul_i32 s69, s30, 98304
    s_add_u32 s69, s69, s71
    s_lshl_b32 s70, s30, 10
    s_add_u32 m0, s70, 0
    s_nop 0
    buffer_load_dwordx4 v12, s[12:15], s69 offen lds
    s_add_u32 m0, m0, 4096
    s_add_u32 s69, s69, 393216
    buffer_load_dwordx4 v12, s[12:15], s69 offen lds
    s_add_u32 m0, m0, 4096
    s_add_u32 s69, s69, 393216
    buffer_load_dwordx4 v12, s[12:15], s69 offen lds
    s_add_u32 m0, m0, 4096
    s_add_u32 s69, s69, 393216
    buffer_load_dwordx4 v12, s[12:15], s69 offen lds
    s_add_u32 m0, m0, 4096
    s_add_u32 s69, s69, 393216
    buffer_load_dwordx4 v12, s[12:15], s69 offen lds
    s_add_u32 m0, m0, 4096
    s_add_u32 s69, s69, 393216
    buffer_load_dwordx4 v12, s[12:15], s69 offen lds
    s_add_u32 m0, m0, 4096
    s_add_u32 s69, s69, 393216
    buffer_load_dwordx4 v12, s[12:15], s69 offen lds
    s_add_u32 m0, m0, 4096
    s_add_u32 s69, s69, 393216
    buffer_load_dwordx4 v12, s[12:15], s69 offen lds
    s_add_u32 m0, m0, 4096
    s_add_u32 s69, s69, 393216
    buffer_load_dwordx4 v12, s[12:15], s69 offen lds
    s_add_u32 m0, m0, 4096
    s_add_u32 s69, s69, 393216
    buffer_load_dwordx4 v12, s[12:15], s69 offen lds
    s_add_u32 m0, m0, 4096
    s_add_u32 s69, s69, 393216
    buffer_load_dwordx4 v12, s[12:15], s69 offen lds
    s_add_u32 m0, m0, 4096
    s_add_u32 s69, s69, 393216
    buffer_load_dwordx4 v12, s[12:15], s69 offen lds
    s_add_u32 m0, m0, 4096
    s_add_u32 s69, s69, 393216
    buffer_load_dwordx4 v12, s[12:15], s69 offen lds
    s_add_u32 m0, m0, 4096
    s_add_u32 s69, s69, 393216
    buffer_load_dwordx4 v12, s[12:15], s69 offen lds
    s_add_u32 m0, m0, 4096
    s_add_u32 s69, s69, 393216
    buffer_load_dwordx4 v12, s[12:15], s69 offen lds
    s_add_u32 m0, m0, 4096
    s_add_u32 s69, s69, 393216
    buffer_load_dwordx4 v12, s[12:15], s69 offen lds
    s_add_u32 m0, m0, 4096
    s_add_u32 s69, s69, 393216
    buffer_load_dwordx4 v12, s[12:15], s69 offen lds
    s_add_u32 m0, m0, 4096
    s_add_u32 s69, s69, 393216
    buffer_load_dwordx4 v12, s[12:15], s69 offen lds
    s_add_u32 m0, m0, 4096
    s_add_u32 s69, s69, 393216
    buffer_load_dwordx4 v12, s[12:15], s69 offen lds
    s_add_u32 m0, m0, 4096
    s_add_u32 s69, s69, 393216
    buffer_load_dwordx4 v12, s[12:15], s69 offen lds
    s_mul_i32 s71, s74, 384
    s_add_u32 s71, s71, 128
    s_mul_i32 s69, s30, 98304
    s_add_u32 s69, s69, s71
    s_lshl_b32 s70, s30, 10
    s_add_u32 m0, s70, 81920
    s_nop 0
    buffer_load_dwordx4 v12, s[12:15], s69 offen lds
    s_add_u32 m0, m0, 4096
    s_add_u32 s69, s69, 393216
    buffer_load_dwordx4 v12, s[12:15], s69 offen lds
    s_add_u32 m0, m0, 4096
    s_add_u32 s69, s69, 393216
    buffer_load_dwordx4 v12, s[12:15], s69 offen lds
    s_add_u32 m0, m0, 4096
    s_add_u32 s69, s69, 393216
    buffer_load_dwordx4 v12, s[12:15], s69 offen lds
    s_add_u32 m0, m0, 4096
    s_add_u32 s69, s69, 393216
    buffer_load_dwordx4 v12, s[12:15], s69 offen lds
    s_add_u32 m0, m0, 4096
    s_add_u32 s69, s69, 393216
    buffer_load_dwordx4 v12, s[12:15], s69 offen lds
    s_add_u32 m0, m0, 4096
    s_add_u32 s69, s69, 393216
    buffer_load_dwordx4 v12, s[12:15], s69 offen lds
    s_add_u32 m0, m0, 4096
    s_add_u32 s69, s69, 393216
    buffer_load_dwordx4 v12, s[12:15], s69 offen lds
    s_add_u32 m0, m0, 4096
    s_add_u32 s69, s69, 393216
    buffer_load_dwordx4 v12, s[12:15], s69 offen lds
    s_add_u32 m0, m0, 4096
    s_add_u32 s69, s69, 393216
    buffer_load_dwordx4 v12, s[12:15], s69 offen lds
    s_add_u32 m0, m0, 4096
    s_add_u32 s69, s69, 393216
    buffer_load_dwordx4 v12, s[12:15], s69 offen lds
    s_add_u32 m0, m0, 4096
    s_add_u32 s69, s69, 393216
    buffer_load_dwordx4 v12, s[12:15], s69 offen lds
    s_add_u32 m0, m0, 4096
    s_add_u32 s69, s69, 393216
    buffer_load_dwordx4 v12, s[12:15], s69 offen lds
    s_add_u32 m0, m0, 4096
    s_add_u32 s69, s69, 393216
    buffer_load_dwordx4 v12, s[12:15], s69 offen lds
    s_add_u32 m0, m0, 4096
    s_add_u32 s69, s69, 393216
    buffer_load_dwordx4 v12, s[12:15], s69 offen lds
    s_add_u32 m0, m0, 4096
    s_add_u32 s69, s69, 393216
    buffer_load_dwordx4 v12, s[12:15], s69 offen lds
    s_add_u32 m0, m0, 4096
    s_add_u32 s69, s69, 393216
    buffer_load_dwordx4 v12, s[12:15], s69 offen lds
    s_add_u32 m0, m0, 4096
    s_add_u32 s69, s69, 393216
    buffer_load_dwordx4 v12, s[12:15], s69 offen lds
    s_add_u32 m0, m0, 4096
    s_add_u32 s69, s69, 393216
    buffer_load_dwordx4 v12, s[12:15], s69 offen lds
    s_add_u32 m0, m0, 4096
    s_add_u32 s69, s69, 393216
    buffer_load_dwordx4 v12, s[12:15], s69 offen lds
    s_waitcnt vmcnt(20)
    s_barrier
    v_add_u32 v9, 0, v14
    ds_read_b64_tr_b16 a[0:1], v9 offset:0
    ds_read_b64_tr_b16 a[2:3], v9 offset:512
    ds_read_b64_tr_b16 a[4:5], v9 offset:4096
    ds_read_b64_tr_b16 a[6:7], v9 offset:4608
    ds_read_b64_tr_b16 a[8:9], v9 offset:8192
    ds_read_b64_tr_b16 a[10:11], v9 offset:8704
    ds_read_b64_tr_b16 a[12:13], v9 offset:12288
    ds_read_b64_tr_b16 a[14:15], v9 offset:12800
    ds_read_b64_tr_b16 a[16:17], v9 offset:16384
    ds_read_b64_tr_b16 a[18:19], v9 offset:16896
    ds_read_b64_tr_b16 a[20:21], v9 offset:20480
    ds_read_b64_tr_b16 a[22:23], v9 offset:20992
    s_waitcnt lgkmcnt(0)
    ds_read_b64_tr_b16 a[24:25], v9 offset:24576
    ds_read_b64_tr_b16 a[26:27], v9 offset:25088
    ds_read_b64_tr_b16 a[28:29], v9 offset:28672
    ds_read_b64_tr_b16 a[30:31], v9 offset:29184
    ds_read_b64_tr_b16 a[32:33], v9 offset:32768
    ds_read_b64_tr_b16 a[34:35], v9 offset:33280
    ds_read_b64_tr_b16 a[36:37], v9 offset:36864
    ds_read_b64_tr_b16 a[38:39], v9 offset:37376
    s_waitcnt lgkmcnt(0)
    v_add_u32 v9, 40960, v14
    ds_read_b64_tr_b16 a[40:41], v9 offset:0
    ds_read_b64_tr_b16 a[42:43], v9 offset:512
    ds_read_b64_tr_b16 a[44:45], v9 offset:4096
    ds_read_b64_tr_b16 a[46:47], v9 offset:4608
    ds_read_b64_tr_b16 a[48:49], v9 offset:8192
    ds_read_b64_tr_b16 a[50:51], v9 offset:8704
    ds_read_b64_tr_b16 a[52:53], v9 offset:12288
    ds_read_b64_tr_b16 a[54:55], v9 offset:12800
    ds_read_b64_tr_b16 a[56:57], v9 offset:16384
    ds_read_b64_tr_b16 a[58:59], v9 offset:16896
    ds_read_b64_tr_b16 a[60:61], v9 offset:20480
    ds_read_b64_tr_b16 a[62:63], v9 offset:20992
    s_waitcnt lgkmcnt(0)
    ds_read_b64_tr_b16 a[64:65], v9 offset:24576
    ds_read_b64_tr_b16 a[66:67], v9 offset:25088
    ds_read_b64_tr_b16 a[68:69], v9 offset:28672
    ds_read_b64_tr_b16 a[70:71], v9 offset:29184
    ds_read_b64_tr_b16 a[72:73], v9 offset:32768
    ds_read_b64_tr_b16 a[74:75], v9 offset:33280
    ds_read_b64_tr_b16 a[76:77], v9 offset:36864
    ds_read_b64_tr_b16 a[78:79], v9 offset:37376
    s_waitcnt lgkmcnt(0)
    s_barrier
    s_mul_i32 s71, s74, 384
    s_add_u32 s71, s71, 256
    s_mul_i32 s69, s30, 98304
    s_add_u32 s69, s69, s71
    s_lshl_b32 s70, s30, 10
    s_add_u32 m0, s70, 0
    s_nop 0
    buffer_load_dwordx4 v12, s[12:15], s69 offen lds
    s_add_u32 m0, m0, 4096
    s_add_u32 s69, s69, 393216
    buffer_load_dwordx4 v12, s[12:15], s69 offen lds
    s_add_u32 m0, m0, 4096
    s_add_u32 s69, s69, 393216
    buffer_load_dwordx4 v12, s[12:15], s69 offen lds
    s_add_u32 m0, m0, 4096
    s_add_u32 s69, s69, 393216
    buffer_load_dwordx4 v12, s[12:15], s69 offen lds
    s_add_u32 m0, m0, 4096
    s_add_u32 s69, s69, 393216
    buffer_load_dwordx4 v12, s[12:15], s69 offen lds
    s_add_u32 m0, m0, 4096
    s_add_u32 s69, s69, 393216
    buffer_load_dwordx4 v12, s[12:15], s69 offen lds
    s_add_u32 m0, m0, 4096
    s_add_u32 s69, s69, 393216
    buffer_load_dwordx4 v12, s[12:15], s69 offen lds
    s_add_u32 m0, m0, 4096
    s_add_u32 s69, s69, 393216
    buffer_load_dwordx4 v12, s[12:15], s69 offen lds
    s_add_u32 m0, m0, 4096
    s_add_u32 s69, s69, 393216
    buffer_load_dwordx4 v12, s[12:15], s69 offen lds
    s_add_u32 m0, m0, 4096
    s_add_u32 s69, s69, 393216
    buffer_load_dwordx4 v12, s[12:15], s69 offen lds
    s_add_u32 m0, m0, 4096
    s_add_u32 s69, s69, 393216
    buffer_load_dwordx4 v12, s[12:15], s69 offen lds
    s_add_u32 m0, m0, 4096
    s_add_u32 s69, s69, 393216
    buffer_load_dwordx4 v12, s[12:15], s69 offen lds
    s_add_u32 m0, m0, 4096
    s_add_u32 s69, s69, 393216
    buffer_load_dwordx4 v12, s[12:15], s69 offen lds
    s_add_u32 m0, m0, 4096
    s_add_u32 s69, s69, 393216
    buffer_load_dwordx4 v12, s[12:15], s69 offen lds
    s_add_u32 m0, m0, 4096
    s_add_u32 s69, s69, 393216
    buffer_load_dwordx4 v12, s[12:15], s69 offen lds
    s_add_u32 m0, m0, 4096
    s_add_u32 s69, s69, 393216
    buffer_load_dwordx4 v12, s[12:15], s69 offen lds
    s_add_u32 m0, m0, 4096
    s_add_u32 s69, s69, 393216
    buffer_load_dwordx4 v12, s[12:15], s69 offen lds
    s_add_u32 m0, m0, 4096
    s_add_u32 s69, s69, 393216
    buffer_load_dwordx4 v12, s[12:15], s69 offen lds
    s_add_u32 m0, m0, 4096
    s_add_u32 s69, s69, 393216
    buffer_load_dwordx4 v12, s[12:15], s69 offen lds
    s_add_u32 m0, m0, 4096
    s_add_u32 s69, s69, 393216
    buffer_load_dwordx4 v12, s[12:15], s69 offen lds
    s_waitcnt vmcnt(20)
    s_barrier
    v_add_u32 v9, 81920, v14
    ds_read_b64_tr_b16 a[80:81], v9 offset:0
    ds_read_b64_tr_b16 a[82:83], v9 offset:512
    ds_read_b64_tr_b16 a[84:85], v9 offset:4096
    ds_read_b64_tr_b16 a[86:87], v9 offset:4608
    ds_read_b64_tr_b16 a[88:89], v9 offset:8192
    ds_read_b64_tr_b16 a[90:91], v9 offset:8704
    ds_read_b64_tr_b16 a[92:93], v9 offset:12288
    ds_read_b64_tr_b16 a[94:95], v9 offset:12800
    ds_read_b64_tr_b16 a[96:97], v9 offset:16384
    ds_read_b64_tr_b16 a[98:99], v9 offset:16896
    ds_read_b64_tr_b16 a[100:101], v9 offset:20480
    ds_read_b64_tr_b16 a[102:103], v9 offset:20992
    s_waitcnt lgkmcnt(0)
    ds_read_b64_tr_b16 a[104:105], v9 offset:24576
    ds_read_b64_tr_b16 a[106:107], v9 offset:25088
    ds_read_b64_tr_b16 a[108:109], v9 offset:28672
    ds_read_b64_tr_b16 a[110:111], v9 offset:29184
    ds_read_b64_tr_b16 a[112:113], v9 offset:32768
    ds_read_b64_tr_b16 a[114:115], v9 offset:33280
    ds_read_b64_tr_b16 a[116:117], v9 offset:36864
    ds_read_b64_tr_b16 a[118:119], v9 offset:37376
    s_waitcnt lgkmcnt(0)
    v_add_u32 v9, 122880, v14
    ds_read_b64_tr_b16 a[120:121], v9 offset:0
    ds_read_b64_tr_b16 a[122:123], v9 offset:512
    ds_read_b64_tr_b16 a[124:125], v9 offset:4096
    ds_read_b64_tr_b16 a[126:127], v9 offset:4608
    ds_read_b64_tr_b16 a[128:129], v9 offset:8192
    ds_read_b64_tr_b16 a[130:131], v9 offset:8704
    ds_read_b64_tr_b16 a[132:133], v9 offset:12288
    ds_read_b64_tr_b16 a[134:135], v9 offset:12800
    ds_read_b64_tr_b16 a[136:137], v9 offset:16384
    ds_read_b64_tr_b16 a[138:139], v9 offset:16896
    ds_read_b64_tr_b16 a[140:141], v9 offset:20480
    ds_read_b64_tr_b16 a[142:143], v9 offset:20992
    s_waitcnt lgkmcnt(0)
    ds_read_b64_tr_b16 a[144:145], v9 offset:24576
    ds_read_b64_tr_b16 a[146:147], v9 offset:25088
    ds_read_b64_tr_b16 a[148:149], v9 offset:28672
    ds_read_b64_tr_b16 a[150:151], v9 offset:29184
    ds_read_b64_tr_b16 a[152:153], v9 offset:32768
    ds_read_b64_tr_b16 a[154:155], v9 offset:33280
    ds_read_b64_tr_b16 a[156:157], v9 offset:36864
    ds_read_b64_tr_b16 a[158:159], v9 offset:37376
    s_waitcnt lgkmcnt(0)
    s_barrier
    s_waitcnt vmcnt(0)
    s_barrier
    v_add_u32 v9, 0, v14
    ds_read_b64_tr_b16 a[160:161], v9 offset:0
    ds_read_b64_tr_b16 a[162:163], v9 offset:512
    ds_read_b64_tr_b16 a[164:165], v9 offset:4096
    ds_read_b64_tr_b16 a[166:167], v9 offset:4608
    ds_read_b64_tr_b16 a[168:169], v9 offset:8192
    ds_read_b64_tr_b16 a[170:171], v9 offset:8704
    ds_read_b64_tr_b16 a[172:173], v9 offset:12288
    ds_read_b64_tr_b16 a[174:175], v9 offset:12800
    ds_read_b64_tr_b16 a[176:177], v9 offset:16384
    ds_read_b64_tr_b16 a[178:179], v9 offset:16896
    ds_read_b64_tr_b16 a[180:181], v9 offset:20480
    ds_read_b64_tr_b16 a[182:183], v9 offset:20992
    s_waitcnt lgkmcnt(0)
    ds_read_b64_tr_b16 a[184:185], v9 offset:24576
    ds_read_b64_tr_b16 a[186:187], v9 offset:25088
    ds_read_b64_tr_b16 a[188:189], v9 offset:28672
    ds_read_b64_tr_b16 a[190:191], v9 offset:29184
    ds_read_b64_tr_b16 a[192:193], v9 offset:32768
    ds_read_b64_tr_b16 a[194:195], v9 offset:33280
    ds_read_b64_tr_b16 a[196:197], v9 offset:36864
    ds_read_b64_tr_b16 a[198:199], v9 offset:37376
    s_waitcnt lgkmcnt(0)
    v_add_u32 v9, 40960, v14
    ds_read_b64_tr_b16 a[200:201], v9 offset:0
    ds_read_b64_tr_b16 a[202:203], v9 offset:512
    ds_read_b64_tr_b16 a[204:205], v9 offset:4096
    ds_read_b64_tr_b16 a[206:207], v9 offset:4608
    ds_read_b64_tr_b16 a[208:209], v9 offset:8192
    ds_read_b64_tr_b16 a[210:211], v9 offset:8704
    ds_read_b64_tr_b16 a[212:213], v9 offset:12288
    ds_read_b64_tr_b16 a[214:215], v9 offset:12800
    ds_read_b64_tr_b16 a[216:217], v9 offset:16384
    ds_read_b64_tr_b16 a[218:219], v9 offset:16896
    ds_read_b64_tr_b16 a[220:221], v9 offset:20480
    ds_read_b64_tr_b16 a[222:223], v9 offset:20992
    s_waitcnt lgkmcnt(0)
    ds_read_b64_tr_b16 a[224:225], v9 offset:24576
    ds_read_b64_tr_b16 a[226:227], v9 offset:25088
    ds_read_b64_tr_b16 a[228:229], v9 offset:28672
    ds_read_b64_tr_b16 a[230:231], v9 offset:29184
    ds_read_b64_tr_b16 a[232:233], v9 offset:32768
    ds_read_b64_tr_b16 a[234:235], v9 offset:33280
    ds_read_b64_tr_b16 a[236:237], v9 offset:36864
    ds_read_b64_tr_b16 a[238:239], v9 offset:37376
    s_waitcnt lgkmcnt(0)
    s_barrier
    v_mov_b32 v2, 128
wa_172:
    buffer_load_dword v3, v2, s[64:67], 0 offen sc1
    s_waitcnt vmcnt(0)
    v_cmp_ne_u32 vcc, 0x100, v3
    s_cbranch_vccz wad_173
    s_sub_u32 s68, s68, 1
    s_cbranch_scc0 ok_174
    s_mov_b32 s69, 1
    s_branch FAIL
ok_174:
    s_sleep 4
    s_branch wa_172
wad_173:
    v_and_b32 v2, 15, v0
    v_lshrrev_b32 v3, 4, v0
    s_and_b32 s69, s30, 1
    s_lshl_b32 s69, s69, 4
    v_add_u32 v2, s69, v2
    s_mov_b32 s69, 1280
    v_mul_u32_u24 v2, s69, v2
    s_lshr_b32 s69, s30, 1
    s_mul_i32 s69, s69, 640
    v_lshl_add_u32 v2, v3, 4, v2
    v_add_u32 v10, s69, v2
    v_lshlrev_b32 v11, 4, v0
    s_lshr_b32 s69, s30, 1
    s_lshl_b32 s69, s69, 10
    s_and_b32 s70, s30, 1
    s_lshl_b32 s70, s70, 3
    s_add_u32 s69, s69, s70
    v_add_u32 v12, s69, v11
    s_lshl_b32 s69, s74, 7
    s_lshl_b32 s70, s30, 2
    s_add_u32 s69, s69, s70
    s_add_u32 s69, s69, 2097152
    v_mov_b32 v13, s69
    s_mul_i32 s75, s74, 786432
    s_add_u32 s75, s75, 4194304
    s_mov_b32 s31, 0
    s_mov_b32 s76, 0
    s_mul_i32 s69, s31, 40960
    s_and_b32 s70, s30, 1
    s_mul_i32 s70, s70, 20
    s_lshr_b32 s71, s30, 1
    s_mul_i32 s71, s71, 10
    s_add_u32 s70, s70, s71
    s_lshl_b32 s70, s70, 10
    s_add_u32 m0, s70, s76
    s_nop 0
    buffer_load_dwordx4 v10, s[8:11], s69 offen offset:0 lds
    s_add_u32 m0, m0, 960
    s_nop 0
    buffer_load_dwordx4 v10, s[8:11], s69 offen offset:64 lds
    s_add_u32 m0, m0, 960
    s_nop 0
    buffer_load_dwordx4 v10, s[8:11], s69 offen offset:128 lds
    s_add_u32 m0, m0, 960
    s_nop 0
    buffer_load_dwordx4 v10, s[8:11], s69 offen offset:192 lds
    s_add_u32 m0, m0, 960
    s_nop 0
    buffer_load_dwordx4 v10, s[8:11], s69 offen offset:256 lds
    s_add_u32 m0, m0, 960
    s_nop 0
    buffer_load_dwordx4 v10, s[8:11], s69 offen offset:320 lds
    s_add_u32 m0, m0, 960
    s_nop 0
    buffer_load_dwordx4 v10, s[8:11], s69 offen offset:384 lds
    s_add_u32 m0, m0, 960
    s_nop 0
    buffer_load_dwordx4 v10, s[8:11], s69 offen offset:448 lds
    s_add_u32 m0, m0, 960
    s_nop 0
    buffer_load_dwordx4 v10, s[8:11], s69 offen offset:512 lds
    s_add_u32 m0, m0, 960
    s_nop 0
    buffer_load_dwordx4 v10, s[8:11], s69 offen offset:576 lds
    s_waitcnt vmcnt(0)
kvloop_175:
    s_barrier
    v_add_u32 v14, s76, v11
    s_xor_b32 s76, s76, 40960
    s_add_u32 s77, s31, 1
    s_mul_i32 s78, s77, 40960
    s_and_b32 s70, s30, 1
    s_mul_i32 s70, s70, 20
    s_lshr_b32 s71, s30, 1
    s_mul_i32 s71, s71, 10
    s_add_u32 s70, s70, s71
    s_lshl_b32 s70, s70, 10
    s_add_u32 m0, s70, s76
    ds_read_b128 v[16:19], v14 offset:0
    ds_read_b128 v[20:23], v14 offset:1024
    ds_read_b128 v[24:27], v14 offset:2048
    ds_read_b128 v[28:31], v14 offset:3072
    ds_read_b128 v[32:35], v14 offset:4096
    s_waitcnt lgkmcnt(4)
    v_mfma_f32_16x16x32_bf16 v[40:43], a[0:3], v[16:19], 0
    v_mfma_f32_16x16x32_bf16 v[48:51], a[80:83], v[16:19], 0
    v_mfma_f32_16x16x32_bf16 v[56:59], a[160:163], v[16:19], 0
    buffer_load_dwordx4 v10, s[8:11], s78 offen offset:0 lds
    s_add_u32 m0, m0, 960
    ds_read_b128 v[36:39], v14 offset:5120
    s_waitcnt lgkmcnt(4)
    v_mfma_f32_16x16x32_bf16 v[40:43], a[4:7], v[20:23], v[40:43]
    v_mfma_f32_16x16x32_bf16 v[48:51], a[84:87], v[20:23], v[48:51]
    v_mfma_f32_16x16x32_bf16 v[56:59], a[164:167], v[20:23], v[56:59]
    ds_read_b128 v[16:19], v14 offset:6144
    s_waitcnt lgkmcnt(4)
    v_mfma_f32_16x16x32_bf16 v[40:43], a[8:11], v[24:27], v[40:43]
    v_mfma_f32_16x16x32_bf16 v[48:51], a[88:91], v[24:27], v[48:51]
    v_mfma_f32_16x16x32_bf16 v[56:59], a[168:171], v[24:27], v[56:59]
    ds_read_b128 v[20:23], v14 offset:7168
    s_waitcnt lgkmcnt(4)
    v_mfma_f32_16x16x32_bf16 v[40:43], a[12:15], v[28:31], v[40:43]
    v_mfma_f32_16x16x32_bf16 v[48:51], a[92:95], v[28:31], v[48:51]
    v_mfma_f32_16x16x32_bf16 v[56:59], a[172:175], v[28:31], v[56:59]
    buffer_load_dwordx4 v10, s[8:11], s78 offen offset:64 lds
    s_add_u32 m0, m0, 960
    ds_read_b128 v[24:27], v14 offset:8192
    s_waitcnt lgkmcnt(4)
    v_mfma_f32_16x16x32_bf16 v[40:43], a[16:19], v[32:35], v[40:43]
    v_mfma_f32_16x16x32_bf16 v[48:51], a[96:99], v[32:35], v[48:51]
    v_mfma_f32_16x16x32_bf16 v[56:59], a[176:179], v[32:35], v[56:59]
    ds_read_b128 v[28:31], v14 offset:9216
    s_waitcnt lgkmcnt(4)
    v_mfma_f32_16x16x32_bf16 v[40:43], a[20:23], v[36:39], v[40:43]
    v_mfma_f32_16x16x32_bf16 v[48:51], a[100:103], v[36:39], v[48:51]
    v_mfma_f32_16x16x32_bf16 v[56:59], a[180:183], v[36:39], v[56:59]
    ds_read_b128 v[32:35], v14 offset:10240
    s_waitcnt lgkmcnt(4)
    v_mfma_f32_16x16x32_bf16 v[40:43], a[24:27], v[16:19], v[40:43]
    v_mfma_f32_16x16x32_bf16 v[48:51], a[104:107], v[16:19], v[48:51]
    v_mfma_f32_16x16x32_bf16 v[56:59], a[184:187], v[16:19], v[56:59]
    buffer_load_dwordx4 v10, s[8:11], s78 offen offset:128 lds
    s_add_u32 m0, m0, 960
    ds_read_b128 v[36:39], v14 offset:11264
    s_waitcnt lgkmcnt(4)
    v_mfma_f32_16x16x32_bf16 v[40:43], a[28:31], v[20:23], v[40:43]
    v_mfma_f32_16x16x32_bf16 v[48:51], a[108:111], v[20:23], v[48:51]
    v_mfma_f32_16x16x32_bf16 v[56:59], a[188:191], v[20:23], v[56:59]
    ds_read_b128 v[16:19], v14 offset:12288
    s_waitcnt lgkmcnt(4)
    v_mfma_f32_16x16x32_bf16 v[40:43], a[32:35], v[24:27], v[40:43]
    v_mfma_f32_16x16x32_bf16 v[48:51], a[112:115], v[24:27], v[48:51]
    v_mfma_f32_16x16x32_bf16 v[56:59], a[192:195], v[24:27], v[56:59]
    ds_read_b128 v[20:23], v14 offset:13312
    s_waitcnt lgkmcnt(4)
    v_mfma_f32_16x16x32_bf16 v[40:43], a[36:39], v[28:31], v[40:43]
    v_mfma_f32_16x16x32_bf16 v[48:51], a[116:119], v[28:31], v[48:51]
    v_mfma_f32_16x16x32_bf16 v[56:59], a[196:199], v[28:31], v[56:59]
    buffer_load_dwordx4 v10, s[8:11], s78 offen offset:192 lds
    s_add_u32 m0, m0, 960
    ds_read_b128 v[24:27], v14 offset:14336
    s_waitcnt lgkmcnt(4)
    v_mfma_f32_16x16x32_bf16 v[40:43], a[40:43], v[32:35], v[40:43]
    v_mfma_f32_16x16x32_bf16 v[48:51], a[120:123], v[32:35], v[48:51]
    v_mfma_f32_16x16x32_bf16 v[56:59], a[200:203], v[32:35], v[56:59]
    ds_read_b128 v[28:31], v14 offset:15360
    s_waitcnt lgkmcnt(4)
    v_mfma_f32_16x16x32_bf16 v[40:43], a[44:47], v[36:39], v[40:43]
    v_mfma_f32_16x16x32_bf16 v[48:51], a[124:127], v[36:39], v[48:51]
    v_mfma_f32_16x16x32_bf16 v[56:59], a[204:207], v[36:39], v[56:59]
    ds_read_b128 v[32:35], v14 offset:16384
    s_waitcnt lgkmcnt(4)
    v_mfma_f32_16x16x32_bf16 v[40:43], a[48:51], v[16:19], v[40:43]
    v_mfma_f32_16x16x32_bf16 v[48:51], a[128:131], v[16:19], v[48:51]
    v_mfma_f32_16x16x32_bf16 v[56:59], a[208:211], v[16:19], v[56:59]
    buffer_load_dwordx4 v10, s[8:11], s78 offen offset:256 lds
    s_add_u32 m0, m0, 960
    ds_read_b128 v[36:39], v14 offset:17408
    s_waitcnt lgkmcnt(4)
    v_mfma_f32_16x16x32_bf16 v[40:43], a[52:55], v[20:23], v[40:43]
    v_mfma_f32_16x16x32_bf16 v[48:51], a[132:135], v[20:23], v[48:51]
    v_mfma_f32_16x16x32_bf16 v[56:59], a[212:215], v[20:23], v[56:59]
    ds_read_b128 v[16:19], v14 offset:18432
    s_waitcnt lgkmcnt(4)
    v_mfma_f32_16x16x32_bf16 v[40:43], a[56:59], v[24:27], v[40:43]
    v_mfma_f32_16x16x32_bf16 v[48:51], a[136:139], v[24:27], v[48:51]
    v_mfma_f32_16x16x32_bf16 v[56:59], a[216:219], v[24:27], v[56:59]
    ds_read_b128 v[20:23], v14 offset:19456
    s_waitcnt lgkmcnt(4)
    v_mfma_f32_16x16x32_bf16 v[40:43], a[60:63], v[28:31], v[40:43]
    v_mfma_f32_16x16x32_bf16 v[48:51], a[140:143], v[28:31], v[48:51]
    v_mfma_f32_16x16x32_bf16 v[56:59], a[220:223], v[28:31], v[56:59]
    buffer_load_dwordx4 v10, s[8:11], s78 offen offset:320 lds
    s_add_u32 m0, m0, 960
    ds_read_b128 v[24:27], v14 offset:20480
    s_waitcnt lgkmcnt(4)
    v_mfma_f32_16x16x32_bf16 v[40:43], a[64:67], v[32:35], v[40:43]
    v_mfma_f32_16x16x32_bf16 v[48:51], a[144:147], v[32:35], v[48:51]
    v_mfma_f32_16x16x32_bf16 v[56:59], a[224:227], v[32:35], v[56:59]
    ds_read_b128 v[28:31], v14 offset:21504
    s_waitcnt lgkmcnt(4)
    v_mfma_f32_16x16x32_bf16 v[40:43], a[68:71], v[36:39], v[40:43]
    v_mfma_f32_16x16x32_bf16 v[48:51], a[148:151], v[36:39], v[48:51]
    v_mfma_f32_16x16x32_bf16 v[56:59], a[228:231], v[36:39], v[56:59]
    ds_read_b128 v[32:35], v14 offset:22528
    s_waitcnt lgkmcnt(4)
    v_mfma_f32_16x16x32_bf16 v[40:43], a[72:75], v[16:19], v[40:43]
    v_mfma_f32_16x16x32_bf16 v[48:51], a[152:155], v[16:19], v[48:51]
    v_mfma_f32_16x16x32_bf16 v[56:59], a[232:235], v[16:19], v[56:59]
    buffer_load_dwordx4 v10, s[8:11], s78 offen offset:384 lds
    s_add_u32 m0, m0, 960
    ds_read_b128 v[36:39], v14 offset:23552
    s_waitcnt lgkmcnt(4)
    v_mfma_f32_16x16x32_bf16 v[40:43], a[76:79], v[20:23], v[40:43]
    v_mfma_f32_16x16x32_bf16 v[48:51], a[156:159], v[20:23], v[48:51]
    v_mfma_f32_16x16x32_bf16 v[56:59], a[236:239], v[20:23], v[56:59]
    ds_read_b128 v[16:19], v14 offset:24576
    s_waitcnt lgkmcnt(4)
    v_mfma_f32_16x16x32_bf16 v[44:47], a[0:3], v[24:27], 0
    v_mfma_f32_16x16x32_bf16 v[52:55], a[80:83], v[24:27], 0
    v_mfma_f32_16x16x32_bf16 v[60:63], a[160:163], v[24:27], 0
    ds_read_b128 v[20:23], v14 offset:25600
    s_waitcnt lgkmcnt(4)
    v_mfma_f32_16x16x32_bf16 v[44:47], a[4:7], v[28:31], v[44:47]
    v_mfma_f32_16x16x32_bf16 v[52:55], a[84:87], v[28:31], v[52:55]
    v_mfma_f32_16x16x32_bf16 v[60:63], a[164:167], v[28:31], v[60:63]
    buffer_load_dwordx4 v10, s[8:11], s78 offen offset:448 lds
    s_add_u32 m0, m0, 960
    ds_read_b128 v[24:27], v14 offset:26624
    s_waitcnt lgkmcnt(4)
    v_mfma_f32_16x16x32_bf16 v[44:47], a[8:11], v[32:35], v[44:47]
    v_mfma_f32_16x16x32_bf16 v[52:55], a[88:91], v[32:35], v[52:55]
    v_mfma_f32_16x16x32_bf16 v[60:63], a[168:171], v[32:35], v[60:63]
    ds_read_b128 v[28:31], v14 offset:27648
    s_waitcnt lgkmcnt(4)
    v_mfma_f32_16x16x32_bf16 v[44:47], a[12:15], v[36:39], v[44:47]
    v_mfma_f32_16x16x32_bf16 v[52:55], a[92:95], v[36:39], v[52:55]
    v_mfma_f32_16x16x32_bf16 v[60:63], a[172:175], v[36:39], v[60:63]
    ds_read_b128 v[32:35], v14 offset:28672
    s_waitcnt lgkmcnt(4)
    v_mfma_f32_16x16x32_bf16 v[44:47], a[16:19], v[16:19], v[44:47]
    v_mfma_f32_16x16x32_bf16 v[52:55], a[96:99], v[16:19], v[52:55]
    v_mfma_f32_16x16x32_bf16 v[60:63], a[176:179], v[16:19], v[60:63]
    buffer_load_dwordx4 v10, s[8:11], s78 offen offset:512 lds
    s_add_u32 m0, m0, 960
    ds_read_b128 v[36:39], v14 offset:29696
    s_waitcnt lgkmcnt(4)
    v_mfma_f32_16x16x32_bf16 v[44:47], a[20:23], v[20:23], v[44:47]
    v_mfma_f32_16x16x32_bf16 v[52:55], a[100:103], v[20:23], v[52:55]
    v_mfma_f32_16x16x32_bf16 v[60:63], a[180:183], v[20:23], v[60:63]
    ds_read_b128 v[16:19], v14 offset:30720
    s_waitcnt lgkmcnt(4)
    v_mfma_f32_16x16x32_bf16 v[44:47], a[24:27], v[24:27], v[44:47]
    v_mfma_f32_16x16x32_bf16 v[52:55], a[104:107], v[24:27], v[52:55]
    v_mfma_f32_16x16x32_bf16 v[60:63], a[184:187], v[24:27], v[60:63]
    ds_read_b128 v[20:23], v14 offset:31744
    s_waitcnt lgkmcnt(4)
    v_mfma_f32_16x16x32_bf16 v[44:47], a[28:31], v[28:31], v[44:47]
    v_mfma_f32_16x16x32_bf16 v[52:55], a[108:111], v[28:31], v[52:55]
    v_mfma_f32_16x16x32_bf16 v[60:63], a[188:191], v[28:31], v[60:63]
    buffer_load_dwordx4 v10, s[8:11], s78 offen offset:576 lds
    s_add_u32 m0, m0, 960
    ds_read_b128 v[24:27], v14 offset:32768
    s_waitcnt lgkmcnt(4)
    v_mfma_f32_16x16x32_bf16 v[44:47], a[32:35], v[32:35], v[44:47]
    v_mfma_f32_16x16x32_bf16 v[52:55], a[112:115], v[32:35], v[52:55]
    v_mfma_f32_16x16x32_bf16 v[60:63], a[192:195], v[32:35], v[60:63]
    ds_read_b128 v[28:31], v14 offset:33792
    s_waitcnt lgkmcnt(4)
    v_mfma_f32_16x16x32_bf16 v[44:47], a[36:39], v[36:39], v[44:47]
    v_mfma_f32_16x16x32_bf16 v[52:55], a[116:119], v[36:39], v[52:55]
    v_mfma_f32_16x16x32_bf16 v[60:63], a[196:199], v[36:39], v[60:63]
    ds_read_b128 v[32:35], v14 offset:34816
    s_waitcnt lgkmcnt(4)
    v_mfma_f32_16x16x32_bf16 v[44:47], a[40:43], v[16:19], v[44:47]
    v_mfma_f32_16x16x32_bf16 v[52:55], a[120:123], v[16:19], v[52:55]
    v_mfma_f32_16x16x32_bf16 v[60:63], a[200:203], v[16:19], v[60:63]
    ds_read_b128 v[36:39], v14 offset:35840
    s_waitcnt lgkmcnt(4)
    v_mfma_f32_16x16x32_bf16 v[44:47], a[44:47], v[20:23], v[44:47]
    v_mfma_f32_16x16x32_bf16 v[52:55], a[124:127], v[20:23], v[52:55]
    v_mfma_f32_16x16x32_bf16 v[60:63], a[204:207], v[20:23], v[60:63]
    ds_read_b128 v[16:19], v14 offset:36864
    s_waitcnt lgkmcnt(4)
    v_mfma_f32_16x16x32_bf16 v[44:47], a[48:51], v[24:27], v[44:47]
    v_mfma_f32_16x16x32_bf16 v[52:55], a[128:131], v[24:27], v[52:55]
    v_mfma_f32_16x16x32_bf16 v[60:63], a[208:211], v[24:27], v[60:63]
    ds_read_b128 v[20:23], v14 offset:37888
    s_waitcnt lgkmcnt(4)
    v_mfma_f32_16x16x32_bf16 v[44:47], a[52:55], v[28:31], v[44:47]
    v_mfma_f32_16x16x32_bf16 v[52:55], a[132:135], v[28:31], v[52:55]
    v_mfma_f32_16x16x32_bf16 v[60:63], a[212:215], v[28:31], v[60:63]
    ds_read_b128 v[24:27], v14 offset:38912
    s_waitcnt lgkmcnt(4)
    v_mfma_f32_16x16x32_bf16 v[44:47], a[56:59], v[32:35], v[44:47]
    v_mfma_f32_16x16x32_bf16 v[52:55], a[136:139], v[32:35], v[52:55]
    v_mfma_f32_16x16x32_bf16 v[60:63], a[216:219], v[32:35], v[60:63]
    ds_read_b128 v[28:31], v14 offset:39936
    s_waitcnt lgkmcnt(4)
    v_mfma_f32_16x16x32_bf16 v[44:47], a[60:63], v[36:39], v[44:47]
    v_mfma_f32_16x16x32_bf16 v[52:55], a[140:143], v[36:39], v[52:55]
    v_mfma_f32_16x16x32_bf16 v[60:63], a[220:223], v[36:39], v[60:63]
    s_waitcnt lgkmcnt(3)
    v_mfma_f32_16x16x32_bf16 v[44:47], a[64:67], v[16:19], v[44:47]
    v_mfma_f32_16x16x32_bf16 v[52:55], a[144:147], v[16:19], v[52:55]
    v_mfma_f32_16x16x32_bf16 v[60:63], a[224:227], v[16:19], v[60:63]
    s_waitcnt lgkmcnt(2)
    v_mfma_f32_16x16x32_bf16 v[44:47], a[68:71], v[20:23], v[44:47]
    v_mfma_f32_16x16x32_bf16 v[52:55], a[148:151], v[20:23], v[52:55]
    v_mfma_f32_16x16x32_bf16 v[60:63], a[228:231], v[20:23], v[60:63]
    s_waitcnt lgkmcnt(1)
    v_mfma_f32_16x16x32_bf16 v[44:47], a[72:75], v[24:27], v[44:47]
    v_mfma_f32_16x16x32_bf16 v[52:55], a[152:155], v[24:27], v[52:55]
    v_mfma_f32_16x16x32_bf16 v[60:63], a[232:235], v[24:27], v[60:63]
    s_waitcnt lgkmcnt(0)
    v_mfma_f32_16x16x32_bf16 v[44:47], a[76:79], v[28:31], v[44:47]
    v_mfma_f32_16x16x32_bf16 v[52:55], a[156:159], v[28:31], v[52:55]
    v_mfma_f32_16x16x32_bf16 v[60:63], a[236:239], v[28:31], v[60:63]
    v_cvt_pk_bf16_f32 v64, v40, v41
    v_cvt_pk_bf16_f32 v65, v42, v43
    s_add_u32 s69, s75, 0
    buffer_store_dwordx2 v[64:65], v12, s[4:7], s69 offen sc1
    s_nop 1
    v_cvt_pk_bf16_f32 v66, v44, v45
    v_cvt_pk_bf16_f32 v67, v46, v47
    s_add_u32 s69, s75, 6144
    buffer_store_dwordx2 v[66:67], v12, s[4:7], s69 offen sc1
    v_cvt_pk_bf16_f32 v68, v48, v49
    v_cvt_pk_bf16_f32 v69, v50, v51
    s_add_u32 s69, s75, 2048
    buffer_store_dwordx2 v[68:69], v12, s[4:7], s69 offen sc1
    v_cvt_pk_bf16_f32 v70, v52, v53
    v_cvt_pk_bf16_f32 v71, v54, v55
    s_add_u32 s69, s75, 8192
    buffer_store_dwordx2 v[70:71], v12, s[4:7], s69 offen sc1
    v_cvt_pk_bf16_f32 v72, v56, v57
    v_cvt_pk_bf16_f32 v73, v58, v59
    s_add_u32 s69, s75, 4096
    buffer_store_dwordx2 v[72:73], v12, s[4:7], s69 offen sc1
    v_cvt_pk_bf16_f32 v74, v60, v61
    v_cvt_pk_bf16_f32 v75, v62, v63
    s_add_u32 s69, s75, 10240
    buffer_store_dwordx2 v[74:75], v12, s[4:7], s69 offen sc1
    s_add_u32 s75, s75, 12288
    s_mov_b32 s31, s77
    s_waitcnt vmcnt(0)
    v_mov_b32 v15, s31
    s_mov_b64 exec, 1
    buffer_store_dword v15, v13, s[4:7], 0 offen sc1
    s_mov_b64 exec, -1
    s_cmp_lt_u32 s31, 64
    s_cbranch_scc1 kvloop_175
    s_branch EXIT
ROLE_VS:
    s_mov_b32 s12, s40
    s_mov_b32 s13, s41
    s_mov_b32 s14, 7864320
    s_mov_b32 s15, 0x20000
    s_sub_u32 s73, s29, 16
    s_lshl_b32 s74, s28, 2
    s_add_u32 s74, s74, s73
    v_lshrrev_b32 v2, 3, v0
    v_and_b32 v3, 7, v0
    v_lshrrev_b32 v4, 4, v0
    v_and_b32 v4, 1, v4
    v_lshlrev_b32 v4, 1, v4
    s_and_b32 s69, s30, 1
    s_lshl_b32 s69, s69, 2
    v_or_b32 v4, s69, v4
    v_xor_b32 v3, v3, v4
    v_lshlrev_b32 v3, 4, v3
    s_mov_b32 s69, 12288
    v_mad_u32_u24 v12, v2, s69, v3
    v_lshrrev_b32 v2, 4, v0
    v_bfe_u32 v3, v0, 2, 2
    v_and_b32 v4, 3, v0
    v_lshrrev_b32 v5, 1, v3
    v_and_b32 v6, 1, v2
    v_lshl_or_b32 v5, v6, 1, v5
    v_lshlrev_b32 v5, 1, v5
    v_lshl_add_u32 v6, v2, 3, v3
    s_lshl_b32 s69, s30, 1
    v_lshrrev_b32 v7, 1, v4
    v_or_b32 v7, s69, v7
    v_xor_b32 v7, v7, v5
    v_lshlrev_b32 v7, 4, v7
    v_and_b32 v4, 1, v4
    v_lshl_or_b32 v7, v4, 3, v7
    v_lshl_add_u32 v14, v6, 7, v7
    s_mul_i32 s71, s74, 384
    s_add_u32 s71, s71, 0
    s_mul_i32 s69, s30, 98304
    s_add_u32 s69, s69, s71
    s_lshl_b32 s70, s30, 10
    s_add_u32 m0, s70, 0
    s_nop 0
    buffer_load_dwordx4 v12, s[12:15], s69 offen lds
    s_add_u32 m0, m0, 4096
    s_add_u32 s69, s69, 393216
    buffer_load_dwordx4 v12, s[12:15], s69 offen lds
    s_add_u32 m0, m0, 4096
    s_add_u32 s69, s69, 393216
    buffer_load_dwordx4 v12, s[12:15], s69 offen lds
    s_add_u32 m0, m0, 4096
    s_add_u32 s69, s69, 393216
    buffer_load_dwordx4 v12, s[12:15], s69 offen lds
    s_add_u32 m0, m0, 4096
    s_add_u32 s69, s69, 393216
    buffer_load_dwordx4 v12, s[12:15], s69 offen lds
    s_add_u32 m0, m0, 4096
    s_add_u32 s69, s69, 393216
    buffer_load_dwordx4 v12, s[12:15], s69 offen lds
    s_add_u32 m0, m0, 4096
    s_add_u32 s69, s69, 393216
    buffer_load_dwordx4 v12, s[12:15], s69 offen lds
    s_add_u32 m0, m0, 4096
    s_add_u32 s69, s69, 393216
    buffer_load_dwordx4 v12, s[12:15], s69 offen lds
    s_add_u32 m0, m0, 4096
    s_add_u32 s69, s69, 393216
    buffer_load_dwordx4 v12, s[12:15], s69 offen lds
    s_add_u32 m0, m0, 4096
    s_add_u32 s69, s69, 393216
    buffer_load_dwordx4 v12, s[12:15], s69 offen lds
    s_add_u32 m0, m0, 4096
    s_add_u32 s69, s69, 393216
    buffer_load_dwordx4 v12, s[12:15], s69 offen lds
    s_add_u32 m0, m0, 4096
    s_add_u32 s69, s69, 393216
    buffer_load_dwordx4 v12, s[12:15], s69 offen lds
    s_add_u32 m0, m0, 4096
    s_add_u32 s69, s69, 393216
    buffer_load_dwordx4 v12, s[12:15], s69 offen lds
    s_add_u32 m0, m0, 4096
    s_add_u32 s69, s69, 393216
    buffer_load_dwordx4 v12, s[12:15], s69 offen lds
    s_add_u32 m0, m0, 4096
    s_add_u32 s69, s69, 393216
    buffer_load_dwordx4 v12, s[12:15], s69 offen lds
    s_add_u32 m0, m0, 4096
    s_add_u32 s69, s69, 393216
    buffer_load_dwordx4 v12, s[12:15], s69 offen lds
    s_add_u32 m0, m0, 4096
    s_add_u32 s69, s69, 393216
    buffer_load_dwordx4 v12, s[12:15], s69 offen lds
    s_add_u32 m0, m0, 4096
    s_add_u32 s69, s69, 393216
    buffer_load_dwordx4 v12, s[12:15], s69 offen lds
    s_add_u32 m0, m0, 4096
    s_add_u32 s69, s69, 393216
    buffer_load_dwordx4 v12, s[12:15], s69 offen lds
    s_add_u32 m0, m0, 4096
    s_add_u32 s69, s69, 393216
    buffer_load_dwordx4 v12, s[12:15], s69 offen lds
    s_mul_i32 s71, s74, 384
    s_add_u32 s71, s71, 128
    s_mul_i32 s69, s30, 98304
    s_add_u32 s69, s69, s71
    s_lshl_b32 s70, s30, 10
    s_add_u32 m0, s70, 81920
    s_nop 0
    buffer_load_dwordx4 v12, s[12:15], s69 offen lds
    s_add_u32 m0, m0, 4096
    s_add_u32 s69, s69, 393216
    buffer_load_dwordx4 v12, s[12:15], s69 offen lds
    s_add_u32 m0, m0, 4096
    s_add_u32 s69, s69, 393216
    buffer_load_dwordx4 v12, s[12:15], s69 offen lds
    s_add_u32 m0, m0, 4096
    s_add_u32 s69, s69, 393216
    buffer_load_dwordx4 v12, s[12:15], s69 offen lds
    s_add_u32 m0, m0, 4096
    s_add_u32 s69, s69, 393216
    buffer_load_dwordx4 v12, s[12:15], s69 offen lds
    s_add_u32 m0, m0, 4096
    s_add_u32 s69, s69, 393216
    buffer_load_dwordx4 v12, s[12:15], s69 offen lds
    s_add_u32 m0, m0, 4096
    s_add_u32 s69, s69, 393216
    buffer_load_dwordx4 v12, s[12:15], s69 offen lds
    s_add_u32 m0, m0, 4096
    s_add_u32 s69, s69, 393216
    buffer_load_dwordx4 v12, s[12:15], s69 offen lds
    s_add_u32 m0, m0, 4096
    s_add_u32 s69, s69, 393216
    buffer_load_dwordx4 v12, s[12:15], s69 offen lds
    s_add_u32 m0, m0, 4096
    s_add_u32 s69, s69, 393216
    buffer_load_dwordx4 v12, s[12:15], s69 offen lds
    s_add_u32 m0, m0, 4096
    s_add_u32 s69, s69, 393216
    buffer_load_dwordx4 v12, s[12:15], s69 offen lds
    s_add_u32 m0, m0, 4096
    s_add_u32 s69, s69, 393216
    buffer_load_dwordx4 v12, s[12:15], s69 offen lds
    s_add_u32 m0, m0, 4096
    s_add_u32 s69, s69, 393216
    buffer_load_dwordx4 v12, s[12:15], s69 offen lds
    s_add_u32 m0, m0, 4096
    s_add_u32 s69, s69, 393216
    buffer_load_dwordx4 v12, s[12:15], s69 offen lds
    s_add_u32 m0, m0, 4096
    s_add_u32 s69, s69, 393216
    buffer_load_dwordx4 v12, s[12:15], s69 offen lds
    s_add_u32 m0, m0, 4096
    s_add_u32 s69, s69, 393216
    buffer_load_dwordx4 v12, s[12:15], s69 offen lds
    s_add_u32 m0, m0, 4096
    s_add_u32 s69, s69, 393216
    buffer_load_dwordx4 v12, s[12:15], s69 offen lds
    s_add_u32 m0, m0, 4096
    s_add_u32 s69, s69, 393216
    buffer_load_dwordx4 v12, s[12:15], s69 offen lds
    s_add_u32 m0, m0, 4096
    s_add_u32 s69, s69, 393216
    buffer_load_dwordx4 v12, s[12:15], s69 offen lds
    s_add_u32 m0, m0, 4096
    s_add_u32 s69, s69, 393216
    buffer_load_dwordx4 v12, s[12:15], s69 offen lds
    s_waitcnt vmcnt(20)
    s_barrier
    v_add_u32 v9, 0, v14
    ds_read_b64_tr_b16 a[0:1], v9 offset:0
    ds_read_b64_tr_b16 a[2:3], v9 offset:512
    ds_read_b64_tr_b16 a[4:5], v9 offset:4096
    ds_read_b64_tr_b16 a[6:7], v9 offset:4608
    ds_read_b64_tr_b16 a[8:9], v9 offset:8192
    ds_read_b64_tr_b16 a[10:11], v9 offset:8704
    ds_read_b64_tr_b16 a[12:13], v9 offset:12288
    ds_read_b64_tr_b16 a[14:15], v9 offset:12800
    ds_read_b64_tr_b16 a[16:17], v9 offset:16384
    ds_read_b64_tr_b16 a[18:19], v9 offset:16896
    ds_read_b64_tr_b16 a[20:21], v9 offset:20480
    ds_read_b64_tr_b16 a[22:23], v9 offset:20992
    s_waitcnt lgkmcnt(0)
    ds_read_b64_tr_b16 a[24:25], v9 offset:24576
    ds_read_b64_tr_b16 a[26:27], v9 offset:25088
    ds_read_b64_tr_b16 a[28:29], v9 offset:28672
    ds_read_b64_tr_b16 a[30:31], v9 offset:29184
    ds_read_b64_tr_b16 a[32:33], v9 offset:32768
    ds_read_b64_tr_b16 a[34:35], v9 offset:33280
    ds_read_b64_tr_b16 a[36:37], v9 offset:36864
    ds_read_b64_tr_b16 a[38:39], v9 offset:37376
    s_waitcnt lgkmcnt(0)
    v_add_u32 v9, 40960, v14
    ds_read_b64_tr_b16 a[40:41], v9 offset:0
    ds_read_b64_tr_b16 a[42:43], v9 offset:512
    ds_read_b64_tr_b16 a[44:45], v9 offset:4096
    ds_read_b64_tr_b16 a[46:47], v9 offset:4608
    ds_read_b64_tr_b16 a[48:49], v9 offset:8192
    ds_read_b64_tr_b16 a[50:51], v9 offset:8704
    ds_read_b64_tr_b16 a[52:53], v9 offset:12288
    ds_read_b64_tr_b16 a[54:55], v9 offset:12800
    ds_read_b64_tr_b16 a[56:57], v9 offset:16384
    ds_read_b64_tr_b16 a[58:59], v9 offset:16896
    ds_read_b64_tr_b16 a[60:61], v9 offset:20480
    ds_read_b64_tr_b16 a[62:63], v9 offset:20992
    s_waitcnt lgkmcnt(0)
    ds_read_b64_tr_b16 a[64:65], v9 offset:24576
    ds_read_b64_tr_b16 a[66:67], v9 offset:25088
    ds_read_b64_tr_b16 a[68:69], v9 offset:28672
    ds_read_b64_tr_b16 a[70:71], v9 offset:29184
    ds_read_b64_tr_b16 a[72:73], v9 offset:32768
    ds_read_b64_tr_b16 a[74:75], v9 offset:33280
    ds_read_b64_tr_b16 a[76:77], v9 offset:36864
    ds_read_b64_tr_b16 a[78:79], v9 offset:37376
    s_waitcnt lgkmcnt(0)
    s_barrier
    s_mul_i32 s71, s74, 384
    s_add_u32 s71, s71, 256
    s_mul_i32 s69, s30, 98304
    s_add_u32 s69, s69, s71
    s_lshl_b32 s70, s30, 10
    s_add_u32 m0, s70, 0
    s_nop 0
    buffer_load_dwordx4 v12, s[12:15], s69 offen lds
    s_add_u32 m0, m0, 4096
    s_add_u32 s69, s69, 393216
    buffer_load_dwordx4 v12, s[12:15], s69 offen lds
    s_add_u32 m0, m0, 4096
    s_add_u32 s69, s69, 393216
    buffer_load_dwordx4 v12, s[12:15], s69 offen lds
    s_add_u32 m0, m0, 4096
    s_add_u32 s69, s69, 393216
    buffer_load_dwordx4 v12, s[12:15], s69 offen lds
    s_add_u32 m0, m0, 4096
    s_add_u32 s69, s69, 393216
    buffer_load_dwordx4 v12, s[12:15], s69 offen lds
    s_add_u32 m0, m0, 4096
    s_add_u32 s69, s69, 393216
    buffer_load_dwordx4 v12, s[12:15], s69 offen lds
    s_add_u32 m0, m0, 4096
    s_add_u32 s69, s69, 393216
    buffer_load_dwordx4 v12, s[12:15], s69 offen lds
    s_add_u32 m0, m0, 4096
    s_add_u32 s69, s69, 393216
    buffer_load_dwordx4 v12, s[12:15], s69 offen lds
    s_add_u32 m0, m0, 4096
    s_add_u32 s69, s69, 393216
    buffer_load_dwordx4 v12, s[12:15], s69 offen lds
    s_add_u32 m0, m0, 4096
    s_add_u32 s69, s69, 393216
    buffer_load_dwordx4 v12, s[12:15], s69 offen lds
    s_add_u32 m0, m0, 4096
    s_add_u32 s69, s69, 393216
    buffer_load_dwordx4 v12, s[12:15], s69 offen lds
    s_add_u32 m0, m0, 4096
    s_add_u32 s69, s69, 393216
    buffer_load_dwordx4 v12, s[12:15], s69 offen lds
    s_add_u32 m0, m0, 4096
    s_add_u32 s69, s69, 393216
    buffer_load_dwordx4 v12, s[12:15], s69 offen lds
    s_add_u32 m0, m0, 4096
    s_add_u32 s69, s69, 393216
    buffer_load_dwordx4 v12, s[12:15], s69 offen lds
    s_add_u32 m0, m0, 4096
    s_add_u32 s69, s69, 393216
    buffer_load_dwordx4 v12, s[12:15], s69 offen lds
    s_add_u32 m0, m0, 4096
    s_add_u32 s69, s69, 393216
    buffer_load_dwordx4 v12, s[12:15], s69 offen lds
    s_add_u32 m0, m0, 4096
    s_add_u32 s69, s69, 393216
    buffer_load_dwordx4 v12, s[12:15], s69 offen lds
    s_add_u32 m0, m0, 4096
    s_add_u32 s69, s69, 393216
    buffer_load_dwordx4 v12, s[12:15], s69 offen lds
    s_add_u32 m0, m0, 4096
    s_add_u32 s69, s69, 393216
    buffer_load_dwordx4 v12, s[12:15], s69 offen lds
    s_add_u32 m0, m0, 4096
    s_add_u32 s69, s69, 393216
    buffer_load_dwordx4 v12, s[12:15], s69 offen lds
    s_waitcnt vmcnt(20)
    s_barrier
    v_add_u32 v9, 81920, v14
    ds_read_b64_tr_b16 a[80:81], v9 offset:0
    ds_read_b64_tr_b16 a[82:83], v9 offset:512
    ds_read_b64_tr_b16 a[84:85], v9 offset:4096
    ds_read_b64_tr_b16 a[86:87], v9 offset:4608
    ds_read_b64_tr_b16 a[88:89], v9 offset:8192
    ds_read_b64_tr_b16 a[90:91], v9 offset:8704
    ds_read_b64_tr_b16 a[92:93], v9 offset:12288
    ds_read_b64_tr_b16 a[94:95], v9 offset:12800
    ds_read_b64_tr_b16 a[96:97], v9 offset:16384
    ds_read_b64_tr_b16 a[98:99], v9 offset:16896
    ds_read_b64_tr_b16 a[100:101], v9 offset:20480
    ds_read_b64_tr_b16 a[102:103], v9 offset:20992
    s_waitcnt lgkmcnt(0)
    ds_read_b64_tr_b16 a[104:105], v9 offset:24576
    ds_read_b64_tr_b16 a[106:107], v9 offset:25088
    ds_read_b64_tr_b16 a[108:109], v9 offset:28672
    ds_read_b64_tr_b16 a[110:111], v9 offset:29184
    ds_read_b64_tr_b16 a[112:113], v9 offset:32768
    ds_read_b64_tr_b16 a[114:115], v9 offset:33280
    ds_read_b64_tr_b16 a[116:117], v9 offset:36864
    ds_read_b64_tr_b16 a[118:119], v9 offset:37376
    s_waitcnt lgkmcnt(0)
    v_add_u32 v9, 122880, v14
    ds_read_b64_tr_b16 a[120:121], v9 offset:0
    ds_read_b64_tr_b16 a[122:123], v9 offset:512
    ds_read_b64_tr_b16 a[124:125], v9 offset:4096
    ds_read_b64_tr_b16 a[126:127], v9 offset:4608
    ds_read_b64_tr_b16 a[128:129], v9 offset:8192
    ds_read_b64_tr_b16 a[130:131], v9 offset:8704
    ds_read_b64_tr_b16 a[132:133], v9 offset:12288
    ds_read_b64_tr_b16 a[134:135], v9 offset:12800
    ds_read_b64_tr_b16 a[136:137], v9 offset:16384
    ds_read_b64_tr_b16 a[138:139], v9 offset:16896
    ds_read_b64_tr_b16 a[140:141], v9 offset:20480
    ds_read_b64_tr_b16 a[142:143], v9 offset:20992
    s_waitcnt lgkmcnt(0)
    ds_read_b64_tr_b16 a[144:145], v9 offset:24576
    ds_read_b64_tr_b16 a[146:147], v9 offset:25088
    ds_read_b64_tr_b16 a[148:149], v9 offset:28672
    ds_read_b64_tr_b16 a[150:151], v9 offset:29184
    ds_read_b64_tr_b16 a[152:153], v9 offset:32768
    ds_read_b64_tr_b16 a[154:155], v9 offset:33280
    ds_read_b64_tr_b16 a[156:157], v9 offset:36864
    ds_read_b64_tr_b16 a[158:159], v9 offset:37376
    s_waitcnt lgkmcnt(0)
    s_barrier
    s_waitcnt vmcnt(0)
    s_barrier
    v_add_u32 v9, 0, v14
    ds_read_b64_tr_b16 a[160:161], v9 offset:0
    ds_read_b64_tr_b16 a[162:163], v9 offset:512
    ds_read_b64_tr_b16 a[164:165], v9 offset:4096
    ds_read_b64_tr_b16 a[166:167], v9 offset:4608
    ds_read_b64_tr_b16 a[168:169], v9 offset:8192
    ds_read_b64_tr_b16 a[170:171], v9 offset:8704
    ds_read_b64_tr_b16 a[172:173], v9 offset:12288
    ds_read_b64_tr_b16 a[174:175], v9 offset:12800
    ds_read_b64_tr_b16 a[176:177], v9 offset:16384
    ds_read_b64_tr_b16 a[178:179], v9 offset:16896
    ds_read_b64_tr_b16 a[180:181], v9 offset:20480
    ds_read_b64_tr_b16 a[182:183], v9 offset:20992
    s_waitcnt lgkmcnt(0)
    ds_read_b64_tr_b16 a[184:185], v9 offset:24576
    ds_read_b64_tr_b16 a[186:187], v9 offset:25088
    ds_read_b64_tr_b16 a[188:189], v9 offset:28672
    ds_read_b64_tr_b16 a[190:191], v9 offset:29184
    ds_read_b64_tr_b16 a[192:193], v9 offset:32768
    ds_read_b64_tr_b16 a[194:195], v9 offset:33280
    ds_read_b64_tr_b16 a[196:197], v9 offset:36864
    ds_read_b64_tr_b16 a[198:199], v9 offset:37376
    s_waitcnt lgkmcnt(0)
    v_add_u32 v9, 40960, v14
    ds_read_b64_tr_b16 a[200:201], v9 offset:0
    ds_read_b64_tr_b16 a[202:203], v9 offset:512
    ds_read_b64_tr_b16 a[204:205], v9 offset:4096
    ds_read_b64_tr_b16 a[206:207], v9 offset:4608
    ds_read_b64_tr_b16 a[208:209], v9 offset:8192
    ds_read_b64_tr_b16 a[210:211], v9 offset:8704
    ds_read_b64_tr_b16 a[212:213], v9 offset:12288
    ds_read_b64_tr_b16 a[214:215], v9 offset:12800
    ds_read_b64_tr_b16 a[216:217], v9 offset:16384
    ds_read_b64_tr_b16 a[218:219], v9 offset:16896
    ds_read_b64_tr_b16 a[220:221], v9 offset:20480
    ds_read_b64_tr_b16 a[222:223], v9 offset:20992
    s_waitcnt lgkmcnt(0)
    ds_read_b64_tr_b16 a[224:225], v9 offset:24576
    ds_read_b64_tr_b16 a[226:227], v9 offset:25088
    ds_read_b64_tr_b16 a[228:229], v9 offset:28672
    ds_read_b64_tr_b16 a[230:231], v9 offset:29184
    ds_read_b64_tr_b16 a[232:233], v9 offset:32768
    ds_read_b64_tr_b16 a[234:235], v9 offset:33280
    ds_read_b64_tr_b16 a[236:237], v9 offset:36864
    ds_read_b64_tr_b16 a[238:239], v9 offset:37376
    s_waitcnt lgkmcnt(0)
    s_barrier
    v_mov_b32 v2, 128
wa_176:
    buffer_load_dword v3, v2, s[64:67], 0 offen sc1
    s_waitcnt vmcnt(0)
    v_cmp_ne_u32 vcc, 0x100, v3
    s_cbranch_vccz wad_177
    s_sub_u32 s68, s68, 1
    s_cbranch_scc0 ok_178
    s_mov_b32 s69, 1
    s_branch FAIL
ok_178:
    s_sleep 4
    s_branch wa_176
wad_177:
    v_and_b32 v2, 15, v0
    v_lshrrev_b32 v3, 4, v0
    s_and_b32 s69, s30, 1
    s_lshl_b32 s69, s69, 4
    v_add_u32 v2, s69, v2
    s_mov_b32 s69, 1280
    v_mul_u32_u24 v2, s69, v2
    s_lshr_b32 s69, s30, 1
    s_mul_i32 s69, s69, 640
    v_lshl_add_u32 v2, v3, 4, v2
    v_add_u32 v10, s69, v2
    v_lshlrev_b32 v11, 4, v0
    s_lshl_b32 s69, s30, 10
    v_add_u32 v12, s69, v11
    s_lshl_b32 s69, s74, 7
    s_lshl_b32 s70, s30, 2
    s_add_u32 s69, s69, s70
    s_add_u32 s69, s69, 2097168
    v_mov_b32 v13, s69
    s_mul_i32 s75, s74, 786432
    s_add_u32 s75, s75, 29360128
    s_mov_b32 s31, 0
    s_mov_b32 s76, 0
    s_mul_i32 s69, s31, 40960
    s_and_b32 s70, s30, 1
    s_mul_i32 s70, s70, 20
    s_lshr_b32 s71, s30, 1
    s_mul_i32 s71, s71, 10
    s_add_u32 s70, s70, s71
    s_lshl_b32 s70, s70, 10
    s_add_u32 m0, s70, s76
    s_nop 0
    buffer_load_dwordx4 v10, s[8:11], s69 offen offset:0 lds
    s_add_u32 m0, m0, 960
    s_nop 0
    buffer_load_dwordx4 v10, s[8:11], s69 offen offset:64 lds
    s_add_u32 m0, m0, 960
    s_nop 0
    buffer_load_dwordx4 v10, s[8:11], s69 offen offset:128 lds
    s_add_u32 m0, m0, 960
    s_nop 0
    buffer_load_dwordx4 v10, s[8:11], s69 offen offset:192 lds
    s_add_u32 m0, m0, 960
    s_nop 0
    buffer_load_dwordx4 v10, s[8:11], s69 offen offset:256 lds
    s_add_u32 m0, m0, 960
    s_nop 0
    buffer_load_dwordx4 v10, s[8:11], s69 offen offset:320 lds
    s_add_u32 m0, m0, 960
    s_nop 0
    buffer_load_dwordx4 v10, s[8:11], s69 offen offset:384 lds
    s_add_u32 m0, m0, 960
    s_nop 0
    buffer_load_dwordx4 v10, s[8:11], s69 offen offset:448 lds
    s_add_u32 m0, m0, 960
    s_nop 0
    buffer_load_dwordx4 v10, s[8:11], s69 offen offset:512 lds
    s_add_u32 m0, m0, 960
    s_nop 0
    buffer_load_dwordx4 v10, s[8:11], s69 offen offset:576 lds
    s_waitcnt vmcnt(0)
kvloop_179:
    s_barrier
    v_add_u32 v14, s76, v11
    s_xor_b32 s76, s76, 40960
    s_add_u32 s77, s31, 1
    s_mul_i32 s78, s77, 40960
    s_and_b32 s70, s30, 1
    s_mul_i32 s70, s70, 20
    s_lshr_b32 s71, s30, 1
    s_mul_i32 s71, s71, 10
    s_add_u32 s70, s70, s71
    s_lshl_b32 s70, s70, 10
    s_add_u32 m0, s70, s76
    ds_read_b128 v[16:19], v14 offset:0
    ds_read_b128 v[20:23], v14 offset:1024
    ds_read_b128 v[24:27], v14 offset:2048
    ds_read_b128 v[28:31], v14 offset:3072
    ds_read_b128 v[32:35], v14 offset:4096
    s_waitcnt lgkmcnt(4)
    v_mfma_f32_16x16x32_bf16 v[40:43], v[16:19], a[0:3], 0
    v_mfma_f32_16x16x32_bf16 v[48:51], v[16:19], a[80:83], 0
    v_mfma_f32_16x16x32_bf16 v[56:59], v[16:19], a[160:163], 0
    buffer_load_dwordx4 v10, s[8:11], s78 offen offset:0 lds
    s_add_u32 m0, m0, 960
    ds_read_b128 v[36:39], v14 offset:5120
    s_waitcnt lgkmcnt(4)
    v_mfma_f32_16x16x32_bf16 v[40:43], v[20:23], a[4:7], v[40:43]
    v_mfma_f32_16x16x32_bf16 v[48:51], v[20:23], a[84:87], v[48:51]
    v_mfma_f32_16x16x32_bf16 v[56:59], v[20:23], a[164:167], v[56:59]
    ds_read_b128 v[16:19], v14 offset:6144
    s_waitcnt lgkmcnt(4)
    v_mfma_f32_16x16x32_bf16 v[40:43], v[24:27], a[8:11], v[40:43]
    v_mfma_f32_16x16x32_bf16 v[48:51], v[24:27], a[88:91], v[48:51]
    v_mfma_f32_16x16x32_bf16 v[56:59], v[24:27], a[168:171], v[56:59]
    ds_read_b128 v[20:23], v14 offset:7168
    s_waitcnt lgkmcnt(4)
    v_mfma_f32_16x16x32_bf16 v[40:43], v[28:31], a[12:15], v[40:43]
    v_mfma_f32_16x16x32_bf16 v[48:51], v[28:31], a[92:95], v[48:51]
    v_mfma_f32_16x16x32_bf16 v[56:59], v[28:31], a[172:175], v[56:59]
    buffer_load_dwordx4 v10, s[8:11], s78 offen offset:64 lds
    s_add_u32 m0, m0, 960
    ds_read_b128 v[24:27], v14 offset:8192
    s_waitcnt lgkmcnt(4)
    v_mfma_f32_16x16x32_bf16 v[40:43], v[32:35], a[16:19], v[40:43]
    v_mfma_f32_16x16x32_bf16 v[48:51], v[32:35], a[96:99], v[48:51]
    v_mfma_f32_16x16x32_bf16 v[56:59], v[32:35], a[176:179], v[56:59]
    ds_read_b128 v[28:31], v14 offset:9216
    s_waitcnt lgkmcnt(4)
    v_mfma_f32_16x16x32_bf16 v[40:43], v[36:39], a[20:23], v[40:43]
    v_mfma_f32_16x16x32_bf16 v[48:51], v[36:39], a[100:103], v[48:51]
    v_mfma_f32_16x16x32_bf16 v[56:59], v[36:39], a[180:183], v[56:59]
    ds_read_b128 v[32:35], v14 offset:10240
    s_waitcnt lgkmcnt(4)
    v_mfma_f32_16x16x32_bf16 v[40:43], v[16:19], a[24:27], v[40:43]
    v_mfma_f32_16x16x32_bf16 v[48:51], v[16:19], a[104:107], v[48:51]
    v_mfma_f32_16x16x32_bf16 v[56:59], v[16:19], a[184:187], v[56:59]
    buffer_load_dwordx4 v10, s[8:11], s78 offen offset:128 lds
    s_add_u32 m0, m0, 960
    ds_read_b128 v[36:39], v14 offset:11264
    s_waitcnt lgkmcnt(4)
    v_mfma_f32_16x16x32_bf16 v[40:43], v[20:23], a[28:31], v[40:43]
    v_mfma_f32_16x16x32_bf16 v[48:51], v[20:23], a[108:111], v[48:51]
    v_mfma_f32_16x16x32_bf16 v[56:59], v[20:23], a[188:191], v[56:59]
    ds_read_b128 v[16:19], v14 offset:12288
    s_waitcnt lgkmcnt(4)
    v_mfma_f32_16x16x32_bf16 v[40:43], v[24:27], a[32:35], v[40:43]
    v_mfma_f32_16x16x32_bf16 v[48:51], v[24:27], a[112:115], v[48:51]
    v_mfma_f32_16x16x32_bf16 v[56:59], v[24:27], a[192:195], v[56:59]
    ds_read_b128 v[20:23], v14 offset:13312
    s_waitcnt lgkmcnt(4)
    v_mfma_f32_16x16x32_bf16 v[40:43], v[28:31], a[36:39], v[40:43]
    v_mfma_f32_16x16x32_bf16 v[48:51], v[28:31], a[116:119], v[48:51]
    v_mfma_f32_16x16x32_bf16 v[56:59], v[28:31], a[196:199], v[56:59]
    buffer_load_dwordx4 v10, s[8:11], s78 offen offset:192 lds
    s_add_u32 m0, m0, 960
    ds_read_b128 v[24:27], v14 offset:14336
    s_waitcnt lgkmcnt(4)
    v_mfma_f32_16x16x32_bf16 v[40:43], v[32:35], a[40:43], v[40:43]
    v_mfma_f32_16x16x32_bf16 v[48:51], v[32:35], a[120:123], v[48:51]
    v_mfma_f32_16x16x32_bf16 v[56:59], v[32:35], a[200:203], v[56:59]
    ds_read_b128 v[28:31], v14 offset:15360
    s_waitcnt lgkmcnt(4)
    v_mfma_f32_16x16x32_bf16 v[40:43], v[36:39], a[44:47], v[40:43]
    v_mfma_f32_16x16x32_bf16 v[48:51], v[36:39], a[124:127], v[48:51]
    v_mfma_f32_16x16x32_bf16 v[56:59], v[36:39], a[204:207], v[56:59]
    ds_read_b128 v[32:35], v14 offset:16384
    s_waitcnt lgkmcnt(4)
    v_mfma_f32_16x16x32_bf16 v[40:43], v[16:19], a[48:51], v[40:43]
    v_mfma_f32_16x16x32_bf16 v[48:51], v[16:19], a[128:131], v[48:51]
    v_mfma_f32_16x16x32_bf16 v[56:59], v[16:19], a[208:211], v[56:59]
    buffer_load_dwordx4 v10, s[8:11], s78 offen offset:256 lds
    s_add_u32 m0, m0, 960
    ds_read_b128 v[36:39], v14 offset:17408
    s_waitcnt lgkmcnt(4)
    v_mfma_f32_16x16x32_bf16 v[40:43], v[20:23], a[52:55], v[40:43]
    v_mfma_f32_16x16x32_bf16 v[48:51], v[20:23], a[132:135], v[48:51]
    v_mfma_f32_16x16x32_bf16 v[56:59], v[20:23], a[212:215], v[56:59]
    ds_read_b128 v[16:19], v14 offset:18432
    s_waitcnt lgkmcnt(4)
    v_mfma_f32_16x16x32_bf16 v[40:43], v[24:27], a[56:59], v[40:43]
    v_mfma_f32_16x16x32_bf16 v[48:51], v[24:27], a[136:139], v[48:51]
    v_mfma_f32_16x16x32_bf16 v[56:59], v[24:27], a[216:219], v[56:59]
    ds_read_b128 v[20:23], v14 offset:19456
    s_waitcnt lgkmcnt(4)
    v_mfma_f32_16x16x32_bf16 v[40:43], v[28:31], a[60:63], v[40:43]
    v_mfma_f32_16x16x32_bf16 v[48:51], v[28:31], a[140:143], v[48:51]
    v_mfma_f32_16x16x32_bf16 v[56:59], v[28:31], a[220:223], v[56:59]
    buffer_load_dwordx4 v10, s[8:11], s78 offen offset:320 lds
    s_add_u32 m0, m0, 960
    ds_read_b128 v[24:27], v14 offset:20480
    s_waitcnt lgkmcnt(4)
    v_mfma_f32_16x16x32_bf16 v[40:43], v[32:35], a[64:67], v[40:43]
    v_mfma_f32_16x16x32_bf16 v[48:51], v[32:35], a[144:147], v[48:51]
    v_mfma_f32_16x16x32_bf16 v[56:59], v[32:35], a[224:227], v[56:59]
    ds_read_b128 v[28:31], v14 offset:21504
    s_waitcnt lgkmcnt(4)
    v_mfma_f32_16x16x32_bf16 v[40:43], v[36:39], a[68:71], v[40:43]
    v_mfma_f32_16x16x32_bf16 v[48:51], v[36:39], a[148:151], v[48:51]
    v_mfma_f32_16x16x32_bf16 v[56:59], v[36:39], a[228:231], v[56:59]
    ds_read_b128 v[32:35], v14 offset:22528
    s_waitcnt lgkmcnt(4)
    v_mfma_f32_16x16x32_bf16 v[40:43], v[16:19], a[72:75], v[40:43]
    v_mfma_f32_16x16x32_bf16 v[48:51], v[16:19], a[152:155], v[48:51]
    v_mfma_f32_16x16x32_bf16 v[56:59], v[16:19], a[232:235], v[56:59]
    buffer_load_dwordx4 v10, s[8:11], s78 offen offset:384 lds
    s_add_u32 m0, m0, 960
    ds_read_b128 v[36:39], v14 offset:23552
    s_waitcnt lgkmcnt(4)
    v_mfma_f32_16x16x32_bf16 v[40:43], v[20:23], a[76:79], v[40:43]
    v_mfma_f32_16x16x32_bf16 v[48:51], v[20:23], a[156:159], v[48:51]
    v_mfma_f32_16x16x32_bf16 v[56:59], v[20:23], a[236:239], v[56:59]
    ds_read_b128 v[16:19], v14 offset:24576
    s_waitcnt lgkmcnt(4)
    v_mfma_f32_16x16x32_bf16 v[44:47], v[24:27], a[0:3], 0
    v_mfma_f32_16x16x32_bf16 v[52:55], v[24:27], a[80:83], 0
    v_mfma_f32_16x16x32_bf16 v[60:63], v[24:27], a[160:163], 0
    ds_read_b128 v[20:23], v14 offset:25600
    s_waitcnt lgkmcnt(4)
    v_mfma_f32_16x16x32_bf16 v[44:47], v[28:31], a[4:7], v[44:47]
    v_mfma_f32_16x16x32_bf16 v[52:55], v[28:31], a[84:87], v[52:55]
    v_mfma_f32_16x16x32_bf16 v[60:63], v[28:31], a[164:167], v[60:63]
    buffer_load_dwordx4 v10, s[8:11], s78 offen offset:448 lds
    s_add_u32 m0, m0, 960
    ds_read_b128 v[24:27], v14 offset:26624
    s_waitcnt lgkmcnt(4)
    v_mfma_f32_16x16x32_bf16 v[44:47], v[32:35], a[8:11], v[44:47]
    v_mfma_f32_16x16x32_bf16 v[52:55], v[32:35], a[88:91], v[52:55]
    v_mfma_f32_16x16x32_bf16 v[60:63], v[32:35], a[168:171], v[60:63]
    ds_read_b128 v[28:31], v14 offset:27648
    s_waitcnt lgkmcnt(4)
    v_mfma_f32_16x16x32_bf16 v[44:47], v[36:39], a[12:15], v[44:47]
    v_mfma_f32_16x16x32_bf16 v[52:55], v[36:39], a[92:95], v[52:55]
    v_mfma_f32_16x16x32_bf16 v[60:63], v[36:39], a[172:175], v[60:63]
    ds_read_b128 v[32:35], v14 offset:28672
    s_waitcnt lgkmcnt(4)
    v_mfma_f32_16x16x32_bf16 v[44:47], v[16:19], a[16:19], v[44:47]
    v_mfma_f32_16x16x32_bf16 v[52:55], v[16:19], a[96:99], v[52:55]
    v_mfma_f32_16x16x32_bf16 v[60:63], v[16:19], a[176:179], v[60:63]
    buffer_load_dwordx4 v10, s[8:11], s78 offen offset:512 lds
    s_add_u32 m0, m0, 960
    ds_read_b128 v[36:39], v14 offset:29696
    s_waitcnt lgkmcnt(4)
    v_mfma_f32_16x16x32_bf16 v[44:47], v[20:23], a[20:23], v[44:47]
    v_mfma_f32_16x16x32_bf16 v[52:55], v[20:23], a[100:103], v[52:55]
    v_mfma_f32_16x16x32_bf16 v[60:63], v[20:23], a[180:183], v[60:63]
    ds_read_b128 v[16:19], v14 offset:30720
    s_waitcnt lgkmcnt(4)
    v_mfma_f32_16x16x32_bf16 v[44:47], v[24:27], a[24:27], v[44:47]
    v_mfma_f32_16x16x32_bf16 v[52:55], v[24:27], a[104:107], v[52:55]
    v_mfma_f32_16x16x32_bf16 v[60:63], v[24:27], a[184:187], v[60:63]
    ds_read_b128 v[20:23], v14 offset:31744
    s_waitcnt lgkmcnt(4)
    v_mfma_f32_16x16x32_bf16 v[44:47], v[28:31], a[28:31], v[44:47]
    v_mfma_f32_16x16x32_bf16 v[52:55], v[28:31], a[108:111], v[52:55]
    v_mfma_f32_16x16x32_bf16 v[60:63], v[28:31], a[188:191], v[60:63]
    buffer_load_dwordx4 v10, s[8:11], s78 offen offset:576 lds
    s_add_u32 m0, m0, 960
    ds_read_b128 v[24:27], v14 offset:32768
    s_waitcnt lgkmcnt(4)
    v_mfma_f32_16x16x32_bf16 v[44:47], v[32:35], a[32:35], v[44:47]
    v_mfma_f32_16x16x32_bf16 v[52:55], v[32:35], a[112:115], v[52:55]
    v_mfma_f32_16x16x32_bf16 v[60:63], v[32:35], a[192:195], v[60:63]
    ds_read_b128 v[28:31], v14 offset:33792
    s_waitcnt lgkmcnt(4)
    v_mfma_f32_16x16x32_bf16 v[44:47], v[36:39], a[36:39], v[44:47]
    v_mfma_f32_16x16x32_bf16 v[52:55], v[36:39], a[116:119], v[52:55]
    v_mfma_f32_16x16x32_bf16 v[60:63], v[36:39], a[196:199], v[60:63]
    ds_read_b128 v[32:35], v14 offset:34816
    s_waitcnt lgkmcnt(4)
    v_mfma_f32_16x16x32_bf16 v[44:47], v[16:19], a[40:43], v[44:47]
    v_mfma_f32_16x16x32_bf16 v[52:55], v[16:19], a[120:123], v[52:55]
    v_mfma_f32_16x16x32_bf16 v[60:63], v[16:19], a[200:203], v[60:63]
    ds_read_b128 v[36:39], v14 offset:35840
    s_waitcnt lgkmcnt(4)
    v_mfma_f32_16x16x32_bf16 v[44:47], v[20:23], a[44:47], v[44:47]
    v_mfma_f32_16x16x32_bf16 v[52:55], v[20:23], a[124:127], v[52:55]
    v_mfma_f32_16x16x32_bf16 v[60:63], v[20:23], a[204:207], v[60:63]
    ds_read_b128 v[16:19], v14 offset:36864
    s_waitcnt lgkmcnt(4)
    v_mfma_f32_16x16x32_bf16 v[44:47], v[24:27], a[48:51], v[44:47]
    v_mfma_f32_16x16x32_bf16 v[52:55], v[24:27], a[128:131], v[52:55]
    v_mfma_f32_16x16x32_bf16 v[60:63], v[24:27], a[208:211], v[60:63]
    ds_read_b128 v[20:23], v14 offset:37888
    s_waitcnt lgkmcnt(4)
    v_mfma_f32_16x16x32_bf16 v[44:47], v[28:31], a[52:55], v[44:47]
    v_mfma_f32_16x16x32_bf16 v[52:55], v[28:31], a[132:135], v[52:55]
    v_mfma_f32_16x16x32_bf16 v[60:63], v[28:31], a[212:215], v[60:63]
    ds_read_b128 v[24:27], v14 offset:38912
    s_waitcnt lgkmcnt(4)
    v_mfma_f32_16x16x32_bf16 v[44:47], v[32:35], a[56:59], v[44:47]
    v_mfma_f32_16x16x32_bf16 v[52:55], v[32:35], a[136:139], v[52:55]
    v_mfma_f32_16x16x32_bf16 v[60:63], v[32:35], a[216:219], v[60:63]
    ds_read_b128 v[28:31], v14 offset:39936
    s_waitcnt lgkmcnt(4)
    v_mfma_f32_16x16x32_bf16 v[44:47], v[36:39], a[60:63], v[44:47]
    v_mfma_f32_16x16x32_bf16 v[52:55], v[36:39], a[140:143], v[52:55]
    v_mfma_f32_16x16x32_bf16 v[60:63], v[36:39], a[220:223], v[60:63]
    s_waitcnt lgkmcnt(3)
    v_mfma_f32_16x16x32_bf16 v[44:47], v[16:19], a[64:67], v[44:47]
    v_mfma_f32_16x16x32_bf16 v[52:55], v[16:19], a[144:147], v[52:55]
    v_mfma_f32_16x16x32_bf16 v[60:63], v[16:19], a[224:227], v[60:63]
    s_waitcnt lgkmcnt(2)
    v_mfma_f32_16x16x32_bf16 v[44:47], v[20:23], a[68:71], v[44:47]
    v_mfma_f32_16x16x32_bf16 v[52:55], v[20:23], a[148:151], v[52:55]
    v_mfma_f32_16x16x32_bf16 v[60:63], v[20:23], a[228:231], v[60:63]
    s_waitcnt lgkmcnt(1)
    v_mfma_f32_16x16x32_bf16 v[44:47], v[24:27], a[72:75], v[44:47]
    v_mfma_f32_16x16x32_bf16 v[52:55], v[24:27], a[152:155], v[52:55]
    v_mfma_f32_16x16x32_bf16 v[60:63], v[24:27], a[232:235], v[60:63]
    s_waitcnt lgkmcnt(0)
    v_mfma_f32_16x16x32_bf16 v[44:47], v[28:31], a[76:79], v[44:47]
    v_mfma_f32_16x16x32_bf16 v[52:55], v[28:31], a[156:159], v[52:55]
    v_mfma_f32_16x16x32_bf16 v[60:63], v[28:31], a[236:239], v[60:63]
    v_cvt_pk_bf16_f32 v64, v40, v41
    v_cvt_pk_bf16_f32 v65, v42, v43
    s_nop 3
    v_cvt_pk_bf16_f32 v66, v44, v45
    v_cvt_pk_bf16_f32 v67, v46, v47
    s_add_u32 s69, s75, 0
    buffer_store_dwordx4 v[64:67], v12, s[4:7], s69 offen sc1
    v_cvt_pk_bf16_f32 v68, v48, v49
    v_cvt_pk_bf16_f32 v69, v50, v51
    v_cvt_pk_bf16_f32 v70, v52, v53
    v_cvt_pk_bf16_f32 v71, v54, v55
    s_add_u32 s69, s75, 4096
    buffer_store_dwordx4 v[68:71], v12, s[4:7], s69 offen sc1
    v_cvt_pk_bf16_f32 v72, v56, v57
    v_cvt_pk_bf16_f32 v73, v58, v59
    v_cvt_pk_bf16_f32 v74, v60, v61
    v_cvt_pk_bf16_f32 v75, v62, v63
    s_add_u32 s69, s75, 8192
    buffer_store_dwordx4 v[72:75], v12, s[4:7], s69 offen sc1
    s_add_u32 s75, s75, 12288
    s_mov_b32 s31, s77
    s_waitcnt vmcnt(0)
    v_mov_b32 v15, s31
    s_mov_b64 exec, 1
    buffer_store_dword v15, v13, s[4:7], 0 offen sc1
    s_mov_b64 exec, -1
    s_cmp_lt_u32 s31, 64
    s_cbranch_scc1 kvloop_179
    s_branch EXIT
ROLE_QS:
    s_mov_b32 s12, s36
    s_mov_b32 s13, s37
    s_mov_b32 s14, 7864320
    s_mov_b32 s15, 0x20000
    s_sub_u32 s73, s29, 20
    s_lshl_b32 s74, s28, 2
    s_add_u32 s74, s74, s73
    v_lshrrev_b32 v2, 3, v0
    v_and_b32 v3, 7, v0
    v_lshrrev_b32 v4, 4, v0
    v_and_b32 v4, 1, v4
    v_lshlrev_b32 v4, 1, v4
    s_and_b32 s69, s30, 1
    s_lshl_b32 s69, s69, 2
    v_or_b32 v4, s69, v4
    v_xor_b32 v3, v3, v4
    v_lshlrev_b32 v3, 4, v3
    s_mov_b32 s69, 12288
    v_mad_u32_u24 v12, v2, s69, v3
    v_lshrrev_b32 v2, 4, v0
    v_bfe_u32 v3, v0, 2, 2
    v_and_b32 v4, 3, v0
    v_lshrrev_b32 v5, 1, v3
    v_and_b32 v6, 1, v2
    v_lshl_or_b32 v5, v6, 1, v5
    v_lshlrev_b32 v5, 1, v5
    v_lshl_add_u32 v6, v2, 3, v3
    s_lshl_b32 s69, s30, 1
    v_lshrrev_b32 v7, 1, v4
    v_or_b32 v7, s69, v7
    v_xor_b32 v7, v7, v5
    v_lshlrev_b32 v7, 4, v7
    v_and_b32 v4, 1, v4
    v_lshl_or_b32 v7, v4, 3, v7
    v_lshl_add_u32 v14, v6, 7, v7
    s_mul_i32 s71, s74, 384
    s_add_u32 s71, s71, 0
    s_mul_i32 s69, s30, 98304
    s_add_u32 s69, s69, s71
    s_lshl_b32 s70, s30, 10
    s_add_u32 m0, s70, 0
    s_nop 0
    buffer_load_dwordx4 v12, s[12:15], s69 offen lds
    s_add_u32 m0, m0, 4096
    s_add_u32 s69, s69, 393216
    buffer_load_dwordx4 v12, s[12:15], s69 offen lds
    s_add_u32 m0, m0, 4096
    s_add_u32 s69, s69, 393216
    buffer_load_dwordx4 v12, s[12:15], s69 offen lds
    s_add_u32 m0, m0, 4096
    s_add_u32 s69, s69, 393216
    buffer_load_dwordx4 v12, s[12:15], s69 offen lds
    s_add_u32 m0, m0, 4096
    s_add_u32 s69, s69, 393216
    buffer_load_dwordx4 v12, s[12:15], s69 offen lds
    s_add_u32 m0, m0, 4096
    s_add_u32 s69, s69, 393216
    buffer_load_dwordx4 v12, s[12:15], s69 offen lds
    s_add_u32 m0, m0, 4096
    s_add_u32 s69, s69, 393216
    buffer_load_dwordx4 v12, s[12:15], s69 offen lds
    s_add_u32 m0, m0, 4096
    s_add_u32 s69, s69, 393216
    buffer_load_dwordx4 v12, s[12:15], s69 offen lds
    s_add_u32 m0, m0, 4096
    s_add_u32 s69, s69, 393216
    buffer_load_dwordx4 v12, s[12:15], s69 offen lds
    s_add_u32 m0, m0, 4096
    s_add_u32 s69, s69, 393216
    buffer_load_dwordx4 v12, s[12:15], s69 offen lds
    s_add_u32 m0, m0, 4096
    s_add_u32 s69, s69, 393216
    buffer_load_dwordx4 v12, s[12:15], s69 offen lds
    s_add_u32 m0, m0, 4096
    s_add_u32 s69, s69, 393216
    buffer_load_dwordx4 v12, s[12:15], s69 offen lds
    s_add_u32 m0, m0, 4096
    s_add_u32 s69, s69, 393216
    buffer_load_dwordx4 v12, s[12:15], s69 offen lds
    s_add_u32 m0, m0, 4096
    s_add_u32 s69, s69, 393216
    buffer_load_dwordx4 v12, s[12:15], s69 offen lds
    s_add_u32 m0, m0, 4096
    s_add_u32 s69, s69, 393216
    buffer_load_dwordx4 v12, s[12:15], s69 offen lds
    s_add_u32 m0, m0, 4096
    s_add_u32 s69, s69, 393216
    buffer_load_dwordx4 v12, s[12:15], s69 offen lds
    s_add_u32 m0, m0, 4096
    s_add_u32 s69, s69, 393216
    buffer_load_dwordx4 v12, s[12:15], s69 offen lds
    s_add_u32 m0, m0, 4096
    s_add_u32 s69, s69, 393216
    buffer_load_dwordx4 v12, s[12:15], s69 offen lds
    s_add_u32 m0, m0, 4096
    s_add_u32 s69, s69, 393216
    buffer_load_dwordx4 v12, s[12:15], s69 offen lds
    s_add_u32 m0, m0, 4096
    s_add_u32 s69, s69, 393216
    buffer_load_dwordx4 v12, s[12:15], s69 offen lds
    s_mul_i32 s71, s74, 384
    s_add_u32 s71, s71, 128
    s_mul_i32 s69, s30, 98304
    s_add_u32 s69, s69, s71
    s_lshl_b32 s70, s30, 10
    s_add_u32 m0, s70, 81920
    s_nop 0
    buffer_load_dwordx4 v12, s[12:15], s69 offen lds
    s_add_u32 m0, m0, 4096
    s_add_u32 s69, s69, 393216
    buffer_load_dwordx4 v12, s[12:15], s69 offen lds
    s_add_u32 m0, m0, 4096
    s_add_u32 s69, s69, 393216
    buffer_load_dwordx4 v12, s[12:15], s69 offen lds
    s_add_u32 m0, m0, 4096
    s_add_u32 s69, s69, 393216
    buffer_load_dwordx4 v12, s[12:15], s69 offen lds
    s_add_u32 m0, m0, 4096
    s_add_u32 s69, s69, 393216
    buffer_load_dwordx4 v12, s[12:15], s69 offen lds
    s_add_u32 m0, m0, 4096
    s_add_u32 s69, s69, 393216
    buffer_load_dwordx4 v12, s[12:15], s69 offen lds
    s_add_u32 m0, m0, 4096
    s_add_u32 s69, s69, 393216
    buffer_load_dwordx4 v12, s[12:15], s69 offen lds
    s_add_u32 m0, m0, 4096
    s_add_u32 s69, s69, 393216
    buffer_load_dwordx4 v12, s[12:15], s69 offen lds
    s_add_u32 m0, m0, 4096
    s_add_u32 s69, s69, 393216
    buffer_load_dwordx4 v12, s[12:15], s69 offen lds
    s_add_u32 m0, m0, 4096
    s_add_u32 s69, s69, 393216
    buffer_load_dwordx4 v12, s[12:15], s69 offen lds
    s_add_u32 m0, m0, 4096
    s_add_u32 s69, s69, 393216
    buffer_load_dwordx4 v12, s[12:15], s69 offen lds
    s_add_u32 m0, m0, 4096
    s_add_u32 s69, s69, 393216
    buffer_load_dwordx4 v12, s[12:15], s69 offen lds
    s_add_u32 m0, m0, 4096
    s_add_u32 s69, s69, 393216
    buffer_load_dwordx4 v12, s[12:15], s69 offen lds
    s_add_u32 m0, m0, 4096
    s_add_u32 s69, s69, 393216
    buffer_load_dwordx4 v12, s[12:15], s69 offen lds
    s_add_u32 m0, m0, 4096
    s_add_u32 s69, s69, 393216
    buffer_load_dwordx4 v12, s[12:15], s69 offen lds
    s_add_u32 m0, m0, 4096
    s_add_u32 s69, s69, 393216
    buffer_load_dwordx4 v12, s[12:15], s69 offen lds
    s_add_u32 m0, m0, 4096
    s_add_u32 s69, s69, 393216
    buffer_load_dwordx4 v12, s[12:15], s69 offen lds
    s_add_u32 m0, m0, 4096
    s_add_u32 s69, s69, 393216
    buffer_load_dwordx4 v12, s[12:15], s69 offen lds
    s_add_u32 m0, m0, 4096
    s_add_u32 s69, s69, 393216
    buffer_load_dwordx4 v12, s[12:15], s69 offen lds
    s_add_u32 m0, m0, 4096
    s_add_u32 s69, s69, 393216
    buffer_load_dwordx4 v12, s[12:15], s69 offen lds
    s_waitcnt vmcnt(20)
    s_barrier
    v_add_u32 v9, 0, v14
    ds_read_b64_tr_b16 a[0:1], v9 offset:0
    ds_read_b64_tr_b16 a[2:3], v9 offset:512
    ds_read_b64_tr_b16 a[4:5], v9 offset:4096
    ds_read_b64_tr_b16 a[6:7], v9 offset:4608
    ds_read_b64_tr_b16 a[8:9], v9 offset:8192
    ds_read_b64_tr_b16 a[10:11], v9 offset:8704
    ds_read_b64_tr_b16 a[12:13], v9 offset:12288
    ds_read_b64_tr_b16 a[14:15], v9 offset:12800
    ds_read_b64_tr_b16 a[16:17], v9 offset:16384
    ds_read_b64_tr_b16 a[18:19], v9 offset:16896
    ds_read_b64_tr_b16 a[20:21], v9 offset:20480
    ds_read_b64_tr_b16 a[22:23], v9 offset:20992
    s_waitcnt lgkmcnt(0)
    ds_read_b64_tr_b16 a[24:25], v9 offset:24576
    ds_read_b64_tr_b16 a[26:27], v9 offset:25088
    ds_read_b64_tr_b16 a[28:29], v9 offset:28672
    ds_read_b64_tr_b16 a[30:31], v9 offset:29184
    ds_read_b64_tr_b16 a[32:33], v9 offset:32768
    ds_read_b64_tr_b16 a[34:35], v9 offset:33280
    ds_read_b64_tr_b16 a[36:37], v9 offset:36864
    ds_read_b64_tr_b16 a[38:39], v9 offset:37376
    s_waitcnt lgkmcnt(0)
    v_add_u32 v9, 40960, v14
    ds_read_b64_tr_b16 a[40:41], v9 offset:0
    ds_read_b64_tr_b16 a[42:43], v9 offset:512
    ds_read_b64_tr_b16 a[44:45], v9 offset:4096
    ds_read_b64_tr_b16 a[46:47], v9 offset:4608
    ds_read_b64_tr_b16 a[48:49], v9 offset:8192
    ds_read_b64_tr_b16 a[50:51], v9 offset:8704
    ds_read_b64_tr_b16 a[52:53], v9 offset:12288
    ds_read_b64_tr_b16 a[54:55], v9 offset:12800
    ds_read_b64_tr_b16 a[56:57], v9 offset:16384
    ds_read_b64_tr_b16 a[58:59], v9 offset:16896
    ds_read_b64_tr_b16 a[60:61], v9 offset:20480
    ds_read_b64_tr_b16 a[62:63], v9 offset:20992
    s_waitcnt lgkmcnt(0)
    ds_read_b64_tr_b16 a[64:65], v9 offset:24576
    ds_read_b64_tr_b16 a[66:67], v9 offset:25088
    ds_read_b64_tr_b16 a[68:69], v9 offset:28672
    ds_read_b64_tr_b16 a[70:71], v9 offset:29184
    ds_read_b64_tr_b16 a[72:73], v9 offset:32768
    ds_read_b64_tr_b16 a[74:75], v9 offset:33280
    ds_read_b64_tr_b16 a[76:77], v9 offset:36864
    ds_read_b64_tr_b16 a[78:79], v9 offset:37376
    s_waitcnt lgkmcnt(0)
    s_barrier
    s_mul_i32 s71, s74, 384
    s_add_u32 s71, s71, 256
    s_mul_i32 s69, s30, 98304
    s_add_u32 s69, s69, s71
    s_lshl_b32 s70, s30, 10
    s_add_u32 m0, s70, 0
    s_nop 0
    buffer_load_dwordx4 v12, s[12:15], s69 offen lds
    s_add_u32 m0, m0, 4096
    s_add_u32 s69, s69, 393216
    buffer_load_dwordx4 v12, s[12:15], s69 offen lds
    s_add_u32 m0, m0, 4096
    s_add_u32 s69, s69, 393216
    buffer_load_dwordx4 v12, s[12:15], s69 offen lds
    s_add_u32 m0, m0, 4096
    s_add_u32 s69, s69, 393216
    buffer_load_dwordx4 v12, s[12:15], s69 offen lds
    s_add_u32 m0, m0, 4096
    s_add_u32 s69, s69, 393216
    buffer_load_dwordx4 v12, s[12:15], s69 offen lds
    s_add_u32 m0, m0, 4096
    s_add_u32 s69, s69, 393216
    buffer_load_dwordx4 v12, s[12:15], s69 offen lds
    s_add_u32 m0, m0, 4096
    s_add_u32 s69, s69, 393216
    buffer_load_dwordx4 v12, s[12:15], s69 offen lds
    s_add_u32 m0, m0, 4096
    s_add_u32 s69, s69, 393216
    buffer_load_dwordx4 v12, s[12:15], s69 offen lds
    s_add_u32 m0, m0, 4096
    s_add_u32 s69, s69, 393216
    buffer_load_dwordx4 v12, s[12:15], s69 offen lds
    s_add_u32 m0, m0, 4096
    s_add_u32 s69, s69, 393216
    buffer_load_dwordx4 v12, s[12:15], s69 offen lds
    s_add_u32 m0, m0, 4096
    s_add_u32 s69, s69, 393216
    buffer_load_dwordx4 v12, s[12:15], s69 offen lds
    s_add_u32 m0, m0, 4096
    s_add_u32 s69, s69, 393216
    buffer_load_dwordx4 v12, s[12:15], s69 offen lds
    s_add_u32 m0, m0, 4096
    s_add_u32 s69, s69, 393216
    buffer_load_dwordx4 v12, s[12:15], s69 offen lds
    s_add_u32 m0, m0, 4096
    s_add_u32 s69, s69, 393216
    buffer_load_dwordx4 v12, s[12:15], s69 offen lds
    s_add_u32 m0, m0, 4096
    s_add_u32 s69, s69, 393216
    buffer_load_dwordx4 v12, s[12:15], s69 offen lds
    s_add_u32 m0, m0, 4096
    s_add_u32 s69, s69, 393216
    buffer_load_dwordx4 v12, s[12:15], s69 offen lds
    s_add_u32 m0, m0, 4096
    s_add_u32 s69, s69, 393216
    buffer_load_dwordx4 v12, s[12:15], s69 offen lds
    s_add_u32 m0, m0, 4096
    s_add_u32 s69, s69, 393216
    buffer_load_dwordx4 v12, s[12:15], s69 offen lds
    s_add_u32 m0, m0, 4096
    s_add_u32 s69, s69, 393216
    buffer_load_dwordx4 v12, s[12:15], s69 offen lds
    s_add_u32 m0, m0, 4096
    s_add_u32 s69, s69, 393216
    buffer_load_dwordx4 v12, s[12:15], s69 offen lds
    s_waitcnt vmcnt(20)
    s_barrier
    v_add_u32 v9, 81920, v14
    ds_read_b64_tr_b16 a[80:81], v9 offset:0
    ds_read_b64_tr_b16 a[82:83], v9 offset:512
    ds_read_b64_tr_b16 a[84:85], v9 offset:4096
    ds_read_b64_tr_b16 a[86:87], v9 offset:4608
    ds_read_b64_tr_b16 a[88:89], v9 offset:8192
    ds_read_b64_tr_b16 a[90:91], v9 offset:8704
    ds_read_b64_tr_b16 a[92:93], v9 offset:12288
    ds_read_b64_tr_b16 a[94:95], v9 offset:12800
    ds_read_b64_tr_b16 a[96:97], v9 offset:16384
    ds_read_b64_tr_b16 a[98:99], v9 offset:16896
    ds_read_b64_tr_b16 a[100:101], v9 offset:20480
    ds_read_b64_tr_b16 a[102:103], v9 offset:20992
    s_waitcnt lgkmcnt(0)
    ds_read_b64_tr_b16 a[104:105], v9 offset:24576
    ds_read_b64_tr_b16 a[106:107], v9 offset:25088
    ds_read_b64_tr_b16 a[108:109], v9 offset:28672
    ds_read_b64_tr_b16 a[110:111], v9 offset:29184
    ds_read_b64_tr_b16 a[112:113], v9 offset:32768
    ds_read_b64_tr_b16 a[114:115], v9 offset:33280
    ds_read_b64_tr_b16 a[116:117], v9 offset:36864
    ds_read_b64_tr_b16 a[118:119], v9 offset:37376
    s_waitcnt lgkmcnt(0)
    v_add_u32 v9, 122880, v14
    ds_read_b64_tr_b16 a[120:121], v9 offset:0
    ds_read_b64_tr_b16 a[122:123], v9 offset:512
    ds_read_b64_tr_b16 a[124:125], v9 offset:4096
    ds_read_b64_tr_b16 a[126:127], v9 offset:4608
    ds_read_b64_tr_b16 a[128:129], v9 offset:8192
    ds_read_b64_tr_b16 a[130:131], v9 offset:8704
    ds_read_b64_tr_b16 a[132:133], v9 offset:12288
    ds_read_b64_tr_b16 a[134:135], v9 offset:12800
    ds_read_b64_tr_b16 a[136:137], v9 offset:16384
    ds_read_b64_tr_b16 a[138:139], v9 offset:16896
    ds_read_b64_tr_b16 a[140:141], v9 offset:20480
    ds_read_b64_tr_b16 a[142:143], v9 offset:20992
    s_waitcnt lgkmcnt(0)
    ds_read_b64_tr_b16 a[144:145], v9 offset:24576
    ds_read_b64_tr_b16 a[146:147], v9 offset:25088
    ds_read_b64_tr_b16 a[148:149], v9 offset:28672
    ds_read_b64_tr_b16 a[150:151], v9 offset:29184
    ds_read_b64_tr_b16 a[152:153], v9 offset:32768
    ds_read_b64_tr_b16 a[154:155], v9 offset:33280
    ds_read_b64_tr_b16 a[156:157], v9 offset:36864
    ds_read_b64_tr_b16 a[158:159], v9 offset:37376
    s_waitcnt lgkmcnt(0)
    s_barrier
    s_waitcnt vmcnt(0)
    s_barrier
    v_add_u32 v9, 0, v14
    ds_read_b64_tr_b16 a[160:161], v9 offset:0
    ds_read_b64_tr_b16 a[162:163], v9 offset:512
    ds_read_b64_tr_b16 a[164:165], v9 offset:4096
    ds_read_b64_tr_b16 a[166:167], v9 offset:4608
    ds_read_b64_tr_b16 a[168:169], v9 offset:8192
    ds_read_b64_tr_b16 a[170:171], v9 offset:8704
    ds_read_b64_tr_b16 a[172:173], v9 offset:12288
    ds_read_b64_tr_b16 a[174:175], v9 offset:12800
    ds_read_b64_tr_b16 a[176:177], v9 offset:16384
    ds_read_b64_tr_b16 a[178:179], v9 offset:16896
    ds_read_b64_tr_b16 a[180:181], v9 offset:20480
    ds_read_b64_tr_b16 a[182:183], v9 offset:20992
    s_waitcnt lgkmcnt(0)
    ds_read_b64_tr_b16 a[184:185], v9 offset:24576
    ds_read_b64_tr_b16 a[186:187], v9 offset:25088
    ds_read_b64_tr_b16 a[188:189], v9 offset:28672
    ds_read_b64_tr_b16 a[190:191], v9 offset:29184
    ds_read_b64_tr_b16 a[192:193], v9 offset:32768
    ds_read_b64_tr_b16 a[194:195], v9 offset:33280
    ds_read_b64_tr_b16 a[196:197], v9 offset:36864
    ds_read_b64_tr_b16 a[198:199], v9 offset:37376
    s_waitcnt lgkmcnt(0)
    v_add_u32 v9, 40960, v14
    ds_read_b64_tr_b16 a[200:201], v9 offset:0
    ds_read_b64_tr_b16 a[202:203], v9 offset:512
    ds_read_b64_tr_b16 a[204:205], v9 offset:4096
    ds_read_b64_tr_b16 a[206:207], v9 offset:4608
    ds_read_b64_tr_b16 a[208:209], v9 offset:8192
    ds_read_b64_tr_b16 a[210:211], v9 offset:8704
    ds_read_b64_tr_b16 a[212:213], v9 offset:12288
    ds_read_b64_tr_b16 a[214:215], v9 offset:12800
    ds_read_b64_tr_b16 a[216:217], v9 offset:16384
    ds_read_b64_tr_b16 a[218:219], v9 offset:16896
    ds_read_b64_tr_b16 a[220:221], v9 offset:20480
    ds_read_b64_tr_b16 a[222:223], v9 offset:20992
    s_waitcnt lgkmcnt(0)
    ds_read_b64_tr_b16 a[224:225], v9 offset:24576
    ds_read_b64_tr_b16 a[226:227], v9 offset:25088
    ds_read_b64_tr_b16 a[228:229], v9 offset:28672
    ds_read_b64_tr_b16 a[230:231], v9 offset:29184
    ds_read_b64_tr_b16 a[232:233], v9 offset:32768
    ds_read_b64_tr_b16 a[234:235], v9 offset:33280
    ds_read_b64_tr_b16 a[236:237], v9 offset:36864
    ds_read_b64_tr_b16 a[238:239], v9 offset:37376
    s_waitcnt lgkmcnt(0)
    s_barrier
    v_mov_b32 v2, 128
wa_180:
    buffer_load_dword v3, v2, s[64:67], 0 offen sc1
    s_waitcnt vmcnt(0)
    v_cmp_ne_u32 vcc, 0x100, v3
    s_cbranch_vccz wad_181
    s_sub_u32 s68, s68, 1
    s_cbranch_scc0 ok_182
    s_mov_b32 s69, 1
    s_branch FAIL
ok_182:
    s_sleep 4
    s_branch wa_180
wad_181:
    v_and_b32 v2, 15, v0
    v_lshrrev_b32 v3, 4, v0
    s_and_b32 s69, s30, 1
    s_lshl_b32 s69, s69, 4
    v_add_u32 v2, s69, v2
    s_mov_b32 s69, 1280
    v_mul_u32_u24 v2, s69, v2
    s_lshr_b32 s69, s30, 1
    s_mul_i32 s69, s69, 640
    v_lshl_add_u32 v2, v3, 4, v2
    v_add_u32 v10, s69, v2
    v_lshlrev_b32 v11, 4, v0
    v_and_b32 v16, 15, v0
    v_lshrrev_b32 v17, 4, v0
    v_and_b32 v18, 7, v0
    s_lshr_b32 s69, s30, 1
    s_lshl_b32 s69, s69, 10
    s_and_b32 s70, s30, 1
    s_lshl_b32 s70, s70, 3
    s_add_u32 s69, s69, s70
    s_add_u32 s69, s69, 81920
    v_add_u32 v12, s69, v11
    s_and_b32 s69, s30, 1
    s_mul_i32 s69, s69, 6144
    s_add_u32 s69, s69, 81920
    v_add_u32 v9, s69, v11
    v_add_u32 v8, 94208, v11
    v_bfe_u32 v19, v0, 2, 2
    v_lshlrev_b32 v19, 4, v19
    v_lshl_add_u32 v19, v17, 6, v19
    v_and_b32 v78, 1, v0
    v_lshl_add_u32 v78, v78, 3, v19
    v_add_u32 v78, 118784, v78
    s_lshr_b32 s69, s30, 1
    s_mul_i32 s69, s69, 1536
    s_add_u32 s69, s69, 121856
    v_and_b32 v19, 1, v17
    v_lshlrev_b32 v19, 7, v19
    v_lshl_add_u32 v19, v16, 3, v19
    v_add_u32 v79, s69, v19
    v_mov_b32 v20, 0xff800000
    v_mov_b32 v21, 0
    v_cmp_le_u32 vcc, 2, v17
    s_nop 1
    v_cndmask_b32 v188, v21, v20, vcc
    v_cndmask_b32 v189, v21, v20, vcc
    v_cndmask_b32 v190, v21, v20, vcc
    v_cndmask_b32 v191, v21, v20, vcc
    s_and_b32 s69, s30, 1
    s_lshl_b32 s69, s69, 4
    v_add_u32 v22, s69, v16
    v_lshl_add_u32 v23, v17, 2, 0
    v_cmp_gt_u32 vcc, v23, v22
    s_nop 1
    v_cndmask_b32 v192, v21, v20, vcc
    v_lshl_add_u32 v23, v17, 2, 1
    v_cmp_gt_u32 vcc, v23, v22
    s_nop 1
    v_cndmask_b32 v193, v21, v20, vcc
    v_lshl_add_u32 v23, v17, 2, 2
    v_cmp_gt_u32 vcc, v23, v22
    s_nop 1
    v_cndmask_b32 v194, v21, v20, vcc
    v_lshl_add_u32 v23, v17, 2, 3
    v_cmp_gt_u32 vcc, v23, v22
    s_nop 1
    v_cndmask_b32 v195, v21, v20, vcc
    v_lshl_add_u32 v23, v17, 2, 16
    v_cmp_gt_u32 vcc, v23, v22
    s_nop 1
    v_cndmask_b32 v196, v21, v20, vcc
    v_lshl_add_u32 v23, v17, 2, 17
    v_cmp_gt_u32 vcc, v23, v22
    s_nop 1
    v_cndmask_b32 v197, v21, v20, vcc
    v_lshl_add_u32 v23, v17, 2, 18
    v_cmp_gt_u32 vcc, v23, v22
    s_nop 1
    v_cndmask_b32 v198, v21, v20, vcc
    v_lshl_add_u32 v23, v17, 2, 19
    v_cmp_gt_u32 vcc, v23, v22
    s_nop 1
    v_cndmask_b32 v199, v21, v20, vcc
    v_mov_b32 v246, 0
    v_mov_b32 v247, 0
    v_mov_b32 v224, 0
    v_mov_b32 v225, 0
    v_mov_b32 v226, 0
    v_mov_b32 v227, 0
    v_mov_b32 v228, 0
    v_mov_b32 v229, 0
    v_mov_b32 v230, 0
    v_mov_b32 v231, 0
    v_mov_b32 v232, 0
    v_mov_b32 v233, 0
    v_mov_b32 v234, 0
    v_mov_b32 v235, 0
    v_mov_b32 v236, 0
    v_mov_b32 v237, 0
    v_mov_b32 v238, 0
    v_mov_b32 v239, 0
    s_lshl_b32 s69, s74, 7
    s_add_u32 s69, s69, 2097152
    v_min_u32 v19, 19, v0
    v_lshlrev_b32 v19, 2, v19
    v_add_u32 v76, s69, v19
    s_lshl_b32 s69, s28, 7
    s_lshl_b32 s70, s73, 4
    s_add_u32 s69, s69, s70
    s_lshl_b32 s70, s30, 2
    s_add_u32 s69, s69, s70
    s_add_u32 s69, s69, 2101248
    v_mov_b32 v13, s69
    s_mul_i32 s71, s30, 3072
    s_mul_i32 s75, s74, 786432
    s_add_u32 s75, s75, 4194304
    s_add_u32 s75, s75, s71
    s_add_u32 s79, s75, 25165824
    s_mul_i32 s80, s74, 196608
    s_add_u32 s80, s80, 79691776
    s_add_u32 s81, s80, 6291456
    s_mul_i32 s82, s28, 3145728
    s_add_u32 s82, s82, 54525952
    s_and_b32 s69, s30, 1
    s_mul_i32 s69, s69, 24576
    s_add_u32 s82, s82, s69
    s_mul_i32 s69, s73, 6
    s_lshr_b32 s70, s30, 1
    s_mul_i32 s70, s70, 3
    s_add_u32 s69, s69, s70
    s_lshl_b32 s69, s69, 10
    s_add_u32 s82, s82, s69
    s_mov_b32 s84, 0x3dd53b95
    s_mov_b32 s31, 0
    s_mov_b32 s76, 0
    s_mul_i32 s69, s31, 40960
    s_and_b32 s70, s30, 1
    s_mul_i32 s70, s70, 20
    s_lshr_b32 s71, s30, 1
    s_mul_i32 s71, s71, 10
    s_add_u32 s70, s70, s71
    s_lshl_b32 s70, s70, 10
    s_add_u32 m0, s70, s76
    s_nop 0
    buffer_load_dwordx4 v10, s[8:11], s69 offen offset:0 lds
    s_add_u32 m0, m0, 960
    s_nop 0
    buffer_load_dwordx4 v10, s[8:11], s69 offen offset:64 lds
    s_add_u32 m0, m0, 960
    s_nop 0
    buffer_load_dwordx4 v10, s[8:11], s69 offen offset:128 lds
    s_add_u32 m0, m0, 960
    s_nop 0
    buffer_load_dwordx4 v10, s[8:11], s69 offen offset:192 lds
    s_add_u32 m0, m0, 960
    s_nop 0
    buffer_load_dwordx4 v10, s[8:11], s69 offen offset:256 lds
    s_add_u32 m0, m0, 960
    s_nop 0
    buffer_load_dwordx4 v10, s[8:11], s69 offen offset:320 lds
    s_add_u32 m0, m0, 960
    s_nop 0
    buffer_load_dwordx4 v10, s[8:11], s69 offen offset:384 lds
    s_add_u32 m0, m0, 960
    s_nop 0
    buffer_load_dwordx4 v10, s[8:11], s69 offen offset:448 lds
    s_add_u32 m0, m0, 960
    s_nop 0
    buffer_load_dwordx4 v10, s[8:11], s69 offen offset:512 lds
    s_add_u32 m0, m0, 960
    s_nop 0
    buffer_load_dwordx4 v10, s[8:11], s69 offen offset:576 lds
    buffer_load_dword v77, v76, s[4:7], 0 offen sc1
    s_waitcnt vmcnt(0)
qloop_183:
    s_barrier
    s_add_u32 s85, s31, 1
fw_184:
    v_cmp_gt_u32 vcc, s85, v77
    s_and_b32 s69, vcc_lo, 0xff
    s_cbranch_scc0 fwd_185
    s_sub_u32 s68, s68, 1
    s_cbranch_scc0 ok_186
    s_mov_b32 s69, 30
    s_branch FAIL
ok_186:
    buffer_load_dword v77, v76, s[4:7], 0 offen sc1
    s_waitcnt vmcnt(0)
    s_branch fw_184
fwd_185:
    s_mul_i32 s70, s30, 3072
    s_add_u32 m0, s70, 94208
    s_nop 0
    buffer_load_dwordx4 v11, s[4:7], s75 offen offset:0 sc1 lds
    buffer_load_dwordx4 v11, s[4:7], s75 offen offset:1024 sc1 lds
    buffer_load_dwordx4 v11, s[4:7], s75 offen offset:2048 sc1 lds
    s_add_u32 m0, s70, 106496
    s_nop 0
    buffer_load_dwordx4 v11, s[4:7], s79 offen offset:0 sc1 lds
    buffer_load_dwordx4 v11, s[4:7], s79 offen offset:1024 sc1 lds
    buffer_load_dwordx4 v11, s[4:7], s79 offen offset:2048 sc1 lds
    v_cmp_gt_u32 vcc, s85, v77
    s_and_b32 s83, vcc_lo, 0xfff00
    s_cbranch_scc1 qlate_187
    s_lshl_b32 s70, s30, 10
    s_cmp_eq_u32 s30, 3
    s_cbranch_scc1 md_188
    s_add_u32 m0, s70, 118784
    s_add_u32 s71, s80, s70
    buffer_load_dwordx4 v11, s[4:7], s71 offen sc1 lds
md_188:
    s_cmp_eq_u32 s30, 0
    s_cbranch_scc1 mdd_189
    s_sub_u32 s70, s70, 1024
    s_add_u32 m0, s70, 121856
    s_add_u32 s71, s81, s70
    buffer_load_dwordx4 v11, s[4:7], s71 offen sc1 lds
mdd_189:
qlate_187:
    v_add_u32 v14, s76, v11
    s_xor_b32 s76, s76, 40960
    s_add_u32 s77, s31, 1
    s_mul_i32 s78, s77, 40960
    s_and_b32 s70, s30, 1
    s_mul_i32 s70, s70, 20
    s_lshr_b32 s71, s30, 1
    s_mul_i32 s71, s71, 10
    s_add_u32 s70, s70, s71
    s_lshl_b32 s70, s70, 10
    s_add_u32 m0, s70, s76
    ds_read_b128 v[16:19], v14 offset:0
    ds_read_b128 v[20:23], v14 offset:1024
    ds_read_b128 v[24:27], v14 offset:2048
    ds_read_b128 v[28:31], v14 offset:3072
    ds_read_b128 v[32:35], v14 offset:4096
    s_waitcnt lgkmcnt(4)
    v_mfma_f32_16x16x32_bf16 v[40:43], a[0:3], v[16:19], 0
    v_mfma_f32_16x16x32_bf16 v[48:51], a[80:83], v[16:19], 0
    v_mfma_f32_16x16x32_bf16 v[56:59], a[160:163], v[16:19], 0
    buffer_load_dwordx4 v10, s[8:11], s78 offen offset:0 lds
    s_add_u32 m0, m0, 960
    ds_read_b128 v[36:39], v14 offset:5120
    s_waitcnt lgkmcnt(4)
    v_mfma_f32_16x16x32_bf16 v[40:43], a[4:7], v[20:23], v[40:43]
    v_mfma_f32_16x16x32_bf16 v[48:51], a[84:87], v[20:23], v[48:51]
    v_mfma_f32_16x16x32_bf16 v[56:59], a[164:167], v[20:23], v[56:59]
    ds_read_b128 v[16:19], v14 offset:6144
    s_waitcnt lgkmcnt(4)
    v_mfma_f32_16x16x32_bf16 v[40:43], a[8:11], v[24:27], v[40:43]
    v_mfma_f32_16x16x32_bf16 v[48:51], a[88:91], v[24:27], v[48:51]
    v_mfma_f32_16x16x32_bf16 v[56:59], a[168:171], v[24:27], v[56:59]
    ds_read_b128 v[20:23], v14 offset:7168
    s_waitcnt lgkmcnt(4)
    v_mfma_f32_16x16x32_bf16 v[40:43], a[12:15], v[28:31], v[40:43]
    v_mfma_f32_16x16x32_bf16 v[48:51], a[92:95], v[28:31], v[48:51]
    v_mfma_f32_16x16x32_bf16 v[56:59], a[172:175], v[28:31], v[56:59]
    buffer_load_dwordx4 v10, s[8:11], s78 offen offset:64 lds
    s_add_u32 m0, m0, 960
    ds_read_b128 v[24:27], v14 offset:8192
    s_waitcnt lgkmcnt(4)
    v_mfma_f32_16x16x32_bf16 v[40:43], a[16:19], v[32:35], v[40:43]
    v_mfma_f32_16x16x32_bf16 v[48:51], a[96:99], v[32:35], v[48:51]
    v_mfma_f32_16x16x32_bf16 v[56:59], a[176:179], v[32:35], v[56:59]
    ds_read_b128 v[28:31], v14 offset:9216
    s_waitcnt lgkmcnt(4)
    v_mfma_f32_16x16x32_bf16 v[40:43], a[20:23], v[36:39], v[40:43]
    v_mfma_f32_16x16x32_bf16 v[48:51], a[100:103], v[36:39], v[48:51]
    v_mfma_f32_16x16x32_bf16 v[56:59], a[180:183], v[36:39], v[56:59]
    ds_read_b128 v[32:35], v14 offset:10240
    s_waitcnt lgkmcnt(4)
    v_mfma_f32_16x16x32_bf16 v[40:43], a[24:27], v[16:19], v[40:43]
    v_mfma_f32_16x16x32_bf16 v[48:51], a[104:107], v[16:19], v[48:51]
    v_mfma_f32_16x16x32_bf16 v[56:59], a[184:187], v[16:19], v[56:59]
    buffer_load_dwordx4 v10, s[8:11], s78 offen offset:128 lds
    s_add_u32 m0, m0, 960
    ds_read_b128 v[36:39], v14 offset:11264
    s_waitcnt lgkmcnt(4)
    v_mfma_f32_16x16x32_bf16 v[40:43], a[28:31], v[20:23], v[40:43]
    v_mfma_f32_16x16x32_bf16 v[48:51], a[108:111], v[20:23], v[48:51]
    v_mfma_f32_16x16x32_bf16 v[56:59], a[188:191], v[20:23], v[56:59]
    ds_read_b128 v[16:19], v14 offset:12288
    s_waitcnt lgkmcnt(4)
    v_mfma_f32_16x16x32_bf16 v[40:43], a[32:35], v[24:27], v[40:43]
    v_mfma_f32_16x16x32_bf16 v[48:51], a[112:115], v[24:27], v[48:51]
    v_mfma_f32_16x16x32_bf16 v[56:59], a[192:195], v[24:27], v[56:59]
    ds_read_b128 v[20:23], v14 offset:13312
    s_waitcnt lgkmcnt(4)
    v_mfma_f32_16x16x32_bf16 v[40:43], a[36:39], v[28:31], v[40:43]
    v_mfma_f32_16x16x32_bf16 v[48:51], a[116:119], v[28:31], v[48:51]
    v_mfma_f32_16x16x32_bf16 v[56:59], a[196:199], v[28:31], v[56:59]
    buffer_load_dwordx4 v10, s[8:11], s78 offen offset:192 lds
    s_add_u32 m0, m0, 960
    ds_read_b128 v[24:27], v14 offset:14336
    s_waitcnt lgkmcnt(4)
    v_mfma_f32_16x16x32_bf16 v[40:43], a[40:43], v[32:35], v[40:43]
    v_mfma_f32_16x16x32_bf16 v[48:51], a[120:123], v[32:35], v[48:51]
    v_mfma_f32_16x16x32_bf16 v[56:59], a[200:203], v[32:35], v[56:59]
    ds_read_b128 v[28:31], v14 offset:15360
    s_waitcnt lgkmcnt(4)
    v_mfma_f32_16x16x32_bf16 v[40:43], a[44:47], v[36:39], v[40:43]
    v_mfma_f32_16x16x32_bf16 v[48:51], a[124:127], v[36:39], v[48:51]
    v_mfma_f32_16x16x32_bf16 v[56:59], a[204:207], v[36:39], v[56:59]
    ds_read_b128 v[32:35], v14 offset:16384
    s_waitcnt lgkmcnt(4)
    v_mfma_f32_16x16x32_bf16 v[40:43], a[48:51], v[16:19], v[40:43]
    v_mfma_f32_16x16x32_bf16 v[48:51], a[128:131], v[16:19], v[48:51]
    v_mfma_f32_16x16x32_bf16 v[56:59], a[208:211], v[16:19], v[56:59]
    buffer_load_dwordx4 v10, s[8:11], s78 offen offset:256 lds
    s_add_u32 m0, m0, 960
    ds_read_b128 v[36:39], v14 offset:17408
    s_waitcnt lgkmcnt(4)
    v_mfma_f32_16x16x32_bf16 v[40:43], a[52:55], v[20:23], v[40:43]
    v_mfma_f32_16x16x32_bf16 v[48:51], a[132:135], v[20:23], v[48:51]
    v_mfma_f32_16x16x32_bf16 v[56:59], a[212:215], v[20:23], v[56:59]
    ds_read_b128 v[16:19], v14 offset:18432
    s_waitcnt lgkmcnt(4)
    v_mfma_f32_16x16x32_bf16 v[40:43], a[56:59], v[24:27], v[40:43]
    v_mfma_f32_16x16x32_bf16 v[48:51], a[136:139], v[24:27], v[48:51]
    v_mfma_f32_16x16x32_bf16 v[56:59], a[216:219], v[24:27], v[56:59]
    ds_read_b128 v[20:23], v14 offset:19456
    s_waitcnt lgkmcnt(4)
    v_mfma_f32_16x16x32_bf16 v[40:43], a[60:63], v[28:31], v[40:43]
    v_mfma_f32_16x16x32_bf16 v[48:51], a[140:143], v[28:31], v[48:51]
    v_mfma_f32_16x16x32_bf16 v[56:59], a[220:223], v[28:31], v[56:59]
    buffer_load_dwordx4 v10, s[8:11], s78 offen offset:320 lds
    s_add_u32 m0, m0, 960
    ds_read_b128 v[24:27], v14 offset:20480
    s_waitcnt lgkmcnt(4)
    v_mfma_f32_16x16x32_bf16 v[40:43], a[64:67], v[32:35], v[40:43]
    v_mfma_f32_16x16x32_bf16 v[48:51], a[144:147], v[32:35], v[48:51]
    v_mfma_f32_16x16x32_bf16 v[56:59], a[224:227], v[32:35], v[56:59]
    ds_read_b128 v[28:31], v14 offset:21504
    s_waitcnt lgkmcnt(4)
    v_mfma_f32_16x16x32_bf16 v[40:43], a[68:71], v[36:39], v[40:43]
    v_mfma_f32_16x16x32_bf16 v[48:51], a[148:151], v[36:39], v[48:51]
    v_mfma_f32_16x16x32_bf16 v[56:59], a[228:231], v[36:39], v[56:59]
    ds_read_b128 v[32:35], v14 offset:22528
    s_waitcnt lgkmcnt(4)
    v_mfma_f32_16x16x32_bf16 v[40:43], a[72:75], v[16:19], v[40:43]
    v_mfma_f32_16x16x32_bf16 v[48:51], a[152:155], v[16:19], v[48:51]
    v_mfma_f32_16x16x32_bf16 v[56:59], a[232:235], v[16:19], v[56:59]
    buffer_load_dwordx4 v10, s[8:11], s78 offen offset:384 lds
    s_add_u32 m0, m0, 960
    ds_read_b128 v[36:39], v14 offset:23552
    s_waitcnt lgkmcnt(4)
    v_mfma_f32_16x16x32_bf16 v[40:43], a[76:79], v[20:23], v[40:43]
    v_mfma_f32_16x16x32_bf16 v[48:51], a[156:159], v[20:23], v[48:51]
    v_mfma_f32_16x16x32_bf16 v[56:59], a[236:239], v[20:23], v[56:59]
    ds_read_b128 v[16:19], v14 offset:24576
    s_waitcnt lgkmcnt(4)
    v_mfma_f32_16x16x32_bf16 v[44:47], a[0:3], v[24:27], 0
    v_mfma_f32_16x16x32_bf16 v[52:55], a[80:83], v[24:27], 0
    v_mfma_f32_16x16x32_bf16 v[60:63], a[160:163], v[24:27], 0
    ds_read_b128 v[20:23], v14 offset:25600
    s_waitcnt lgkmcnt(4)
    v_mfma_f32_16x16x32_bf16 v[44:47], a[4:7], v[28:31], v[44:47]
    v_mfma_f32_16x16x32_bf16 v[52:55], a[84:87], v[28:31], v[52:55]
    v_mfma_f32_16x16x32_bf16 v[60:63], a[164:167], v[28:31], v[60:63]
    buffer_load_dwordx4 v10, s[8:11], s78 offen offset:448 lds
    s_add_u32 m0, m0, 960
    ds_read_b128 v[24:27], v14 offset:26624
    s_waitcnt lgkmcnt(4)
    v_mfma_f32_16x16x32_bf16 v[44:47], a[8:11], v[32:35], v[44:47]
    v_mfma_f32_16x16x32_bf16 v[52:55], a[88:91], v[32:35], v[52:55]
    v_mfma_f32_16x16x32_bf16 v[60:63], a[168:171], v[32:35], v[60:63]
    ds_read_b128 v[28:31], v14 offset:27648
    s_waitcnt lgkmcnt(4)
    v_mfma_f32_16x16x32_bf16 v[44:47], a[12:15], v[36:39], v[44:47]
    v_mfma_f32_16x16x32_bf16 v[52:55], a[92:95], v[36:39], v[52:55]
    v_mfma_f32_16x16x32_bf16 v[60:63], a[172:175], v[36:39], v[60:63]
    ds_read_b128 v[32:35], v14 offset:28672
    s_waitcnt lgkmcnt(4)
    v_mfma_f32_16x16x32_bf16 v[44:47], a[16:19], v[16:19], v[44:47]
    v_mfma_f32_16x16x32_bf16 v[52:55], a[96:99], v[16:19], v[52:55]
    v_mfma_f32_16x16x32_bf16 v[60:63], a[176:179], v[16:19], v[60:63]
    buffer_load_dwordx4 v10, s[8:11], s78 offen offset:512 lds
    s_add_u32 m0, m0, 960
    ds_read_b128 v[36:39], v14 offset:29696
    s_waitcnt lgkmcnt(4)
    v_mfma_f32_16x16x32_bf16 v[44:47], a[20:23], v[20:23], v[44:47]
    v_mfma_f32_16x16x32_bf16 v[52:55], a[100:103], v[20:23], v[52:55]
    v_mfma_f32_16x16x32_bf16 v[60:63], a[180:183], v[20:23], v[60:63]
    ds_read_b128 v[16:19], v14 offset:30720
    s_waitcnt lgkmcnt(4)
    v_mfma_f32_16x16x32_bf16 v[44:47], a[24:27], v[24:27], v[44:47]
    v_mfma_f32_16x16x32_bf16 v[52:55], a[104:107], v[24:27], v[52:55]
    v_mfma_f32_16x16x32_bf16 v[60:63], a[184:187], v[24:27], v[60:63]
    ds_read_b128 v[20:23], v14 offset:31744
    s_waitcnt lgkmcnt(4)
    v_mfma_f32_16x16x32_bf16 v[44:47], a[28:31], v[28:31], v[44:47]
    v_mfma_f32_16x16x32_bf16 v[52:55], a[108:111], v[28:31], v[52:55]
    v_mfma_f32_16x16x32_bf16 v[60:63], a[188:191], v[28:31], v[60:63]
    buffer_load_dwordx4 v10, s[8:11], s78 offen offset:576 lds
    s_add_u32 m0, m0, 960
    ds_read_b128 v[24:27], v14 offset:32768
    s_waitcnt lgkmcnt(4)
    v_mfma_f32_16x16x32_bf16 v[44:47], a[32:35], v[32:35], v[44:47]
    v_mfma_f32_16x16x32_bf16 v[52:55], a[112:115], v[32:35], v[52:55]
    v_mfma_f32_16x16x32_bf16 v[60:63], a[192:195], v[32:35], v[60:63]
    ds_read_b128 v[28:31], v14 offset:33792
    s_waitcnt lgkmcnt(4)
    v_mfma_f32_16x16x32_bf16 v[44:47], a[36:39], v[36:39], v[44:47]
    v_mfma_f32_16x16x32_bf16 v[52:55], a[116:119], v[36:39], v[52:55]
    v_mfma_f32_16x16x32_bf16 v[60:63], a[196:199], v[36:39], v[60:63]
    ds_read_b128 v[32:35], v14 offset:34816
    s_waitcnt lgkmcnt(4)
    v_mfma_f32_16x16x32_bf16 v[44:47], a[40:43], v[16:19], v[44:47]
    v_mfma_f32_16x16x32_bf16 v[52:55], a[120:123], v[16:19], v[52:55]
    v_mfma_f32_16x16x32_bf16 v[60:63], a[200:203], v[16:19], v[60:63]
    ds_read_b128 v[36:39], v14 offset:35840
    s_waitcnt lgkmcnt(4)
    v_mfma_f32_16x16x32_bf16 v[44:47], a[44:47], v[20:23], v[44:47]
    v_mfma_f32_16x16x32_bf16 v[52:55], a[124:127], v[20:23], v[52:55]
    v_mfma_f32_16x16x32_bf16 v[60:63], a[204:207], v[20:23], v[60:63]
    ds_read_b128 v[16:19], v14 offset:36864
    s_waitcnt lgkmcnt(4)
    v_mfma_f32_16x16x32_bf16 v[44:47], a[48:51], v[24:27], v[44:47]
    v_mfma_f32_16x16x32_bf16 v[52:55], a[128:131], v[24:27], v[52:55]
    v_mfma_f32_16x16x32_bf16 v[60:63], a[208:211], v[24:27], v[60:63]
    ds_read_b128 v[20:23], v14 offset:37888
    s_waitcnt lgkmcnt(4)
    v_mfma_f32_16x16x32_bf16 v[44:47], a[52:55], v[28:31], v[44:47]
    v_mfma_f32_16x16x32_bf16 v[52:55], a[132:135], v[28:31], v[52:55]
    v_mfma_f32_16x16x32_bf16 v[60:63], a[212:215], v[28:31], v[60:63]
    ds_read_b128 v[24:27], v14 offset:38912
    s_waitcnt lgkmcnt(4)
    v_mfma_f32_16x16x32_bf16 v[44:47], a[56:59], v[32:35], v[44:47]
    v_mfma_f32_16x16x32_bf16 v[52:55], a[136:139], v[32:35], v[52:55]
    v_mfma_f32_16x16x32_bf16 v[60:63], a[216:219], v[32:35], v[60:63]
    ds_read_b128 v[28:31], v14 offset:39936
    s_waitcnt lgkmcnt(4)
    v_mfma_f32_16x16x32_bf16 v[44:47], a[60:63], v[36:39], v[44:47]
    v_mfma_f32_16x16x32_bf16 v[52:55], a[140:143], v[36:39], v[52:55]
    v_mfma_f32_16x16x32_bf16 v[60:63], a[220:223], v[36:39], v[60:63]
    s_waitcnt lgkmcnt(3)
    v_mfma_f32_16x16x32_bf16 v[44:47], a[64:67], v[16:19], v[44:47]
    v_mfma_f32_16x16x32_bf16 v[52:55], a[144:147], v[16:19], v[52:55]
    v_mfma_f32_16x16x32_bf16 v[60:63], a[224:227], v[16:19], v[60:63]
    s_waitcnt lgkmcnt(2)
    v_mfma_f32_16x16x32_bf16 v[44:47], a[68:71], v[20:23], v[44:47]
    v_mfma_f32_16x16x32_bf16 v[52:55], a[148:151], v[20:23], v[52:55]
    v_mfma_f32_16x16x32_bf16 v[60:63], a[228:231], v[20:23], v[60:63]
    s_waitcnt lgkmcnt(1)
    v_mfma_f32_16x16x32_bf16 v[44:47], a[72:75], v[24:27], v[44:47]
    v_mfma_f32_16x16x32_bf16 v[52:55], a[152:155], v[24:27], v[52:55]
    v_mfma_f32_16x16x32_bf16 v[60:63], a[232:235], v[24:27], v[60:63]
    s_waitcnt lgkmcnt(0)
    v_mfma_f32_16x16x32_bf16 v[44:47], a[76:79], v[28:31], v[44:47]
    v_mfma_f32_16x16x32_bf16 v[52:55], a[156:159], v[28:31], v[52:55]
    v_mfma_f32_16x16x32_bf16 v[60:63], a[236:239], v[28:31], v[60:63]
    v_cvt_pk_bf16_f32 v64, v40, v41
    v_cvt_pk_bf16_f32 v65, v42, v43
    ds_write_b64 v12, v[64:65] offset:0
    s_nop 2
    v_cvt_pk_bf16_f32 v66, v44, v45
    v_cvt_pk_bf16_f32 v67, v46, v47
    ds_write_b64 v12, v[66:67] offset:6144
    v_cvt_pk_bf16_f32 v68, v48, v49
    v_cvt_pk_bf16_f32 v69, v50, v51
    ds_write_b64 v12, v[68:69] offset:2048
    v_cvt_pk_bf16_f32 v70, v52, v53
    v_cvt_pk_bf16_f32 v71, v54, v55
    ds_write_b64 v12, v[70:71] offset:8192
    v_cvt_pk_bf16_f32 v72, v56, v57
    v_cvt_pk_bf16_f32 v73, v58, v59
    ds_write_b64 v12, v[72:73] offset:4096
    v_cvt_pk_bf16_f32 v74, v60, v61
    v_cvt_pk_bf16_f32 v75, v62, v63
    ds_write_b64 v12, v[74:75] offset:10240
    s_cmp_eq_u32 s83, 0
    s_cbranch_scc1 qmem_190
    buffer_load_dword v77, v76, s[4:7], 0 offen sc1
    s_waitcnt vmcnt(0)
fw_191:
    v_cmp_gt_u32 vcc, s85, v77
    s_and_b32 s69, vcc_lo, 0xfff00
    s_cbranch_scc0 fwd_192
    s_sub_u32 s68, s68, 1
    s_cbranch_scc0 ok_193
    s_mov_b32 s69, 31
    s_branch FAIL
ok_193:
    buffer_load_dword v77, v76, s[4:7], 0 offen sc1
    s_waitcnt vmcnt(0)
    s_branch fw_191
fwd_192:
    s_lshl_b32 s70, s30, 10
    s_cmp_eq_u32 s30, 3
    s_cbranch_scc1 md_194
    s_add_u32 m0, s70, 118784
    s_add_u32 s71, s80, s70
    buffer_load_dwordx4 v11, s[4:7], s71 offen sc1 lds
md_194:
    s_cmp_eq_u32 s30, 0
    s_cbranch_scc1 mdd_195
    s_sub_u32 s70, s70, 1024
    s_add_u32 m0, s70, 121856
    s_add_u32 s71, s81, s70
    buffer_load_dwordx4 v11, s[4:7], s71 offen sc1 lds
mdd_195:
qmem_190:
    s_waitcnt vmcnt(0) lgkmcnt(0)
    s_barrier
    ds_read_b128 v[80:83], v9 offset:0
    ds_read_b64_tr_b16 v[152:153], v78 offset:0
    ds_read_b64_tr_b16 v[154:155], v78 offset:256
    ds_read_b128 v[104:107], v8 offset:0
    ds_read_b128 v[128:131], v8 offset:6144
    ds_read_b128 v[84:87], v9 offset:1024
    ds_read_b64_tr_b16 v[156:157], v78 offset:512
    ds_read_b64_tr_b16 v[158:159], v78 offset:768
    ds_read_b128 v[108:111], v8 offset:1024
    ds_read_b128 v[132:135], v8 offset:7168
    ds_read_b128 v[88:91], v9 offset:2048
    ds_read_b64_tr_b16 v[160:161], v78 offset:1024
    ds_read_b64_tr_b16 v[162:163], v78 offset:1280
    ds_read_b128 v[112:115], v8 offset:2048
    ds_read_b128 v[136:139], v8 offset:8192
    s_waitcnt lgkmcnt(10)
    v_mfma_f32_16x16x32_bf16 v[176:179], v[152:155], v[80:83], v[188:191]
    v_mfma_f32_16x16x32_bf16 v[180:183], v[104:107], v[80:83], v[192:195]
    v_mfma_f32_16x16x32_bf16 v[184:187], v[128:131], v[80:83], v[196:199]
    ds_read_b128 v[92:95], v9 offset:3072
    ds_read_b64_tr_b16 v[164:165], v78 offset:1536
    ds_read_b64_tr_b16 v[166:167], v78 offset:1792
    ds_read_b128 v[116:119], v8 offset:3072
    ds_read_b128 v[140:143], v8 offset:9216
    s_waitcnt lgkmcnt(10)
    v_mfma_f32_16x16x32_bf16 v[176:179], v[156:159], v[84:87], v[176:179]
    v_mfma_f32_16x16x32_bf16 v[180:183], v[108:111], v[84:87], v[180:183]
    v_mfma_f32_16x16x32_bf16 v[184:187], v[132:135], v[84:87], v[184:187]
    ds_read_b128 v[96:99], v9 offset:4096
    ds_read_b64_tr_b16 v[168:169], v78 offset:2048
    ds_read_b64_tr_b16 v[170:171], v78 offset:2304
    ds_read_b128 v[120:123], v8 offset:4096
    ds_read_b128 v[144:147], v8 offset:10240
    s_waitcnt lgkmcnt(10)
    v_mfma_f32_16x16x32_bf16 v[176:179], v[160:163], v[88:91], v[176:179]
    v_mfma_f32_16x16x32_bf16 v[180:183], v[112:115], v[88:91], v[180:183]
    v_mfma_f32_16x16x32_bf16 v[184:187], v[136:139], v[88:91], v[184:187]
    ds_read_b128 v[100:103], v9 offset:5120
    ds_read_b64_tr_b16 v[172:173], v78 offset:2560
    ds_read_b64_tr_b16 v[174:175], v78 offset:2816
    ds_read_b128 v[124:127], v8 offset:5120
    ds_read_b128 v[148:151], v8 offset:11264
    s_waitcnt lgkmcnt(10)
    v_mfma_f32_16x16x32_bf16 v[176:179], v[164:167], v[92:95], v[176:179]
    v_mfma_f32_16x16x32_bf16 v[180:183], v[116:119], v[92:95], v[180:183]
    v_mfma_f32_16x16x32_bf16 v[184:187], v[140:143], v[92:95], v[184:187]
    s_waitcnt lgkmcnt(5)
    v_mfma_f32_16x16x32_bf16 v[176:179], v[168:171], v[96:99], v[176:179]
    v_mfma_f32_16x16x32_bf16 v[180:183], v[120:123], v[96:99], v[180:183]
    v_mfma_f32_16x16x32_bf16 v[184:187], v[144:147], v[96:99], v[184:187]
    s_waitcnt lgkmcnt(0)
    v_mfma_f32_16x16x32_bf16 v[176:179], v[172:175], v[100:103], v[176:179]
    v_mfma_f32_16x16x32_bf16 v[180:183], v[124:127], v[100:103], v[180:183]
    v_mfma_f32_16x16x32_bf16 v[184:187], v[148:151], v[100:103], v[184:187]
    s_lshr_b32 s69, s30, 1
    s_mul_i32 s69, s69, 6144
    s_add_u32 s69, s69, 106496
    v_add_u32 v16, s69, v11
    ds_read_b128 v[200:203], v16 offset:0
    ds_read_b64 v[224:225], v79 offset:0
    ds_read_b128 v[204:207], v16 offset:1024
    ds_read_b64 v[226:227], v79 offset:256
    ds_read_b128 v[208:211], v16 offset:2048
    ds_read_b64 v[228:229], v79 offset:512
    ds_read_b128 v[212:215], v16 offset:3072
    ds_read_b64 v[230:231], v79 offset:768
    ds_read_b128 v[216:219], v16 offset:4096
    ds_read_b64 v[232:233], v79 offset:1024
    ds_read_b128 v[220:223], v16 offset:5120
    ds_read_b64 v[234:235], v79 offset:1280
    v_max3_f32 v24, v176, v177, v178
    v_max3_f32 v25, v179, v180, v181
    v_max3_f32 v24, v24, v182, v183
    v_max3_f32 v25, v25, v184, v185
    v_max3_f32 v24, v24, v186, v187
    v_max_f32 v24, v24, v25
    v_mov_b32 v25, v24
    s_nop 1
    v_permlane32_swap_b32 v24, v25
    v_max_f32 v24, v24, v25
    v_mov_b32 v25, v24
    s_nop 1
    v_permlane16_swap_b32 v24, v25
    v_max_f32 v24, v24, v25
    v_mul_f32 v24, s84, v24
    v_fma_f32 v176, v176, s84, -v24
    v_fma_f32 v177, v177, s84, -v24
    v_fma_f32 v178, v178, s84, -v24
    v_fma_f32 v179, v179, s84, -v24
    v_fma_f32 v180, v180, s84, -v24
    v_fma_f32 v181, v181, s84, -v24
    v_fma_f32 v182, v182, s84, -v24
    v_fma_f32 v183, v183, s84, -v24
    v_fma_f32 v184, v184, s84, -v24
    v_fma_f32 v185, v185, s84, -v24
    v_fma_f32 v186, v186, s84, -v24
    v_fma_f32 v187, v187, s84, -v24
    v_exp_f32 v176, v176
    v_exp_f32 v177, v177
    v_exp_f32 v178, v178
    v_exp_f32 v179, v179
    v_exp_f32 v180, v180
    v_exp_f32 v181, v181
    v_exp_f32 v182, v182
    v_exp_f32 v183, v183
    v_exp_f32 v184, v184
    v_exp_f32 v185, v185
    v_exp_f32 v186, v186
    v_exp_f32 v187, v187
    v_add_f32 v24, v176, v177
    v_add_f32 v25, v178, v179
    v_add_f32 v26, v180, v181
    v_add_f32 v27, v182, v183
    v_add_f32 v28, v184, v185
    v_add_f32 v29, v186, v187
    v_add_f32 v24, v24, v25
    v_add_f32 v26, v26, v27
    v_add_f32 v28, v28, v29
    v_add_f32 v24, v24, v26
    v_add_f32 v24, v24, v28
    v_mov_b32 v25, v24
    s_nop 1
    v_permlane32_swap_b32 v24, v25
    v_add_f32 v24, v24, v25
    v_mov_b32 v25, v24
    s_nop 1
    v_permlane16_swap_b32 v24, v25
    v_add_f32 v24, v24, v25
    v_rcp_f32 v24, v24
    s_nop 0
    v_mul_f32 v176, v176, v24
    v_mul_f32 v177, v177, v24
    v_mul_f32 v178, v178, v24
    v_mul_f32 v179, v179, v24
    v_mul_f32 v180, v180, v24
    v_mul_f32 v181, v181, v24
    v_mul_f32 v182, v182, v24
    v_mul_f32 v183, v183, v24
    v_mul_f32 v184, v184, v24
    v_mul_f32 v185, v185, v24
    v_mul_f32 v186, v186, v24
    v_mul_f32 v187, v187, v24
    v_cvt_pk_bf16_f32 v244, v176, v177
    v_cvt_pk_bf16_f32 v245, v178, v179
    v_cvt_pk_bf16_f32 v240, v180, v181
    v_cvt_pk_bf16_f32 v241, v182, v183
    v_cvt_pk_bf16_f32 v242, v184, v185
    v_cvt_pk_bf16_f32 v243, v186, v187
    s_waitcnt lgkmcnt(0)
    s_nop 0
    v_mfma_f32_16x16x32_bf16 v[40:43], v[200:203], v[240:243], 0
    v_mfma_f32_16x16x32_bf16 v[44:47], v[204:207], v[240:243], 0
    v_mfma_f32_16x16x32_bf16 v[48:51], v[208:211], v[240:243], 0
    v_mfma_f32_16x16x32_bf16 v[52:55], v[212:215], v[240:243], 0
    v_mfma_f32_16x16x32_bf16 v[56:59], v[216:219], v[240:243], 0
    v_mfma_f32_16x16x32_bf16 v[60:63], v[220:223], v[240:243], 0
    v_mfma_f32_16x16x32_bf16 v[40:43], v[224:227], v[244:247], v[40:43]
    v_mfma_f32_16x16x32_bf16 v[44:47], v[226:229], v[244:247], v[44:47]
    v_mfma_f32_16x16x32_bf16 v[48:51], v[228:231], v[244:247], v[48:51]
    v_mfma_f32_16x16x32_bf16 v[52:55], v[230:233], v[244:247], v[52:55]
    v_mfma_f32_16x16x32_bf16 v[56:59], v[232:235], v[244:247], v[56:59]
    v_mfma_f32_16x16x32_bf16 v[60:63], v[234:237], v[244:247], v[60:63]
    s_nop 2
    v_cvt_pk_bf16_f32 v64, v40, v41
    v_cvt_pk_bf16_f32 v65, v42, v43
    v_cvt_pk_bf16_f32 v66, v44, v45
    v_cvt_pk_bf16_f32 v67, v46, v47
    buffer_store_dwordx4 v[64:67], v11, s[4:7], s82 offen offset:0 sc1
    v_cvt_pk_bf16_f32 v68, v48, v49
    v_cvt_pk_bf16_f32 v69, v50, v51
    v_cvt_pk_bf16_f32 v70, v52, v53
    v_cvt_pk_bf16_f32 v71, v54, v55
    buffer_store_dwordx4 v[68:71], v11, s[4:7], s82 offen offset:1024 sc1
    v_cvt_pk_bf16_f32 v72, v56, v57
    v_cvt_pk_bf16_f32 v73, v58, v59
    v_cvt_pk_bf16_f32 v74, v60, v61
    v_cvt_pk_bf16_f32 v75, v62, v63
    buffer_store_dwordx4 v[72:75], v11, s[4:7], s82 offen offset:2048 sc1
    buffer_load_dword v77, v76, s[4:7], 0 offen sc1
    s_add_u32 s75, s75, 12288
    s_add_u32 s79, s79, 12288
    s_add_u32 s80, s80, 3072
    s_add_u32 s81, s81, 3072
    s_add_u32 s82, s82, 49152
    s_mov_b32 s31, s77
    s_waitcnt vmcnt(0)
    v_mov_b32 v15, s31
    s_mov_b64 exec, 1
    buffer_store_dword v15, v13, s[4:7], 0 offen sc1
    s_mov_b64 exec, -1
    s_cmp_lt_u32 s31, 64
    s_cbranch_scc1 qloop_183
    s_branch EXIT
ROLE_FS:
    s_mov_b32 s12, s48
    s_mov_b32 s13, s49
    s_mov_b32 s14, 1966080
    s_mov_b32 s15, 0x20000
    s_mov_b32 s16, s50
    s_mov_b32 s17, s51
    s_mov_b32 s18, 1966080
    s_mov_b32 s19, 0x20000
    s_mov_b32 s20, s54
    s_mov_b32 s21, s55
    s_mov_b32 s22, 1280
    s_mov_b32 s23, 0x20000
    s_sub_u32 s73, s29, 24
    s_mul_i32 s74, s28, 3
    s_add_u32 s74, s74, s73
    v_lshrrev_b32 v2, 4, v0
    v_lshlrev_b32 v2, 4, v2
    buffer_load_dwordx4 a[160:163], v2, s[20:23], 0 offen offset:0
    buffer_load_dwordx4 a[164:167], v2, s[20:23], 0 offen offset:64
    buffer_load_dwordx4 a[168:171], v2, s[20:23], 0 offen offset:128
    buffer_load_dwordx4 a[172:175], v2, s[20:23], 0 offen offset:192
    buffer_load_dwordx4 a[176:179], v2, s[20:23], 0 offen offset:256
    buffer_load_dwordx4 a[180:183], v2, s[20:23], 0 offen offset:320
    buffer_load_dwordx4 a[184:187], v2, s[20:23], 0 offen offset:384
    buffer_load_dwordx4 a[188:191], v2, s[20:23], 0 offen offset:448
    buffer_load_dwordx4 a[192:195], v2, s[20:23], 0 offen offset:512
    buffer_load_dwordx4 a[196:199], v2, s[20:23], 0 offen offset:576
    buffer_load_dwordx4 a[200:203], v2, s[20:23], 0 offen offset:640
    buffer_load_dwordx4 a[204:207], v2, s[20:23], 0 offen offset:704
    buffer_load_dwordx4 a[208:211], v2, s[20:23], 0 offen offset:768
    buffer_load_dwordx4 a[212:215], v2, s[20:23], 0 offen offset:832
    buffer_load_dwordx4 a[216:219], v2, s[20:23], 0 offen offset:896
    buffer_load_dwordx4 a[220:223], v2, s[20:23], 0 offen offset:960
    buffer_load_dwordx4 a[224:227], v2, s[20:23], 0 offen offset:1024
    buffer_load_dwordx4 a[228:231], v2, s[20:23], 0 offen offset:1088
    buffer_load_dwordx4 a[232:235], v2, s[20:23], 0 offen offset:1152
    buffer_load_dwordx4 a[236:239], v2, s[20:23], 0 offen offset:1216
    v_lshrrev_b32 v2, 3, v0
    v_and_b32 v3, 7, v0
    v_lshrrev_b32 v4, 4, v0
    v_and_b32 v4, 1, v4
    v_lshlrev_b32 v4, 1, v4
    s_and_b32 s69, s30, 1
    s_lshl_b32 s69, s69, 2
    v_or_b32 v4, s69, v4
    v_xor_b32 v3, v3, v4
    v_lshlrev_b32 v3, 4, v3
    s_mov_b32 s69, 3072
    v_mad_u32_u24 v12, v2, s69, v3
    v_lshrrev_b32 v2, 4, v0
    v_bfe_u32 v3, v0, 2, 2
    v_and_b32 v4, 3, v0
    v_lshrrev_b32 v5, 1, v3
    v_and_b32 v6, 1, v2
    v_lshl_or_b32 v5, v6, 1, v5
    v_lshlrev_b32 v5, 1, v5
    v_lshl_add_u32 v6, v2, 3, v3
    s_lshl_b32 s69, s30, 1
    v_lshrrev_b32 v7, 1, v4
    v_or_b32 v7, s69, v7
    v_xor_b32 v7, v7, v5
    v_lshlrev_b32 v7, 4, v7
    v_and_b32 v4, 1, v4
    v_lshl_or_b32 v7, v4, 3, v7
    v_lshl_add_u32 v14, v6, 7, v7
    s_lshl_b32 s71, s74, 7
    s_mul_i32 s69, s30, 24576
    s_add_u32 s69, s69, s71
    s_lshl_b32 s70, s30, 10
    s_add_u32 m0, s70, 0
    s_nop 0
    buffer_load_dwordx4 v12, s[12:15], s69 offen lds
    s_add_u32 m0, m0, 4096
    s_add_u32 s69, s69, 98304
    buffer_load_dwordx4 v12, s[12:15], s69 offen lds
    s_add_u32 m0, m0, 4096
    s_add_u32 s69, s69, 98304
    buffer_load_dwordx4 v12, s[12:15], s69 offen lds
    s_add_u32 m0, m0, 4096
    s_add_u32 s69, s69, 98304
    buffer_load_dwordx4 v12, s[12:15], s69 offen lds
    s_add_u32 m0, m0, 4096
    s_add_u32 s69, s69, 98304
    buffer_load_dwordx4 v12, s[12:15], s69 offen lds
    s_add_u32 m0, m0, 4096
    s_add_u32 s69, s69, 98304
    buffer_load_dwordx4 v12, s[12:15], s69 offen lds
    s_add_u32 m0, m0, 4096
    s_add_u32 s69, s69, 98304
    buffer_load_dwordx4 v12, s[12:15], s69 offen lds
    s_add_u32 m0, m0, 4096
    s_add_u32 s69, s69, 98304
    buffer_load_dwordx4 v12, s[12:15], s69 offen lds
    s_add_u32 m0, m0, 4096
    s_add_u32 s69, s69, 98304
    buffer_load_dwordx4 v12, s[12:15], s69 offen lds
    s_add_u32 m0, m0, 4096
    s_add_u32 s69, s69, 98304
    buffer_load_dwordx4 v12, s[12:15], s69 offen lds
    s_add_u32 m0, m0, 4096
    s_add_u32 s69, s69, 98304
    buffer_load_dwordx4 v12, s[12:15], s69 offen lds
    s_add_u32 m0, m0, 4096
    s_add_u32 s69, s69, 98304
    buffer_load_dwordx4 v12, s[12:15], s69 offen lds
    s_add_u32 m0, m0, 4096
    s_add_u32 s69, s69, 98304
    buffer_load_dwordx4 v12, s[12:15], s69 offen lds
    s_add_u32 m0, m0, 4096
    s_add_u32 s69, s69, 98304
    buffer_load_dwordx4 v12, s[12:15], s69 offen lds
    s_add_u32 m0, m0, 4096
    s_add_u32 s69, s69, 98304
    buffer_load_dwordx4 v12, s[12:15], s69 offen lds
    s_add_u32 m0, m0, 4096
    s_add_u32 s69, s69, 98304
    buffer_load_dwordx4 v12, s[12:15], s69 offen lds
    s_add_u32 m0, m0, 4096
    s_add_u32 s69, s69, 98304
    buffer_load_dwordx4 v12, s[12:15], s69 offen lds
    s_add_u32 m0, m0, 4096
    s_add_u32 s69, s69, 98304
    buffer_load_dwordx4 v12, s[12:15], s69 offen lds
    s_add_u32 m0, m0, 4096
    s_add_u32 s69, s69, 98304
    buffer_load_dwordx4 v12, s[12:15], s69 offen lds
    s_add_u32 m0, m0, 4096
    s_add_u32 s69, s69, 98304
    buffer_load_dwordx4 v12, s[12:15], s69 offen lds
    s_lshl_b32 s71, s74, 7
    s_mul_i32 s69, s30, 24576
    s_add_u32 s69, s69, s71
    s_lshl_b32 s70, s30, 10
    s_add_u32 m0, s70, 81920
    s_nop 0
    buffer_load_dwordx4 v12, s[16:19], s69 offen lds
    s_add_u32 m0, m0, 4096
    s_add_u32 s69, s69, 98304
    buffer_load_dwordx4 v12, s[16:19], s69 offen lds
    s_add_u32 m0, m0, 4096
    s_add_u32 s69, s69, 98304
    buffer_load_dwordx4 v12, s[16:19], s69 offen lds
    s_add_u32 m0, m0, 4096
    s_add_u32 s69, s69, 98304
    buffer_load_dwordx4 v12, s[16:19], s69 offen lds
    s_add_u32 m0, m0, 4096
    s_add_u32 s69, s69, 98304
    buffer_load_dwordx4 v12, s[16:19], s69 offen lds
    s_add_u32 m0, m0, 4096
    s_add_u32 s69, s69, 98304
    buffer_load_dwordx4 v12, s[16:19], s69 offen lds
    s_add_u32 m0, m0, 4096
    s_add_u32 s69, s69, 98304
    buffer_load_dwordx4 v12, s[16:19], s69 offen lds
    s_add_u32 m0, m0, 4096
    s_add_u32 s69, s69, 98304
    buffer_load_dwordx4 v12, s[16:19], s69 offen lds
    s_add_u32 m0, m0, 4096
    s_add_u32 s69, s69, 98304
    buffer_load_dwordx4 v12, s[16:19], s69 offen lds
    s_add_u32 m0, m0, 4096
    s_add_u32 s69, s69, 98304
    buffer_load_dwordx4 v12, s[16:19], s69 offen lds
    s_add_u32 m0, m0, 4096
    s_add_u32 s69, s69, 98304
    buffer_load_dwordx4 v12, s[16:19], s69 offen lds
    s_add_u32 m0, m0, 4096
    s_add_u32 s69, s69, 98304
    buffer_load_dwordx4 v12, s[16:19], s69 offen lds
    s_add_u32 m0, m0, 4096
    s_add_u32 s69, s69, 98304
    buffer_load_dwordx4 v12, s[16:19], s69 offen lds
    s_add_u32 m0, m0, 4096
    s_add_u32 s69, s69, 98304
    buffer_load_dwordx4 v12, s[16:19], s69 offen lds
    s_add_u32 m0, m0, 4096
    s_add_u32 s69, s69, 98304
    buffer_load_dwordx4 v12, s[16:19], s69 offen lds
    s_add_u32 m0, m0, 4096
    s_add_u32 s69, s69, 98304
    buffer_load_dwordx4 v12, s[16:19], s69 offen lds
    s_add_u32 m0, m0, 4096
    s_add_u32 s69, s69, 98304
    buffer_load_dwordx4 v12, s[16:19], s69 offen lds
    s_add_u32 m0, m0, 4096
    s_add_u32 s69, s69, 98304
    buffer_load_dwordx4 v12, s[16:19], s69 offen lds
    s_add_u32 m0, m0, 4096
    s_add_u32 s69, s69, 98304
    buffer_load_dwordx4 v12, s[16:19], s69 offen lds
    s_add_u32 m0, m0, 4096
    s_add_u32 s69, s69, 98304
    buffer_load_dwordx4 v12, s[16:19], s69 offen lds
    s_waitcnt vmcnt(20)
    s_barrier
    v_add_u32 v9, 0, v14
    ds_read_b64_tr_b16 a[0:1], v9 offset:0
    ds_read_b64_tr_b16 a[2:3], v9 offset:512
    ds_read_b64_tr_b16 a[4:5], v9 offset:4096
    ds_read_b64_tr_b16 a[6:7], v9 offset:4608
    ds_read_b64_tr_b16 a[8:9], v9 offset:8192
    ds_read_b64_tr_b16 a[10:11], v9 offset:8704
    ds_read_b64_tr_b16 a[12:13], v9 offset:12288
    ds_read_b64_tr_b16 a[14:15], v9 offset:12800
    ds_read_b64_tr_b16 a[16:17], v9 offset:16384
    ds_read_b64_tr_b16 a[18:19], v9 offset:16896
    ds_read_b64_tr_b16 a[20:21], v9 offset:20480
    ds_read_b64_tr_b16 a[22:23], v9 offset:20992
    s_waitcnt lgkmcnt(0)
    ds_read_b64_tr_b16 a[24:25], v9 offset:24576
    ds_read_b64_tr_b16 a[26:27], v9 offset:25088
    ds_read_b64_tr_b16 a[28:29], v9 offset:28672
    ds_read_b64_tr_b16 a[30:31], v9 offset:29184
    ds_read_b64_tr_b16 a[32:33], v9 offset:32768
    ds_read_b64_tr_b16 a[34:35], v9 offset:33280
    ds_read_b64_tr_b16 a[36:37], v9 offset:36864
    ds_read_b64_tr_b16 a[38:39], v9 offset:37376
    s_waitcnt lgkmcnt(0)
    v_add_u32 v9, 40960, v14
    ds_read_b64_tr_b16 a[40:41], v9 offset:0
    ds_read_b64_tr_b16 a[42:43], v9 offset:512
    ds_read_b64_tr_b16 a[44:45], v9 offset:4096
    ds_read_b64_tr_b16 a[46:47], v9 offset:4608
    ds_read_b64_tr_b16 a[48:49], v9 offset:8192
    ds_read_b64_tr_b16 a[50:51], v9 offset:8704
    ds_read_b64_tr_b16 a[52:53], v9 offset:12288
    ds_read_b64_tr_b16 a[54:55], v9 offset:12800
    ds_read_b64_tr_b16 a[56:57], v9 offset:16384
    ds_read_b64_tr_b16 a[58:59], v9 offset:16896
    ds_read_b64_tr_b16 a[60:61], v9 offset:20480
    ds_read_b64_tr_b16 a[62:63], v9 offset:20992
    s_waitcnt lgkmcnt(0)
    ds_read_b64_tr_b16 a[64:65], v9 offset:24576
    ds_read_b64_tr_b16 a[66:67], v9 offset:25088
    ds_read_b64_tr_b16 a[68:69], v9 offset:28672
    ds_read_b64_tr_b16 a[70:71], v9 offset:29184
    ds_read_b64_tr_b16 a[72:73], v9 offset:32768
    ds_read_b64_tr_b16 a[74:75], v9 offset:33280
    ds_read_b64_tr_b16 a[76:77], v9 offset:36864
    ds_read_b64_tr_b16 a[78:79], v9 offset:37376
    s_waitcnt lgkmcnt(0)
    s_barrier
    s_waitcnt vmcnt(0)
    s_barrier
    v_add_u32 v9, 81920, v14
    ds_read_b64_tr_b16 a[80:81], v9 offset:0
    ds_read_b64_tr_b16 a[82:83], v9 offset:512
    ds_read_b64_tr_b16 a[84:85], v9 offset:4096
    ds_read_b64_tr_b16 a[86:87], v9 offset:4608
    ds_read_b64_tr_b16 a[88:89], v9 offset:8192
    ds_read_b64_tr_b16 a[90:91], v9 offset:8704
    ds_read_b64_tr_b16 a[92:93], v9 offset:12288
    ds_read_b64_tr_b16 a[94:95], v9 offset:12800
    ds_read_b64_tr_b16 a[96:97], v9 offset:16384
    ds_read_b64_tr_b16 a[98:99], v9 offset:16896
    ds_read_b64_tr_b16 a[100:101], v9 offset:20480
    ds_read_b64_tr_b16 a[102:103], v9 offset:20992
    s_waitcnt lgkmcnt(0)
    ds_read_b64_tr_b16 a[104:105], v9 offset:24576
    ds_read_b64_tr_b16 a[106:107], v9 offset:25088
    ds_read_b64_tr_b16 a[108:109], v9 offset:28672
    ds_read_b64_tr_b16 a[110:111], v9 offset:29184
    ds_read_b64_tr_b16 a[112:113], v9 offset:32768
    ds_read_b64_tr_b16 a[114:115], v9 offset:33280
    ds_read_b64_tr_b16 a[116:117], v9 offset:36864
    ds_read_b64_tr_b16 a[118:119], v9 offset:37376
    s_waitcnt lgkmcnt(0)
    v_add_u32 v9, 122880, v14
    ds_read_b64_tr_b16 a[120:121], v9 offset:0
    ds_read_b64_tr_b16 a[122:123], v9 offset:512
    ds_read_b64_tr_b16 a[124:125], v9 offset:4096
    ds_read_b64_tr_b16 a[126:127], v9 offset:4608
    ds_read_b64_tr_b16 a[128:129], v9 offset:8192
    ds_read_b64_tr_b16 a[130:131], v9 offset:8704
    ds_read_b64_tr_b16 a[132:133], v9 offset:12288
    ds_read_b64_tr_b16 a[134:135], v9 offset:12800
    ds_read_b64_tr_b16 a[136:137], v9 offset:16384
    ds_read_b64_tr_b16 a[138:139], v9 offset:16896
    ds_read_b64_tr_b16 a[140:141], v9 offset:20480
    ds_read_b64_tr_b16 a[142:143], v9 offset:20992
    s_waitcnt lgkmcnt(0)
    ds_read_b64_tr_b16 a[144:145], v9 offset:24576
    ds_read_b64_tr_b16 a[146:147], v9 offset:25088
    ds_read_b64_tr_b16 a[148:149], v9 offset:28672
    ds_read_b64_tr_b16 a[150:151], v9 offset:29184
    ds_read_b64_tr_b16 a[152:153], v9 offset:32768
    ds_read_b64_tr_b16 a[154:155], v9 offset:33280
    ds_read_b64_tr_b16 a[156:157], v9 offset:36864
    ds_read_b64_tr_b16 a[158:159], v9 offset:37376
    s_waitcnt lgkmcnt(0)
    s_barrier
    v_mov_b32 v2, 128
wa_196:
    buffer_load_dword v3, v2, s[64:67], 0 offen sc1
    s_waitcnt vmcnt(0)
    v_cmp_ne_u32 vcc, 0x100, v3
    s_cbranch_vccz wad_197
    s_sub_u32 s68, s68, 1
    s_cbranch_scc0 ok_198
    s_mov_b32 s69, 1
    s_branch FAIL
ok_198:
    s_sleep 4
    s_branch wa_196
wad_197:
    v_and_b32 v2, 15, v0
    v_lshrrev_b32 v3, 4, v0
    s_and_b32 s69, s30, 1
    s_lshl_b32 s69, s69, 4
    v_add_u32 v2, s69, v2
    s_mov_b32 s69, 1280
    v_mul_u32_u24 v2, s69, v2
    s_lshr_b32 s69, s30, 1
    s_mul_i32 s69, s69, 640
    v_lshl_add_u32 v2, v3, 4, v2
    v_add_u32 v10, s69, v2
    v_lshlrev_b32 v11, 4, v0
    s_lshr_b32 s69, s30, 1
    s_lshl_b32 s69, s69, 10
    s_and_b32 s70, s30, 1
    s_lshl_b32 s70, s70, 3
    s_add_u32 s69, s69, s70
    v_add_u32 v12, s69, v11
    s_lshl_b32 s69, s28, 7
    s_lshl_b32 s70, s73, 4
    s_add_u32 s69, s69, s70
    s_lshl_b32 s70, s30, 2
    s_add_u32 s69, s69, s70
    s_add_u32 s69, s69, 2101312
    v_mov_b32 v13, s69
    s_mul_i32 s75, s28, 786432
    s_add_u32 s75, s75, 92274688
    s_lshl_b32 s69, s73, 11
    s_add_u32 s75, s75, s69
    s_lshl_b32 s79, s28, 13
    s_add_u32 s79, s79, 98566144
    s_add_u32 s80, s73, s30
    v_and_b32 v9, 15, v0
    v_lshlrev_b32 v9, 2, v9
    s_mov_b32 s31, 0
    s_mov_b32 s76, 0
    s_mul_i32 s69, s31, 40960
    s_and_b32 s70, s30, 1
    s_mul_i32 s70, s70, 20
    s_lshr_b32 s71, s30, 1
    s_mul_i32 s71, s71, 10
    s_add_u32 s70, s70, s71
    s_lshl_b32 s70, s70, 10
    s_add_u32 m0, s70, s76
    s_nop 0
    buffer_load_dwordx4 v10, s[8:11], s69 offen offset:0 lds
    s_add_u32 m0, m0, 960
    s_nop 0
    buffer_load_dwordx4 v10, s[8:11], s69 offen offset:64 lds
    s_add_u32 m0, m0, 960
    s_nop 0
    buffer_load_dwordx4 v10, s[8:11], s69 offen offset:128 lds
    s_add_u32 m0, m0, 960
    s_nop 0
    buffer_load_dwordx4 v10, s[8:11], s69 offen offset:192 lds
    s_add_u32 m0, m0, 960
    s_nop 0
    buffer_load_dwordx4 v10, s[8:11], s69 offen offset:256 lds
    s_add_u32 m0, m0, 960
    s_nop 0
    buffer_load_dwordx4 v10, s[8:11], s69 offen offset:320 lds
    s_add_u32 m0, m0, 960
    s_nop 0
    buffer_load_dwordx4 v10, s[8:11], s69 offen offset:384 lds
    s_add_u32 m0, m0, 960
    s_nop 0
    buffer_load_dwordx4 v10, s[8:11], s69 offen offset:448 lds
    s_add_u32 m0, m0, 960
    s_nop 0
    buffer_load_dwordx4 v10, s[8:11], s69 offen offset:512 lds
    s_add_u32 m0, m0, 960
    s_nop 0
    buffer_load_dwordx4 v10, s[8:11], s69 offen offset:576 lds
    s_waitcnt vmcnt(0)
floop_199:
    s_barrier
    v_add_u32 v14, s76, v11
    s_xor_b32 s76, s76, 40960
    s_add_u32 s77, s31, 1
    s_mul_i32 s78, s77, 40960
    s_and_b32 s70, s30, 1
    s_mul_i32 s70, s70, 20
    s_lshr_b32 s71, s30, 1
    s_mul_i32 s71, s71, 10
    s_add_u32 s70, s70, s71
    s_lshl_b32 s70, s70, 10
    s_add_u32 m0, s70, s76
    ds_read_b128 v[16:19], v14 offset:0
    ds_read_b128 v[20:23], v14 offset:1024
    ds_read_b128 v[24:27], v14 offset:2048
    ds_read_b128 v[28:31], v14 offset:3072
    ds_read_b128 v[32:35], v14 offset:4096
    s_waitcnt lgkmcnt(4)
    v_mfma_f32_16x16x32_bf16 v[40:43], a[0:3], v[16:19], 0
    v_mfma_f32_16x16x32_bf16 v[48:51], a[80:83], v[16:19], 0
    v_mfma_f32_16x16x32_bf16 v[56:59], a[160:163], v[16:19], 0
    buffer_load_dwordx4 v10, s[8:11], s78 offen offset:0 lds
    s_add_u32 m0, m0, 960
    ds_read_b128 v[36:39], v14 offset:5120
    s_waitcnt lgkmcnt(4)
    v_mfma_f32_16x16x32_bf16 v[40:43], a[4:7], v[20:23], v[40:43]
    v_mfma_f32_16x16x32_bf16 v[48:51], a[84:87], v[20:23], v[48:51]
    v_mfma_f32_16x16x32_bf16 v[56:59], a[164:167], v[20:23], v[56:59]
    ds_read_b128 v[16:19], v14 offset:6144
    s_waitcnt lgkmcnt(4)
    v_mfma_f32_16x16x32_bf16 v[40:43], a[8:11], v[24:27], v[40:43]
    v_mfma_f32_16x16x32_bf16 v[48:51], a[88:91], v[24:27], v[48:51]
    v_mfma_f32_16x16x32_bf16 v[56:59], a[168:171], v[24:27], v[56:59]
    ds_read_b128 v[20:23], v14 offset:7168
    s_waitcnt lgkmcnt(4)
    v_mfma_f32_16x16x32_bf16 v[40:43], a[12:15], v[28:31], v[40:43]
    v_mfma_f32_16x16x32_bf16 v[48:51], a[92:95], v[28:31], v[48:51]
    v_mfma_f32_16x16x32_bf16 v[56:59], a[172:175], v[28:31], v[56:59]
    buffer_load_dwordx4 v10, s[8:11], s78 offen offset:64 lds
    s_add_u32 m0, m0, 960
    ds_read_b128 v[24:27], v14 offset:8192
    s_waitcnt lgkmcnt(4)
    v_mfma_f32_16x16x32_bf16 v[40:43], a[16:19], v[32:35], v[40:43]
    v_mfma_f32_16x16x32_bf16 v[48:51], a[96:99], v[32:35], v[48:51]
    v_mfma_f32_16x16x32_bf16 v[56:59], a[176:179], v[32:35], v[56:59]
    ds_read_b128 v[28:31], v14 offset:9216
    s_waitcnt lgkmcnt(4)
    v_mfma_f32_16x16x32_bf16 v[40:43], a[20:23], v[36:39], v[40:43]
    v_mfma_f32_16x16x32_bf16 v[48:51], a[100:103], v[36:39], v[48:51]
    v_mfma_f32_16x16x32_bf16 v[56:59], a[180:183], v[36:39], v[56:59]
    ds_read_b128 v[32:35], v14 offset:10240
    s_waitcnt lgkmcnt(4)
    v_mfma_f32_16x16x32_bf16 v[40:43], a[24:27], v[16:19], v[40:43]
    v_mfma_f32_16x16x32_bf16 v[48:51], a[104:107], v[16:19], v[48:51]
    v_mfma_f32_16x16x32_bf16 v[56:59], a[184:187], v[16:19], v[56:59]
    buffer_load_dwordx4 v10, s[8:11], s78 offen offset:128 lds
    s_add_u32 m0, m0, 960
    ds_read_b128 v[36:39], v14 offset:11264
    s_waitcnt lgkmcnt(4)
    v_mfma_f32_16x16x32_bf16 v[40:43], a[28:31], v[20:23], v[40:43]
    v_mfma_f32_16x16x32_bf16 v[48:51], a[108:111], v[20:23], v[48:51]
    v_mfma_f32_16x16x32_bf16 v[56:59], a[188:191], v[20:23], v[56:59]
    ds_read_b128 v[16:19], v14 offset:12288
    s_waitcnt lgkmcnt(4)
    v_mfma_f32_16x16x32_bf16 v[40:43], a[32:35], v[24:27], v[40:43]
    v_mfma_f32_16x16x32_bf16 v[48:51], a[112:115], v[24:27], v[48:51]
    v_mfma_f32_16x16x32_bf16 v[56:59], a[192:195], v[24:27], v[56:59]
    ds_read_b128 v[20:23], v14 offset:13312
    s_waitcnt lgkmcnt(4)
    v_mfma_f32_16x16x32_bf16 v[40:43], a[36:39], v[28:31], v[40:43]
    v_mfma_f32_16x16x32_bf16 v[48:51], a[116:119], v[28:31], v[48:51]
    v_mfma_f32_16x16x32_bf16 v[56:59], a[196:199], v[28:31], v[56:59]
    buffer_load_dwordx4 v10, s[8:11], s78 offen offset:192 lds
    s_add_u32 m0, m0, 960
    ds_read_b128 v[24:27], v14 offset:14336
    s_waitcnt lgkmcnt(4)
    v_mfma_f32_16x16x32_bf16 v[40:43], a[40:43], v[32:35], v[40:43]
    v_mfma_f32_16x16x32_bf16 v[48:51], a[120:123], v[32:35], v[48:51]
    v_mfma_f32_16x16x32_bf16 v[56:59], a[200:203], v[32:35], v[56:59]
    ds_read_b128 v[28:31], v14 offset:15360
    s_waitcnt lgkmcnt(4)
    v_mfma_f32_16x16x32_bf16 v[40:43], a[44:47], v[36:39], v[40:43]
    v_mfma_f32_16x16x32_bf16 v[48:51], a[124:127], v[36:39], v[48:51]
    v_mfma_f32_16x16x32_bf16 v[56:59], a[204:207], v[36:39], v[56:59]
    ds_read_b128 v[32:35], v14 offset:16384
    s_waitcnt lgkmcnt(4)
    v_mfma_f32_16x16x32_bf16 v[40:43], a[48:51], v[16:19], v[40:43]
    v_mfma_f32_16x16x32_bf16 v[48:51], a[128:131], v[16:19], v[48:51]
    v_mfma_f32_16x16x32_bf16 v[56:59], a[208:211], v[16:19], v[56:59]
    buffer_load_dwordx4 v10, s[8:11], s78 offen offset:256 lds
    s_add_u32 m0, m0, 960
    ds_read_b128 v[36:39], v14 offset:17408
    s_waitcnt lgkmcnt(4)
    v_mfma_f32_16x16x32_bf16 v[40:43], a[52:55], v[20:23], v[40:43]
    v_mfma_f32_16x16x32_bf16 v[48:51], a[132:135], v[20:23], v[48:51]
    v_mfma_f32_16x16x32_bf16 v[56:59], a[212:215], v[20:23], v[56:59]
    ds_read_b128 v[16:19], v14 offset:18432
    s_waitcnt lgkmcnt(4)
    v_mfma_f32_16x16x32_bf16 v[40:43], a[56:59], v[24:27], v[40:43]
    v_mfma_f32_16x16x32_bf16 v[48:51], a[136:139], v[24:27], v[48:51]
    v_mfma_f32_16x16x32_bf16 v[56:59], a[216:219], v[24:27], v[56:59]
    ds_read_b128 v[20:23], v14 offset:19456
    s_waitcnt lgkmcnt(4)
    v_mfma_f32_16x16x32_bf16 v[40:43], a[60:63], v[28:31], v[40:43]
    v_mfma_f32_16x16x32_bf16 v[48:51], a[140:143], v[28:31], v[48:51]
    v_mfma_f32_16x16x32_bf16 v[56:59], a[220:223], v[28:31], v[56:59]
    buffer_load_dwordx4 v10, s[8:11], s78 offen offset:320 lds
    s_add_u32 m0, m0, 960
    ds_read_b128 v[24:27], v14 offset:20480
    s_waitcnt lgkmcnt(4)
    v_mfma_f32_16x16x32_bf16 v[40:43], a[64:67], v[32:35], v[40:43]
    v_mfma_f32_16x16x32_bf16 v[48:51], a[144:147], v[32:35], v[48:51]
    v_mfma_f32_16x16x32_bf16 v[56:59], a[224:227], v[32:35], v[56:59]
    ds_read_b128 v[28:31], v14 offset:21504
    s_waitcnt lgkmcnt(4)
    v_mfma_f32_16x16x32_bf16 v[40:43], a[68:71], v[36:39], v[40:43]
    v_mfma_f32_16x16x32_bf16 v[48:51], a[148:151], v[36:39], v[48:51]
    v_mfma_f32_16x16x32_bf16 v[56:59], a[228:231], v[36:39], v[56:59]
    ds_read_b128 v[32:35], v14 offset:22528
    s_waitcnt lgkmcnt(4)
    v_mfma_f32_16x16x32_bf16 v[40:43], a[72:75], v[16:19], v[40:43]
    v_mfma_f32_16x16x32_bf16 v[48:51], a[152:155], v[16:19], v[48:51]
    v_mfma_f32_16x16x32_bf16 v[56:59], a[232:235], v[16:19], v[56:59]
    buffer_load_dwordx4 v10, s[8:11], s78 offen offset:384 lds
    s_add_u32 m0, m0, 960
    ds_read_b128 v[36:39], v14 offset:23552
    s_waitcnt lgkmcnt(4)
    v_mfma_f32_16x16x32_bf16 v[40:43], a[76:79], v[20:23], v[40:43]
    v_mfma_f32_16x16x32_bf16 v[48:51], a[156:159], v[20:23], v[48:51]
    v_mfma_f32_16x16x32_bf16 v[56:59], a[236:239], v[20:23], v[56:59]
    ds_read_b128 v[16:19], v14 offset:24576
    s_waitcnt lgkmcnt(4)
    v_mfma_f32_16x16x32_bf16 v[44:47], a[0:3], v[24:27], 0
    v_mfma_f32_16x16x32_bf16 v[52:55], a[80:83], v[24:27], 0
    v_mfma_f32_16x16x32_bf16 v[60:63], a[160:163], v[24:27], 0
    ds_read_b128 v[20:23], v14 offset:25600
    s_waitcnt lgkmcnt(4)
    v_mfma_f32_16x16x32_bf16 v[44:47], a[4:7], v[28:31], v[44:47]
    v_mfma_f32_16x16x32_bf16 v[52:55], a[84:87], v[28:31], v[52:55]
    v_mfma_f32_16x16x32_bf16 v[60:63], a[164:167], v[28:31], v[60:63]
    buffer_load_dwordx4 v10, s[8:11], s78 offen offset:448 lds
    s_add_u32 m0, m0, 960
    ds_read_b128 v[24:27], v14 offset:26624
    s_waitcnt lgkmcnt(4)
    v_mfma_f32_16x16x32_bf16 v[44:47], a[8:11], v[32:35], v[44:47]
    v_mfma_f32_16x16x32_bf16 v[52:55], a[88:91], v[32:35], v[52:55]
    v_mfma_f32_16x16x32_bf16 v[60:63], a[168:171], v[32:35], v[60:63]
    ds_read_b128 v[28:31], v14 offset:27648
    s_waitcnt lgkmcnt(4)
    v_mfma_f32_16x16x32_bf16 v[44:47], a[12:15], v[36:39], v[44:47]
    v_mfma_f32_16x16x32_bf16 v[52:55], a[92:95], v[36:39], v[52:55]
    v_mfma_f32_16x16x32_bf16 v[60:63], a[172:175], v[36:39], v[60:63]
    ds_read_b128 v[32:35], v14 offset:28672
    s_waitcnt lgkmcnt(4)
    v_mfma_f32_16x16x32_bf16 v[44:47], a[16:19], v[16:19], v[44:47]
    v_mfma_f32_16x16x32_bf16 v[52:55], a[96:99], v[16:19], v[52:55]
    v_mfma_f32_16x16x32_bf16 v[60:63], a[176:179], v[16:19], v[60:63]
    buffer_load_dwordx4 v10, s[8:11], s78 offen offset:512 lds
    s_add_u32 m0, m0, 960
    ds_read_b128 v[36:39], v14 offset:29696
    s_waitcnt lgkmcnt(4)
    v_mfma_f32_16x16x32_bf16 v[44:47], a[20:23], v[20:23], v[44:47]
    v_mfma_f32_16x16x32_bf16 v[52:55], a[100:103], v[20:23], v[52:55]
    v_mfma_f32_16x16x32_bf16 v[60:63], a[180:183], v[20:23], v[60:63]
    ds_read_b128 v[16:19], v14 offset:30720
    s_waitcnt lgkmcnt(4)
    v_mfma_f32_16x16x32_bf16 v[44:47], a[24:27], v[24:27], v[44:47]
    v_mfma_f32_16x16x32_bf16 v[52:55], a[104:107], v[24:27], v[52:55]
    v_mfma_f32_16x16x32_bf16 v[60:63], a[184:187], v[24:27], v[60:63]
    ds_read_b128 v[20:23], v14 offset:31744
    s_waitcnt lgkmcnt(4)
    v_mfma_f32_16x16x32_bf16 v[44:47], a[28:31], v[28:31], v[44:47]
    v_mfma_f32_16x16x32_bf16 v[52:55], a[108:111], v[28:31], v[52:55]
    v_mfma_f32_16x16x32_bf16 v[60:63], a[188:191], v[28:31], v[60:63]
    buffer_load_dwordx4 v10, s[8:11], s78 offen offset:576 lds
    s_add_u32 m0, m0, 960
    ds_read_b128 v[24:27], v14 offset:32768
    s_waitcnt lgkmcnt(4)
    v_mfma_f32_16x16x32_bf16 v[44:47], a[32:35], v[32:35], v[44:47]
    v_mfma_f32_16x16x32_bf16 v[52:55], a[112:115], v[32:35], v[52:55]
    v_mfma_f32_16x16x32_bf16 v[60:63], a[192:195], v[32:35], v[60:63]
    ds_read_b128 v[28:31], v14 offset:33792
    s_waitcnt lgkmcnt(4)
    v_mfma_f32_16x16x32_bf16 v[44:47], a[36:39], v[36:39], v[44:47]
    v_mfma_f32_16x16x32_bf16 v[52:55], a[116:119], v[36:39], v[52:55]
    v_mfma_f32_16x16x32_bf16 v[60:63], a[196:199], v[36:39], v[60:63]
    ds_read_b128 v[32:35], v14 offset:34816
    s_waitcnt lgkmcnt(4)
    v_mfma_f32_16x16x32_bf16 v[44:47], a[40:43], v[16:19], v[44:47]
    v_mfma_f32_16x16x32_bf16 v[52:55], a[120:123], v[16:19], v[52:55]
    v_mfma_f32_16x16x32_bf16 v[60:63], a[200:203], v[16:19], v[60:63]
    ds_read_b128 v[36:39], v14 offset:35840
    s_waitcnt lgkmcnt(4)
    v_mfma_f32_16x16x32_bf16 v[44:47], a[44:47], v[20:23], v[44:47]
    v_mfma_f32_16x16x32_bf16 v[52:55], a[124:127], v[20:23], v[52:55]
    v_mfma_f32_16x16x32_bf16 v[60:63], a[204:207], v[20:23], v[60:63]
    ds_read_b128 v[16:19], v14 offset:36864
    s_waitcnt lgkmcnt(4)
    v_mfma_f32_16x16x32_bf16 v[44:47], a[48:51], v[24:27], v[44:47]
    v_mfma_f32_16x16x32_bf16 v[52:55], a[128:131], v[24:27], v[52:55]
    v_mfma_f32_16x16x32_bf16 v[60:63], a[208:211], v[24:27], v[60:63]
    ds_read_b128 v[20:23], v14 offset:37888
    s_waitcnt lgkmcnt(4)
    v_mfma_f32_16x16x32_bf16 v[44:47], a[52:55], v[28:31], v[44:47]
    v_mfma_f32_16x16x32_bf16 v[52:55], a[132:135], v[28:31], v[52:55]
    v_mfma_f32_16x16x32_bf16 v[60:63], a[212:215], v[28:31], v[60:63]
    ds_read_b128 v[24:27], v14 offset:38912
    s_waitcnt lgkmcnt(4)
    v_mfma_f32_16x16x32_bf16 v[44:47], a[56:59], v[32:35], v[44:47]
    v_mfma_f32_16x16x32_bf16 v[52:55], a[136:139], v[32:35], v[52:55]
    v_mfma_f32_16x16x32_bf16 v[60:63], a[216:219], v[32:35], v[60:63]
    ds_read_b128 v[28:31], v14 offset:39936
    s_waitcnt lgkmcnt(4)
    v_mfma_f32_16x16x32_bf16 v[44:47], a[60:63], v[36:39], v[44:47]
    v_mfma_f32_16x16x32_bf16 v[52:55], a[140:143], v[36:39], v[52:55]
    v_mfma_f32_16x16x32_bf16 v[60:63], a[220:223], v[36:39], v[60:63]
    s_waitcnt lgkmcnt(3)
    v_mfma_f32_16x16x32_bf16 v[44:47], a[64:67], v[16:19], v[44:47]
    v_mfma_f32_16x16x32_bf16 v[52:55], a[144:147], v[16:19], v[52:55]
    v_mfma_f32_16x16x32_bf16 v[60:63], a[224:227], v[16:19], v[60:63]
    s_waitcnt lgkmcnt(2)
    v_mfma_f32_16x16x32_bf16 v[44:47], a[68:71], v[20:23], v[44:47]
    v_mfma_f32_16x16x32_bf16 v[52:55], a[148:151], v[20:23], v[52:55]
    v_mfma_f32_16x16x32_bf16 v[60:63], a[228:231], v[20:23], v[60:63]
    s_waitcnt lgkmcnt(1)
    v_mfma_f32_16x16x32_bf16 v[44:47], a[72:75], v[24:27], v[44:47]
    v_mfma_f32_16x16x32_bf16 v[52:55], a[152:155], v[24:27], v[52:55]
    v_mfma_f32_16x16x32_bf16 v[60:63], a[232:235], v[24:27], v[60:63]
    s_waitcnt lgkmcnt(0)
    v_mfma_f32_16x16x32_bf16 v[44:47], a[76:79], v[28:31], v[44:47]
    v_mfma_f32_16x16x32_bf16 v[52:55], a[156:159], v[28:31], v[52:55]
    v_mfma_f32_16x16x32_bf16 v[60:63], a[236:239], v[28:31], v[60:63]
    v_mul_f32 v40, 0xbfb8aa3b, v40
    v_mul_f32 v41, 0xbfb8aa3b, v41
    v_mul_f32 v42, 0xbfb8aa3b, v42
    v_mul_f32 v43, 0xbfb8aa3b, v43
    v_exp_f32 v40, v40
    v_exp_f32 v41, v41
    v_exp_f32 v42, v42
    v_exp_f32 v43, v43
    v_add_f32 v40, 1.0, v40
    v_add_f32 v41, 1.0, v41
    v_add_f32 v42, 1.0, v42
    v_add_f32 v43, 1.0, v43
    v_rcp_f32 v40, v40
    v_rcp_f32 v41, v41
    v_rcp_f32 v42, v42
    v_rcp_f32 v43, v43
    v_mul_f32 v40, v40, v48
    v_mul_f32 v41, v41, v49
    v_mul_f32 v42, v42, v50
    v_mul_f32 v43, v43, v51
    v_cvt_pk_bf16_f32 v64, v40, v41
    v_cvt_pk_bf16_f32 v65, v42, v43
    s_add_u32 s69, s75, 0
    buffer_store_dwordx2 v[64:65], v12, s[4:7], s69 offen sc1
    v_mul_f32 v44, 0xbfb8aa3b, v44
    v_mul_f32 v45, 0xbfb8aa3b, v45
    v_mul_f32 v46, 0xbfb8aa3b, v46
    v_mul_f32 v47, 0xbfb8aa3b, v47
    v_exp_f32 v44, v44
    v_exp_f32 v45, v45
    v_exp_f32 v46, v46
    v_exp_f32 v47, v47
    v_add_f32 v44, 1.0, v44
    v_add_f32 v45, 1.0, v45
    v_add_f32 v46, 1.0, v46
    v_add_f32 v47, 1.0, v47
    v_rcp_f32 v44, v44
    v_rcp_f32 v45, v45
    v_rcp_f32 v46, v46
    v_rcp_f32 v47, v47
    v_mul_f32 v44, v44, v52
    v_mul_f32 v45, v45, v53
    v_mul_f32 v46, v46, v54
    v_mul_f32 v47, v47, v55
    v_cvt_pk_bf16_f32 v66, v44, v45
    v_cvt_pk_bf16_f32 v67, v46, v47
    s_add_u32 s69, s75, 6144
    buffer_store_dwordx2 v[66:67], v12, s[4:7], s69 offen sc1
    s_cmp_lg_u32 s80, 0
    s_cbranch_scc1 nogate_200
    v_mul_f32 v70, 0xbfb8aa3b, v56
    v_exp_f32 v70, v70
    s_nop 0
    v_add_f32 v70, 1.0, v70
    v_rcp_f32 v70, v70
    v_mul_f32 v71, 0xbfb8aa3b, v60
    v_exp_f32 v71, v71
    s_nop 0
    v_add_f32 v71, 1.0, v71
    v_rcp_f32 v71, v71
    s_mov_b64 exec, 0xffff
    buffer_store_dword v70, v9, s[4:7], s79 offen offset:0 sc1
    buffer_store_dword v71, v9, s[4:7], s79 offen offset:64 sc1
    s_mov_b64 exec, -1
nogate_200:
    s_add_u32 s75, s75, 12288
    s_add_u32 s79, s79, 128
    s_mov_b32 s31, s77
    s_waitcnt vmcnt(0)
    v_mov_b32 v15, s31
    s_mov_b64 exec, 1
    buffer_store_dword v15, v13, s[4:7], 0 offen sc1
    s_mov_b64 exec, -1
    s_cmp_lt_u32 s31, 64
    s_cbranch_scc1 floop_199
    s_branch EXIT
ROLE_WS:
    s_mov_b32 s12, s42
    s_mov_b32 s13, s43
    s_mov_b32 s14, 7864320
    s_mov_b32 s15, 0x20000
    s_mov_b32 s16, s52
    s_mov_b32 s17, s53
    s_mov_b32 s18, 1966080
    s_mov_b32 s19, 0x20000
    s_mov_b32 s24, s56
    s_mov_b32 s25, s57
    s_mov_b32 s26, 2621440
    s_mov_b32 s27, 0x20000
    s_sub_u32 s73, s29, 27
    v_lshrrev_b32 v2, 3, v0
    v_and_b32 v3, 7, v0
    v_lshrrev_b32 v4, 4, v0
    v_lshlrev_b32 v4, 1, v4
    v_xor_b32 v3, v3, v4
    v_lshlrev_b32 v3, 4, v3
    s_mov_b32 s69, 1280
    v_mad_u32_u24 v12, v2, s69, v3
    v_lshrrev_b32 v2, 4, v0
    v_bfe_u32 v3, v0, 2, 2
    v_and_b32 v4, 3, v0
    v_lshrrev_b32 v5, 1, v3
    v_and_b32 v6, 1, v2
    v_lshl_or_b32 v5, v6, 1, v5
    v_lshlrev_b32 v5, 1, v5
    v_lshl_add_u32 v6, v2, 2, v3
    s_lshl_b32 s69, s30, 1
    v_lshrrev_b32 v7, 1, v4
    v_or_b32 v7, s69, v7
    v_xor_b32 v7, v7, v5
    v_lshlrev_b32 v7, 4, v7
    v_and_b32 v4, 1, v4
    v_lshl_or_b32 v7, v4, 3, v7
    v_lshl_add_u32 v14, v6, 7, v7
    s_mul_i32 s71, s28, 983040
    s_lshl_b32 s72, s73, 8
    s_add_u32 s71, s71, s72
    s_add_u32 s71, s71, 0
    s_mul_i32 s69, s30, 10240
    s_add_u32 s69, s69, s71
    s_lshl_b32 s70, s30, 10
    s_add_u32 m0, s70, 0
    s_nop 0
    buffer_load_dwordx4 v12, s[12:15], s69 offen lds
    s_add_u32 m0, m0, 4096
    s_add_u32 s69, s69, 40960
    buffer_load_dwordx4 v12, s[12:15], s69 offen lds
    s_add_u32 m0, m0, 4096
    s_add_u32 s69, s69, 40960
    buffer_load_dwordx4 v12, s[12:15], s69 offen lds
    s_add_u32 m0, m0, 4096
    s_add_u32 s69, s69, 40960
    buffer_load_dwordx4 v12, s[12:15], s69 offen lds
    s_add_u32 m0, m0, 4096
    s_add_u32 s69, s69, 40960
    buffer_load_dwordx4 v12, s[12:15], s69 offen lds
    s_add_u32 m0, m0, 4096
    s_add_u32 s69, s69, 40960
    buffer_load_dwordx4 v12, s[12:15], s69 offen lds
    s_add_u32 m0, m0, 4096
    s_add_u32 s69, s69, 40960
    buffer_load_dwordx4 v12, s[12:15], s69 offen lds
    s_add_u32 m0, m0, 4096
    s_add_u32 s69, s69, 40960
    buffer_load_dwordx4 v12, s[12:15], s69 offen lds
    s_add_u32 m0, m0, 4096
    s_add_u32 s69, s69, 40960
    buffer_load_dwordx4 v12, s[12:15], s69 offen lds
    s_add_u32 m0, m0, 4096
    s_add_u32 s69, s69, 40960
    buffer_load_dwordx4 v12, s[12:15], s69 offen lds
    s_add_u32 m0, m0, 4096
    s_add_u32 s69, s69, 40960
    buffer_load_dwordx4 v12, s[12:15], s69 offen lds
    s_add_u32 m0, m0, 4096
    s_add_u32 s69, s69, 40960
    buffer_load_dwordx4 v12, s[12:15], s69 offen lds
    s_mul_i32 s71, s28, 983040
    s_lshl_b32 s72, s73, 8
    s_add_u32 s71, s71, s72
    s_add_u32 s71, s71, 491520
    s_mul_i32 s69, s30, 10240
    s_add_u32 s69, s69, s71
    s_lshl_b32 s70, s30, 10
    s_add_u32 m0, s70, 81920
    s_nop 0
    buffer_load_dwordx4 v12, s[12:15], s69 offen lds
    s_add_u32 m0, m0, 4096
    s_add_u32 s69, s69, 40960
    buffer_load_dwordx4 v12, s[12:15], s69 offen lds
    s_add_u32 m0, m0, 4096
    s_add_u32 s69, s69, 40960
    buffer_load_dwordx4 v12, s[12:15], s69 offen lds
    s_add_u32 m0, m0, 4096
    s_add_u32 s69, s69, 40960
    buffer_load_dwordx4 v12, s[12:15], s69 offen lds
    s_add_u32 m0, m0, 4096
    s_add_u32 s69, s69, 40960
    buffer_load_dwordx4 v12, s[12:15], s69 offen lds
    s_add_u32 m0, m0, 4096
    s_add_u32 s69, s69, 40960
    buffer_load_dwordx4 v12, s[12:15], s69 offen lds
    s_add_u32 m0, m0, 4096
    s_add_u32 s69, s69, 40960
    buffer_load_dwordx4 v12, s[12:15], s69 offen lds
    s_add_u32 m0, m0, 4096
    s_add_u32 s69, s69, 40960
    buffer_load_dwordx4 v12, s[12:15], s69 offen lds
    s_add_u32 m0, m0, 4096
    s_add_u32 s69, s69, 40960
    buffer_load_dwordx4 v12, s[12:15], s69 offen lds
    s_add_u32 m0, m0, 4096
    s_add_u32 s69, s69, 40960
    buffer_load_dwordx4 v12, s[12:15], s69 offen lds
    s_add_u32 m0, m0, 4096
    s_add_u32 s69, s69, 40960
    buffer_load_dwordx4 v12, s[12:15], s69 offen lds
    s_add_u32 m0, m0, 4096
    s_add_u32 s69, s69, 40960
    buffer_load_dwordx4 v12, s[12:15], s69 offen lds
    s_waitcnt vmcnt(12)
    s_barrier
    v_add_u32 v9, 0, v14
    ds_read_b64_tr_b16 a[0:1], v9 offset:0
    ds_read_b64_tr_b16 a[2:3], v9 offset:2048
    ds_read_b64_tr_b16 a[4:5], v9 offset:4096
    ds_read_b64_tr_b16 a[6:7], v9 offset:6144
    ds_read_b64_tr_b16 a[8:9], v9 offset:8192
    ds_read_b64_tr_b16 a[10:11], v9 offset:10240
    ds_read_b64_tr_b16 a[12:13], v9 offset:12288
    ds_read_b64_tr_b16 a[14:15], v9 offset:14336
    ds_read_b64_tr_b16 a[16:17], v9 offset:16384
    ds_read_b64_tr_b16 a[18:19], v9 offset:18432
    ds_read_b64_tr_b16 a[20:21], v9 offset:20480
    ds_read_b64_tr_b16 a[22:23], v9 offset:22528
    s_waitcnt lgkmcnt(0)
    ds_read_b64_tr_b16 a[24:25], v9 offset:24576
    ds_read_b64_tr_b16 a[26:27], v9 offset:26624
    ds_read_b64_tr_b16 a[28:29], v9 offset:28672
    ds_read_b64_tr_b16 a[30:31], v9 offset:30720
    ds_read_b64_tr_b16 a[32:33], v9 offset:32768
    ds_read_b64_tr_b16 a[34:35], v9 offset:34816
    ds_read_b64_tr_b16 a[36:37], v9 offset:36864
    ds_read_b64_tr_b16 a[38:39], v9 offset:38912
    s_waitcnt lgkmcnt(0)
    v_add_u32 v9, 40960, v14
    ds_read_b64_tr_b16 a[40:41], v9 offset:0
    ds_read_b64_tr_b16 a[42:43], v9 offset:2048
    ds_read_b64_tr_b16 a[44:45], v9 offset:4096
    ds_read_b64_tr_b16 a[46:47], v9 offset:6144
    s_waitcnt lgkmcnt(0)
    s_barrier
    s_mul_i32 s71, s28, 983040
    s_lshl_b32 s72, s73, 8
    s_add_u32 s71, s71, s72
    s_add_u32 s71, s71, 128
    s_mul_i32 s69, s30, 10240
    s_add_u32 s69, s69, s71
    s_lshl_b32 s70, s30, 10
    s_add_u32 m0, s70, 0
    s_nop 0
    buffer_load_dwordx4 v12, s[12:15], s69 offen lds
    s_add_u32 m0, m0, 4096
    s_add_u32 s69, s69, 40960
    buffer_load_dwordx4 v12, s[12:15], s69 offen lds
    s_add_u32 m0, m0, 4096
    s_add_u32 s69, s69, 40960
    buffer_load_dwordx4 v12, s[12:15], s69 offen lds
    s_add_u32 m0, m0, 4096
    s_add_u32 s69, s69, 40960
    buffer_load_dwordx4 v12, s[12:15], s69 offen lds
    s_add_u32 m0, m0, 4096
    s_add_u32 s69, s69, 40960
    buffer_load_dwordx4 v12, s[12:15], s69 offen lds
    s_add_u32 m0, m0, 4096
    s_add_u32 s69, s69, 40960
    buffer_load_dwordx4 v12, s[12:15], s69 offen lds
    s_add_u32 m0, m0, 4096
    s_add_u32 s69, s69, 40960
    buffer_load_dwordx4 v12, s[12:15], s69 offen lds
    s_add_u32 m0, m0, 4096
    s_add_u32 s69, s69, 40960
    buffer_load_dwordx4 v12, s[12:15], s69 offen lds
    s_add_u32 m0, m0, 4096
    s_add_u32 s69, s69, 40960
    buffer_load_dwordx4 v12, s[12:15], s69 offen lds
    s_add_u32 m0, m0, 4096
    s_add_u32 s69, s69, 40960
    buffer_load_dwordx4 v12, s[12:15], s69 offen lds
    s_add_u32 m0, m0, 4096
    s_add_u32 s69, s69, 40960
    buffer_load_dwordx4 v12, s[12:15], s69 offen lds
    s_add_u32 m0, m0, 4096
    s_add_u32 s69, s69, 40960
    buffer_load_dwordx4 v12, s[12:15], s69 offen lds
    s_waitcnt vmcnt(12)
    s_barrier
    v_add_u32 v9, 81920, v14
    ds_read_b64_tr_b16 a[48:49], v9 offset:0
    ds_read_b64_tr_b16 a[50:51], v9 offset:2048
    ds_read_b64_tr_b16 a[52:53], v9 offset:4096
    ds_read_b64_tr_b16 a[54:55], v9 offset:6144
    ds_read_b64_tr_b16 a[56:57], v9 offset:8192
    ds_read_b64_tr_b16 a[58:59], v9 offset:10240
    ds_read_b64_tr_b16 a[60:61], v9 offset:12288
    ds_read_b64_tr_b16 a[62:63], v9 offset:14336
    ds_read_b64_tr_b16 a[64:65], v9 offset:16384
    ds_read_b64_tr_b16 a[66:67], v9 offset:18432
    ds_read_b64_tr_b16 a[68:69], v9 offset:20480
    ds_read_b64_tr_b16 a[70:71], v9 offset:22528
    s_waitcnt lgkmcnt(0)
    ds_read_b64_tr_b16 a[72:73], v9 offset:24576
    ds_read_b64_tr_b16 a[74:75], v9 offset:26624
    ds_read_b64_tr_b16 a[76:77], v9 offset:28672
    ds_read_b64_tr_b16 a[78:79], v9 offset:30720
    ds_read_b64_tr_b16 a[80:81], v9 offset:32768
    ds_read_b64_tr_b16 a[82:83], v9 offset:34816
    ds_read_b64_tr_b16 a[84:85], v9 offset:36864
    ds_read_b64_tr_b16 a[86:87], v9 offset:38912
    s_waitcnt lgkmcnt(0)
    v_add_u32 v9, 122880, v14
    ds_read_b64_tr_b16 a[88:89], v9 offset:0
    ds_read_b64_tr_b16 a[90:91], v9 offset:2048
    ds_read_b64_tr_b16 a[92:93], v9 offset:4096
    ds_read_b64_tr_b16 a[94:95], v9 offset:6144
    s_waitcnt lgkmcnt(0)
    s_barrier
    s_mul_i32 s71, s28, 983040
    s_lshl_b32 s72, s73, 8
    s_add_u32 s71, s71, s72
    s_add_u32 s71, s71, 491648
    s_mul_i32 s69, s30, 10240
    s_add_u32 s69, s69, s71
    s_lshl_b32 s70, s30, 10
    s_add_u32 m0, s70, 81920
    s_nop 0
    buffer_load_dwordx4 v12, s[12:15], s69 offen lds
    s_add_u32 m0, m0, 4096
    s_add_u32 s69, s69, 40960
    buffer_load_dwordx4 v12, s[12:15], s69 offen lds
    s_add_u32 m0, m0, 4096
    s_add_u32 s69, s69, 40960
    buffer_load_dwordx4 v12, s[12:15], s69 offen lds
    s_add_u32 m0, m0, 4096
    s_add_u32 s69, s69, 40960
    buffer_load_dwordx4 v12, s[12:15], s69 offen lds
    s_add_u32 m0, m0, 4096
    s_add_u32 s69, s69, 40960
    buffer_load_dwordx4 v12, s[12:15], s69 offen lds
    s_add_u32 m0, m0, 4096
    s_add_u32 s69, s69, 40960
    buffer_load_dwordx4 v12, s[12:15], s69 offen lds
    s_add_u32 m0, m0, 4096
    s_add_u32 s69, s69, 40960
    buffer_load_dwordx4 v12, s[12:15], s69 offen lds
    s_add_u32 m0, m0, 4096
    s_add_u32 s69, s69, 40960
    buffer_load_dwordx4 v12, s[12:15], s69 offen lds
    s_add_u32 m0, m0, 4096
    s_add_u32 s69, s69, 40960
    buffer_load_dwordx4 v12, s[12:15], s69 offen lds
    s_add_u32 m0, m0, 4096
    s_add_u32 s69, s69, 40960
    buffer_load_dwordx4 v12, s[12:15], s69 offen lds
    s_add_u32 m0, m0, 4096
    s_add_u32 s69, s69, 40960
    buffer_load_dwordx4 v12, s[12:15], s69 offen lds
    s_add_u32 m0, m0, 4096
    s_add_u32 s69, s69, 40960
    buffer_load_dwordx4 v12, s[12:15], s69 offen lds
    s_waitcnt vmcnt(12)
    s_barrier
    v_add_u32 v9, 0, v14
    ds_read_b64_tr_b16 a[96:97], v9 offset:0
    ds_read_b64_tr_b16 a[98:99], v9 offset:2048
    ds_read_b64_tr_b16 a[100:101], v9 offset:4096
    ds_read_b64_tr_b16 a[102:103], v9 offset:6144
    ds_read_b64_tr_b16 a[104:105], v9 offset:8192
    ds_read_b64_tr_b16 a[106:107], v9 offset:10240
    ds_read_b64_tr_b16 a[108:109], v9 offset:12288
    ds_read_b64_tr_b16 a[110:111], v9 offset:14336
    ds_read_b64_tr_b16 a[112:113], v9 offset:16384
    ds_read_b64_tr_b16 a[114:115], v9 offset:18432
    ds_read_b64_tr_b16 a[116:117], v9 offset:20480
    ds_read_b64_tr_b16 a[118:119], v9 offset:22528
    s_waitcnt lgkmcnt(0)
    ds_read_b64_tr_b16 a[120:121], v9 offset:24576
    ds_read_b64_tr_b16 a[122:123], v9 offset:26624
    ds_read_b64_tr_b16 a[124:125], v9 offset:28672
    ds_read_b64_tr_b16 a[126:127], v9 offset:30720
    ds_read_b64_tr_b16 a[128:129], v9 offset:32768
    ds_read_b64_tr_b16 a[130:131], v9 offset:34816
    ds_read_b64_tr_b16 a[132:133], v9 offset:36864
    ds_read_b64_tr_b16 a[134:135], v9 offset:38912
    s_waitcnt lgkmcnt(0)
    v_add_u32 v9, 40960, v14
    ds_read_b64_tr_b16 a[136:137], v9 offset:0
    ds_read_b64_tr_b16 a[138:139], v9 offset:2048
    ds_read_b64_tr_b16 a[140:141], v9 offset:4096
    ds_read_b64_tr_b16 a[142:143], v9 offset:6144
    s_waitcnt lgkmcnt(0)
    s_barrier
    s_mul_i32 s71, s28, 245760
    s_lshl_b32 s72, s73, 8
    s_add_u32 s71, s71, s72
    s_add_u32 s71, s71, 0
    s_mul_i32 s69, s30, 10240
    s_add_u32 s69, s69, s71
    s_lshl_b32 s70, s30, 10
    s_add_u32 m0, s70, 0
    s_nop 0
    buffer_load_dwordx4 v12, s[16:19], s69 offen lds
    s_add_u32 m0, m0, 4096
    s_add_u32 s69, s69, 40960
    buffer_load_dwordx4 v12, s[16:19], s69 offen lds
    s_add_u32 m0, m0, 4096
    s_add_u32 s69, s69, 40960
    buffer_load_dwordx4 v12, s[16:19], s69 offen lds
    s_add_u32 m0, m0, 4096
    s_add_u32 s69, s69, 40960
    buffer_load_dwordx4 v12, s[16:19], s69 offen lds
    s_add_u32 m0, m0, 4096
    s_add_u32 s69, s69, 40960
    buffer_load_dwordx4 v12, s[16:19], s69 offen lds
    s_add_u32 m0, m0, 4096
    s_add_u32 s69, s69, 40960
    buffer_load_dwordx4 v12, s[16:19], s69 offen lds
    s_waitcnt vmcnt(6)
    s_barrier
    v_add_u32 v9, 81920, v14
    ds_read_b64_tr_b16 a[144:145], v9 offset:0
    ds_read_b64_tr_b16 a[146:147], v9 offset:2048
    ds_read_b64_tr_b16 a[148:149], v9 offset:4096
    ds_read_b64_tr_b16 a[150:151], v9 offset:6144
    ds_read_b64_tr_b16 a[152:153], v9 offset:8192
    ds_read_b64_tr_b16 a[154:155], v9 offset:10240
    ds_read_b64_tr_b16 a[156:157], v9 offset:12288
    ds_read_b64_tr_b16 a[158:159], v9 offset:14336
    ds_read_b64_tr_b16 a[160:161], v9 offset:16384
    ds_read_b64_tr_b16 a[162:163], v9 offset:18432
    ds_read_b64_tr_b16 a[164:165], v9 offset:20480
    ds_read_b64_tr_b16 a[166:167], v9 offset:22528
    s_waitcnt lgkmcnt(0)
    ds_read_b64_tr_b16 a[168:169], v9 offset:24576
    ds_read_b64_tr_b16 a[170:171], v9 offset:26624
    ds_read_b64_tr_b16 a[172:173], v9 offset:28672
    ds_read_b64_tr_b16 a[174:175], v9 offset:30720
    ds_read_b64_tr_b16 a[176:177], v9 offset:32768
    ds_read_b64_tr_b16 a[178:179], v9 offset:34816
    ds_read_b64_tr_b16 a[180:181], v9 offset:36864
    ds_read_b64_tr_b16 a[182:183], v9 offset:38912
    s_waitcnt lgkmcnt(0)
    v_add_u32 v9, 122880, v14
    ds_read_b64_tr_b16 a[184:185], v9 offset:0
    ds_read_b64_tr_b16 a[186:187], v9 offset:2048
    ds_read_b64_tr_b16 a[188:189], v9 offset:4096
    ds_read_b64_tr_b16 a[190:191], v9 offset:6144
    s_waitcnt lgkmcnt(0)
    s_barrier
    s_mul_i32 s71, s28, 245760
    s_lshl_b32 s72, s73, 8
    s_add_u32 s71, s71, s72
    s_add_u32 s71, s71, 128
    s_mul_i32 s69, s30, 10240
    s_add_u32 s69, s69, s71
    s_lshl_b32 s70, s30, 10
    s_add_u32 m0, s70, 81920
    s_nop 0
    buffer_load_dwordx4 v12, s[16:19], s69 offen lds
    s_add_u32 m0, m0, 4096
    s_add_u32 s69, s69, 40960
    buffer_load_dwordx4 v12, s[16:19], s69 offen lds
    s_add_u32 m0, m0, 4096
    s_add_u32 s69, s69, 40960
    buffer_load_dwordx4 v12, s[16:19], s69 offen lds
    s_add_u32 m0, m0, 4096
    s_add_u32 s69, s69, 40960
    buffer_load_dwordx4 v12, s[16:19], s69 offen lds
    s_add_u32 m0, m0, 4096
    s_add_u32 s69, s69, 40960
    buffer_load_dwordx4 v12, s[16:19], s69 offen lds
    s_add_u32 m0, m0, 4096
    s_add_u32 s69, s69, 40960
    buffer_load_dwordx4 v12, s[16:19], s69 offen lds
    s_waitcnt vmcnt(6)
    s_barrier
    v_add_u32 v9, 0, v14
    ds_read_b64_tr_b16 a[192:193], v9 offset:0
    ds_read_b64_tr_b16 a[194:195], v9 offset:2048
    ds_read_b64_tr_b16 a[196:197], v9 offset:4096
    ds_read_b64_tr_b16 a[198:199], v9 offset:6144
    ds_read_b64_tr_b16 a[200:201], v9 offset:8192
    ds_read_b64_tr_b16 a[202:203], v9 offset:10240
    ds_read_b64_tr_b16 a[204:205], v9 offset:12288
    ds_read_b64_tr_b16 a[206:207], v9 offset:14336
    ds_read_b64_tr_b16 a[208:209], v9 offset:16384
    ds_read_b64_tr_b16 a[210:211], v9 offset:18432
    ds_read_b64_tr_b16 a[212:213], v9 offset:20480
    ds_read_b64_tr_b16 a[214:215], v9 offset:22528
    s_waitcnt lgkmcnt(0)
    s_barrier
    s_waitcnt vmcnt(0)
    s_barrier
    v_add_u32 v9, 81920, v14
    ds_read_b64_tr_b16 a[216:217], v9 offset:0
    ds_read_b64_tr_b16 a[218:219], v9 offset:2048
    ds_read_b64_tr_b16 a[220:221], v9 offset:4096
    ds_read_b64_tr_b16 a[222:223], v9 offset:6144
    ds_read_b64_tr_b16 a[224:225], v9 offset:8192
    ds_read_b64_tr_b16 a[226:227], v9 offset:10240
    ds_read_b64_tr_b16 a[228:229], v9 offset:12288
    ds_read_b64_tr_b16 a[230:231], v9 offset:14336
    ds_read_b64_tr_b16 a[232:233], v9 offset:16384
    ds_read_b64_tr_b16 a[234:235], v9 offset:18432
    ds_read_b64_tr_b16 a[236:237], v9 offset:20480
    ds_read_b64_tr_b16 a[238:239], v9 offset:22528
    s_waitcnt lgkmcnt(0)
    s_barrier
    v_mov_b32 v2, 128
wa_201:
    buffer_load_dword v3, v2, s[64:67], 0 offen sc1
    s_waitcnt vmcnt(0)
    v_cmp_ne_u32 vcc, 0x100, v3
    s_cbranch_vccz wad_202
    s_sub_u32 s68, s68, 1
    s_cbranch_scc0 ok_203
    s_mov_b32 s69, 1
    s_branch FAIL
ok_203:
    s_sleep 4
    s_branch wa_201
wad_202:
    v_lshlrev_b32 v10, 4, v0
    v_and_b32 v16, 15, v0
    v_lshrrev_b32 v17, 4, v0
    v_and_b32 v18, 31, v0
    v_lshrrev_b32 v19, 5, v0
    s_lshl_b32 s69, s28, 7
    s_add_u32 s69, s69, 2101248
    v_min_u32 v20, 27, v0
    v_lshlrev_b32 v20, 2, v20
    v_add_u32 v11, s69, v20
    s_lshl_b32 s69, s73, 7
    s_add_u32 s69, s69, 2102272
    v_lshlrev_b32 v20, 2, v18
    v_add_u32 v12, s69, v20
    s_lshl_b32 s70, s28, 4
    s_lshl_b32 s71, s30, 2
    s_add_u32 s69, s69, s70
    s_add_u32 s69, s69, s71
    v_mov_b32 v13, s69
    v_lshrrev_b32 v20, 2, v16
    v_lshlrev_b32 v20, 14, v20
    v_and_b32 v21, 3, v16
    v_lshl_add_u32 v20, v21, 9, v20
    v_lshl_add_u32 v20, v17, 4, v20
    s_lshl_b32 s69, s30, 6
    v_add_u32 v14, s69, v20
    v_lshlrev_b32 v20, 11, v19
    v_lshl_add_u32 v20, v18, 4, v20
    s_lshl_b32 s69, s30, 9
    v_add_u32 v15, s69, v20
    v_lshlrev_b32 v8, 3, v18
    v_lshlrev_b32 v9, 2, v16
    s_mul_i32 s75, s28, 3145728
    s_add_u32 s75, s75, 54525952
    s_mul_i32 s69, s30, 12288
    s_add_u32 s75, s75, s69
    s_mul_i32 s76, s28, 786432
    s_add_u32 s76, s76, 92274688
    s_mul_i32 s69, s30, 3072
    s_add_u32 s76, s76, s69
    s_lshl_b32 s77, s28, 13
    s_add_u32 s77, s77, 98566144
    s_lshl_b32 s78, s73, 17
    s_add_u32 s78, s78, 98631680
    s_lshl_b32 s69, s28, 14
    s_add_u32 s79, s78, s69
    s_sub_u32 s79, s79, 1310720
    s_lshl_b32 s69, s28, 11
    s_add_u32 s78, s78, s69
    s_lshl_b32 s69, s28, 2
    s_add_u32 s69, s69, s30
    s_mul_i32 s69, s69, 1280
    s_lshl_b32 s70, s73, 8
    s_add_u32 s80, s69, s70
    s_sub_u32 s80, s80, 81920
    s_mov_b32 s31, 0
    buffer_load_dword v76, v11, s[4:7], 0 offen sc1
    s_waitcnt vmcnt(0)
wloop_204:
    s_add_u32 s81, s31, 1
fw_206:
    v_cmp_gt_u32 vcc, s81, v76
    s_and_b32 s69, vcc_lo, 0xfffffff
    s_cbranch_scc0 fwd_207
    s_sub_u32 s68, s68, 1
    s_cbranch_scc0 ok_208
    s_mov_b32 s69, 40
    s_branch FAIL
ok_208:
    buffer_load_dword v76, v11, s[4:7], 0 offen sc1
    s_waitcnt vmcnt(0)
    s_branch fw_206
fwd_207:
    s_barrier
    s_mul_i32 s70, s30, 12288
    s_add_u32 m0, s70, 0
    s_mov_b32 s71, s75
    buffer_load_dwordx4 v10, s[4:7], s71 offen offset:0 sc1 lds
    buffer_load_dwordx4 v10, s[4:7], s71 offen offset:1024 sc1 lds
    buffer_load_dwordx4 v10, s[4:7], s71 offen offset:2048 sc1 lds
    buffer_load_dwordx4 v10, s[4:7], s71 offen offset:3072 sc1 lds
    s_add_u32 m0, m0, 4096
    s_add_u32 s71, s71, 4096
    buffer_load_dwordx4 v10, s[4:7], s71 offen offset:0 sc1 lds
    buffer_load_dwordx4 v10, s[4:7], s71 offen offset:1024 sc1 lds
    buffer_load_dwordx4 v10, s[4:7], s71 offen offset:2048 sc1 lds
    buffer_load_dwordx4 v10, s[4:7], s71 offen offset:3072 sc1 lds
    s_add_u32 m0, m0, 4096
    s_add_u32 s71, s71, 4096
    buffer_load_dwordx4 v10, s[4:7], s71 offen offset:0 sc1 lds
    buffer_load_dwordx4 v10, s[4:7], s71 offen offset:1024 sc1 lds
    buffer_load_dwordx4 v10, s[4:7], s71 offen offset:2048 sc1 lds
    buffer_load_dwordx4 v10, s[4:7], s71 offen offset:3072 sc1 lds
    s_mul_i32 s70, s30, 3072
    s_add_u32 m0, s70, 49152
    s_nop 0
    buffer_load_dwordx4 v10, s[4:7], s76 offen offset:0 sc1 lds
    buffer_load_dwordx4 v10, s[4:7], s76 offen offset:1024 sc1 lds
    buffer_load_dwordx4 v10, s[4:7], s76 offen offset:2048 sc1 lds
    buffer_load_dword v78, v9, s[4:7], s77 offen offset:0 sc1
    buffer_load_dword v79, v9, s[4:7], s77 offen offset:64 sc1
    s_waitcnt vmcnt(0)
wdma_205:
    s_barrier
    buffer_load_dword v77, v12, s[4:7], 0 offen sc1
    ds_read_b128 v[16:19], v10 offset:0
    ds_read_b128 v[20:23], v10 offset:24576
    ds_read_b128 v[24:27], v10 offset:1024
    ds_read_b128 v[28:31], v10 offset:25600
    ds_read_b128 v[32:35], v10 offset:2048
    s_waitcnt lgkmcnt(4)
    v_mfma_f32_16x16x32_bf16 v[40:43], a[0:3], v[16:19], 0
    v_mfma_f32_16x16x32_bf16 v[44:47], a[96:99], v[16:19], 0
    ds_read_b128 v[36:39], v10 offset:26624
    s_waitcnt lgkmcnt(4)
    v_mfma_f32_16x16x32_bf16 v[48:51], a[0:3], v[20:23], 0
    v_mfma_f32_16x16x32_bf16 v[52:55], a[96:99], v[20:23], 0
    ds_read_b128 v[16:19], v10 offset:3072
    s_waitcnt lgkmcnt(4)
    v_mfma_f32_16x16x32_bf16 v[40:43], a[4:7], v[24:27], v[40:43]
    v_mfma_f32_16x16x32_bf16 v[44:47], a[100:103], v[24:27], v[44:47]
    ds_read_b128 v[20:23], v10 offset:27648
    s_waitcnt lgkmcnt(4)
    v_mfma_f32_16x16x32_bf16 v[48:51], a[4:7], v[28:31], v[48:51]
    v_mfma_f32_16x16x32_bf16 v[52:55], a[100:103], v[28:31], v[52:55]
    ds_read_b128 v[24:27], v10 offset:4096
    s_waitcnt lgkmcnt(4)
    v_mfma_f32_16x16x32_bf16 v[40:43], a[8:11], v[32:35], v[40:43]
    v_mfma_f32_16x16x32_bf16 v[44:47], a[104:107], v[32:35], v[44:47]
    ds_read_b128 v[28:31], v10 offset:28672
    s_waitcnt lgkmcnt(4)
    v_mfma_f32_16x16x32_bf16 v[48:51], a[8:11], v[36:39], v[48:51]
    v_mfma_f32_16x16x32_bf16 v[52:55], a[104:107], v[36:39], v[52:55]
    ds_read_b128 v[32:35], v10 offset:5120
    s_waitcnt lgkmcnt(4)
    v_mfma_f32_16x16x32_bf16 v[40:43], a[12:15], v[16:19], v[40:43]
    v_mfma_f32_16x16x32_bf16 v[44:47], a[108:111], v[16:19], v[44:47]
    ds_read_b128 v[36:39], v10 offset:29696
    s_waitcnt lgkmcnt(4)
    v_mfma_f32_16x16x32_bf16 v[48:51], a[12:15], v[20:23], v[48:51]
    v_mfma_f32_16x16x32_bf16 v[52:55], a[108:111], v[20:23], v[52:55]
    ds_read_b128 v[16:19], v10 offset:6144
    s_waitcnt lgkmcnt(4)
    v_mfma_f32_16x16x32_bf16 v[40:43], a[16:19], v[24:27], v[40:43]
    v_mfma_f32_16x16x32_bf16 v[44:47], a[112:115], v[24:27], v[44:47]
    ds_read_b128 v[20:23], v10 offset:30720
    s_waitcnt lgkmcnt(4)
    v_mfma_f32_16x16x32_bf16 v[48:51], a[16:19], v[28:31], v[48:51]
    v_mfma_f32_16x16x32_bf16 v[52:55], a[112:115], v[28:31], v[52:55]
    ds_read_b128 v[24:27], v10 offset:7168
    s_waitcnt lgkmcnt(4)
    v_mfma_f32_16x16x32_bf16 v[40:43], a[20:23], v[32:35], v[40:43]
    v_mfma_f32_16x16x32_bf16 v[44:47], a[116:119], v[32:35], v[44:47]
    ds_read_b128 v[28:31], v10 offset:31744
    s_waitcnt lgkmcnt(4)
    v_mfma_f32_16x16x32_bf16 v[48:51], a[20:23], v[36:39], v[48:51]
    v_mfma_f32_16x16x32_bf16 v[52:55], a[116:119], v[36:39], v[52:55]
    ds_read_b128 v[32:35], v10 offset:8192
    s_waitcnt lgkmcnt(4)
    v_mfma_f32_16x16x32_bf16 v[40:43], a[24:27], v[16:19], v[40:43]
    v_mfma_f32_16x16x32_bf16 v[44:47], a[120:123], v[16:19], v[44:47]
    ds_read_b128 v[36:39], v10 offset:32768
    s_waitcnt lgkmcnt(4)
    v_mfma_f32_16x16x32_bf16 v[48:51], a[24:27], v[20:23], v[48:51]
    v_mfma_f32_16x16x32_bf16 v[52:55], a[120:123], v[20:23], v[52:55]
    ds_read_b128 v[16:19], v10 offset:9216
    s_waitcnt lgkmcnt(4)
    v_mfma_f32_16x16x32_bf16 v[40:43], a[28:31], v[24:27], v[40:43]
    v_mfma_f32_16x16x32_bf16 v[44:47], a[124:127], v[24:27], v[44:47]
    ds_read_b128 v[20:23], v10 offset:33792
    s_waitcnt lgkmcnt(4)
    v_mfma_f32_16x16x32_bf16 v[48:51], a[28:31], v[28:31], v[48:51]
    v_mfma_f32_16x16x32_bf16 v[52:55], a[124:127], v[28:31], v[52:55]
    ds_read_b128 v[24:27], v10 offset:10240
    s_waitcnt lgkmcnt(4)
    v_mfma_f32_16x16x32_bf16 v[40:43], a[32:35], v[32:35], v[40:43]
    v_mfma_f32_16x16x32_bf16 v[44:47], a[128:131], v[32:35], v[44:47]
    ds_read_b128 v[28:31], v10 offset:34816
    s_waitcnt lgkmcnt(4)
    v_mfma_f32_16x16x32_bf16 v[48:51], a[32:35], v[36:39], v[48:51]
    v_mfma_f32_16x16x32_bf16 v[52:55], a[128:131], v[36:39], v[52:55]
    ds_read_b128 v[32:35], v10 offset:11264
    s_waitcnt lgkmcnt(4)
    v_mfma_f32_16x16x32_bf16 v[40:43], a[36:39], v[16:19], v[40:43]
    v_mfma_f32_16x16x32_bf16 v[44:47], a[132:135], v[16:19], v[44:47]
    ds_read_b128 v[36:39], v10 offset:35840
    s_waitcnt lgkmcnt(4)
    v_mfma_f32_16x16x32_bf16 v[48:51], a[36:39], v[20:23], v[48:51]
    v_mfma_f32_16x16x32_bf16 v[52:55], a[132:135], v[20:23], v[52:55]
    ds_read_b128 v[16:19], v10 offset:12288
    s_waitcnt lgkmcnt(4)
    v_mfma_f32_16x16x32_bf16 v[40:43], a[40:43], v[24:27], v[40:43]
    v_mfma_f32_16x16x32_bf16 v[44:47], a[136:139], v[24:27], v[44:47]
    ds_read_b128 v[20:23], v10 offset:36864
    s_waitcnt lgkmcnt(4)
    v_mfma_f32_16x16x32_bf16 v[48:51], a[40:43], v[28:31], v[48:51]
    v_mfma_f32_16x16x32_bf16 v[52:55], a[136:139], v[28:31], v[52:55]
    ds_read_b128 v[24:27], v10 offset:13312
    s_waitcnt lgkmcnt(4)
    v_mfma_f32_16x16x32_bf16 v[40:43], a[44:47], v[32:35], v[40:43]
    v_mfma_f32_16x16x32_bf16 v[44:47], a[140:143], v[32:35], v[44:47]
    ds_read_b128 v[28:31], v10 offset:37888
    s_waitcnt lgkmcnt(4)
    v_mfma_f32_16x16x32_bf16 v[48:51], a[44:47], v[36:39], v[48:51]
    v_mfma_f32_16x16x32_bf16 v[52:55], a[140:143], v[36:39], v[52:55]
    ds_read_b128 v[32:35], v10 offset:14336
    s_waitcnt lgkmcnt(4)
    s_cmp_eq_u32 s31, 0
    s_cbranch_scc1 nored_209
    s_waitcnt vmcnt(0)
    v_mov_b32 v75, s31
    s_mov_b64 exec, 1
    buffer_store_dword v75, v13, s[4:7], 0 offen sc1
    s_mov_b64 exec, -1
    s_cmp_eq_u32 s31, 1
    s_cbranch_scc1 nored_209
    s_sub_u32 s81, s31, 1
fw_210:
    v_cmp_gt_u32 vcc, s81, v77
    s_and_b32 s69, vcc_lo, 0xffffffff
    s_cbranch_scc0 fwd_211
    s_sub_u32 s68, s68, 1
    s_cbranch_scc0 ok_212
    s_mov_b32 s69, 41
    s_branch FAIL
ok_212:
    buffer_load_dword v77, v12, s[4:7], 0 offen sc1
    s_waitcnt vmcnt(0)
    s_branch fw_210
fwd_211:
    s_add_u32 s69, s79, 0
    buffer_load_dwordx4 v[80:83], v15, s[4:7], s69 offen sc1
    s_add_u32 s69, s79, 4096
    buffer_load_dwordx4 v[84:87], v15, s[4:7], s69 offen sc1
    s_add_u32 s69, s79, 8192
    buffer_load_dwordx4 v[88:91], v15, s[4:7], s69 offen sc1
    s_add_u32 s69, s79, 12288
    buffer_load_dwordx4 v[92:95], v15, s[4:7], s69 offen sc1
nored_209:
    v_mfma_f32_16x16x32_bf16 v[40:43], a[48:51], v[16:19], v[40:43]
    v_mfma_f32_16x16x32_bf16 v[44:47], a[144:147], v[16:19], v[44:47]
    ds_read_b128 v[36:39], v10 offset:38912
    s_waitcnt lgkmcnt(4)
    v_mfma_f32_16x16x32_bf16 v[48:51], a[48:51], v[20:23], v[48:51]
    v_mfma_f32_16x16x32_bf16 v[52:55], a[144:147], v[20:23], v[52:55]
    ds_read_b128 v[16:19], v10 offset:15360
    s_waitcnt lgkmcnt(4)
    v_mfma_f32_16x16x32_bf16 v[40:43], a[52:55], v[24:27], v[40:43]
    v_mfma_f32_16x16x32_bf16 v[44:47], a[148:151], v[24:27], v[44:47]
    ds_read_b128 v[20:23], v10 offset:39936
    s_waitcnt lgkmcnt(4)
    v_mfma_f32_16x16x32_bf16 v[48:51], a[52:55], v[28:31], v[48:51]
    v_mfma_f32_16x16x32_bf16 v[52:55], a[148:151], v[28:31], v[52:55]
    ds_read_b128 v[24:27], v10 offset:16384
    s_waitcnt lgkmcnt(4)
    v_mfma_f32_16x16x32_bf16 v[40:43], a[56:59], v[32:35], v[40:43]
    v_mfma_f32_16x16x32_bf16 v[44:47], a[152:155], v[32:35], v[44:47]
    ds_read_b128 v[28:31], v10 offset:40960
    s_waitcnt lgkmcnt(4)
    v_mfma_f32_16x16x32_bf16 v[48:51], a[56:59], v[36:39], v[48:51]
    v_mfma_f32_16x16x32_bf16 v[52:55], a[152:155], v[36:39], v[52:55]
    ds_read_b128 v[32:35], v10 offset:17408
    s_waitcnt lgkmcnt(4)
    v_mfma_f32_16x16x32_bf16 v[40:43], a[60:63], v[16:19], v[40:43]
    v_mfma_f32_16x16x32_bf16 v[44:47], a[156:159], v[16:19], v[44:47]
    ds_read_b128 v[36:39], v10 offset:41984
    s_waitcnt lgkmcnt(4)
    v_mfma_f32_16x16x32_bf16 v[48:51], a[60:63], v[20:23], v[48:51]
    v_mfma_f32_16x16x32_bf16 v[52:55], a[156:159], v[20:23], v[52:55]
    ds_read_b128 v[16:19], v10 offset:18432
    s_waitcnt lgkmcnt(4)
    v_mfma_f32_16x16x32_bf16 v[40:43], a[64:67], v[24:27], v[40:43]
    v_mfma_f32_16x16x32_bf16 v[44:47], a[160:163], v[24:27], v[44:47]
    ds_read_b128 v[20:23], v10 offset:43008
    s_waitcnt lgkmcnt(4)
    v_mfma_f32_16x16x32_bf16 v[48:51], a[64:67], v[28:31], v[48:51]
    v_mfma_f32_16x16x32_bf16 v[52:55], a[160:163], v[28:31], v[52:55]
    ds_read_b128 v[24:27], v10 offset:19456
    s_waitcnt lgkmcnt(4)
    v_mfma_f32_16x16x32_bf16 v[40:43], a[68:71], v[32:35], v[40:43]
    v_mfma_f32_16x16x32_bf16 v[44:47], a[164:167], v[32:35], v[44:47]
    ds_read_b128 v[28:31], v10 offset:44032
    s_waitcnt lgkmcnt(4)
    v_mfma_f32_16x16x32_bf16 v[48:51], a[68:71], v[36:39], v[48:51]
    v_mfma_f32_16x16x32_bf16 v[52:55], a[164:167], v[36:39], v[52:55]
    ds_read_b128 v[32:35], v10 offset:20480
    s_waitcnt lgkmcnt(4)
    v_mfma_f32_16x16x32_bf16 v[40:43], a[72:75], v[16:19], v[40:43]
    v_mfma_f32_16x16x32_bf16 v[44:47], a[168:171], v[16:19], v[44:47]
    ds_read_b128 v[36:39], v10 offset:45056
    s_waitcnt lgkmcnt(4)
    v_mfma_f32_16x16x32_bf16 v[48:51], a[72:75], v[20:23], v[48:51]
    v_mfma_f32_16x16x32_bf16 v[52:55], a[168:171], v[20:23], v[52:55]
    ds_read_b128 v[16:19], v10 offset:21504
    s_waitcnt lgkmcnt(4)
    v_mfma_f32_16x16x32_bf16 v[40:43], a[76:79], v[24:27], v[40:43]
    v_mfma_f32_16x16x32_bf16 v[44:47], a[172:175], v[24:27], v[44:47]
    ds_read_b128 v[20:23], v10 offset:46080
    s_waitcnt lgkmcnt(4)
    v_mfma_f32_16x16x32_bf16 v[48:51], a[76:79], v[28:31], v[48:51]
    v_mfma_f32_16x16x32_bf16 v[52:55], a[172:175], v[28:31], v[52:55]
    ds_read_b128 v[24:27], v10 offset:22528
    s_waitcnt lgkmcnt(4)
    v_mfma_f32_16x16x32_bf16 v[40:43], a[80:83], v[32:35], v[40:43]
    v_mfma_f32_16x16x32_bf16 v[44:47], a[176:179], v[32:35], v[44:47]
    ds_read_b128 v[28:31], v10 offset:47104
    s_waitcnt lgkmcnt(4)
    v_mfma_f32_16x16x32_bf16 v[48:51], a[80:83], v[36:39], v[48:51]
    v_mfma_f32_16x16x32_bf16 v[52:55], a[176:179], v[36:39], v[52:55]
    ds_read_b128 v[32:35], v10 offset:23552
    s_waitcnt lgkmcnt(4)
    v_mfma_f32_16x16x32_bf16 v[40:43], a[84:87], v[16:19], v[40:43]
    v_mfma_f32_16x16x32_bf16 v[44:47], a[180:183], v[16:19], v[44:47]
    ds_read_b128 v[36:39], v10 offset:48128
    s_waitcnt lgkmcnt(4)
    v_mfma_f32_16x16x32_bf16 v[48:51], a[84:87], v[20:23], v[48:51]
    v_mfma_f32_16x16x32_bf16 v[52:55], a[180:183], v[20:23], v[52:55]
    ds_read_b128 v[16:19], v10 offset:49152
    s_waitcnt lgkmcnt(4)
    buffer_load_dword v76, v11, s[4:7], 0 offen sc1
    v_mfma_f32_16x16x32_bf16 v[40:43], a[88:91], v[24:27], v[40:43]
    v_mfma_f32_16x16x32_bf16 v[44:47], a[184:187], v[24:27], v[44:47]
    ds_read_b128 v[20:23], v10 offset:55296
    s_waitcnt lgkmcnt(4)
    v_mfma_f32_16x16x32_bf16 v[48:51], a[88:91], v[28:31], v[48:51]
    v_mfma_f32_16x16x32_bf16 v[52:55], a[184:187], v[28:31], v[52:55]
    ds_read_b128 v[24:27], v10 offset:50176
    s_waitcnt lgkmcnt(4)
    v_mfma_f32_16x16x32_bf16 v[40:43], a[92:95], v[32:35], v[40:43]
    v_mfma_f32_16x16x32_bf16 v[44:47], a[188:191], v[32:35], v[44:47]
    ds_read_b128 v[28:31], v10 offset:56320
    s_waitcnt lgkmcnt(4)
    v_mfma_f32_16x16x32_bf16 v[48:51], a[92:95], v[36:39], v[48:51]
    v_mfma_f32_16x16x32_bf16 v[52:55], a[188:191], v[36:39], v[52:55]
    ds_read_b128 v[32:35], v10 offset:51200
    s_waitcnt lgkmcnt(4)
    v_mfma_f32_16x16x32_bf16 v[56:59], a[192:195], v[16:19], 0
    v_mfma_f32_16x16x32_bf16 v[60:63], a[216:219], v[16:19], 0
    ds_read_b128 v[36:39], v10 offset:57344
    s_waitcnt lgkmcnt(4)
    v_mfma_f32_16x16x32_bf16 v[64:67], a[192:195], v[20:23], 0
    v_mfma_f32_16x16x32_bf16 v[68:71], a[216:219], v[20:23], 0
    ds_read_b128 v[16:19], v10 offset:52224
    s_waitcnt lgkmcnt(4)
    v_mfma_f32_16x16x32_bf16 v[56:59], a[196:199], v[24:27], v[56:59]
    v_mfma_f32_16x16x32_bf16 v[60:63], a[220:223], v[24:27], v[60:63]
    ds_read_b128 v[20:23], v10 offset:58368
    s_waitcnt lgkmcnt(4)
    v_mfma_f32_16x16x32_bf16 v[64:67], a[196:199], v[28:31], v[64:67]
    v_mfma_f32_16x16x32_bf16 v[68:71], a[220:223], v[28:31], v[68:71]
    ds_read_b128 v[24:27], v10 offset:53248
    s_waitcnt lgkmcnt(4)
    v_mfma_f32_16x16x32_bf16 v[56:59], a[200:203], v[32:35], v[56:59]
    v_mfma_f32_16x16x32_bf16 v[60:63], a[224:227], v[32:35], v[60:63]
    ds_read_b128 v[28:31], v10 offset:59392
    s_waitcnt lgkmcnt(4)
    v_mfma_f32_16x16x32_bf16 v[64:67], a[200:203], v[36:39], v[64:67]
    v_mfma_f32_16x16x32_bf16 v[68:71], a[224:227], v[36:39], v[68:71]
    ds_read_b128 v[32:35], v10 offset:54272
    s_waitcnt lgkmcnt(4)
    v_mfma_f32_16x16x32_bf16 v[56:59], a[204:207], v[16:19], v[56:59]
    v_mfma_f32_16x16x32_bf16 v[60:63], a[228:231], v[16:19], v[60:63]
    ds_read_b128 v[36:39], v10 offset:60416
    s_waitcnt lgkmcnt(4)
    v_mfma_f32_16x16x32_bf16 v[64:67], a[204:207], v[20:23], v[64:67]
    v_mfma_f32_16x16x32_bf16 v[68:71], a[228:231], v[20:23], v[68:71]
    s_waitcnt lgkmcnt(3)
    v_mfma_f32_16x16x32_bf16 v[56:59], a[208:211], v[24:27], v[56:59]
    v_mfma_f32_16x16x32_bf16 v[60:63], a[232:235], v[24:27], v[60:63]
    s_waitcnt lgkmcnt(2)
    v_mfma_f32_16x16x32_bf16 v[64:67], a[208:211], v[28:31], v[64:67]
    v_mfma_f32_16x16x32_bf16 v[68:71], a[232:235], v[28:31], v[68:71]
    s_waitcnt lgkmcnt(1)
    v_mfma_f32_16x16x32_bf16 v[56:59], a[212:215], v[32:35], v[56:59]
    v_mfma_f32_16x16x32_bf16 v[60:63], a[236:239], v[32:35], v[60:63]
    s_waitcnt lgkmcnt(0)
    v_mfma_f32_16x16x32_bf16 v[64:67], a[212:215], v[36:39], v[64:67]
    v_mfma_f32_16x16x32_bf16 v[68:71], a[236:239], v[36:39], v[68:71]
    s_waitcnt vmcnt(0)
    v_mov_b32 v72, v78
    v_mov_b32 v73, v79
    s_add_u32 s75, s75, 49152
    s_add_u32 s76, s76, 12288
    s_add_u32 s77, s77, 128
    s_add_u32 s81, s31, 2
    s_cmp_ge_u32 s31, 63
    s_cbranch_scc1 wlate_213
    v_cmp_gt_u32 vcc, s81, v76
    s_and_b32 s69, vcc_lo, 0xfffffff
    s_cbranch_scc1 wlate_213
    s_barrier
    s_mul_i32 s70, s30, 12288
    s_add_u32 m0, s70, 0
    s_mov_b32 s71, s75
    buffer_load_dwordx4 v10, s[4:7], s71 offen offset:0 sc1 lds
    buffer_load_dwordx4 v10, s[4:7], s71 offen offset:1024 sc1 lds
    buffer_load_dwordx4 v10, s[4:7], s71 offen offset:2048 sc1 lds
    buffer_load_dwordx4 v10, s[4:7], s71 offen offset:3072 sc1 lds
    s_add_u32 m0, m0, 4096
    s_add_u32 s71, s71, 4096
    buffer_load_dwordx4 v10, s[4:7], s71 offen offset:0 sc1 lds
    buffer_load_dwordx4 v10, s[4:7], s71 offen offset:1024 sc1 lds
    buffer_load_dwordx4 v10, s[4:7], s71 offen offset:2048 sc1 lds
    buffer_load_dwordx4 v10, s[4:7], s71 offen offset:3072 sc1 lds
    s_add_u32 m0, m0, 4096
    s_add_u32 s71, s71, 4096
    buffer_load_dwordx4 v10, s[4:7], s71 offen offset:0 sc1 lds
    buffer_load_dwordx4 v10, s[4:7], s71 offen offset:1024 sc1 lds
    buffer_load_dwordx4 v10, s[4:7], s71 offen offset:2048 sc1 lds
    buffer_load_dwordx4 v10, s[4:7], s71 offen offset:3072 sc1 lds
    s_mul_i32 s70, s30, 3072
    s_add_u32 m0, s70, 49152
    s_nop 0
    buffer_load_dwordx4 v10, s[4:7], s76 offen offset:0 sc1 lds
    buffer_load_dwordx4 v10, s[4:7], s76 offen offset:1024 sc1 lds
    buffer_load_dwordx4 v10, s[4:7], s76 offen offset:2048 sc1 lds
    buffer_load_dword v78, v9, s[4:7], s77 offen offset:0 sc1
    buffer_load_dword v79, v9, s[4:7], s77 offen offset:64 sc1
    s_cmp_lt_u32 s31, 2
    s_cbranch_scc1 nored_214
    v_add_f32 v80, v80, v84
    v_add_f32 v88, v88, v92
    v_add_f32 v81, v81, v85
    v_add_f32 v89, v89, v93
    v_add_f32 v82, v82, v86
    v_add_f32 v90, v90, v94
    v_add_f32 v83, v83, v87
    v_add_f32 v91, v91, v95
    v_add_f32 v80, v80, v88
    v_add_f32 v81, v81, v89
    v_add_f32 v82, v82, v90
    v_add_f32 v83, v83, v91
    v_mov_b32 v84, v80
    v_mov_b32 v85, v81
    v_mov_b32 v86, v82
    v_mov_b32 v87, v83
    v_permlane32_swap_b32 v80, v84
    v_permlane32_swap_b32 v81, v85
    v_permlane32_swap_b32 v82, v86
    v_permlane32_swap_b32 v83, v87
    v_add_f32 v80, v80, v84
    v_add_f32 v81, v81, v85
    v_add_f32 v82, v82, v86
    v_add_f32 v83, v83, v87
    v_cvt_pk_bf16_f32 v84, v80, v81
    v_cvt_pk_bf16_f32 v85, v82, v83
    s_mov_b32 exec_hi, 0
    buffer_store_dwordx2 v[84:85], v8, s[24:27], s80 offen
    s_mov_b32 exec_hi, -1
nored_214:
    v_sub_f32 v40, v40, v56
    v_sub_f32 v41, v41, v57
    v_sub_f32 v42, v42, v58
    v_sub_f32 v43, v43, v59
    v_fma_f32 v40, v40, v72, v56
    v_fma_f32 v41, v41, v72, v57
    v_fma_f32 v42, v42, v72, v58
    v_fma_f32 v43, v43, v72, v59
    s_add_u32 s69, s78, 0
    buffer_store_dwordx4 v[40:43], v14, s[4:7], s69 offen sc1
    v_sub_f32 v44, v44, v60
    v_sub_f32 v45, v45, v61
    v_sub_f32 v46, v46, v62
    v_sub_f32 v47, v47, v63
    v_fma_f32 v44, v44, v72, v60
    v_fma_f32 v45, v45, v72, v61
    v_fma_f32 v46, v46, v72, v62
    v_fma_f32 v47, v47, v72, v63
    s_add_u32 s69, s78, 256
    buffer_store_dwordx4 v[44:47], v14, s[4:7], s69 offen sc1
    v_sub_f32 v48, v48, v64
    v_sub_f32 v49, v49, v65
    v_sub_f32 v50, v50, v66
    v_sub_f32 v51, v51, v67
    v_fma_f32 v48, v48, v73, v64
    v_fma_f32 v49, v49, v73, v65
    v_fma_f32 v50, v50, v73, v66
    v_fma_f32 v51, v51, v73, v67
    s_add_u32 s69, s78, 65536
    buffer_store_dwordx4 v[48:51], v14, s[4:7], s69 offen sc1
    v_sub_f32 v52, v52, v68
    v_sub_f32 v53, v53, v69
    v_sub_f32 v54, v54, v70
    v_sub_f32 v55, v55, v71
    v_fma_f32 v52, v52, v73, v68
    v_fma_f32 v53, v53, v73, v69
    v_fma_f32 v54, v54, v73, v70
    v_fma_f32 v55, v55, v73, v71
    s_add_u32 s69, s78, 65792
    buffer_store_dwordx4 v[52:55], v14, s[4:7], s69 offen sc1
    s_add_u32 s78, s78, 655360
    s_add_u32 s79, s79, 655360
    s_add_u32 s80, s80, 40960
    s_add_u32 s31, s31, 1
    s_waitcnt vmcnt(4)
    s_branch wdma_205
wlate_213:
    s_cmp_lt_u32 s31, 2
    s_cbranch_scc1 nored_215
    v_add_f32 v80, v80, v84
    v_add_f32 v88, v88, v92
    v_add_f32 v81, v81, v85
    v_add_f32 v89, v89, v93
    v_add_f32 v82, v82, v86
    v_add_f32 v90, v90, v94
    v_add_f32 v83, v83, v87
    v_add_f32 v91, v91, v95
    v_add_f32 v80, v80, v88
    v_add_f32 v81, v81, v89
    v_add_f32 v82, v82, v90
    v_add_f32 v83, v83, v91
    v_mov_b32 v84, v80
    v_mov_b32 v85, v81
    v_mov_b32 v86, v82
    v_mov_b32 v87, v83
    v_permlane32_swap_b32 v80, v84
    v_permlane32_swap_b32 v81, v85
    v_permlane32_swap_b32 v82, v86
    v_permlane32_swap_b32 v83, v87
    v_add_f32 v80, v80, v84
    v_add_f32 v81, v81, v85
    v_add_f32 v82, v82, v86
    v_add_f32 v83, v83, v87
    v_cvt_pk_bf16_f32 v84, v80, v81
    v_cvt_pk_bf16_f32 v85, v82, v83
    s_mov_b32 exec_hi, 0
    buffer_store_dwordx2 v[84:85], v8, s[24:27], s80 offen
    s_mov_b32 exec_hi, -1
nored_215:
    v_sub_f32 v40, v40, v56
    v_sub_f32 v41, v41, v57
    v_sub_f32 v42, v42, v58
    v_sub_f32 v43, v43, v59
    v_fma_f32 v40, v40, v72, v56
    v_fma_f32 v41, v41, v72, v57
    v_fma_f32 v42, v42, v72, v58
    v_fma_f32 v43, v43, v72, v59
    s_add_u32 s69, s78, 0
    buffer_store_dwordx4 v[40:43], v14, s[4:7], s69 offen sc1
    v_sub_f32 v44, v44, v60
    v_sub_f32 v45, v45, v61
    v_sub_f32 v46, v46, v62
    v_sub_f32 v47, v47, v63
    v_fma_f32 v44, v44, v72, v60
    v_fma_f32 v45, v45, v72, v61
    v_fma_f32 v46, v46, v72, v62
    v_fma_f32 v47, v47, v72, v63
    s_add_u32 s69, s78, 256
    buffer_store_dwordx4 v[44:47], v14, s[4:7], s69 offen sc1
    v_sub_f32 v48, v48, v64
    v_sub_f32 v49, v49, v65
    v_sub_f32 v50, v50, v66
    v_sub_f32 v51, v51, v67
    v_fma_f32 v48, v48, v73, v64
    v_fma_f32 v49, v49, v73, v65
    v_fma_f32 v50, v50, v73, v66
    v_fma_f32 v51, v51, v73, v67
    s_add_u32 s69, s78, 65536
    buffer_store_dwordx4 v[48:51], v14, s[4:7], s69 offen sc1
    v_sub_f32 v52, v52, v68
    v_sub_f32 v53, v53, v69
    v_sub_f32 v54, v54, v70
    v_sub_f32 v55, v55, v71
    v_fma_f32 v52, v52, v73, v68
    v_fma_f32 v53, v53, v73, v69
    v_fma_f32 v54, v54, v73, v70
    v_fma_f32 v55, v55, v73, v71
    s_add_u32 s69, s78, 65792
    buffer_store_dwordx4 v[52:55], v14, s[4:7], s69 offen sc1
    s_add_u32 s78, s78, 655360
    s_add_u32 s79, s79, 655360
    s_add_u32 s80, s80, 40960
    s_add_u32 s31, s31, 1
    s_cmp_lt_u32 s31, 64
    s_cbranch_scc1 wloop_204
    buffer_load_dword v77, v12, s[4:7], 0 offen sc1
    s_waitcnt vmcnt(0)
    v_mov_b32 v75, s31
    s_mov_b64 exec, 1
    buffer_store_dword v75, v13, s[4:7], 0 offen sc1
    s_mov_b64 exec, -1
    s_sub_u32 s81, s31, 1
fw_216:
    v_cmp_gt_u32 vcc, s81, v77
    s_and_b32 s69, vcc_lo, 0xffffffff
    s_cbranch_scc0 fwd_217
    s_sub_u32 s68, s68, 1
    s_cbranch_scc0 ok_218
    s_mov_b32 s69, 43
    s_branch FAIL
ok_218:
    buffer_load_dword v77, v12, s[4:7], 0 offen sc1
    s_waitcnt vmcnt(0)
    s_branch fw_216
fwd_217:
    s_sub_u32 s82, s79, 0
    s_add_u32 s69, s82, 0
    buffer_load_dwordx4 v[96:99], v15, s[4:7], s69 offen sc1
    s_add_u32 s69, s82, 4096
    buffer_load_dwordx4 v[100:103], v15, s[4:7], s69 offen sc1
    s_add_u32 s69, s82, 8192
    buffer_load_dwordx4 v[104:107], v15, s[4:7], s69 offen sc1
    s_add_u32 s69, s82, 12288
    buffer_load_dwordx4 v[108:111], v15, s[4:7], s69 offen sc1
    s_add_u32 s82, s79, 655360
    s_add_u32 s83, s80, 40960
    buffer_load_dword v77, v12, s[4:7], 0 offen sc1
    s_waitcnt vmcnt(0)
    v_add_f32 v96, v96, v100
    v_add_f32 v104, v104, v108
    v_add_f32 v97, v97, v101
    v_add_f32 v105, v105, v109
    v_add_f32 v98, v98, v102
    v_add_f32 v106, v106, v110
    v_add_f32 v99, v99, v103
    v_add_f32 v107, v107, v111
    v_add_f32 v96, v96, v104
    v_add_f32 v97, v97, v105
    v_add_f32 v98, v98, v106
    v_add_f32 v99, v99, v107
    v_mov_b32 v100, v96
    v_mov_b32 v101, v97
    v_mov_b32 v102, v98
    v_mov_b32 v103, v99
    v_permlane32_swap_b32 v96, v100
    v_permlane32_swap_b32 v97, v101
    v_permlane32_swap_b32 v98, v102
    v_permlane32_swap_b32 v99, v103
    v_add_f32 v96, v96, v100
    v_add_f32 v97, v97, v101
    v_add_f32 v98, v98, v102
    v_add_f32 v99, v99, v103
    v_cvt_pk_bf16_f32 v100, v96, v97
    v_cvt_pk_bf16_f32 v101, v98, v99
    s_mov_b32 exec_hi, 0
    buffer_store_dwordx2 v[100:101], v8, s[24:27], s80 offen
    s_mov_b32 exec_hi, -1
fw_219:
    v_cmp_gt_u32 vcc, s31, v77
    s_and_b32 s69, vcc_lo, 0xffffffff
    s_cbranch_scc0 fwd_220
    s_sub_u32 s68, s68, 1
    s_cbranch_scc0 ok_221
    s_mov_b32 s69, 42
    s_branch FAIL
ok_221:
    buffer_load_dword v77, v12, s[4:7], 0 offen sc1
    s_waitcnt vmcnt(0)
    s_branch fw_219
fwd_220:
    s_add_u32 s69, s82, 0
    buffer_load_dwordx4 v[80:83], v15, s[4:7], s69 offen sc1
    s_add_u32 s69, s82, 4096
    buffer_load_dwordx4 v[84:87], v15, s[4:7], s69 offen sc1
    s_add_u32 s69, s82, 8192
    buffer_load_dwordx4 v[88:91], v15, s[4:7], s69 offen sc1
    s_add_u32 s69, s82, 12288
    buffer_load_dwordx4 v[92:95], v15, s[4:7], s69 offen sc1
    s_waitcnt vmcnt(0)
    v_add_f32 v80, v80, v84
    v_add_f32 v88, v88, v92
    v_add_f32 v81, v81, v85
    v_add_f32 v89, v89, v93
    v_add_f32 v82, v82, v86
    v_add_f32 v90, v90, v94
    v_add_f32 v83, v83, v87
    v_add_f32 v91, v91, v95
    v_add_f32 v80, v80, v88
    v_add_f32 v81, v81, v89
    v_add_f32 v82, v82, v90
    v_add_f32 v83, v83, v91
    v_mov_b32 v84, v80
    v_mov_b32 v85, v81
    v_mov_b32 v86, v82
    v_mov_b32 v87, v83
    v_permlane32_swap_b32 v80, v84
    v_permlane32_swap_b32 v81, v85
    v_permlane32_swap_b32 v82, v86
    v_permlane32_swap_b32 v83, v87
    v_add_f32 v80, v80, v84
    v_add_f32 v81, v81, v85
    v_add_f32 v82, v82, v86
    v_add_f32 v83, v83, v87
    v_cvt_pk_bf16_f32 v84, v80, v81
    v_cvt_pk_bf16_f32 v85, v82, v83
    s_mov_b32 exec_hi, 0
    buffer_store_dwordx2 v[84:85], v8, s[24:27], s83 offen
    s_mov_b32 exec_hi, -1
    s_waitcnt vmcnt(0)
    s_branch EXIT
FAIL:
    v_mov_b32 v1, s69
    v_mov_b32 v2, 252
    s_mov_b64 exec, 1
    buffer_store_dword v1, v2, s[64:67], 0 offen sc1
    s_waitcnt vmcnt(0)
EXIT:
    s_endpgm
.section .rodata,"a"
.p2align 6
.amdhsa_kernel gated_mix__memory_aug_recurrent_mem_tr__glu_gated_glu__prompt_kernel
  .amdhsa_next_free_vgpr 512
  .amdhsa_next_free_sgpr 102
  .amdhsa_accum_offset 256
  .amdhsa_group_segment_fixed_size 0
  .amdhsa_kernarg_size 120
  .amdhsa_user_sgpr_count 2
  .amdhsa_user_sgpr_kernarg_segment_ptr 1
  .amdhsa_system_sgpr_workgroup_id_x 1
.end_amdhsa_kernel
```
